```python
import torch

def _softmax(x, axis=-1):
    return torch.softmax(x, dim=axis)
def _gelu(x):
    return torch.nn.functional.gelu(x, approximate="tanh")
def _silu(x):
    return torch.nn.functional.silu(x)
def _sigmoid(x):
    return torch.sigmoid(x)
def _layernorm(x, axis=-1, eps=1e-5):
    m = x.mean(dim=axis, keepdim=True)
    v = x.var(dim=axis, keepdim=True, unbiased=False)
    return (x - m) / torch.sqrt(v + eps)
def _scatter_add(tgt, idx, src, axis=0):
    return tgt.clone().index_add_(axis, idx, src)
def _segment_sum(src, seg, n):
    out = torch.zeros((n,) + src.shape[1:], dtype=src.dtype)
    return out.index_add_(0, seg, src)
def _pad(x, pw):
    flat = tuple(v for pair in reversed(pw) for v in pair)
    return torch.nn.functional.pad(x, flat)

kernel_name = 'interleave_layers__grouped_kv_mqa__dense_activation_gelu__prompt'

def setup_inputs():

    _w = (lambda a: (lambda t: t.to(torch.bfloat16) if t.is_floating_point() else t)(torch.as_tensor(a)))
    def _A_setup():
        B, S, D, H = 1, 2048, 512, 32
        Dh = D // H
        return {
            "x": _w((lambda *s: torch.randn(*s, dtype=torch.bfloat16) * 0.05)(B, S, D)),
            "wq": _w((lambda *s: torch.randn(*s, dtype=torch.bfloat16) * 0.05)(D, H * Dh)),
            "wk": _w((lambda *s: torch.randn(*s, dtype=torch.bfloat16) * 0.05)(D, Dh)),
            "wv": _w((lambda *s: torch.randn(*s, dtype=torch.bfloat16) * 0.05)(D, Dh)),
            "wo": _w((lambda *s: torch.randn(*s, dtype=torch.bfloat16) * 0.05)(H * Dh, D)),
        }
    _A_in = _A_setup()

    def _B_setup():
        B, S, D, F = 1, 2048, 512, 1792
        return {
            "x": _w((lambda *s: torch.randn(*s, dtype=torch.bfloat16) * 0.05)(B, S, D)),
            "w1": _w((lambda *s: torch.randn(*s, dtype=torch.bfloat16) * 0.8)(D, F) * (D ** -0.5)),
            "b1": _w((lambda *s: torch.randn(*s, dtype=torch.bfloat16) * 12.8)(F) * 0.01),
            "w2": _w((lambda *s: torch.randn(*s, dtype=torch.bfloat16) * 0.2)(F, D) * (F ** -0.5)),
            "b2": _w((lambda *s: torch.randn(*s, dtype=torch.bfloat16) * 1.6)(D) * 0.01),
        }
    _B_in = _B_setup()

    return {
        "A_x": _A_in["x"],
        "A_wq": _A_in["wq"],
        "A_wk": _A_in["wk"],
        "A_wv": _A_in["wv"],
        "A_wo": _A_in["wo"],
        "B_x": _B_in["x"],
        "B_w1": _B_in["w1"],
        "B_b1": _B_in["b1"],
        "B_w2": _B_in["w2"],
        "B_b2": _B_in["b2"],
    }

def reference(A_x, A_wq, A_wk, A_wv, A_wo, B_x, B_w1, B_b1, B_w2, B_b2):
    def _A_ref(x, wq, wk, wv, wo):
        B, S, D = x.shape
        H = 32
        Dh = D // H
        q = (lambda x, *d: x.permute(*d))((x @ wq).reshape(B, S, H, Dh), 0, 2, 1, 3)
        k = x @ wk
        v = x @ wv
        scores = torch.einsum("bhqd,bkd->bhqk", q, k) * (Dh ** -0.5)
        p = _softmax(scores, axis=-1)
        o = torch.einsum("bhqk,bkd->bhqd", p, v)
        return (lambda x, *d: x.permute(*d))(o, 0, 2, 1, 3).reshape(B, S, H * Dh) @ wo

    def _B_ref(x, w1, b1, w2, b2):
        h = torch.einsum("bsd,df->bsf", x, w1) + b1
        h = _gelu(h)
        return torch.einsum("bsf,fd->bsd", h, w2) + b2

    x = A_x
    x = x + _A_ref(_layernorm(x, axis=-1), A_wq, A_wk, A_wv, A_wo)
    x = x + _B_ref(_layernorm(x, axis=-1), B_w1, B_b1, B_w2, B_b2)
    x = x + _A_ref(_layernorm(x, axis=-1), A_wq, A_wk, A_wv, A_wo)
    x = x + _B_ref(_layernorm(x, axis=-1), B_w1, B_b1, B_w2, B_b2)
    return x
```

```asm
; @launch grid=(256,1,1) block=(256,1,1) lds=163840
.amdgcn_target "amdgcn-amd-amdhsa--gfx950"
.text
.globl interleave_layers__grouped_kv_mqa__dense_activation_gelu__prompt_kernel
.p2align 8
.type interleave_layers__grouped_kv_mqa__dense_activation_gelu__prompt_kernel,@function
interleave_layers__grouped_kv_mqa__dense_activation_gelu__prompt_kernel:
    s_cmp_ge_u32 s2, 256
    s_cbranch_scc1 KEXIT
    s_load_dwordx16 s[32:47], s[0:1], 0
    s_load_dwordx8 s[48:55], s[0:1], 64
    s_load_dwordx2 s[56:57], s[0:1], 96
    s_getpc_b64 s[70:71]
PCREF:
    v_lshrrev_b32 v2, 6, v0
    s_lshr_b32 s73, s2, 3
    s_mul_i32 s73, s73, 3072
    v_mul_u32_u24 v3, 12, v0
    v_readfirstlane_b32 s60, v2
    s_mov_b32 s72, KEND-PCREF-4
    v_add_u32 v4, s73, v3
    v_min_u32 v4, s72, v4
    v_mov_b32 v5, s71
    v_add_co_u32 v4, vcc, s70, v4
    s_nop 1
    v_addc_co_u32 v5, vcc, 0, v5, vcc
    global_load_dword v253, v[4:5], off
    v_and_b32 v1, 63, v0
    v_lshlrev_b32 v1, 4, v1
    s_and_b32 s58, s2, 7
    s_lshr_b32 s59, s2, 3
    s_lshr_b32 s61, s2, 5
    s_and_b32 s62, s59, 3
    s_lshl_b32 s70, s58, 3
    s_add_u32 s70, s70, s61
    s_lshl2_add_u32 s70, s70, s60
    s_lshl_b32 s70, s70, 13
    v_lshrrev_b32 v2, 7, v1
    v_and_b32 v4, 0x70, v1
    v_lshl_add_u32 v2, v2, 10, v4
    s_mul_i32 s72, s60, 28672
    s_lshl_b32 s69, s60, 4
    s_add_u32 s69, s69, 8
    s_load_dwordx4 s[96:99], s[0:1], s69
    s_lshl_b32 s100, s60, 3
    s_lshr_b32 s88, 0x00700120, s100
    s_lshr_b32 s89, 0x70702001, s100
    s_and_b32 s88, s88, 0xff
    s_and_b32 s89, s89, 0xff
    s_lshl_b32 s100, s2, 6
    s_mul_i32 s88, s88, s100
    s_mul_i32 s89, s89, s100
    s_lshl_b32 s80, s62, 8
    s_add_u32 s80, s80, s70
    s_xor_b32 s81, s80, 256
    s_xor_b32 s82, s80, 512
    s_xor_b32 s83, s80, 768
    s_and_b32 s86, s61, 3
    s_lshl_b32 s86, s86, 10
    s_lshl_b32 s84, s60, 12
    s_add_u32 s84, s84, s86
    s_add_u32 s86, s86, s72
    v_lshrrev_b32 v30, 6, v1
    v_lshlrev_b32 v30, 10, v30
    v_and_or_b32 v30, v1, 48, v30
    v_lshrrev_b32 v65, 9, v1
    v_lshlrev_b32 v31, 9, v65
    v_bfe_u32 v65, v1, 6, 2
    v_lshl_add_u32 v31, v65, 6, v31
    v_bfe_u32 v65, v1, 8, 1
    v_lshl_add_u32 v31, v65, 5, v31
    v_bfe_u32 v65, v1, 4, 1
    v_lshl_add_u32 v31, v65, 4, v31
    v_bfe_u32 v65, v1, 5, 1
    v_lshl_add_u32 v31, v65, 3, v31
    v_add_u32 v31, s72, v31
    v_and_b32 v27, 0x300, v1
    v_bfe_u32 v65, v1, 4, 4
    v_lshl_add_u32 v27, v65, 3, v27
    v_add_u32 v27, s72, v27
    s_cmp_lt_u32 s2, 112
    s_cbranch_scc1 PJ1
    s_cmp_lt_u32 s2, 224
    s_cselect_b32 s26, 0x140000, 0
    s_cselect_b32 s77, 0x70, 32
    s_cselect_b32 s78, 0, 0x70
    s_cselect_b32 s87, 3670016, 0
    s_add_u32 s87, s87, 524288
    s_sub_u32 s78, s2, s78
    s_sub_u32 s78, s78, 0x70
    s_and_b32 s79, s78, 7
    s_lshl_b32 s79, s79, 1
    s_and_b32 s74, s60, 1
    s_add_u32 s79, s79, s74
    s_lshr_b32 s78, s78, 3
    s_lshl_b32 s78, s78, 1
    s_lshr_b32 s74, s60, 1
    s_add_u32 s78, s78, s74
    s_lshl_b32 s74, s78, 16
    s_lshl_b32 s75, s79, 6
    s_add_u32 s74, s74, s75
    s_mul_i32 s79, s79, s77
    s_lshl2_add_u32 s79, s78, s79
    s_lshl_b32 s79, s79, 10
    s_add_u32 s87, s87, s79
    s_mov_b32 s75, 16384
    s_mov_b32 s76, 536870912
    v_mov_b32 v66, v30
    v_mov_b32 v28, v31
    v_add_u32 v29, 256, v31
    s_branch PJD
PJ1:
    s_mov_b32 s26, 0x140000
    s_and_b32 s78, s2, 3
    s_and_b32 s79, s2, 0xfc
    s_add_u32 s79, s79, s60
    s_mul_i32 s74, s78, 458752
    s_lshl_b32 s75, s79, 5
    s_add_u32 s74, s74, s75
    s_mul_i32 s76, s78, 7168
    s_lshl1_add_u32 s76, s75, s76
    s_add_u32 s76, s76, 65536
    s_lshl2_add_u32 s79, s79, s78
    s_lshl_b32 s79, s79, 12
    s_add_u32 s87, s79, 2097152
    s_mov_b32 s75, 114688
    v_lshrrev_b32 v66, 5, v1
    v_mul_u32_u24 v66, 3584, v66
    v_and_or_b32 v66, v1, 16, v66
    v_mov_b32 v28, v27
    v_add_u32 v29, 128, v27
PJD:
    s_mov_b32 s27, 0x20000
    s_add_u32 s26, s26, 0x80000
    s_and_b32 s71, s58, 3
    s_lshl2_add_u32 s71, s61, s71
    s_lshl2_add_u32 s73, s62, s60
    s_lshl_b32 s73, s73, 6
    s_lshl_b32 s77, s71, 14
    s_or_b32 s73, s73, s77
    s_lshl_b32 s63, s58, 21
    s_add_u32 s63, s63, 8388608
    s_lshl_b32 s77, s59, 10
    s_add_u32 s77, s77, s63
    s_add_u32 s77, s77, 1507328
    s_and_b32 s78, s59, 7
    s_lshl2_add_u32 s78, s78, s60
    s_lshl_b32 s78, s78, 5
    v_lshrrev_b32 v65, 9, v1
    v_lshlrev_b32 v65, 4, v65
    s_mov_b32 s6, 268435456
    s_mov_b32 s7, 0x20000
    s_mov_b32 s10, 2097152
    s_mov_b32 s11, 0x20000
    s_mov_b32 s14, 1024
    s_mov_b32 s15, 0x20000
    s_mov_b32 s18, 524288
    s_mov_b32 s19, 0x20000
    s_mov_b32 s22, 16384
    s_mov_b32 s23, 0x20000
    s_waitcnt lgkmcnt(0)
    s_mov_b64 s[8:9], s[32:33]
    s_load_dword s101, s[96:97], s88
    s_load_dword s101, s[98:99], s89
    buffer_load_dwordx4 v[32:35], v2, s[8:11], s80 offen offset:0
    buffer_load_dwordx4 v[36:39], v2, s[8:11], s80 offen offset:128
    s_load_dword s28, s[56:57], 0
    s_bitcmp1_b32 s62, 0
    s_cselect_b64 s[20:21], s[38:39], s[36:37]
    s_mov_b64 s[16:17], s[34:35]
    s_xor_b32 m0, s86, 0
    s_xor_b32 s79, s84, 0
    buffer_load_dwordx4 v1, s[20:23], s79 offen lds
    s_cmp_lt_u32 s2, 224
    s_cselect_b64 s[24:25], s[48:49], s[40:41]
    s_cmp_lt_u32 s2, 112
    s_cselect_b64 s[24:25], s[44:45], s[24:25]
    s_mov_b64 s[4:5], s[56:57]
    s_mov_b64 s[12:13], s[50:51]
    s_mov_b32 s69, s74
    buffer_load_dword v252, v1, s[4:7], s77 offen sc1
    buffer_load_dwordx4 a[240:243], v65, s[12:15], s78 offen
    s_add_u32 m0, s72, 4096
    s_xor_b32 s74, s73, 0
    buffer_load_dwordx4 v30, s[16:19], s74 offen lds
    s_add_u32 m0, s72, 5120
    s_xor_b32 s74, s73, 16384
    buffer_load_dwordx4 v30, s[16:19], s74 offen lds
    s_add_u32 m0, s72, 6144
    s_xor_b32 s74, s73, 32768
    buffer_load_dwordx4 v30, s[16:19], s74 offen lds
    s_add_u32 m0, s72, 7168
    s_xor_b32 s74, s73, 49152
    buffer_load_dwordx4 v30, s[16:19], s74 offen lds
    s_mov_b32 s12, s52
    s_mov_b32 s13, s53
    s_mov_b32 s14, 2097152
    s_mov_b32 s15, 0x20000
    v_accvgpr_write_b32 a0, v66
    v_accvgpr_write_b32 a1, v28
    v_accvgpr_write_b32 a2, v29
    s_getreg_b32 s67, hwreg(HW_REG_XCC_ID, 0, 4)
    s_mov_b32 s68, 0x3f803f80
    s_mov_b32 s29, 0x40000
    s_mov_b32 s31, 0
    s_mov_b32 s91, 0xffff0000
    s_lshl_b32 s64, s58, 7
    s_add_u32 s64, s64, 16384
    s_mov_b32 s65, 262144
    s_lshl_b32 s66, s60, 13
    s_add_u32 s66, s66, 98304
    s_mul_i32 s85, s60, 4160
    s_add_u32 s85, s85, 117760
    s_cmp_eq_u32 s60, 0
    s_cselect_b32 s94, 1, 0
    s_mov_b32 s95, 0
    v_add_u32 v3, 117760, v1
    v_mov_b32 v65, s68
    v_lshrrev_b32 v66, 4, v1
    v_xor_b32 v66, v66, v1
    v_and_b32 v66, 16, v66
    v_cmp_eq_u32 vcc, 0, v66
    s_nop 1
    v_cndmask_b32 v66, 0, v65, vcc
    v_accvgpr_write_b32 a244, -1
    v_accvgpr_write_b32 a248, v65
    v_accvgpr_write_b32 a252, v66
    v_accvgpr_write_b32 a245, -1
    v_accvgpr_write_b32 a249, v65
    v_accvgpr_write_b32 a253, v66
    v_accvgpr_write_b32 a246, -1
    v_accvgpr_write_b32 a250, v65
    v_accvgpr_write_b32 a254, v66
    v_accvgpr_write_b32 a247, -1
    v_accvgpr_write_b32 a251, v65
    v_accvgpr_write_b32 a255, v66
    s_lshl2_add_u32 s40, s62, s60
    s_lshl_b32 s40, s40, 5
    s_add_u32 s40, s40, s71
    s_lshl_b32 s40, s40, 10
    s_add_u32 s40, s40, 1048576
    s_cmp_lt_u32 s58, 4
    s_cselect_b32 s40, s40, 536870912
    s_lshl_b32 s38, s71, 5
    s_mul_i32 s77, s60, 8320
    s_add_u32 s77, s77, 117760
    v_lshrrev_b32 v96, 7, v1
    v_mul_u32_u24 v112, 1040, v96
    v_and_b32 v97, 0x70, v1
    v_add3_u32 v112, v112, v97, s77
    s_lshl_b32 s77, s60, 5
    s_add_u32 s77, s77, 114688
    v_lshl_add_u32 v114, v96, 2, s77
    s_lshr_b32 s78, s62, 1
    s_mul_i32 s77, s78, 16640
    s_lshl_b32 s79, s60, 8
    s_add_u32 s77, s77, s79
    s_add_u32 s77, s77, 117760
    v_bfe_u32 v96, v1, 4, 4
    v_lshrrev_b32 v97, 8, v1
    v_mul_u32_u24 v113, 1040, v96
    v_lshl_add_u32 v113, v97, 4, v113
    v_add_u32 v113, s77, v113
    s_lshl_b32 s77, s60, 10
    v_add_u32 v120, 151360, v1
    v_add_u32 v115, s77, v120
    s_bitcmp1_b32 s62, 0
    s_cselect_b64 vcc, -1, 0
    s_cselect_b32 s79, 4, 0
    s_lshl_b32 s77, s78, 6
    s_add_u32 s77, s77, 114688
    v_lshlrev_b32 v98, 2, v97
    v_cndmask_b32 v98, v96, v98, vcc
    v_lshl_add_u32 v116, v98, 2, s77
    v_add_u32 v117, s79, v116
    v_add_u32 v118, s79, v117
    v_add_u32 v119, s79, v118
    s_lshl_b32 s77, s60, 7
    s_add_u32 s77, s77, 114944
    v_and_b32 v98, 1, v96
    v_lshl_add_u32 v98, v98, 2, v97
    v_lshl_add_u32 v124, v98, 4, s77
    v_cndmask_b32 v5, v97, v96, vcc
    v_lshlrev_b32 v5, 4, v5
    v_add_u32 v5, 116736, v5
    s_lshl_b32 s77, s60, 8
    v_add_u32 v4, s77, v5
    v_lshrrev_b32 v100, 1, v97
    v_and_b32 v101, 1, v97
    v_lshlrev_b32 v101, 3, v101
    v_lshl_add_u32 v98, v100, 9, v101
    v_lshl_add_u32 v98, v96, 4, v98
    v_lshl_add_u32 v99, v100, 8, v101
    v_and_b32 v100, 0x30, v1
    v_add_u32 v99, v99, v100
    v_bfe_u32 v100, v1, 6, 1
    v_lshl_add_u32 v99, v100, 7, v99
    v_bfe_u32 v100, v1, 7, 1
    v_lshl_add_u32 v99, v100, 6, v99
    v_cndmask_b32 v121, v98, v99, vcc
    s_mul_i32 s77, s60, 2080
    s_add_u32 s77, s77, 117760
    v_add_u32 v126, s77, v98
    v_add_u32 v127, s77, v99
    v_bfe_u32 v96, v1, 4, 5
    v_lshrrev_b32 v97, 9, v1
    v_mul_u32_u24 v7, 1040, v96
    v_lshl_add_u32 v7, v97, 4, v7
    v_add_u32 v7, 117760, v7
    s_lshl2_add_u32 s77, s62, s60
    s_lshl_b32 s77, s77, 6
    v_add_u32 v122, s77, v7
    v_lshlrev_b32 v96, 2, v96
    v_add_u32 v123, 114688, v96
    s_lshl_b32 s77, s60, 7
    s_add_u32 s77, s77, 114944
    v_lshl_add_u32 v125, v97, 4, s77
    s_lshl_b32 s77, s78, 8
    s_lshl_b32 s78, s78, 9
    s_add_u32 s78, s78, 1024
    s_bitcmp1_b32 s62, 0
    s_cselect_b32 s77, s78, s77
    s_lshl_b32 s78, s58, 3
    s_add_u32 s78, s78, s61
    s_lshl_b32 s78, s78, 11
    s_add_u32 s78, s78, s65
    s_add_u32 s78, s78, s77
    s_lshl_b32 s39, s58, 12
    s_add_u32 s39, s39, 98304
    s_lshl_b32 s79, s59, 7
    s_add_u32 s79, s79, s39
    s_add_u32 s33, s63, 1507328
    s_lshl_b32 s32, s59, 10
    s_add_u32 s32, s32, s33
    s_cmp_eq_u32 s60, 0
    s_cselect_b32 s32, s32, 536870912
    s_cselect_b32 s78, s78, 536870912
    s_lshl_b32 s34, s60, 13
    s_add_u32 s33, s33, s34
    s_add_u32 s34, s33, 4096
    s_lshl_b32 s42, s58, 15
    s_add_u32 s43, s42, 0x8000
    s_and_b32 s43, s43, 0x3ffff
    s_lshl_b32 s41, s59, 10
    s_add_u32 s41, s41, s42
    s_add_u32 s41, s41, 1572864
    s_cmp_eq_u32 s60, 1
    s_cselect_b32 s41, s41, 536870912
    s_lshl_b32 s44, s60, 13
    s_add_u32 s44, s44, 1572864
    s_add_u32 s42, s42, s44
    s_add_u32 s43, s43, s44
    s_add_u32 s44, s43, 4096
    v_bfe_u32 v96, v1, 4, 2
    v_mul_u32_u24 v96, 2080, v96
    v_and_b32 v97, 0x100, v1
    v_cmp_ne_u32 vcc, 0, v97
    v_lshrrev_b32 v97, 4, v97
    v_add_u32 v96, 157568, v96
    v_add_u32 v96, v97, v96
    v_mov_b32 v97, s68
    v_cndmask_b32 v100, v97, 0, vcc
    v_cndmask_b32 v101, v97, 0, vcc
    v_cndmask_b32 v102, v97, 0, vcc
    v_cndmask_b32 v103, v97, 0, vcc
    ds_write_b128 v96, v[100:103]
    s_and_b32 s77, s80, 0x300
    v_add_u32 v64, s77, v112
    s_and_b32 s77, s81, 0x300
    v_add_u32 v65, s77, v112
    s_and_b32 s77, s82, 0x300
    v_add_u32 v66, s77, v112
    s_and_b32 s77, s83, 0x300
    v_add_u32 v67, s77, v112
    v_mov_b32 v84, 0
    v_mov_b32 v85, 0
    v_mov_b32 v86, 0
    v_mov_b32 v87, 0
    v_mov_b32 v88, 0
    v_mov_b32 v89, 0
    v_mov_b32 v90, 0
    v_mov_b32 v91, 0
    s_mov_b64 exec, 0
    s_cmp_eq_u32 s60, 0
    s_cbranch_scc1 TCH0
    s_cmp_eq_u32 s60, 1
    s_cbranch_scc1 TCH1
    s_cmp_eq_u32 s60, 2
    s_cbranch_scc1 TCH2
    s_branch TCH3
.p2align 12
TCHRET:
    s_mov_b64 exec, -1
    buffer_load_dwordx4 v[40:43], v2, s[8:11], s81 offen offset:0
    buffer_load_dwordx4 v[44:47], v2, s[8:11], s81 offen offset:128
    buffer_load_dwordx4 v[48:51], v2, s[8:11], s82 offen offset:0
    buffer_load_dwordx4 v[52:55], v2, s[8:11], s82 offen offset:128
    buffer_load_dwordx4 v[56:59], v2, s[8:11], s83 offen offset:0
    buffer_load_dwordx4 v[60:63], v2, s[8:11], s83 offen offset:128
    s_xor_b32 m0, s86, 1024
    s_xor_b32 s74, s84, 1024
    buffer_load_dwordx4 v1, s[20:23], s74 offen lds
    s_xor_b32 m0, s86, 2048
    s_xor_b32 s74, s84, 2048
    buffer_load_dwordx4 v1, s[20:23], s74 offen lds
    s_xor_b32 m0, s86, 3072
    s_xor_b32 s74, s84, 3072
    buffer_load_dwordx4 v1, s[20:23], s74 offen lds
    s_waitcnt lgkmcnt(0)
    s_add_u32 s28, s28, 0x9e3779b9
    v_mov_b32 v6, s28
    s_add_u32 s30, s28, s67
    s_add_u32 s35, s28, 33
    s_waitcnt vmcnt(16)
    ds_write_b128 v64, v[32:35] offset:0
    ds_write_b128 v64, v[36:39] offset:128
    s_add_u32 m0, s72, 8192
    s_xor_b32 s74, s73, 65536
    buffer_load_dwordx4 v30, s[16:19], s74 offen lds
    v_dot2c_f32_bf16 v84, s68, v32
    v_dot2c_f32_bf16 v86, v32, v32
    v_dot2c_f32_bf16 v85, s68, v33
    v_dot2c_f32_bf16 v87, v33, v33
    s_add_u32 m0, s72, 9216
    s_xor_b32 s74, s73, 81920
    buffer_load_dwordx4 v30, s[16:19], s74 offen lds
    v_dot2c_f32_bf16 v84, s68, v34
    v_dot2c_f32_bf16 v86, v34, v34
    v_dot2c_f32_bf16 v85, s68, v35
    v_dot2c_f32_bf16 v87, v35, v35
    s_add_u32 m0, s72, 10240
    s_xor_b32 s74, s73, 98304
    buffer_load_dwordx4 v30, s[16:19], s74 offen lds
    v_dot2c_f32_bf16 v84, s68, v36
    v_dot2c_f32_bf16 v86, v36, v36
    v_dot2c_f32_bf16 v85, s68, v37
    v_dot2c_f32_bf16 v87, v37, v37
    s_add_u32 m0, s72, 11264
    s_xor_b32 s74, s73, 114688
    buffer_load_dwordx4 v30, s[16:19], s74 offen lds
    v_dot2c_f32_bf16 v84, s68, v38
    v_dot2c_f32_bf16 v86, v38, v38
    v_dot2c_f32_bf16 v85, s68, v39
    v_dot2c_f32_bf16 v87, v39, v39
    s_waitcnt vmcnt(11)
    ds_write_b128 v65, v[40:43] offset:0
    ds_write_b128 v65, v[44:47] offset:128
    s_add_u32 m0, s72, 12288
    s_xor_b32 s74, s73, 131072
    buffer_load_dwordx4 v30, s[16:19], s74 offen lds
    v_dot2c_f32_bf16 v84, s68, v40
    v_dot2c_f32_bf16 v86, v40, v40
    v_dot2c_f32_bf16 v85, s68, v41
    v_dot2c_f32_bf16 v87, v41, v41
    s_add_u32 m0, s72, 13312
    s_xor_b32 s74, s73, 147456
    buffer_load_dwordx4 v30, s[16:19], s74 offen lds
    v_dot2c_f32_bf16 v84, s68, v42
    v_dot2c_f32_bf16 v86, v42, v42
    v_dot2c_f32_bf16 v85, s68, v43
    v_dot2c_f32_bf16 v87, v43, v43
    s_add_u32 m0, s72, 14336
    s_xor_b32 s74, s73, 163840
    buffer_load_dwordx4 v30, s[16:19], s74 offen lds
    v_dot2c_f32_bf16 v84, s68, v44
    v_dot2c_f32_bf16 v86, v44, v44
    v_dot2c_f32_bf16 v85, s68, v45
    v_dot2c_f32_bf16 v87, v45, v45
    s_add_u32 m0, s72, 15360
    s_xor_b32 s74, s73, 180224
    buffer_load_dwordx4 v30, s[16:19], s74 offen lds
    v_dot2c_f32_bf16 v84, s68, v46
    v_dot2c_f32_bf16 v86, v46, v46
    v_dot2c_f32_bf16 v85, s68, v47
    v_dot2c_f32_bf16 v87, v47, v47
    s_waitcnt vmcnt(13)
    ds_write_b128 v66, v[48:51] offset:0
    ds_write_b128 v66, v[52:55] offset:128
    s_add_u32 m0, s72, 16384
    s_xor_b32 s74, s73, 196608
    buffer_load_dwordx4 v30, s[16:19], s74 offen lds
    v_dot2c_f32_bf16 v84, s68, v48
    v_dot2c_f32_bf16 v86, v48, v48
    v_dot2c_f32_bf16 v85, s68, v49
    v_dot2c_f32_bf16 v87, v49, v49
    s_add_u32 m0, s72, 17408
    s_xor_b32 s74, s73, 212992
    buffer_load_dwordx4 v30, s[16:19], s74 offen lds
    v_dot2c_f32_bf16 v84, s68, v50
    v_dot2c_f32_bf16 v86, v50, v50
    v_dot2c_f32_bf16 v85, s68, v51
    v_dot2c_f32_bf16 v87, v51, v51
    s_add_u32 m0, s72, 18432
    s_xor_b32 s74, s73, 229376
    buffer_load_dwordx4 v30, s[16:19], s74 offen lds
    v_dot2c_f32_bf16 v84, s68, v52
    v_dot2c_f32_bf16 v86, v52, v52
    v_dot2c_f32_bf16 v85, s68, v53
    v_dot2c_f32_bf16 v87, v53, v53
    s_add_u32 m0, s72, 19456
    s_xor_b32 s74, s73, 245760
    buffer_load_dwordx4 v30, s[16:19], s74 offen lds
    v_dot2c_f32_bf16 v84, s68, v54
    v_dot2c_f32_bf16 v86, v54, v54
    v_dot2c_f32_bf16 v85, s68, v55
    v_dot2c_f32_bf16 v87, v55, v55
    s_waitcnt vmcnt(15)
    ds_write_b128 v67, v[56:59] offset:0
    ds_write_b128 v67, v[60:63] offset:128
    s_waitcnt vmcnt(12)
    ds_read_b64_tr_b16 a[224:225], v27 offset:0
    ds_read_b64_tr_b16 a[226:227], v27 offset:128
    ds_read_b64_tr_b16 a[228:229], v27 offset:1024
    ds_read_b64_tr_b16 a[230:231], v27 offset:1152
    ds_read_b64_tr_b16 a[232:233], v27 offset:2048
    ds_read_b64_tr_b16 a[234:235], v27 offset:2176
    ds_read_b64_tr_b16 a[236:237], v27 offset:3072
    ds_read_b64_tr_b16 a[238:239], v27 offset:3200
    s_waitcnt vmcnt(21)
    ds_read_b64_tr_b16 v[128:129], v31 offset:4096
    ds_read_b64_tr_b16 v[130:131], v31 offset:4352
    ds_read_b64_tr_b16 v[132:133], v31 offset:5120
    ds_read_b64_tr_b16 v[134:135], v31 offset:5376
    ds_read_b64_tr_b16 v[136:137], v31 offset:6144
    ds_read_b64_tr_b16 v[138:139], v31 offset:6400
    ds_read_b64_tr_b16 v[140:141], v31 offset:7168
    ds_read_b64_tr_b16 v[142:143], v31 offset:7424
    s_add_u32 m0, s72, 20480
    s_xor_b32 s74, s73, 262144
    buffer_load_dwordx4 v30, s[16:19], s74 offen lds
    s_add_u32 m0, s72, 21504
    s_xor_b32 s74, s73, 278528
    buffer_load_dwordx4 v30, s[16:19], s74 offen lds
    v_dot2c_f32_bf16 v84, s68, v56
    v_dot2c_f32_bf16 v86, v56, v56
    v_dot2c_f32_bf16 v85, s68, v57
    v_dot2c_f32_bf16 v87, v57, v57
    v_dot2c_f32_bf16 v84, s68, v58
    v_dot2c_f32_bf16 v86, v58, v58
    v_dot2c_f32_bf16 v85, s68, v59
    v_dot2c_f32_bf16 v87, v59, v59
    s_add_u32 m0, s72, 22528
    s_xor_b32 s74, s73, 294912
    buffer_load_dwordx4 v30, s[16:19], s74 offen lds
    s_add_u32 m0, s72, 23552
    s_xor_b32 s74, s73, 311296
    buffer_load_dwordx4 v30, s[16:19], s74 offen lds
    s_waitcnt lgkmcnt(0)
    s_barrier
    ds_read_b128 v[64:67], v113 offset:0
    ds_read_b128 v[68:71], v113 offset:64
    ds_read_b128 v[72:75], v113 offset:128
    ds_read_b128 v[76:79], v113 offset:192
    s_add_u32 m0, s72, 24576
    s_xor_b32 s74, s73, 327680
    buffer_load_dwordx4 v30, s[16:19], s74 offen lds
    s_add_u32 m0, s72, 25600
    s_xor_b32 s74, s73, 344064
    buffer_load_dwordx4 v30, s[16:19], s74 offen lds
    v_dot2c_f32_bf16 v84, s68, v60
    v_dot2c_f32_bf16 v86, v60, v60
    v_dot2c_f32_bf16 v85, s68, v61
    v_dot2c_f32_bf16 v87, v61, v61
    v_dot2c_f32_bf16 v84, s68, v62
    v_dot2c_f32_bf16 v86, v62, v62
    v_dot2c_f32_bf16 v85, s68, v63
    v_dot2c_f32_bf16 v87, v63, v63
    s_add_u32 m0, s72, 26624
    s_xor_b32 s74, s73, 360448
    buffer_load_dwordx4 v30, s[16:19], s74 offen lds
    s_add_u32 m0, s72, 27648
    s_xor_b32 s74, s73, 376832
    buffer_load_dwordx4 v30, s[16:19], s74 offen lds
    s_bitcmp1_b32 s62, 0
    v_add_f32 v84, v84, v85
    v_add_f32 v86, v86, v87
    s_nop 0
    v_add_f32_dpp v84, v84, v84 quad_perm:[1,0,3,2] row_mask:0xf bank_mask:0xf
    v_add_f32_dpp v86, v86, v86 quad_perm:[1,0,3,2] row_mask:0xf bank_mask:0xf
    s_nop 0
    v_add_f32_dpp v84, v84, v84 quad_perm:[2,3,0,1] row_mask:0xf bank_mask:0xf
    v_add_f32_dpp v86, v86, v86 quad_perm:[2,3,0,1] row_mask:0xf bank_mask:0xf
    s_nop 0
    v_add_f32_dpp v84, v84, v84 row_half_mirror row_mask:0xf bank_mask:0xf
    v_add_f32_dpp v86, v86, v86 row_half_mirror row_mask:0xf bank_mask:0xf
    s_cbranch_scc1 KVV_1
    s_waitcnt lgkmcnt(3)
    v_mfma_f32_16x16x32_bf16 v[80:83], a[224:227], v[64:67], 0
    v_mfma_f32_16x16x32_bf16 v[8:11], a[224:227], a[248:251], 0
    s_waitcnt lgkmcnt(2)
    v_mfma_f32_16x16x32_bf16 v[80:83], a[228:231], v[68:71], v[80:83]
    v_mfma_f32_16x16x32_bf16 v[8:11], a[228:231], a[248:251], v[8:11]
    s_waitcnt lgkmcnt(1)
    v_mfma_f32_16x16x32_bf16 v[80:83], a[232:235], v[72:75], v[80:83]
    v_mfma_f32_16x16x32_bf16 v[8:11], a[232:235], a[248:251], v[8:11]
    s_waitcnt lgkmcnt(0)
    v_mfma_f32_16x16x32_bf16 v[80:83], a[236:239], v[76:79], v[80:83]
    v_mfma_f32_16x16x32_bf16 v[8:11], a[236:239], a[248:251], v[8:11]
KVD_2:
    v_mul_f32 v84, 989855744, v84
    v_mul_f32 v86, 989855744, v86
    v_fma_f32 v86, -v84, v84, v86
    v_max_f32 v86, 0, v86
    v_add_f32 v86, 925353388, v86
    v_rsq_f32 v86, v86
    s_nop 0
    ds_write2_b32 v114, v84, v86 offset1:32
    ds_write_b128 v115, v[80:83]
    ds_write_b128 v4, v[8:11]
    s_waitcnt vmcnt(16)
    ds_read_b64_tr_b16 v[144:145], v31 offset:8192
    ds_read_b64_tr_b16 v[146:147], v31 offset:8448
    ds_read_b64_tr_b16 v[148:149], v31 offset:9216
    ds_read_b64_tr_b16 v[150:151], v31 offset:9472
    ds_read_b64_tr_b16 v[152:153], v31 offset:10240
    ds_read_b64_tr_b16 v[154:155], v31 offset:10496
    ds_read_b64_tr_b16 v[156:157], v31 offset:11264
    ds_read_b64_tr_b16 v[158:159], v31 offset:11520
    s_waitcnt lgkmcnt(8)
    s_barrier
    ds_read_b128 v[96:99], v120 offset:0
    ds_read_b128 v[100:103], v120 offset:1024
    ds_read_b128 v[104:107], v120 offset:2048
    ds_read_b128 v[108:111], v120 offset:3072
    ds_read2_b32 v[88:89], v116 offset1:32
    ds_read2_b32 v[90:91], v117 offset1:32
    ds_read2_b32 v[92:93], v118 offset1:32
    ds_read2_b32 v[94:95], v119 offset1:32
    ds_read_b128 v[12:15], v5 offset:0
    ds_read_b128 v[16:19], v5 offset:256
    ds_read_b128 v[20:23], v5 offset:512
    ds_read_b128 v[24:27], v5 offset:768
    v_mov_b32 v82, s35
    v_mov_b32 v83, s35
    s_waitcnt lgkmcnt(10)
    v_add_f32 v96, v96, v100
    v_add_f32 v97, v97, v101
    v_add_f32 v98, v98, v102
    v_add_f32 v99, v99, v103
    s_waitcnt lgkmcnt(8)
    v_add_f32 v104, v104, v108
    v_add_f32 v105, v105, v109
    v_add_f32 v106, v106, v110
    v_add_f32 v107, v107, v111
    v_add_f32 v96, v96, v104
    v_add_f32 v97, v97, v105
    v_add_f32 v98, v98, v106
    v_add_f32 v99, v99, v107
    s_waitcnt lgkmcnt(0)
    v_pk_add_f32 v[12:13], v[12:13], v[16:17]
    v_pk_add_f32 v[14:15], v[14:15], v[18:19]
    v_pk_add_f32 v[20:21], v[20:21], v[24:25]
    v_pk_add_f32 v[22:23], v[22:23], v[26:27]
    v_pk_add_f32 v[8:9], v[12:13], v[20:21]
    v_pk_add_f32 v[10:11], v[14:15], v[22:23]
    v_fma_f32 v96, -v88, v8, v96
    v_fma_f32 v97, -v90, v9, v97
    v_fma_f32 v98, -v92, v10, v98
    v_fma_f32 v99, -v94, v11, v99
    v_mul_f32 v96, v96, v89
    v_mul_f32 v97, v97, v91
    v_mul_f32 v98, v98, v93
    v_mul_f32 v99, v99, v95
    v_cvt_pk_bf16_f32 v80, v96, v97
    v_cvt_pk_bf16_f32 v81, v98, v99
    buffer_store_dwordx4 v[80:83], v1, s[4:7], s32 offen
    buffer_store_dwordx4 v[80:83], v1, s[4:7], s41 offen sc1
    buffer_store_dwordx2 v[80:81], v121, s[4:7], s78 offen sc1
    s_xor_b32 s37, s38, 0
    v_add_u32 v114, s37, v7
    ds_read_b128 v[48:51], v114
    s_xor_b32 s37, s38, 32
    v_add_u32 v115, s37, v7
    ds_read_b128 v[52:55], v115
    s_xor_b32 s37, s38, 64
    v_add_u32 v114, s37, v7
    ds_read_b128 v[56:59], v114
    s_xor_b32 s37, s38, 96
    v_add_u32 v115, s37, v7
    ds_read_b128 v[60:63], v115
    s_add_u32 m0, s72, 0
    s_xor_b32 s74, s73, 393216
    buffer_load_dwordx4 v30, s[16:19], s74 offen lds
    s_add_u32 m0, s72, 1024
    s_xor_b32 s74, s73, 409600
    buffer_load_dwordx4 v30, s[16:19], s74 offen lds
    s_waitcnt vmcnt(17)
    ds_read_b64_tr_b16 v[160:161], v31 offset:12288
    ds_read_b64_tr_b16 v[162:163], v31 offset:12544
    ds_read_b64_tr_b16 v[164:165], v31 offset:13312
    ds_read_b64_tr_b16 v[166:167], v31 offset:13568
    ds_read_b64_tr_b16 v[168:169], v31 offset:14336
    ds_read_b64_tr_b16 v[170:171], v31 offset:14592
    ds_read_b64_tr_b16 v[172:173], v31 offset:15360
    ds_read_b64_tr_b16 v[174:175], v31 offset:15616
    s_waitcnt lgkmcnt(11)
    v_mfma_f32_32x32x16_bf16 v[32:47], v[128:131], v[48:51], 0
    s_xor_b32 s37, s38, 128
    v_add_u32 v114, s37, v7
    ds_read_b128 v[64:67], v114
    v_mfma_f32_16x16x32_bf16 v[116:119], v[128:131], a[252:255], 0
    s_add_u32 m0, s72, 2048
    s_xor_b32 s74, s73, 425984
    buffer_load_dwordx4 v30, s[16:19], s74 offen lds
    s_waitcnt lgkmcnt(11)
    v_mfma_f32_32x32x16_bf16 v[32:47], v[132:135], v[52:55], v[32:47]
    s_xor_b32 s37, s38, 160
    v_add_u32 v115, s37, v7
    ds_read_b128 v[68:71], v115
    v_mfma_f32_16x16x32_bf16 v[116:119], v[132:135], a[252:255], v[116:119]
    s_add_u32 m0, s72, 3072
    s_xor_b32 s74, s73, 442368
    buffer_load_dwordx4 v30, s[16:19], s74 offen lds
    v_mov_b32 v2, 0xdddddddd
    v_lshrrev_b32 v112, 9, v1
    s_waitcnt lgkmcnt(11)
    v_mfma_f32_32x32x16_bf16 v[32:47], v[136:139], v[56:59], v[32:47]
    s_xor_b32 s37, s38, 192
    v_add_u32 v114, s37, v7
    ds_read_b128 v[72:75], v114
    v_mfma_f32_16x16x32_bf16 v[116:119], v[136:139], a[252:255], v[116:119]
    s_add_u32 m0, s72, 4096
    s_xor_b32 s74, s73, 458752
    buffer_load_dwordx4 v30, s[16:19], s74 offen lds
    v_and_b32 v4, 0xf0, v1
    v_lshl_add_u32 v4, v112, 8, v4
    s_waitcnt lgkmcnt(11)
    v_mfma_f32_32x32x16_bf16 v[32:47], v[140:143], v[60:63], v[32:47]
    s_xor_b32 s37, s38, 224
    v_add_u32 v115, s37, v7
    ds_read_b128 v[76:79], v115
    v_mfma_f32_16x16x32_bf16 v[116:119], v[140:143], a[252:255], v[116:119]
    s_add_u32 m0, s72, 5120
    s_xor_b32 s74, s73, 475136
    buffer_load_dwordx4 v30, s[16:19], s74 offen lds
    v_add_u32 v4, 118784, v4
    v_add_u32 v5, 512, v4
    s_waitcnt lgkmcnt(3)
    v_mfma_f32_32x32x16_bf16 v[32:47], v[144:147], v[64:67], v[32:47]
    s_xor_b32 s37, s38, 256
    v_add_u32 v114, s37, v7
    ds_read_b128 v[48:51], v114
    v_mfma_f32_16x16x32_bf16 v[116:119], v[144:147], a[252:255], v[116:119]
    s_add_u32 m0, s72, 6144
    s_xor_b32 s74, s73, 491520
    buffer_load_dwordx4 v30, s[16:19], s74 offen lds
    v_mov_b32 v113, 119808
    v_and_b32 v112, 0xb0, v1
    s_waitcnt lgkmcnt(3)
    v_mfma_f32_32x32x16_bf16 v[32:47], v[148:151], v[68:71], v[32:47]
    s_xor_b32 s37, s38, 288
    v_add_u32 v115, s37, v7
    ds_read_b128 v[52:55], v115
    v_mfma_f32_16x16x32_bf16 v[116:119], v[148:151], a[252:255], v[116:119]
    s_add_u32 m0, s72, 7168
    s_xor_b32 s74, s73, 507904
    buffer_load_dwordx4 v30, s[16:19], s74 offen lds
    v_cmp_ne_u32 vcc, 0, v112
    v_mov_b32 v112, 119824
    s_waitcnt lgkmcnt(3)
    v_mfma_f32_32x32x16_bf16 v[32:47], v[152:155], v[72:75], v[32:47]
    s_xor_b32 s37, s38, 320
    v_add_u32 v114, s37, v7
    ds_read_b128 v[56:59], v114
    v_mfma_f32_16x16x32_bf16 v[116:119], v[152:155], a[252:255], v[116:119]
    v_cndmask_b32 v113, v113, v112, vcc
    v_and_b32 v112, 0x100, v1
    s_waitcnt lgkmcnt(3)
    v_mfma_f32_32x32x16_bf16 v[32:47], v[156:159], v[76:79], v[32:47]
    s_xor_b32 s37, s38, 352
    v_add_u32 v115, s37, v7
    ds_read_b128 v[60:63], v115
    v_mfma_f32_16x16x32_bf16 v[116:119], v[156:159], a[252:255], v[116:119]
    v_cmp_ne_u32 vcc, 0, v112
    s_nop 0
    s_waitcnt lgkmcnt(3)
    v_mfma_f32_32x32x16_bf16 v[32:47], v[160:163], v[48:51], v[32:47]
    s_xor_b32 s37, s38, 384
    v_add_u32 v114, s37, v7
    s_waitcnt vmcnt(21)
    ds_read_b64_tr_b16 v[176:177], v31 offset:16384
    ds_read_b64_tr_b16 v[178:179], v31 offset:16640
    ds_read_b128 v[64:67], v114
    v_mfma_f32_16x16x32_bf16 v[116:119], v[160:163], a[252:255], v[116:119]
    v_cndmask_b32 v4, v4, v113, vcc
    v_cndmask_b32 v5, v5, v113, vcc
    s_waitcnt lgkmcnt(5)
    v_mfma_f32_32x32x16_bf16 v[32:47], v[164:167], v[52:55], v[32:47]
    s_xor_b32 s37, s38, 416
    v_add_u32 v115, s37, v7
    ds_read_b64_tr_b16 v[180:181], v31 offset:17408
    ds_read_b64_tr_b16 v[182:183], v31 offset:17664
    ds_read_b128 v[68:71], v115
    v_mfma_f32_16x16x32_bf16 v[116:119], v[164:167], a[252:255], v[116:119]
    v_bfe_u32 v120, v1, 4, 3
    v_mul_u32_u24 v120, 2080, v120
    s_waitcnt lgkmcnt(7)
    v_mfma_f32_32x32x16_bf16 v[32:47], v[168:171], v[56:59], v[32:47]
    s_xor_b32 s37, s38, 448
    v_add_u32 v114, s37, v7
    s_waitcnt vmcnt(19)
    ds_read_b64_tr_b16 v[184:185], v31 offset:18432
    ds_read_b64_tr_b16 v[186:187], v31 offset:18688
    ds_read_b128 v[72:75], v114
    v_mfma_f32_16x16x32_bf16 v[116:119], v[168:171], a[252:255], v[116:119]
    v_lshrrev_b32 v112, 4, v112
    v_bfe_u32 v113, v1, 7, 1
    s_waitcnt lgkmcnt(9)
    v_mfma_f32_32x32x16_bf16 v[32:47], v[172:175], v[60:63], v[32:47]
    s_xor_b32 s37, s38, 480
    v_add_u32 v115, s37, v7
    ds_read_b64_tr_b16 v[188:189], v31 offset:19456
    ds_read_b64_tr_b16 v[190:191], v31 offset:19712
    ds_read_b128 v[76:79], v115
    v_mfma_f32_16x16x32_bf16 v[116:119], v[172:175], a[252:255], v[116:119]
    v_mul_u32_u24 v113, 29440, v113
    v_add_u32 v120, v113, v120
    s_waitcnt lgkmcnt(9)
    v_mfma_f32_32x32x16_bf16 v[32:47], v[176:179], v[64:67], v[32:47]
    s_xor_b32 s37, s38, 512
    v_add_u32 v114, s37, v7
    s_waitcnt vmcnt(17)
    ds_read_b64_tr_b16 v[192:193], v31 offset:20480
    ds_read_b64_tr_b16 v[194:195], v31 offset:20736
    ds_read_b128 v[48:51], v114
    v_mfma_f32_16x16x32_bf16 v[116:119], v[176:179], a[252:255], v[116:119]
    v_add_u32 v120, 119808, v120
    v_add_u32 v120, v112, v120
    s_waitcnt lgkmcnt(9)
    v_mfma_f32_32x32x16_bf16 v[32:47], v[180:183], v[68:71], v[32:47]
    s_xor_b32 s37, s38, 544
    v_add_u32 v115, s37, v7
    ds_read_b64_tr_b16 v[196:197], v31 offset:21504
    ds_read_b64_tr_b16 v[198:199], v31 offset:21760
    ds_read_b128 v[52:55], v115
    v_mfma_f32_16x16x32_bf16 v[116:119], v[180:183], a[252:255], v[116:119]
    v_mov_b32 v112, s68
    v_cndmask_b32 v24, v112, 0, vcc
    s_waitcnt lgkmcnt(9)
    v_mfma_f32_32x32x16_bf16 v[32:47], v[184:187], v[72:75], v[32:47]
    s_xor_b32 s37, s38, 576
    v_add_u32 v114, s37, v7
    s_waitcnt vmcnt(15)
    ds_read_b64_tr_b16 v[200:201], v31 offset:22528
    ds_read_b64_tr_b16 v[202:203], v31 offset:22784
    ds_read_b128 v[56:59], v114
    v_mfma_f32_16x16x32_bf16 v[116:119], v[184:187], a[252:255], v[116:119]
    v_cndmask_b32 v25, v112, 0, vcc
    v_cndmask_b32 v26, v112, 0, vcc
    s_waitcnt lgkmcnt(9)
    v_mfma_f32_32x32x16_bf16 v[32:47], v[188:191], v[76:79], v[32:47]
    s_xor_b32 s37, s38, 608
    v_add_u32 v115, s37, v7
    ds_read_b64_tr_b16 v[204:205], v31 offset:23552
    ds_read_b64_tr_b16 v[206:207], v31 offset:23808
    ds_read_b128 v[60:63], v115
    v_mfma_f32_16x16x32_bf16 v[116:119], v[188:191], a[252:255], v[116:119]
    buffer_load_dwordx4 v[80:83], v1, s[4:7], s33 offen offset:0 sc1
    v_cndmask_b32 v27, v112, 0, vcc
    s_waitcnt lgkmcnt(9)
    v_mfma_f32_32x32x16_bf16 v[32:47], v[192:195], v[48:51], v[32:47]
    s_xor_b32 s37, s38, 640
    v_add_u32 v114, s37, v7
    s_waitcnt vmcnt(14)
    ds_read_b64_tr_b16 v[208:209], v31 offset:24576
    ds_read_b64_tr_b16 v[210:211], v31 offset:24832
    ds_read_b128 v[64:67], v114
    v_mfma_f32_16x16x32_bf16 v[116:119], v[192:195], a[252:255], v[116:119]
    buffer_load_dwordx4 v[84:87], v1, s[4:7], s33 offen offset:1024 sc1
    s_waitcnt lgkmcnt(9)
    v_mfma_f32_32x32x16_bf16 v[32:47], v[196:199], v[52:55], v[32:47]
    s_xor_b32 s37, s38, 672
    v_add_u32 v115, s37, v7
    ds_read_b64_tr_b16 v[212:213], v31 offset:25600
    ds_read_b64_tr_b16 v[214:215], v31 offset:25856
    ds_read_b128 v[68:71], v115
    v_mfma_f32_16x16x32_bf16 v[116:119], v[196:199], a[252:255], v[116:119]
    buffer_load_dwordx4 v[88:91], v1, s[4:7], s33 offen offset:2048 sc1
    s_waitcnt lgkmcnt(9)
    v_mfma_f32_32x32x16_bf16 v[32:47], v[200:203], v[56:59], v[32:47]
    s_xor_b32 s37, s38, 704
    v_add_u32 v114, s37, v7
    s_waitcnt vmcnt(14)
    ds_read_b64_tr_b16 v[216:217], v31 offset:26624
    ds_read_b64_tr_b16 v[218:219], v31 offset:26880
    ds_read_b128 v[72:75], v114
    v_mfma_f32_16x16x32_bf16 v[116:119], v[200:203], a[252:255], v[116:119]
    buffer_load_dwordx4 v[92:95], v1, s[4:7], s33 offen offset:3072 sc1
    s_waitcnt lgkmcnt(9)
    v_mfma_f32_32x32x16_bf16 v[32:47], v[204:207], v[60:63], v[32:47]
    s_xor_b32 s37, s38, 736
    v_add_u32 v115, s37, v7
    ds_read_b64_tr_b16 v[220:221], v31 offset:27648
    ds_read_b64_tr_b16 v[222:223], v31 offset:27904
    ds_read_b128 v[76:79], v115
    v_mfma_f32_16x16x32_bf16 v[116:119], v[204:207], a[252:255], v[116:119]
    buffer_load_dwordx4 v[96:99], v1, s[4:7], s34 offen offset:0 sc1
    s_waitcnt lgkmcnt(9)
    v_mfma_f32_32x32x16_bf16 v[32:47], v[208:211], v[64:67], v[32:47]
    s_xor_b32 s37, s38, 768
    v_add_u32 v114, s37, v7
    s_waitcnt vmcnt(11)
    ds_read_b64_tr_b16 v[224:225], v31 offset:0
    ds_read_b64_tr_b16 v[226:227], v31 offset:256
    ds_read_b128 v[48:51], v114
    v_mfma_f32_16x16x32_bf16 v[116:119], v[208:211], a[252:255], v[116:119]
    buffer_load_dwordx4 v[100:103], v1, s[4:7], s34 offen offset:1024 sc1
    s_waitcnt lgkmcnt(9)
    v_mfma_f32_32x32x16_bf16 v[32:47], v[212:215], v[68:71], v[32:47]
    s_xor_b32 s37, s38, 800
    v_add_u32 v115, s37, v7
    ds_read_b64_tr_b16 v[228:229], v31 offset:1024
    ds_read_b64_tr_b16 v[230:231], v31 offset:1280
    ds_read_b128 v[52:55], v115
    v_mfma_f32_16x16x32_bf16 v[116:119], v[212:215], a[252:255], v[116:119]
    buffer_load_dwordx4 v[104:107], v1, s[4:7], s34 offen offset:2048 sc1
    s_waitcnt lgkmcnt(9)
    v_mfma_f32_32x32x16_bf16 v[32:47], v[216:219], v[72:75], v[32:47]
    s_xor_b32 s37, s38, 832
    v_add_u32 v114, s37, v7
    s_waitcnt vmcnt(11)
    ds_read_b64_tr_b16 v[232:233], v31 offset:2048
    ds_read_b64_tr_b16 v[234:235], v31 offset:2304
    ds_read_b128 v[56:59], v114
    v_mfma_f32_16x16x32_bf16 v[116:119], v[216:219], a[252:255], v[116:119]
    buffer_load_dwordx4 v[108:111], v1, s[4:7], s34 offen offset:3072 sc1
    s_waitcnt lgkmcnt(9)
    v_mfma_f32_32x32x16_bf16 v[32:47], v[220:223], v[76:79], v[32:47]
    s_xor_b32 s37, s38, 864
    v_add_u32 v115, s37, v7
    ds_read_b64_tr_b16 v[236:237], v31 offset:3072
    ds_read_b64_tr_b16 v[238:239], v31 offset:3328
    ds_read_b128 v[60:63], v115
    v_mfma_f32_16x16x32_bf16 v[116:119], v[220:223], a[252:255], v[116:119]
    s_waitcnt lgkmcnt(9)
    v_mfma_f32_32x32x16_bf16 v[32:47], v[224:227], v[48:51], v[32:47]
    s_xor_b32 s37, s38, 896
    v_add_u32 v114, s37, v7
    s_waitcnt vmcnt(10)
    ds_read_b64_tr_b16 v[240:241], v31 offset:4096
    ds_read_b64_tr_b16 v[242:243], v31 offset:4352
    ds_read_b128 v[64:67], v114
    v_mfma_f32_16x16x32_bf16 v[116:119], v[224:227], a[252:255], v[116:119]
    s_waitcnt lgkmcnt(9)
    v_mfma_f32_32x32x16_bf16 v[32:47], v[228:231], v[52:55], v[32:47]
    s_xor_b32 s37, s38, 928
    v_add_u32 v115, s37, v7
    ds_read_b64_tr_b16 v[244:245], v31 offset:5120
    ds_read_b64_tr_b16 v[246:247], v31 offset:5376
    ds_read_b128 v[68:71], v115
    v_mfma_f32_16x16x32_bf16 v[116:119], v[228:231], a[252:255], v[116:119]
    s_waitcnt lgkmcnt(9)
    v_mfma_f32_32x32x16_bf16 v[32:47], v[232:235], v[56:59], v[32:47]
    s_xor_b32 s37, s38, 960
    v_add_u32 v114, s37, v7
    s_waitcnt vmcnt(8)
    ds_read_b64_tr_b16 v[248:249], v31 offset:6144
    ds_read_b64_tr_b16 v[250:251], v31 offset:6400
    ds_read_b128 v[72:75], v114
    v_mfma_f32_16x16x32_bf16 v[116:119], v[232:235], a[252:255], v[116:119]
    v_accvgpr_read_b32 v30, a0
    s_waitcnt lgkmcnt(9)
    v_mfma_f32_32x32x16_bf16 v[32:47], v[236:239], v[60:63], v[32:47]
    s_xor_b32 s37, s38, 992
    v_add_u32 v115, s37, v7
    ds_read_b64_tr_b16 v[252:253], v31 offset:7168
    ds_read_b64_tr_b16 v[254:255], v31 offset:7424
    ds_read_b128 v[76:79], v115
    v_mfma_f32_16x16x32_bf16 v[116:119], v[236:239], a[252:255], v[116:119]
    s_branch NEAR_5
TAGRT_3:
    s_cmp_eq_u32 s29, 0
    s_cbranch_scc1 TAGBK_4
    s_sub_u32 s29, s29, 1
    s_and_b32 s37, s29, 3
    s_cselect_b32 s36, s33, s42
    s_add_u32 s37, s36, 4096
    buffer_load_dwordx4 v[80:83], v1, s[4:7], s36 offen offset:0 sc1
    buffer_load_dwordx4 v[84:87], v1, s[4:7], s36 offen offset:1024 sc1
    buffer_load_dwordx4 v[88:91], v1, s[4:7], s36 offen offset:2048 sc1
    buffer_load_dwordx4 v[92:95], v1, s[4:7], s36 offen offset:3072 sc1
    buffer_load_dwordx4 v[96:99], v1, s[4:7], s37 offen offset:0 sc1
    buffer_load_dwordx4 v[100:103], v1, s[4:7], s37 offen offset:1024 sc1
    buffer_load_dwordx4 v[104:107], v1, s[4:7], s37 offen offset:2048 sc1
    buffer_load_dwordx4 v[108:111], v1, s[4:7], s37 offen offset:3072 sc1
    s_waitcnt vmcnt(0)
    v_sad_u32 v83, v82, s35, 0
    v_sad_u32 v83, v86, s35, v83 clamp
    v_sad_u32 v83, v90, s35, v83 clamp
    v_sad_u32 v83, v94, s35, v83 clamp
    v_sad_u32 v83, v98, s35, v83 clamp
    v_sad_u32 v83, v102, s35, v83 clamp
    v_sad_u32 v83, v106, s35, v83 clamp
    v_sad_u32 v83, v110, s35, v83 clamp
    v_cmp_ne_u32 vcc, 0, v83
    s_cbranch_vccnz TAGRT_3
    s_branch TAGBK_4
RT_8:
    s_cmp_eq_u32 s29, 0
    s_cbranch_scc1 BK_9
    s_sub_u32 s29, s29, 1
    s_cmp_lg_u32 s31, 0
    s_cbranch_scc1 SF_10
SFD_11:
    s_mov_b64 exec, vcc
    buffer_load_dword v160, v123, s[4:7], s66 offen sc1
    s_waitcnt vmcnt(0)
    v_sad_u32 v160, v160, s30, 0
    v_cmp_lt_u32 vcc, 15, v160
    s_mov_b64 exec, -1
    s_cbranch_vccnz RT_8
    s_branch BK_9
RT_12:
    s_cmp_eq_u32 s29, 0
    s_cbranch_scc1 BK_13
    s_sub_u32 s29, s29, 1
    s_cmp_lg_u32 s31, 0
    s_cbranch_scc1 SF_14
SFD_15:
    buffer_load_dwordx4 v[128:131], v1, s[4:7], s43 offen offset:0 sc1
    buffer_load_dwordx4 v[132:135], v1, s[4:7], s43 offen offset:1024 sc1
    buffer_load_dwordx4 v[136:139], v1, s[4:7], s43 offen offset:2048 sc1
    buffer_load_dwordx4 v[140:143], v1, s[4:7], s43 offen offset:3072 sc1
    buffer_load_dwordx4 v[144:147], v1, s[4:7], s44 offen offset:0 sc1
TCH0:
    s_cbranch_execz TCH4
    buffer_load_dwordx4 v[148:151], v1, s[4:7], s44 offen offset:1024 sc1
    buffer_load_dwordx4 v[152:155], v1, s[4:7], s44 offen offset:2048 sc1
    buffer_load_dwordx4 v[156:159], v1, s[4:7], s44 offen offset:3072 sc1
    s_waitcnt vmcnt(0)
    v_sad_u32 v131, v130, s35, 0
    v_sad_u32 v131, v134, s35, v131 clamp
    v_sad_u32 v131, v138, s35, v131 clamp
    v_sad_u32 v131, v142, s35, v131 clamp
    v_sad_u32 v131, v146, s35, v131 clamp
    v_sad_u32 v131, v150, s35, v131 clamp
    v_sad_u32 v131, v154, s35, v131 clamp
    v_sad_u32 v131, v158, s35, v131 clamp
    v_cmp_ne_u32 vcc, 0, v131
    s_cbranch_vccnz RT_12
    s_branch BK_13
NEAR_5:
    s_waitcnt lgkmcnt(9)
    v_mfma_f32_32x32x16_bf16 v[32:47], v[240:243], v[64:67], v[32:47]
    ds_read_b128 v[12:15], v122
    ds_read_b128 v[16:19], v122 offset:32
    ds_read2_b32 v[28:29], v123 offset1:32
    v_mfma_f32_16x16x32_bf16 v[116:119], v[240:243], a[252:255], v[116:119]
    s_waitcnt vmcnt(0)
    v_sad_u32 v83, v82, s35, 0
    v_sad_u32 v83, v86, s35, v83 clamp
    v_sad_u32 v83, v90, s35, v83 clamp
    v_sad_u32 v83, v94, s35, v83 clamp
    v_sad_u32 v83, v98, s35, v83 clamp
    s_waitcnt lgkmcnt(9)
    v_mfma_f32_32x32x16_bf16 v[32:47], v[244:247], v[68:71], v[32:47]
    v_mfma_f32_16x16x32_bf16 v[116:119], v[244:247], a[252:255], v[116:119]
    v_sad_u32 v83, v102, s35, v83 clamp
    v_sad_u32 v83, v106, s35, v83 clamp
    v_sad_u32 v83, v110, s35, v83 clamp
    v_cmp_ne_u32 vcc, 0, v83
    s_waitcnt lgkmcnt(6)
    v_mfma_f32_32x32x16_bf16 v[32:47], v[248:251], v[72:75], v[32:47]
    v_mfma_f32_16x16x32_bf16 v[116:119], v[248:251], a[252:255], v[116:119]
    s_cbranch_vccnz TAGRT_3
TAGBK_4:
    ds_write_b64 v126, v[96:97] offset:37760
    ds_write_b64 v127, v[100:101] offset:38784
    ds_write_b64 v126, v[104:105] offset:38016
    ds_write_b64 v127, v[108:109] offset:39296
    s_add_u32 m0, s72, 8192
    s_nop 0
    buffer_load_dwordx4 v30, s[24:27], s69 offen lds
    s_add_u32 m0, s72, 9216
    s_add_u32 s69, s69, s75
    buffer_load_dwordx4 v30, s[24:27], s69 offen lds
    s_waitcnt lgkmcnt(7)
    v_mfma_f32_32x32x16_bf16 v[32:47], v[252:255], v[76:79], v[32:47]
    v_mfma_f32_16x16x32_bf16 v[116:119], v[252:255], a[252:255], v[116:119]
    s_add_u32 m0, s72, 10240
    s_add_u32 s69, s69, s75
    buffer_load_dwordx4 v30, s[24:27], s69 offen lds
    s_add_u32 m0, s72, 11264
    s_add_u32 s69, s69, s75
    buffer_load_dwordx4 v30, s[24:27], s69 offen lds
    buffer_store_dwordx4 v[128:131], v1, s[4:7], s40 offen sc1
    s_mov_b64 s[24:25], s[46:47]
    s_mov_b32 s26, 3584
    v_mov_b32 v121, s30
    s_waitcnt lgkmcnt(0)
    s_barrier
    ds_write_b128 v124, v[116:119]
    ds_read_b128 v[48:51], v125 offset:0
    ds_read_b128 v[52:55], v125 offset:32
    ds_read_b128 v[56:59], v125 offset:64
    ds_read_b128 v[60:63], v125 offset:96
    ds_read_b128 v[96:99], v3 offset:37760
    ds_read_b128 v[104:107], v4 offset:37760
    ds_read_b128 v[112:115], v5 offset:37760
    ds_write_b64 v126, v[80:81] offset:29440
    ds_write_b64 v127, v[84:85] offset:30464
    ds_write_b64 v126, v[88:89] offset:29696
    ds_write_b64 v127, v[92:93] offset:30976
    ds_write_b128 v120, v[24:27]
    s_mov_b64 exec, s[94:95]
    buffer_store_dword v121, off, s[4:7], s79 sc1
    s_mov_b64 exec, -1
    v_mul_f32 v29, 1052289595, v29
    s_waitcnt lgkmcnt(8)
    v_pk_fma_f32 v[32:33], v[48:49], v[28:29], v[32:33] op_sel_hi:[1,0,1] neg_lo:[0,1,0] neg_hi:[0,1,0]
    v_pk_fma_f32 v[34:35], v[50:51], v[28:29], v[34:35] op_sel_hi:[1,0,1] neg_lo:[0,1,0] neg_hi:[0,1,0]
    v_pk_fma_f32 v[36:37], v[52:53], v[28:29], v[36:37] op_sel_hi:[1,0,1] neg_lo:[0,1,0] neg_hi:[0,1,0]
    v_pk_fma_f32 v[38:39], v[54:55], v[28:29], v[38:39] op_sel_hi:[1,0,1] neg_lo:[0,1,0] neg_hi:[0,1,0]
    v_pk_fma_f32 v[40:41], v[56:57], v[28:29], v[40:41] op_sel_hi:[1,0,1] neg_lo:[0,1,0] neg_hi:[0,1,0]
    v_pk_fma_f32 v[42:43], v[58:59], v[28:29], v[42:43] op_sel_hi:[1,0,1] neg_lo:[0,1,0] neg_hi:[0,1,0]
    v_pk_fma_f32 v[44:45], v[60:61], v[28:29], v[44:45] op_sel_hi:[1,0,1] neg_lo:[0,1,0] neg_hi:[0,1,0]
    v_pk_fma_f32 v[46:47], v[62:63], v[28:29], v[46:47] op_sel_hi:[1,0,1] neg_lo:[0,1,0] neg_hi:[0,1,0]
    v_pk_mul_f32 v[32:33], v[32:33], v[28:29] op_sel:[0,1]
    v_pk_mul_f32 v[34:35], v[34:35], v[28:29] op_sel:[0,1]
    v_pk_mul_f32 v[36:37], v[36:37], v[28:29] op_sel:[0,1]
    v_pk_mul_f32 v[38:39], v[38:39], v[28:29] op_sel:[0,1]
    v_pk_mul_f32 v[40:41], v[40:41], v[28:29] op_sel:[0,1]
    v_pk_mul_f32 v[42:43], v[42:43], v[28:29] op_sel:[0,1]
    v_pk_mul_f32 v[44:45], v[44:45], v[28:29] op_sel:[0,1]
    v_pk_mul_f32 v[46:47], v[46:47], v[28:29] op_sel:[0,1]
    v_cvt_pk_bf16_f32 v20, v32, v33
    v_cvt_pk_bf16_f32 v21, v34, v35
    v_cvt_pk_bf16_f32 v22, v36, v37
    v_cvt_pk_bf16_f32 v23, v38, v39
    s_waitcnt lgkmcnt(0)
    v_cvt_pk_bf16_f32 v24, v40, v41
    v_cvt_pk_bf16_f32 v25, v42, v43
    v_cvt_pk_bf16_f32 v26, v44, v45
    v_cvt_pk_bf16_f32 v27, v46, v47
    v_mov_b32 v64, 0
    v_mov_b32 v65, 0
    v_mov_b32 v66, 0
    v_mov_b32 v67, 0
    v_mov_b32 v68, 0
    v_mov_b32 v69, 0
    v_mov_b32 v70, 0
    v_mov_b32 v71, 0
    v_mov_b32 v72, 0
    v_mov_b32 v73, 0
    v_mov_b32 v74, 0
    v_mov_b32 v75, 0
    v_mov_b32 v76, 0
    v_mov_b32 v77, 0
    v_mov_b32 v78, 0
    v_mov_b32 v79, 0
    s_waitcnt lgkmcnt(7)
    v_mfma_f32_32x32x16_bf16 v[32:47], v[96:99], v[20:23], 0
    v_mov_b32 v80, 0
    v_mov_b32 v81, 0
    v_mov_b32 v82, 0
    v_mov_b32 v83, 0
    v_mov_b32 v84, 0
    v_mov_b32 v85, 0
    v_mov_b32 v86, 0
    v_mov_b32 v87, 0
    v_mov_b32 v88, 0
    v_mov_b32 v89, 0
    v_mov_b32 v90, 0
    v_mov_b32 v91, 0
    v_mov_b32 v92, 0
    v_mov_b32 v93, 0
    v_mov_b32 v94, 0
    v_mov_b32 v95, 0
    s_lshl2_add_u32 s83, s62, s60
    s_lshl2_add_u32 s83, s83, s62
    s_lshl_b32 s83, s83, 13
    s_add_u32 s83, s83, 524288
    s_lshl2_add_u32 s70, s59, s60
    s_mul_i32 s88, s70, 11520
    s_add_u32 s88, s88, s63
    s_lshl_b32 s89, s58, 7
    s_add_u32 s89, s89, s70
    s_lshl_b32 s89, s89, 11
    v_lshlrev_b32 v7, 1, v1
    s_and_b32 s70, s60, 1
    s_lshl_b32 s70, s70, 8
    v_xor_b32 v124, s70, v1
    s_and_b32 s71, s59, 15
    s_mul_i32 s86, s60, 28672
    s_mul_i32 s80, s71, 114688
    s_add_u32 s80, s80, s86
    s_add_u32 s80, s80, 2097152
    s_mul_i32 s71, s71, 112
    s_lshl_b32 s70, s60, 5
    s_add_u32 s71, s71, s70
    v_bfe_u32 v125, v1, 4, 5
    v_add_lshl_u32 v125, s71, v125, 1
    s_and_b32 s70, s59, 7
    s_lshl_b32 s70, s70, 1
    s_lshr_b32 s71, s60, 1
    s_add_u32 s70, s70, s71
    s_xor_b32 s71, s70, 1
    s_mul_i32 s81, s70, 114688
    s_mul_i32 s82, s71, 114688
    s_add_u32 s70, s86, 4194304
    s_add_u32 s81, s81, s70
    s_add_u32 s82, s82, s70
    s_waitcnt lgkmcnt(0)
    v_exp_f32 v32, v32
    v_exp_f32 v33, v33
    ds_read_b128 v[100:103], v3 offset:39840
    v_exp_f32 v34, v34
    v_exp_f32 v35, v35
    v_exp_f32 v36, v36
    v_mfma_f32_32x32x16_bf16 v[48:63], v[96:99], v[24:27], 0
    ds_read_b128 v[108:111], v4 offset:39840
    v_exp_f32 v37, v37
    v_exp_f32 v38, v38
    v_exp_f32 v39, v39
    v_exp_f32 v40, v40
    v_exp_f32 v41, v41
    v_exp_f32 v42, v42
    v_smfmac_f32_32x32x32_bf16 v[64:79], v[104:107], v[32:39], v2
    ds_read_b128 v[116:119], v5 offset:39840
    v_exp_f32 v43, v43
    v_exp_f32 v44, v44
    v_exp_f32 v45, v45
    v_exp_f32 v46, v46
    v_exp_f32 v47, v47
    v_exp_f32 v48, v48
    v_exp_f32 v49, v49
    v_smfmac_f32_32x32x32_bf16 v[64:79], v[112:115], v[40:47], v2
    s_waitcnt lgkmcnt(2)
    v_exp_f32 v50, v50
    v_exp_f32 v51, v51
    v_exp_f32 v52, v52
    v_mfma_f32_32x32x16_bf16 v[32:47], v[100:103], v[20:23], 0
    v_exp_f32 v53, v53
    v_exp_f32 v54, v54
    v_exp_f32 v55, v55
    v_exp_f32 v56, v56
    v_exp_f32 v57, v57
    v_exp_f32 v58, v58
    v_smfmac_f32_32x32x32_bf16 v[80:95], v[104:107], v[48:55], v2
    s_waitcnt lgkmcnt(0)
    v_exp_f32 v59, v59
    v_exp_f32 v60, v60
    v_exp_f32 v61, v61
    v_exp_f32 v62, v62
    v_exp_f32 v63, v63
    v_exp_f32 v32, v32
    v_exp_f32 v33, v33
    v_smfmac_f32_32x32x32_bf16 v[80:95], v[112:115], v[56:63], v2
    ds_read_b128 v[96:99], v3 offset:41920
    v_exp_f32 v34, v34
    v_exp_f32 v35, v35
    v_exp_f32 v36, v36
    v_mfma_f32_32x32x16_bf16 v[48:63], v[100:103], v[24:27], 0
    ds_read_b128 v[104:107], v4 offset:41920
    v_exp_f32 v37, v37
    v_exp_f32 v38, v38
    v_exp_f32 v39, v39
    v_exp_f32 v40, v40
    v_exp_f32 v41, v41
    v_exp_f32 v42, v42
    v_smfmac_f32_32x32x32_bf16 v[64:79], v[108:111], v[32:39], v2
    ds_read_b128 v[112:115], v5 offset:41920
    v_exp_f32 v43, v43
    v_exp_f32 v44, v44
    v_exp_f32 v45, v45
    v_exp_f32 v46, v46
    v_exp_f32 v47, v47
    v_exp_f32 v48, v48
    v_exp_f32 v49, v49
    v_smfmac_f32_32x32x32_bf16 v[64:79], v[116:119], v[40:47], v2
    s_waitcnt lgkmcnt(2)
    v_exp_f32 v50, v50
    v_exp_f32 v51, v51
    v_exp_f32 v52, v52
    v_mfma_f32_32x32x16_bf16 v[32:47], v[96:99], v[20:23], 0
    buffer_load_dwordx4 v[128:131], v1, s[4:7], s43 offen offset:0 sc1
    v_exp_f32 v53, v53
    v_exp_f32 v54, v54
    v_exp_f32 v55, v55
    v_exp_f32 v56, v56
    v_exp_f32 v57, v57
    v_exp_f32 v58, v58
    v_smfmac_f32_32x32x32_bf16 v[80:95], v[108:111], v[48:55], v2
    buffer_load_dwordx4 v[132:135], v1, s[4:7], s43 offen offset:1024 sc1
    s_waitcnt lgkmcnt(0)
    v_exp_f32 v59, v59
    v_exp_f32 v60, v60
    v_exp_f32 v61, v61
    v_exp_f32 v62, v62
    v_exp_f32 v63, v63
    v_exp_f32 v32, v32
    v_exp_f32 v33, v33
    v_smfmac_f32_32x32x32_bf16 v[80:95], v[116:119], v[56:63], v2
    ds_read_b128 v[100:103], v3 offset:44000
    v_exp_f32 v34, v34
    v_exp_f32 v35, v35
    v_exp_f32 v36, v36
    v_mfma_f32_32x32x16_bf16 v[48:63], v[96:99], v[24:27], 0
    buffer_load_dwordx4 v[136:139], v1, s[4:7], s43 offen offset:2048 sc1
    ds_read_b128 v[108:111], v4 offset:44000
    v_exp_f32 v37, v37
    v_exp_f32 v38, v38
    v_exp_f32 v39, v39
    v_exp_f32 v40, v40
    v_exp_f32 v41, v41
    v_exp_f32 v42, v42
    v_smfmac_f32_32x32x32_bf16 v[64:79], v[104:107], v[32:39], v2
    buffer_load_dwordx4 v[140:143], v1, s[4:7], s43 offen offset:3072 sc1
    ds_read_b128 v[116:119], v5 offset:44000
    v_exp_f32 v43, v43
    v_exp_f32 v44, v44
    v_exp_f32 v45, v45
    v_exp_f32 v46, v46
    v_exp_f32 v47, v47
    v_exp_f32 v48, v48
    v_exp_f32 v49, v49
    v_smfmac_f32_32x32x32_bf16 v[64:79], v[112:115], v[40:47], v2
    s_waitcnt lgkmcnt(2)
    v_exp_f32 v50, v50
    v_exp_f32 v51, v51
    v_exp_f32 v52, v52
    v_mfma_f32_32x32x16_bf16 v[32:47], v[100:103], v[20:23], 0
    buffer_load_dwordx4 v[144:147], v1, s[4:7], s44 offen offset:0 sc1
    v_exp_f32 v53, v53
    v_exp_f32 v54, v54
    v_exp_f32 v55, v55
    v_exp_f32 v56, v56
    v_exp_f32 v57, v57
    v_exp_f32 v58, v58
    v_smfmac_f32_32x32x32_bf16 v[80:95], v[104:107], v[48:55], v2
    buffer_load_dwordx4 v[148:151], v1, s[4:7], s44 offen offset:1024 sc1
    s_waitcnt lgkmcnt(0)
    s_barrier
    v_exp_f32 v59, v59
    v_exp_f32 v60, v60
    v_exp_f32 v61, v61
    v_exp_f32 v62, v62
    v_exp_f32 v63, v63
    v_exp_f32 v32, v32
    v_exp_f32 v33, v33
    v_smfmac_f32_32x32x32_bf16 v[80:95], v[112:115], v[56:63], v2
    ds_read_b128 v[96:99], v3 offset:29440
    v_exp_f32 v34, v34
    v_exp_f32 v35, v35
    v_exp_f32 v36, v36
    v_mfma_f32_32x32x16_bf16 v[48:63], v[100:103], v[24:27], 0
    buffer_load_dwordx4 v[152:155], v1, s[4:7], s44 offen offset:2048 sc1
    ds_read_b128 v[104:107], v4 offset:29440
    v_exp_f32 v37, v37
    v_exp_f32 v38, v38
    v_exp_f32 v39, v39
    v_exp_f32 v40, v40
    v_exp_f32 v41, v41
    v_exp_f32 v42, v42
    v_smfmac_f32_32x32x32_bf16 v[64:79], v[108:111], v[32:39], v2
    buffer_load_dwordx4 v[156:159], v1, s[4:7], s44 offen offset:3072 sc1
    ds_read_b128 v[112:115], v5 offset:29440
    v_exp_f32 v43, v43
    v_exp_f32 v44, v44
    v_exp_f32 v45, v45
    v_exp_f32 v46, v46
    v_exp_f32 v47, v47
    v_exp_f32 v48, v48
    v_exp_f32 v49, v49
    v_smfmac_f32_32x32x32_bf16 v[64:79], v[116:119], v[40:47], v2
    s_waitcnt lgkmcnt(2)
    v_exp_f32 v50, v50
    v_exp_f32 v51, v51
    v_exp_f32 v52, v52
    v_mfma_f32_32x32x16_bf16 v[32:47], v[96:99], v[20:23], 0
    v_exp_f32 v53, v53
    v_exp_f32 v54, v54
    v_exp_f32 v55, v55
    v_exp_f32 v56, v56
    v_exp_f32 v57, v57
    v_exp_f32 v58, v58
    v_smfmac_f32_32x32x32_bf16 v[80:95], v[108:111], v[48:55], v2
    s_waitcnt lgkmcnt(0)
    v_exp_f32 v59, v59
    v_exp_f32 v60, v60
    v_exp_f32 v61, v61
    v_exp_f32 v62, v62
    v_exp_f32 v63, v63
    v_exp_f32 v32, v32
    v_exp_f32 v33, v33
    v_smfmac_f32_32x32x32_bf16 v[80:95], v[116:119], v[56:63], v2
    ds_read_b128 v[100:103], v3 offset:31520
    v_exp_f32 v34, v34
    v_exp_f32 v35, v35
    v_exp_f32 v36, v36
    v_mfma_f32_32x32x16_bf16 v[48:63], v[96:99], v[24:27], 0
    ds_read_b128 v[108:111], v4 offset:31520
    v_exp_f32 v37, v37
    v_exp_f32 v38, v38
    v_exp_f32 v39, v39
    v_exp_f32 v40, v40
    v_exp_f32 v41, v41
    v_exp_f32 v42, v42
    v_smfmac_f32_32x32x32_bf16 v[64:79], v[104:107], v[32:39], v2
    ds_read_b128 v[116:119], v5 offset:31520
    v_exp_f32 v43, v43
    v_exp_f32 v44, v44
    v_exp_f32 v45, v45
    v_exp_f32 v46, v46
    v_exp_f32 v47, v47
    v_exp_f32 v48, v48
    v_exp_f32 v49, v49
    v_smfmac_f32_32x32x32_bf16 v[64:79], v[112:115], v[40:47], v2
    s_waitcnt lgkmcnt(2)
    v_exp_f32 v50, v50
    v_exp_f32 v51, v51
    v_exp_f32 v52, v52
    v_mfma_f32_32x32x16_bf16 v[32:47], v[100:103], v[20:23], 0
    v_accvgpr_read_b32 v30, a1
    v_accvgpr_read_b32 v31, a2
    v_exp_f32 v53, v53
    v_exp_f32 v54, v54
    v_exp_f32 v55, v55
    v_exp_f32 v56, v56
    v_exp_f32 v57, v57
    v_exp_f32 v58, v58
    v_smfmac_f32_32x32x32_bf16 v[80:95], v[104:107], v[48:55], v2
    s_waitcnt lgkmcnt(0)
    v_exp_f32 v59, v59
    v_exp_f32 v60, v60
    v_exp_f32 v61, v61
    v_exp_f32 v62, v62
    v_exp_f32 v63, v63
    v_exp_f32 v32, v32
    v_exp_f32 v33, v33
    v_smfmac_f32_32x32x32_bf16 v[80:95], v[112:115], v[56:63], v2
    ds_read_b128 v[96:99], v3 offset:33600
    v_exp_f32 v34, v34
    v_exp_f32 v35, v35
    v_exp_f32 v36, v36
    v_mfma_f32_32x32x16_bf16 v[48:63], v[100:103], v[24:27], 0
    ds_read_b128 v[104:107], v4 offset:33600
    v_exp_f32 v37, v37
    v_exp_f32 v38, v38
    v_exp_f32 v39, v39
    v_exp_f32 v40, v40
    v_exp_f32 v41, v41
    v_exp_f32 v42, v42
    v_smfmac_f32_32x32x32_bf16 v[64:79], v[108:111], v[32:39], v2
    ds_read_b128 v[112:115], v5 offset:33600
    v_exp_f32 v43, v43
    v_exp_f32 v44, v44
    v_exp_f32 v45, v45
    v_exp_f32 v46, v46
    v_exp_f32 v47, v47
    v_exp_f32 v48, v48
    v_exp_f32 v49, v49
    v_smfmac_f32_32x32x32_bf16 v[64:79], v[116:119], v[40:47], v2
    s_waitcnt lgkmcnt(2)
    v_exp_f32 v50, v50
    v_exp_f32 v51, v51
    v_exp_f32 v52, v52
    v_mfma_f32_32x32x16_bf16 v[32:47], v[96:99], v[20:23], 0
    s_waitcnt vmcnt(0)
    v_sad_u32 v131, v130, s35, 0
    v_sad_u32 v131, v134, s35, v131 clamp
    v_sad_u32 v131, v138, s35, v131 clamp
    v_sad_u32 v131, v142, s35, v131 clamp
    v_exp_f32 v53, v53
    v_exp_f32 v54, v54
    v_exp_f32 v55, v55
    v_exp_f32 v56, v56
    v_exp_f32 v57, v57
    v_exp_f32 v58, v58
    v_smfmac_f32_32x32x32_bf16 v[80:95], v[108:111], v[48:55], v2
    s_waitcnt lgkmcnt(0)
    v_sad_u32 v131, v146, s35, v131 clamp
    v_sad_u32 v131, v150, s35, v131 clamp
    v_sad_u32 v131, v154, s35, v131 clamp
    v_sad_u32 v131, v158, s35, v131 clamp
    v_cmp_ne_u32 vcc, 0, v131
    v_exp_f32 v59, v59
    v_exp_f32 v60, v60
    v_exp_f32 v61, v61
    v_exp_f32 v62, v62
    v_exp_f32 v63, v63
    v_exp_f32 v32, v32
    v_exp_f32 v33, v33
    v_smfmac_f32_32x32x32_bf16 v[80:95], v[116:119], v[56:63], v2
    ds_read_b128 v[100:103], v3 offset:35680
    s_cbranch_vccnz RT_12
BK_13:
    ds_write_b64 v126, v[128:129] offset:0
    ds_write_b64 v127, v[132:133] offset:1024
    v_exp_f32 v34, v34
    v_exp_f32 v35, v35
    v_exp_f32 v36, v36
    v_mfma_f32_32x32x16_bf16 v[48:63], v[96:99], v[24:27], 0
    ds_read_b128 v[108:111], v4 offset:35680
    ds_write_b64 v126, v[136:137] offset:256
    ds_write_b64 v127, v[140:141] offset:1536
    v_exp_f32 v37, v37
    v_exp_f32 v38, v38
    v_exp_f32 v39, v39
    v_exp_f32 v40, v40
    v_exp_f32 v41, v41
    v_exp_f32 v42, v42
    v_smfmac_f32_32x32x32_bf16 v[64:79], v[104:107], v[32:39], v2
    ds_read_b128 v[116:119], v5 offset:35680
    ds_write_b64 v126, v[144:145] offset:8320
    ds_write_b64 v127, v[148:149] offset:9344
    v_lshlrev_b32 v123, 3, v1
    v_exp_f32 v43, v43
    v_exp_f32 v44, v44
    v_exp_f32 v45, v45
    v_exp_f32 v46, v46
    v_exp_f32 v47, v47
    v_exp_f32 v48, v48
    v_exp_f32 v49, v49
    v_smfmac_f32_32x32x32_bf16 v[64:79], v[112:115], v[40:47], v2
    s_waitcnt lgkmcnt(8)
    ds_write_b64 v126, v[152:153] offset:8576
    ds_write_b64 v127, v[156:157] offset:9856
    buffer_load_dword v160, v123, s[4:7], s66 offen sc1
    v_exp_f32 v50, v50
    v_exp_f32 v51, v51
    v_exp_f32 v52, v52
    v_mfma_f32_32x32x16_bf16 v[32:47], v[100:103], v[20:23], 0
    ds_read_b64_tr_b16 v[164:165], v30 offset:8192
    ds_read_b64_tr_b16 v[166:167], v31 offset:8192
    v_exp_f32 v53, v53
    v_exp_f32 v54, v54
    v_exp_f32 v55, v55
    v_exp_f32 v56, v56
    v_exp_f32 v57, v57
    v_exp_f32 v58, v58
    v_smfmac_f32_32x32x32_bf16 v[80:95], v[104:107], v[48:55], v2
    s_waitcnt lgkmcnt(0)
    s_barrier
    v_exp_f32 v59, v59
    v_exp_f32 v60, v60
    v_exp_f32 v61, v61
    v_exp_f32 v62, v62
    v_exp_f32 v63, v63
    v_exp_f32 v32, v32
    v_exp_f32 v33, v33
    v_smfmac_f32_32x32x32_bf16 v[80:95], v[112:115], v[56:63], v2
    ds_read_b128 v[96:99], v3 offset:8320
    v_exp_f32 v34, v34
    v_exp_f32 v35, v35
    v_exp_f32 v36, v36
    v_mfma_f32_32x32x16_bf16 v[48:63], v[100:103], v[24:27], 0
    ds_read_b128 v[104:107], v4 offset:8320
    ds_read_b64_tr_b16 v[168:169], v30 offset:9216
    ds_read_b64_tr_b16 v[170:171], v31 offset:9216
    v_exp_f32 v37, v37
    v_exp_f32 v38, v38
    v_exp_f32 v39, v39
    v_exp_f32 v40, v40
    v_exp_f32 v41, v41
    v_exp_f32 v42, v42
    v_smfmac_f32_32x32x32_bf16 v[64:79], v[108:111], v[32:39], v2
    ds_read_b128 v[112:115], v5 offset:8320
    ds_read_b64_tr_b16 v[172:173], v30 offset:10240
    ds_read_b64_tr_b16 v[174:175], v31 offset:10240
    v_exp_f32 v43, v43
    v_exp_f32 v44, v44
    v_exp_f32 v45, v45
    v_exp_f32 v46, v46
    v_exp_f32 v47, v47
    v_exp_f32 v48, v48
    v_exp_f32 v49, v49
    v_smfmac_f32_32x32x32_bf16 v[64:79], v[116:119], v[40:47], v2
    s_waitcnt lgkmcnt(6)
    ds_read_b64_tr_b16 v[176:177], v30 offset:11264
    ds_read_b64_tr_b16 v[178:179], v31 offset:11264
    v_exp_f32 v50, v50
    v_exp_f32 v51, v51
    v_exp_f32 v52, v52
    v_mfma_f32_32x32x16_bf16 v[32:47], v[96:99], v[20:23], 0
    v_lshrrev_b32 v184, 8, v1
    v_lshlrev_b32 v184, 4, v184
    v_exp_f32 v53, v53
    v_exp_f32 v54, v54
    v_exp_f32 v55, v55
    v_exp_f32 v56, v56
    v_exp_f32 v57, v57
    v_exp_f32 v58, v58
    v_smfmac_f32_32x32x32_bf16 v[80:95], v[108:111], v[48:55], v2
    s_waitcnt lgkmcnt(0)
    v_exp_f32 v59, v59
    v_exp_f32 v60, v60
    v_exp_f32 v61, v61
    v_exp_f32 v62, v62
    v_exp_f32 v63, v63
    v_exp_f32 v32, v32
    v_exp_f32 v33, v33
    v_smfmac_f32_32x32x32_bf16 v[80:95], v[116:119], v[56:63], v2
    ds_read_b128 v[100:103], v3 offset:10400
    v_exp_f32 v34, v34
    v_exp_f32 v35, v35
    v_exp_f32 v36, v36
    v_mfma_f32_32x32x16_bf16 v[48:63], v[96:99], v[24:27], 0
    ds_read_b128 v[108:111], v4 offset:10400
    v_mfma_f32_16x16x32_bf16 v[180:183], v[164:167], a[248:251], 0
    v_exp_f32 v37, v37
    v_exp_f32 v38, v38
    v_exp_f32 v39, v39
    v_exp_f32 v40, v40
    v_exp_f32 v41, v41
    v_exp_f32 v42, v42
    v_smfmac_f32_32x32x32_bf16 v[64:79], v[104:107], v[32:39], v2
    ds_read_b128 v[116:119], v5 offset:10400
    buffer_store_dwordx4 v[164:167], v1, s[4:7], s87 offen offset:0 sc1
    v_mfma_f32_16x16x32_bf16 v[180:183], v[168:171], a[248:251], v[180:183]
    v_exp_f32 v43, v43
    v_exp_f32 v44, v44
    v_exp_f32 v45, v45
    v_exp_f32 v46, v46
    v_exp_f32 v47, v47
    v_exp_f32 v48, v48
    v_exp_f32 v49, v49
    v_smfmac_f32_32x32x32_bf16 v[64:79], v[112:115], v[40:47], v2
    s_waitcnt lgkmcnt(2)
    buffer_store_dwordx4 v[168:171], v1, s[4:7], s87 offen offset:1024 sc1
    v_mfma_f32_16x16x32_bf16 v[180:183], v[172:175], a[248:251], v[180:183]
    v_exp_f32 v50, v50
    v_exp_f32 v51, v51
    v_exp_f32 v52, v52
    v_mfma_f32_32x32x16_bf16 v[32:47], v[100:103], v[20:23], 0
    buffer_store_dwordx4 v[172:175], v1, s[4:7], s87 offen offset:2048 sc1
    v_mfma_f32_16x16x32_bf16 v[180:183], v[176:179], a[248:251], v[180:183]
    v_exp_f32 v53, v53
    v_exp_f32 v54, v54
    v_exp_f32 v55, v55
    v_exp_f32 v56, v56
    v_exp_f32 v57, v57
    v_exp_f32 v58, v58
    v_smfmac_f32_32x32x32_bf16 v[80:95], v[104:107], v[48:55], v2
    s_waitcnt lgkmcnt(0)
    buffer_store_dwordx4 v[176:179], v1, s[4:7], s87 offen offset:3072 sc1
    v_exp_f32 v59, v59
    v_exp_f32 v60, v60
    v_exp_f32 v61, v61
    v_exp_f32 v62, v62
    v_exp_f32 v63, v63
    v_exp_f32 v32, v32
    v_exp_f32 v33, v33
    v_smfmac_f32_32x32x32_bf16 v[80:95], v[112:115], v[56:63], v2
    ds_read_b128 v[96:99], v3 offset:12480
    v_exp_f32 v34, v34
    v_exp_f32 v35, v35
    v_exp_f32 v36, v36
    v_mfma_f32_32x32x16_bf16 v[48:63], v[100:103], v[24:27], 0
    ds_read_b128 v[104:107], v4 offset:12480
    v_exp_f32 v37, v37
    v_exp_f32 v38, v38
    v_exp_f32 v39, v39
    v_exp_f32 v40, v40
    v_exp_f32 v41, v41
    v_exp_f32 v42, v42
    v_smfmac_f32_32x32x32_bf16 v[64:79], v[108:111], v[32:39], v2
    ds_read_b128 v[112:115], v5 offset:12480
    buffer_store_dwordx4 v[180:183], v184, s[4:7], s76 offen sc1
    v_exp_f32 v43, v43
    v_exp_f32 v44, v44
    v_exp_f32 v45, v45
    v_exp_f32 v46, v46
    v_exp_f32 v47, v47
    v_exp_f32 v48, v48
    v_exp_f32 v49, v49
    v_smfmac_f32_32x32x32_bf16 v[64:79], v[116:119], v[40:47], v2
    s_waitcnt lgkmcnt(2)
    v_exp_f32 v50, v50
    v_exp_f32 v51, v51
    v_exp_f32 v52, v52
    v_mfma_f32_32x32x16_bf16 v[32:47], v[96:99], v[20:23], 0
    s_waitcnt vmcnt(5)
    v_sad_u32 v160, v160, s30, 0
    v_cmp_lt_u32 vcc, 15, v160
    v_exp_f32 v53, v53
    v_exp_f32 v54, v54
    v_exp_f32 v55, v55
    v_exp_f32 v56, v56
    v_exp_f32 v57, v57
    v_exp_f32 v58, v58
    v_smfmac_f32_32x32x32_bf16 v[80:95], v[108:111], v[48:55], v2
    s_waitcnt lgkmcnt(0)
    s_cbranch_vccnz RT_8
BK_9:
    s_barrier
    s_lshl_b32 s70, s60, 12
    s_add_u32 s70, s70, s65
    v_add_u32 v126, s70, v1
    s_add_u32 s84, s58, 2
    s_and_b32 s84, s84, 7
    s_lshl_b32 s84, s84, 14
    v_exp_f32 v59, v59
    v_exp_f32 v60, v60
    v_exp_f32 v61, v61
    v_exp_f32 v62, v62
    v_exp_f32 v63, v63
    v_exp_f32 v32, v32
    v_exp_f32 v33, v33
    v_smfmac_f32_32x32x32_bf16 v[80:95], v[116:119], v[56:63], v2
    ds_read_b128 v[100:103], v3 offset:14560
    v_exp_f32 v34, v34
    v_exp_f32 v35, v35
    v_exp_f32 v36, v36
    v_mfma_f32_32x32x16_bf16 v[48:63], v[96:99], v[24:27], 0
    ds_read_b128 v[108:111], v4 offset:14560
    s_add_u32 m0, s85, 29440
    v_exp_f32 v37, v37
    v_exp_f32 v38, v38
    v_exp_f32 v39, v39
    v_exp_f32 v40, v40
    v_exp_f32 v41, v41
    v_exp_f32 v42, v42
    v_smfmac_f32_32x32x32_bf16 v[64:79], v[104:107], v[32:39], v2
    ds_read_b128 v[116:119], v5 offset:14560
    buffer_load_dwordx4 v126, s[4:7], s84 offen offset:0 sc1 lds
    v_exp_f32 v43, v43
    v_exp_f32 v44, v44
    v_exp_f32 v45, v45
    v_exp_f32 v46, v46
    v_exp_f32 v47, v47
    v_exp_f32 v48, v48
    v_exp_f32 v49, v49
    v_smfmac_f32_32x32x32_bf16 v[64:79], v[112:115], v[40:47], v2
    s_waitcnt lgkmcnt(2)
    buffer_load_dwordx4 v126, s[4:7], s84 offen offset:1024 sc1 lds
    s_add_u32 m0, s85, 29472
    v_exp_f32 v50, v50
    v_exp_f32 v51, v51
    v_exp_f32 v52, v52
    v_mfma_f32_32x32x16_bf16 v[32:47], v[100:103], v[20:23], 0
    buffer_load_dwordx4 v126, s[4:7], s84 offen offset:2048 sc1 lds
    v_exp_f32 v53, v53
    v_exp_f32 v54, v54
    v_exp_f32 v55, v55
    v_exp_f32 v56, v56
    v_exp_f32 v57, v57
    v_exp_f32 v58, v58
    v_smfmac_f32_32x32x32_bf16 v[80:95], v[104:107], v[48:55], v2
    s_waitcnt lgkmcnt(0)
    buffer_load_dwordx4 v126, s[4:7], s84 offen offset:3072 sc1 lds
    v_exp_f32 v59, v59
    v_exp_f32 v60, v60
    v_exp_f32 v61, v61
    v_exp_f32 v62, v62
    v_exp_f32 v63, v63
    v_exp_f32 v32, v32
    v_exp_f32 v33, v33
    v_smfmac_f32_32x32x32_bf16 v[80:95], v[112:115], v[56:63], v2
    ds_read_b128 v[96:99], v3 offset:0
    s_add_u32 s84, s84, 0x4000
    s_and_b32 s84, s84, 0x1ffff
    v_exp_f32 v34, v34
    v_exp_f32 v35, v35
    v_exp_f32 v36, v36
    v_mfma_f32_32x32x16_bf16 v[48:63], v[100:103], v[24:27], 0
    ds_read_b128 v[104:107], v4 offset:0
    v_and_b32 v161, 0xf80, v123
    v_exp_f32 v37, v37
    v_exp_f32 v38, v38
    v_exp_f32 v39, v39
    v_exp_f32 v40, v40
    v_exp_f32 v41, v41
    v_exp_f32 v42, v42
    v_smfmac_f32_32x32x32_bf16 v[64:79], v[108:111], v[32:39], v2
    ds_read_b128 v[112:115], v5 offset:0
    buffer_load_dword v161, v161, s[4:7], s39 offen sc1
    v_exp_f32 v43, v43
    v_exp_f32 v44, v44
    v_exp_f32 v45, v45
    v_exp_f32 v46, v46
    v_exp_f32 v47, v47
    v_exp_f32 v48, v48
    v_exp_f32 v49, v49
    v_smfmac_f32_32x32x32_bf16 v[64:79], v[116:119], v[40:47], v2
    s_waitcnt lgkmcnt(2)
    v_exp_f32 v50, v50
    v_exp_f32 v51, v51
    v_exp_f32 v52, v52
    v_mfma_f32_32x32x16_bf16 v[32:47], v[96:99], v[20:23], 0
    v_exp_f32 v53, v53
    v_exp_f32 v54, v54
    v_exp_f32 v55, v55
    v_exp_f32 v56, v56
    v_exp_f32 v57, v57
    v_exp_f32 v58, v58
    v_smfmac_f32_32x32x32_bf16 v[80:95], v[108:111], v[48:55], v2
    s_waitcnt lgkmcnt(0)
    s_waitcnt vmcnt(5)
    s_barrier
    v_exp_f32 v59, v59
    v_exp_f32 v60, v60
    v_exp_f32 v61, v61
    v_exp_f32 v62, v62
    v_exp_f32 v63, v63
TCH1:
    s_cbranch_execz TCH5
    v_exp_f32 v32, v32
    v_exp_f32 v33, v33
    v_smfmac_f32_32x32x32_bf16 v[80:95], v[116:119], v[56:63], v2
    ds_read_b128 v[100:103], v3 offset:2080
    v_exp_f32 v34, v34
    v_exp_f32 v35, v35
    v_exp_f32 v36, v36
    v_mfma_f32_32x32x16_bf16 v[48:63], v[96:99], v[24:27], 0
    ds_read_b128 v[108:111], v4 offset:2080
    s_add_u32 s79, s79, 65536
    s_mov_b64 exec, s[94:95]
    buffer_store_dword v6, off, s[4:7], s79 sc1
    s_mov_b64 exec, -1
    v_exp_f32 v37, v37
    v_exp_f32 v38, v38
    v_exp_f32 v39, v39
    v_exp_f32 v40, v40
    v_exp_f32 v41, v41
    v_exp_f32 v42, v42
    v_smfmac_f32_32x32x32_bf16 v[64:79], v[104:107], v[32:39], v2
    ds_read_b128 v[116:119], v5 offset:2080
    v_exp_f32 v43, v43
    v_exp_f32 v44, v44
    v_exp_f32 v45, v45
    v_exp_f32 v46, v46
    v_exp_f32 v47, v47
    v_exp_f32 v48, v48
    v_exp_f32 v49, v49
    v_smfmac_f32_32x32x32_bf16 v[64:79], v[112:115], v[40:47], v2
    s_waitcnt lgkmcnt(2)
    v_exp_f32 v50, v50
    v_exp_f32 v51, v51
    v_exp_f32 v52, v52
    v_mfma_f32_32x32x16_bf16 v[32:47], v[100:103], v[20:23], 0
    v_exp_f32 v53, v53
    v_exp_f32 v54, v54
    v_exp_f32 v55, v55
    v_exp_f32 v56, v56
    v_exp_f32 v57, v57
    v_exp_f32 v58, v58
    v_smfmac_f32_32x32x32_bf16 v[80:95], v[104:107], v[48:55], v2
    s_waitcnt lgkmcnt(0)
    v_exp_f32 v59, v59
    v_exp_f32 v60, v60
    v_exp_f32 v61, v61
    v_exp_f32 v62, v62
    v_exp_f32 v63, v63
    v_exp_f32 v32, v32
    v_exp_f32 v33, v33
    v_smfmac_f32_32x32x32_bf16 v[80:95], v[112:115], v[56:63], v2
    ds_read_b128 v[96:99], v3 offset:4160
    v_exp_f32 v34, v34
    v_exp_f32 v35, v35
    v_exp_f32 v36, v36
    v_mfma_f32_32x32x16_bf16 v[48:63], v[100:103], v[24:27], 0
    ds_read_b128 v[104:107], v4 offset:4160
    v_exp_f32 v37, v37
    v_exp_f32 v38, v38
    v_exp_f32 v39, v39
    v_exp_f32 v40, v40
    v_exp_f32 v41, v41
    v_exp_f32 v42, v42
    v_smfmac_f32_32x32x32_bf16 v[64:79], v[108:111], v[32:39], v2
    ds_read_b128 v[112:115], v5 offset:4160
    s_add_u32 s77, s88, 0
    v_exp_f32 v43, v43
    v_exp_f32 v44, v44
    v_exp_f32 v45, v45
    v_exp_f32 v46, v46
    v_exp_f32 v47, v47
    v_exp_f32 v48, v48
    v_exp_f32 v49, v49
    v_smfmac_f32_32x32x32_bf16 v[64:79], v[116:119], v[40:47], v2
    s_waitcnt lgkmcnt(2)
    buffer_store_dwordx4 a[244:247], v1, s[4:7], s77 offen offset:0 sc1
    v_exp_f32 v50, v50
    v_exp_f32 v51, v51
    v_exp_f32 v52, v52
    v_mfma_f32_32x32x16_bf16 v[32:47], v[96:99], v[20:23], 0
    buffer_store_dwordx4 a[244:247], v1, s[4:7], s77 offen offset:1024 sc1
    v_exp_f32 v53, v53
    v_exp_f32 v54, v54
    v_exp_f32 v55, v55
    v_exp_f32 v56, v56
    v_exp_f32 v57, v57
    v_exp_f32 v58, v58
    v_smfmac_f32_32x32x32_bf16 v[80:95], v[108:111], v[48:55], v2
    s_waitcnt lgkmcnt(0)
    v_exp_f32 v59, v59
    v_exp_f32 v60, v60
    v_exp_f32 v61, v61
    v_exp_f32 v62, v62
    v_exp_f32 v63, v63
    v_exp_f32 v32, v32
    v_exp_f32 v33, v33
    v_smfmac_f32_32x32x32_bf16 v[80:95], v[116:119], v[56:63], v2
    ds_read_b128 v[100:103], v3 offset:6240
    v_exp_f32 v34, v34
    v_exp_f32 v35, v35
    v_exp_f32 v36, v36
    v_mfma_f32_32x32x16_bf16 v[48:63], v[96:99], v[24:27], 0
    ds_read_b128 v[108:111], v4 offset:6240
    s_waitcnt vmcnt(2)
    v_cmp_ne_u32 vcc, s30, v161
    v_exp_f32 v37, v37
    v_exp_f32 v38, v38
    v_exp_f32 v39, v39
    v_exp_f32 v40, v40
    v_exp_f32 v41, v41
    v_exp_f32 v42, v42
    v_smfmac_f32_32x32x32_bf16 v[64:79], v[104:107], v[32:39], v2
    ds_read_b128 v[116:119], v5 offset:6240
    s_cmp_lg_u64 vcc, 0
    s_cselect_b32 s31, 1, 0
    v_exp_f32 v43, v43
    v_exp_f32 v44, v44
    v_exp_f32 v45, v45
    v_exp_f32 v46, v46
    v_exp_f32 v47, v47
    v_exp_f32 v48, v48
    v_exp_f32 v49, v49
    v_smfmac_f32_32x32x32_bf16 v[64:79], v[112:115], v[40:47], v2
    s_waitcnt lgkmcnt(2)
    v_exp_f32 v50, v50
    v_exp_f32 v51, v51
    v_exp_f32 v52, v52
    v_mfma_f32_32x32x16_bf16 v[32:47], v[100:103], v[20:23], 0
    s_add_u32 m0, s85, 0
    v_exp_f32 v53, v53
    v_exp_f32 v54, v54
    v_exp_f32 v55, v55
    v_exp_f32 v56, v56
    v_exp_f32 v57, v57
    v_exp_f32 v58, v58
    v_smfmac_f32_32x32x32_bf16 v[80:95], v[104:107], v[48:55], v2
    s_waitcnt vmcnt(3) lgkmcnt(0)
    s_barrier
    buffer_load_dwordx4 v126, s[4:7], s84 offen offset:0 sc1 lds
    v_exp_f32 v59, v59
    v_exp_f32 v60, v60
    v_exp_f32 v61, v61
    v_exp_f32 v62, v62
    v_exp_f32 v63, v63
    v_exp_f32 v32, v32
    v_exp_f32 v33, v33
    v_smfmac_f32_32x32x32_bf16 v[80:95], v[112:115], v[56:63], v2
    ds_read_b128 v[96:99], v3 offset:37760
    v_exp_f32 v34, v34
    v_exp_f32 v35, v35
    v_exp_f32 v36, v36
    v_mfma_f32_32x32x16_bf16 v[48:63], v[100:103], v[24:27], 0
    ds_read_b128 v[104:107], v4 offset:37760
    v_exp_f32 v37, v37
    v_exp_f32 v38, v38
    v_exp_f32 v39, v39
    v_exp_f32 v40, v40
    v_exp_f32 v41, v41
    v_exp_f32 v42, v42
    v_smfmac_f32_32x32x32_bf16 v[64:79], v[108:111], v[32:39], v2
    ds_read_b128 v[112:115], v5 offset:37760
    v_exp_f32 v43, v43
    v_exp_f32 v44, v44
    v_exp_f32 v45, v45
    v_exp_f32 v46, v46
    v_exp_f32 v47, v47
    v_exp_f32 v48, v48
    v_exp_f32 v49, v49
    v_smfmac_f32_32x32x32_bf16 v[64:79], v[116:119], v[40:47], v2
    s_waitcnt lgkmcnt(2)
    buffer_load_dwordx4 v126, s[4:7], s84 offen offset:1024 sc1 lds
    s_add_u32 m0, s85, 32
    v_exp_f32 v50, v50
    v_exp_f32 v51, v51
    v_exp_f32 v52, v52
    v_mfma_f32_32x32x16_bf16 v[32:47], v[96:99], v[20:23], 0
    buffer_load_dwordx4 v126, s[4:7], s84 offen offset:2048 sc1 lds
    v_exp_f32 v53, v53
    v_exp_f32 v54, v54
    v_exp_f32 v55, v55
    v_exp_f32 v56, v56
    v_exp_f32 v57, v57
    v_exp_f32 v58, v58
    v_smfmac_f32_32x32x32_bf16 v[80:95], v[108:111], v[48:55], v2
    s_waitcnt lgkmcnt(0)
    buffer_load_dwordx4 v126, s[4:7], s84 offen offset:3072 sc1 lds
    v_exp_f32 v59, v59
    v_exp_f32 v60, v60
    v_exp_f32 v61, v61
    v_exp_f32 v62, v62
    v_exp_f32 v63, v63
    v_exp_f32 v32, v32
    v_exp_f32 v33, v33
    v_smfmac_f32_32x32x32_bf16 v[80:95], v[116:119], v[56:63], v2
    ds_read_b128 v[100:103], v3 offset:39840
    s_add_u32 s84, s84, 0x4000
    s_and_b32 s84, s84, 0x1ffff
    v_exp_f32 v34, v34
    v_exp_f32 v35, v35
    v_exp_f32 v36, v36
    v_mfma_f32_32x32x16_bf16 v[48:63], v[96:99], v[24:27], 0
    ds_read_b128 v[108:111], v4 offset:39840
    v_exp_f32 v37, v37
    v_exp_f32 v38, v38
    v_exp_f32 v39, v39
    v_exp_f32 v40, v40
    v_exp_f32 v41, v41
    v_exp_f32 v42, v42
    v_smfmac_f32_32x32x32_bf16 v[64:79], v[104:107], v[32:39], v2
    ds_read_b128 v[116:119], v5 offset:39840
    v_exp_f32 v43, v43
    v_exp_f32 v44, v44
    v_exp_f32 v45, v45
    v_exp_f32 v46, v46
    v_exp_f32 v47, v47
    v_exp_f32 v48, v48
    v_exp_f32 v49, v49
    v_smfmac_f32_32x32x32_bf16 v[64:79], v[112:115], v[40:47], v2
    s_waitcnt lgkmcnt(2)
    v_exp_f32 v50, v50
    v_exp_f32 v51, v51
    v_exp_f32 v52, v52
    v_mfma_f32_32x32x16_bf16 v[32:47], v[100:103], v[20:23], 0
    v_exp_f32 v53, v53
    v_exp_f32 v54, v54
    v_exp_f32 v55, v55
    v_exp_f32 v56, v56
    v_exp_f32 v57, v57
    v_exp_f32 v58, v58
    v_smfmac_f32_32x32x32_bf16 v[80:95], v[104:107], v[48:55], v2
    s_waitcnt lgkmcnt(0)
    v_exp_f32 v59, v59
    v_exp_f32 v60, v60
    v_exp_f32 v61, v61
    v_exp_f32 v62, v62
    v_exp_f32 v63, v63
    v_exp_f32 v32, v32
    v_exp_f32 v33, v33
    v_smfmac_f32_32x32x32_bf16 v[80:95], v[112:115], v[56:63], v2
    ds_read_b128 v[96:99], v3 offset:41920
    v_exp_f32 v34, v34
    v_exp_f32 v35, v35
    v_exp_f32 v36, v36
    v_mfma_f32_32x32x16_bf16 v[48:63], v[100:103], v[24:27], 0
    ds_read_b128 v[104:107], v4 offset:41920
    v_exp_f32 v37, v37
    v_exp_f32 v38, v38
    v_exp_f32 v39, v39
    v_exp_f32 v40, v40
    v_exp_f32 v41, v41
    v_exp_f32 v42, v42
    v_smfmac_f32_32x32x32_bf16 v[64:79], v[108:111], v[32:39], v2
    ds_read_b128 v[112:115], v5 offset:41920
    v_exp_f32 v43, v43
    v_exp_f32 v44, v44
    v_exp_f32 v45, v45
    v_exp_f32 v46, v46
    v_exp_f32 v47, v47
    v_exp_f32 v48, v48
    v_exp_f32 v49, v49
    v_smfmac_f32_32x32x32_bf16 v[64:79], v[116:119], v[40:47], v2
    s_waitcnt lgkmcnt(2)
    v_exp_f32 v50, v50
    v_exp_f32 v51, v51
    v_exp_f32 v52, v52
    v_mfma_f32_32x32x16_bf16 v[32:47], v[96:99], v[20:23], 0
    v_exp_f32 v53, v53
    v_exp_f32 v54, v54
    v_exp_f32 v55, v55
    v_exp_f32 v56, v56
    v_exp_f32 v57, v57
    v_exp_f32 v58, v58
    v_smfmac_f32_32x32x32_bf16 v[80:95], v[108:111], v[48:55], v2
    s_waitcnt lgkmcnt(0)
    v_exp_f32 v59, v59
    v_exp_f32 v60, v60
    v_exp_f32 v61, v61
    v_exp_f32 v62, v62
    v_exp_f32 v63, v63
    v_exp_f32 v32, v32
    v_exp_f32 v33, v33
    v_smfmac_f32_32x32x32_bf16 v[80:95], v[116:119], v[56:63], v2
    ds_read_b128 v[100:103], v3 offset:44000
    v_exp_f32 v34, v34
    v_exp_f32 v35, v35
    v_exp_f32 v36, v36
    v_mfma_f32_32x32x16_bf16 v[48:63], v[96:99], v[24:27], 0
    ds_read_b128 v[108:111], v4 offset:44000
    v_exp_f32 v37, v37
    v_exp_f32 v38, v38
    v_exp_f32 v39, v39
    v_exp_f32 v40, v40
    v_exp_f32 v41, v41
    v_exp_f32 v42, v42
    v_smfmac_f32_32x32x32_bf16 v[64:79], v[104:107], v[32:39], v2
    ds_read_b128 v[116:119], v5 offset:44000
    v_exp_f32 v43, v43
    v_exp_f32 v44, v44
    v_exp_f32 v45, v45
    v_exp_f32 v46, v46
    v_exp_f32 v47, v47
    v_exp_f32 v48, v48
    v_exp_f32 v49, v49
    v_smfmac_f32_32x32x32_bf16 v[64:79], v[112:115], v[40:47], v2
    s_waitcnt lgkmcnt(2)
    v_exp_f32 v50, v50
    v_exp_f32 v51, v51
    v_exp_f32 v52, v52
    v_mfma_f32_32x32x16_bf16 v[32:47], v[100:103], v[20:23], 0
    v_exp_f32 v53, v53
    v_exp_f32 v54, v54
    v_exp_f32 v55, v55
    v_exp_f32 v56, v56
    v_exp_f32 v57, v57
    v_exp_f32 v58, v58
    v_smfmac_f32_32x32x32_bf16 v[80:95], v[104:107], v[48:55], v2
    s_waitcnt lgkmcnt(0)
    v_exp_f32 v59, v59
    v_exp_f32 v60, v60
    v_exp_f32 v61, v61
    v_exp_f32 v62, v62
    v_exp_f32 v63, v63
    v_exp_f32 v32, v32
    v_exp_f32 v33, v33
    v_smfmac_f32_32x32x32_bf16 v[80:95], v[112:115], v[56:63], v2
    ds_read_b128 v[96:99], v3 offset:29440
    v_exp_f32 v34, v34
    v_exp_f32 v35, v35
    v_exp_f32 v36, v36
    v_mfma_f32_32x32x16_bf16 v[48:63], v[100:103], v[24:27], 0
    ds_read_b128 v[104:107], v4 offset:29440
    s_add_u32 s77, s88, 2048
    v_exp_f32 v37, v37
    v_exp_f32 v38, v38
    v_exp_f32 v39, v39
    v_exp_f32 v40, v40
    v_exp_f32 v41, v41
    v_exp_f32 v42, v42
    v_smfmac_f32_32x32x32_bf16 v[64:79], v[108:111], v[32:39], v2
    ds_read_b128 v[112:115], v5 offset:29440
    buffer_store_dwordx4 a[244:247], v1, s[4:7], s77 offen offset:0 sc1
    s_add_u32 s78, s66, 65536
    v_exp_f32 v43, v43
    v_exp_f32 v44, v44
    v_exp_f32 v45, v45
    v_exp_f32 v46, v46
    v_exp_f32 v47, v47
    v_exp_f32 v48, v48
    v_exp_f32 v49, v49
    v_smfmac_f32_32x32x32_bf16 v[64:79], v[116:119], v[40:47], v2
    s_waitcnt lgkmcnt(2)
    buffer_load_dword v160, v123, s[4:7], s78 offen sc1
    v_exp_f32 v50, v50
    v_exp_f32 v51, v51
    v_exp_f32 v52, v52
    v_mfma_f32_32x32x16_bf16 v[32:47], v[96:99], v[20:23], 0
    buffer_store_dwordx4 a[244:247], v1, s[4:7], s77 offen offset:1024 sc1
    v_exp_f32 v53, v53
    v_exp_f32 v54, v54
    v_exp_f32 v55, v55
    v_exp_f32 v56, v56
    v_exp_f32 v57, v57
    v_exp_f32 v58, v58
    v_smfmac_f32_32x32x32_bf16 v[80:95], v[108:111], v[48:55], v2
    s_waitcnt lgkmcnt(0)
    v_exp_f32 v59, v59
    v_exp_f32 v60, v60
    v_exp_f32 v61, v61
    v_exp_f32 v62, v62
    v_exp_f32 v63, v63
    v_exp_f32 v32, v32
    v_exp_f32 v33, v33
    v_smfmac_f32_32x32x32_bf16 v[80:95], v[116:119], v[56:63], v2
    ds_read_b128 v[100:103], v3 offset:31520
    v_exp_f32 v34, v34
    v_exp_f32 v35, v35
    v_exp_f32 v36, v36
    v_mfma_f32_32x32x16_bf16 v[48:63], v[96:99], v[24:27], 0
    ds_read_b128 v[108:111], v4 offset:31520
    v_exp_f32 v37, v37
    v_exp_f32 v38, v38
    v_exp_f32 v39, v39
    v_exp_f32 v40, v40
    v_exp_f32 v41, v41
    v_exp_f32 v42, v42
    v_smfmac_f32_32x32x32_bf16 v[64:79], v[104:107], v[32:39], v2
    ds_read_b128 v[116:119], v5 offset:31520
    v_exp_f32 v43, v43
    v_exp_f32 v44, v44
    v_exp_f32 v45, v45
    v_exp_f32 v46, v46
    v_exp_f32 v47, v47
    v_exp_f32 v48, v48
    v_exp_f32 v49, v49
    v_smfmac_f32_32x32x32_bf16 v[64:79], v[112:115], v[40:47], v2
    s_waitcnt lgkmcnt(2)
    v_exp_f32 v50, v50
    v_exp_f32 v51, v51
    v_exp_f32 v52, v52
    v_mfma_f32_32x32x16_bf16 v[32:47], v[100:103], v[20:23], 0
    v_exp_f32 v53, v53
    v_exp_f32 v54, v54
    v_exp_f32 v55, v55
    v_exp_f32 v56, v56
    v_exp_f32 v57, v57
    v_exp_f32 v58, v58
    v_smfmac_f32_32x32x32_bf16 v[80:95], v[104:107], v[48:55], v2
    s_waitcnt lgkmcnt(0)
    v_exp_f32 v59, v59
    v_exp_f32 v60, v60
    v_exp_f32 v61, v61
    v_exp_f32 v62, v62
    v_exp_f32 v63, v63
    v_exp_f32 v32, v32
    v_exp_f32 v33, v33
    v_smfmac_f32_32x32x32_bf16 v[80:95], v[112:115], v[56:63], v2
    ds_read_b128 v[96:99], v3 offset:33600
    v_exp_f32 v34, v34
    v_exp_f32 v35, v35
    v_exp_f32 v36, v36
    v_mfma_f32_32x32x16_bf16 v[48:63], v[100:103], v[24:27], 0
    ds_read_b128 v[104:107], v4 offset:33600
    v_exp_f32 v37, v37
    v_exp_f32 v38, v38
    v_exp_f32 v39, v39
    v_exp_f32 v40, v40
    v_exp_f32 v41, v41
    v_exp_f32 v42, v42
    v_smfmac_f32_32x32x32_bf16 v[64:79], v[108:111], v[32:39], v2
    ds_read_b128 v[112:115], v5 offset:33600
    v_exp_f32 v43, v43
    v_exp_f32 v44, v44
    v_exp_f32 v45, v45
    v_exp_f32 v46, v46
    v_exp_f32 v47, v47
    v_exp_f32 v48, v48
    v_exp_f32 v49, v49
    v_smfmac_f32_32x32x32_bf16 v[64:79], v[116:119], v[40:47], v2
    s_waitcnt lgkmcnt(2)
    v_exp_f32 v50, v50
    v_exp_f32 v51, v51
    v_exp_f32 v52, v52
    v_mfma_f32_32x32x16_bf16 v[32:47], v[96:99], v[20:23], 0
    s_waitcnt vmcnt(1)
    v_sad_u32 v160, v160, s28, 0
    v_cmp_lt_u32 vcc, 0, v160
    v_exp_f32 v53, v53
    v_exp_f32 v54, v54
    v_exp_f32 v55, v55
    v_exp_f32 v56, v56
    v_exp_f32 v57, v57
    v_exp_f32 v58, v58
    v_smfmac_f32_32x32x32_bf16 v[80:95], v[108:111], v[48:55], v2
    s_waitcnt lgkmcnt(0)
    s_cbranch_vccnz RT_16
BK_17:
    v_exp_f32 v59, v59
    v_exp_f32 v60, v60
    v_exp_f32 v61, v61
    v_exp_f32 v62, v62
    v_exp_f32 v63, v63
    v_exp_f32 v32, v32
    v_exp_f32 v33, v33
    v_smfmac_f32_32x32x32_bf16 v[80:95], v[116:119], v[56:63], v2
    ds_read_b128 v[100:103], v3 offset:35680
    v_exp_f32 v34, v34
    v_exp_f32 v35, v35
    v_exp_f32 v36, v36
    v_mfma_f32_32x32x16_bf16 v[48:63], v[96:99], v[24:27], 0
    ds_read_b128 v[108:111], v4 offset:35680
    v_exp_f32 v37, v37
    v_exp_f32 v38, v38
    v_exp_f32 v39, v39
    v_exp_f32 v40, v40
    v_exp_f32 v41, v41
    v_exp_f32 v42, v42
    v_smfmac_f32_32x32x32_bf16 v[64:79], v[104:107], v[32:39], v2
    ds_read_b128 v[116:119], v5 offset:35680
    v_exp_f32 v43, v43
    v_exp_f32 v44, v44
    v_exp_f32 v45, v45
    v_exp_f32 v46, v46
    v_exp_f32 v47, v47
    v_exp_f32 v48, v48
    v_exp_f32 v49, v49
    v_smfmac_f32_32x32x32_bf16 v[64:79], v[112:115], v[40:47], v2
    s_waitcnt lgkmcnt(2)
    v_exp_f32 v50, v50
    v_exp_f32 v51, v51
    v_exp_f32 v52, v52
    v_mfma_f32_32x32x16_bf16 v[32:47], v[100:103], v[20:23], 0
    s_add_u32 m0, s85, 29440
    v_exp_f32 v53, v53
    v_exp_f32 v54, v54
    v_exp_f32 v55, v55
    v_exp_f32 v56, v56
    v_exp_f32 v57, v57
    v_exp_f32 v58, v58
    v_smfmac_f32_32x32x32_bf16 v[80:95], v[104:107], v[48:55], v2
    s_waitcnt vmcnt(3) lgkmcnt(0)
    s_barrier
    buffer_load_dwordx4 v126, s[4:7], s84 offen offset:0 sc1 lds
    v_exp_f32 v59, v59
    v_exp_f32 v60, v60
    v_exp_f32 v61, v61
    v_exp_f32 v62, v62
    v_exp_f32 v63, v63
    v_exp_f32 v32, v32
    v_exp_f32 v33, v33
    v_smfmac_f32_32x32x32_bf16 v[80:95], v[112:115], v[56:63], v2
    ds_read_b128 v[96:99], v3 offset:8320
    v_exp_f32 v34, v34
    v_exp_f32 v35, v35
    v_exp_f32 v36, v36
    v_mfma_f32_32x32x16_bf16 v[48:63], v[100:103], v[24:27], 0
    ds_read_b128 v[104:107], v4 offset:8320
    v_exp_f32 v37, v37
    v_exp_f32 v38, v38
    v_exp_f32 v39, v39
    v_exp_f32 v40, v40
    v_exp_f32 v41, v41
    v_exp_f32 v42, v42
    v_smfmac_f32_32x32x32_bf16 v[64:79], v[108:111], v[32:39], v2
    ds_read_b128 v[112:115], v5 offset:8320
    v_exp_f32 v43, v43
    v_exp_f32 v44, v44
    v_exp_f32 v45, v45
    v_exp_f32 v46, v46
    v_exp_f32 v47, v47
    v_exp_f32 v48, v48
    v_exp_f32 v49, v49
    v_smfmac_f32_32x32x32_bf16 v[64:79], v[116:119], v[40:47], v2
    s_waitcnt lgkmcnt(2)
    buffer_load_dwordx4 v126, s[4:7], s84 offen offset:1024 sc1 lds
    s_add_u32 m0, s85, 29472
    v_exp_f32 v50, v50
    v_exp_f32 v51, v51
    v_exp_f32 v52, v52
    v_mfma_f32_32x32x16_bf16 v[32:47], v[96:99], v[20:23], 0
    buffer_load_dwordx4 v126, s[4:7], s84 offen offset:2048 sc1 lds
    v_exp_f32 v53, v53
    v_exp_f32 v54, v54
    v_exp_f32 v55, v55
    v_exp_f32 v56, v56
    v_exp_f32 v57, v57
    v_exp_f32 v58, v58
    v_smfmac_f32_32x32x32_bf16 v[80:95], v[108:111], v[48:55], v2
    s_waitcnt lgkmcnt(0)
    buffer_load_dwordx4 v126, s[4:7], s84 offen offset:3072 sc1 lds
    v_exp_f32 v59, v59
    v_exp_f32 v60, v60
    v_exp_f32 v61, v61
    v_exp_f32 v62, v62
    v_exp_f32 v63, v63
    v_exp_f32 v32, v32
    v_exp_f32 v33, v33
    v_smfmac_f32_32x32x32_bf16 v[80:95], v[116:119], v[56:63], v2
    ds_read_b128 v[100:103], v3 offset:10400
    s_add_u32 s84, s84, 0x4000
    s_and_b32 s84, s84, 0x1ffff
    v_exp_f32 v34, v34
    v_exp_f32 v35, v35
    v_exp_f32 v36, v36
    v_mfma_f32_32x32x16_bf16 v[48:63], v[96:99], v[24:27], 0
    ds_read_b128 v[108:111], v4 offset:10400
    v_exp_f32 v37, v37
    v_exp_f32 v38, v38
    v_exp_f32 v39, v39
    v_exp_f32 v40, v40
    v_exp_f32 v41, v41
    v_exp_f32 v42, v42
    v_smfmac_f32_32x32x32_bf16 v[64:79], v[104:107], v[32:39], v2
    ds_read_b128 v[116:119], v5 offset:10400
    buffer_load_dwordx4 a[0:3], v124, s[4:7], s81 offen offset:0 sc1
    s_add_u32 s77, s88, 4096
    v_exp_f32 v43, v43
    v_exp_f32 v44, v44
    v_exp_f32 v45, v45
    v_exp_f32 v46, v46
    v_exp_f32 v47, v47
    v_exp_f32 v48, v48
    v_exp_f32 v49, v49
    v_smfmac_f32_32x32x32_bf16 v[64:79], v[112:115], v[40:47], v2
    s_waitcnt lgkmcnt(2)
    buffer_store_dwordx4 a[244:247], v1, s[4:7], s77 offen offset:0 sc1
    v_exp_f32 v50, v50
    v_exp_f32 v51, v51
    v_exp_f32 v52, v52
    v_mfma_f32_32x32x16_bf16 v[32:47], v[100:103], v[20:23], 0
    buffer_store_dwordx4 a[244:247], v1, s[4:7], s77 offen offset:1024 sc1
    s_xor_b32 s75, s83, 0
    v_exp_f32 v53, v53
    v_exp_f32 v54, v54
    v_exp_f32 v55, v55
    v_exp_f32 v56, v56
    v_exp_f32 v57, v57
    v_exp_f32 v58, v58
    v_smfmac_f32_32x32x32_bf16 v[80:95], v[104:107], v[48:55], v2
    s_waitcnt lgkmcnt(0)
    buffer_load_dwordx4 v[128:131], v1, s[4:7], s75 offen offset:0 sc1
    v_exp_f32 v59, v59
    v_exp_f32 v60, v60
    v_exp_f32 v61, v61
    v_exp_f32 v62, v62
    v_exp_f32 v63, v63
    v_exp_f32 v32, v32
    v_exp_f32 v33, v33
    v_smfmac_f32_32x32x32_bf16 v[80:95], v[112:115], v[56:63], v2
    ds_read_b128 v[96:99], v3 offset:12480
    v_exp_f32 v34, v34
    v_exp_f32 v35, v35
    v_exp_f32 v36, v36
    v_mfma_f32_32x32x16_bf16 v[48:63], v[100:103], v[24:27], 0
    ds_read_b128 v[104:107], v4 offset:12480
    s_mov_b32 m0, s86
    v_exp_f32 v37, v37
    v_exp_f32 v38, v38
    v_exp_f32 v39, v39
    v_exp_f32 v40, v40
    v_exp_f32 v41, v41
    v_exp_f32 v42, v42
    v_smfmac_f32_32x32x32_bf16 v[64:79], v[108:111], v[32:39], v2
    ds_read_b128 v[112:115], v5 offset:12480
    buffer_load_dwordx4 v1, s[4:7], s80 offen offset:0 sc1 lds
    v_exp_f32 v43, v43
    v_exp_f32 v44, v44
    v_exp_f32 v45, v45
    v_exp_f32 v46, v46
    v_exp_f32 v47, v47
    v_exp_f32 v48, v48
    v_exp_f32 v49, v49
    v_smfmac_f32_32x32x32_bf16 v[64:79], v[116:119], v[40:47], v2
    s_waitcnt lgkmcnt(2)
    buffer_load_dwordx4 a[8:11], v124, s[4:7], s81 offen offset:1024 sc1
    v_exp_f32 v50, v50
    v_exp_f32 v51, v51
    v_exp_f32 v52, v52
    v_mfma_f32_32x32x16_bf16 v[32:47], v[96:99], v[20:23], 0
    buffer_load_dwordx4 v[132:135], v1, s[4:7], s75 offen offset:1024 sc1
    v_exp_f32 v53, v53
    v_exp_f32 v54, v54
    v_exp_f32 v55, v55
    v_exp_f32 v56, v56
    v_exp_f32 v57, v57
    v_exp_f32 v58, v58
    v_smfmac_f32_32x32x32_bf16 v[80:95], v[108:111], v[48:55], v2
    s_waitcnt lgkmcnt(0)
    buffer_load_dwordx4 a[16:19], v124, s[4:7], s81 offen offset:2048 sc1
    v_exp_f32 v59, v59
    v_exp_f32 v60, v60
    v_exp_f32 v61, v61
    v_exp_f32 v62, v62
    v_exp_f32 v63, v63
    v_exp_f32 v32, v32
    v_exp_f32 v33, v33
    v_smfmac_f32_32x32x32_bf16 v[80:95], v[116:119], v[56:63], v2
    ds_read_b128 v[100:103], v3 offset:14560
    v_exp_f32 v34, v34
    v_exp_f32 v35, v35
    v_exp_f32 v36, v36
    v_mfma_f32_32x32x16_bf16 v[48:63], v[96:99], v[24:27], 0
    ds_read_b128 v[108:111], v4 offset:14560
    v_exp_f32 v37, v37
    v_exp_f32 v38, v38
    v_exp_f32 v39, v39
    v_exp_f32 v40, v40
    v_exp_f32 v41, v41
    v_exp_f32 v42, v42
    v_smfmac_f32_32x32x32_bf16 v[64:79], v[104:107], v[32:39], v2
    ds_read_b128 v[116:119], v5 offset:14560
    buffer_load_dwordx4 v1, s[4:7], s80 offen offset:1024 sc1 lds
    v_exp_f32 v43, v43
    v_exp_f32 v44, v44
    v_exp_f32 v45, v45
    v_exp_f32 v46, v46
    v_exp_f32 v47, v47
    v_exp_f32 v48, v48
    v_exp_f32 v49, v49
    v_smfmac_f32_32x32x32_bf16 v[64:79], v[112:115], v[40:47], v2
    s_waitcnt lgkmcnt(2)
    buffer_load_dwordx4 a[24:27], v124, s[4:7], s81 offen offset:3072 sc1
    v_exp_f32 v50, v50
    v_exp_f32 v51, v51
    v_exp_f32 v52, v52
    v_mfma_f32_32x32x16_bf16 v[32:47], v[100:103], v[20:23], 0
    buffer_load_dwordx4 v[136:139], v1, s[4:7], s75 offen offset:2048 sc1
    s_add_u32 s81, s81, 4096
    v_exp_f32 v53, v53
    v_exp_f32 v54, v54
    v_exp_f32 v55, v55
    v_exp_f32 v56, v56
    v_exp_f32 v57, v57
    v_exp_f32 v58, v58
    v_smfmac_f32_32x32x32_bf16 v[80:95], v[104:107], v[48:55], v2
    s_waitcnt lgkmcnt(0)
    buffer_load_dwordx4 a[32:35], v124, s[4:7], s81 offen offset:0 sc1
    v_exp_f32 v59, v59
    v_exp_f32 v60, v60
    v_exp_f32 v61, v61
    v_exp_f32 v62, v62
    v_exp_f32 v63, v63
    v_exp_f32 v32, v32
    v_exp_f32 v33, v33
    v_smfmac_f32_32x32x32_bf16 v[80:95], v[112:115], v[56:63], v2
    ds_read_b128 v[96:99], v3 offset:0
    v_exp_f32 v34, v34
    v_exp_f32 v35, v35
    v_exp_f32 v36, v36
    v_mfma_f32_32x32x16_bf16 v[48:63], v[100:103], v[24:27], 0
    ds_read_b128 v[104:107], v4 offset:0
    v_exp_f32 v37, v37
    v_exp_f32 v38, v38
    v_exp_f32 v39, v39
    v_exp_f32 v40, v40
    v_exp_f32 v41, v41
    v_exp_f32 v42, v42
    v_smfmac_f32_32x32x32_bf16 v[64:79], v[108:111], v[32:39], v2
    ds_read_b128 v[112:115], v5 offset:0
    buffer_load_dwordx4 v1, s[4:7], s80 offen offset:2048 sc1 lds
    v_exp_f32 v43, v43
    v_exp_f32 v44, v44
    v_exp_f32 v45, v45
    v_exp_f32 v46, v46
    v_exp_f32 v47, v47
    v_exp_f32 v48, v48
    v_exp_f32 v49, v49
    v_smfmac_f32_32x32x32_bf16 v[64:79], v[116:119], v[40:47], v2
    s_waitcnt lgkmcnt(2)
    buffer_load_dwordx4 v[140:143], v1, s[4:7], s75 offen offset:3072 sc1
    v_exp_f32 v50, v50
    v_exp_f32 v51, v51
    v_exp_f32 v52, v52
    v_mfma_f32_32x32x16_bf16 v[32:47], v[96:99], v[20:23], 0
    buffer_load_dwordx4 a[40:43], v124, s[4:7], s81 offen offset:1024 sc1
    v_exp_f32 v53, v53
    v_exp_f32 v54, v54
    v_exp_f32 v55, v55
    v_exp_f32 v56, v56
    v_exp_f32 v57, v57
    v_exp_f32 v58, v58
    v_smfmac_f32_32x32x32_bf16 v[80:95], v[108:111], v[48:55], v2
    s_waitcnt lgkmcnt(0)
    buffer_load_dwordx4 a[48:51], v124, s[4:7], s81 offen offset:2048 sc1
    v_exp_f32 v59, v59
    v_exp_f32 v60, v60
    v_exp_f32 v61, v61
    v_exp_f32 v62, v62
    v_exp_f32 v63, v63
    v_exp_f32 v32, v32
    v_exp_f32 v33, v33
    v_smfmac_f32_32x32x32_bf16 v[80:95], v[116:119], v[56:63], v2
    ds_read_b128 v[100:103], v3 offset:2080
    v_exp_f32 v34, v34
    v_exp_f32 v35, v35
    v_exp_f32 v36, v36
    v_mfma_f32_32x32x16_bf16 v[48:63], v[96:99], v[24:27], 0
    ds_read_b128 v[108:111], v4 offset:2080
    s_xor_b32 s75, s83, 4096
    v_exp_f32 v37, v37
    v_exp_f32 v38, v38
    v_exp_f32 v39, v39
    v_exp_f32 v40, v40
    v_exp_f32 v41, v41
    v_exp_f32 v42, v42
    v_smfmac_f32_32x32x32_bf16 v[64:79], v[104:107], v[32:39], v2
    ds_read_b128 v[116:119], v5 offset:2080
    buffer_load_dwordx4 v[144:147], v1, s[4:7], s75 offen offset:0 sc1
    v_exp_f32 v43, v43
    v_exp_f32 v44, v44
    v_exp_f32 v45, v45
    v_exp_f32 v46, v46
    v_exp_f32 v47, v47
    v_exp_f32 v48, v48
    v_exp_f32 v49, v49
    v_smfmac_f32_32x32x32_bf16 v[64:79], v[112:115], v[40:47], v2
    s_waitcnt lgkmcnt(2)
    buffer_load_dwordx4 v1, s[4:7], s80 offen offset:3072 sc1 lds
    v_exp_f32 v50, v50
    v_exp_f32 v51, v51
    v_exp_f32 v52, v52
    v_mfma_f32_32x32x16_bf16 v[32:47], v[100:103], v[20:23], 0
    buffer_load_dwordx4 a[56:59], v124, s[4:7], s81 offen offset:3072 sc1
    v_exp_f32 v53, v53
    v_exp_f32 v54, v54
    v_exp_f32 v55, v55
    v_exp_f32 v56, v56
    v_exp_f32 v57, v57
    v_exp_f32 v58, v58
    v_smfmac_f32_32x32x32_bf16 v[80:95], v[104:107], v[48:55], v2
    s_waitcnt lgkmcnt(0)
    buffer_load_dwordx4 v[148:151], v1, s[4:7], s75 offen offset:1024 sc1
    v_exp_f32 v59, v59
    v_exp_f32 v60, v60
    v_exp_f32 v61, v61
    v_exp_f32 v62, v62
    v_exp_f32 v63, v63
    v_exp_f32 v32, v32
    v_exp_f32 v33, v33
    v_smfmac_f32_32x32x32_bf16 v[80:95], v[112:115], v[56:63], v2
    ds_read_b128 v[96:99], v3 offset:4160
    v_exp_f32 v34, v34
    v_exp_f32 v35, v35
    v_exp_f32 v36, v36
    v_mfma_f32_32x32x16_bf16 v[48:63], v[100:103], v[24:27], 0
    ds_read_b128 v[104:107], v4 offset:4160
    s_add_u32 s81, s81, 4096
    v_exp_f32 v37, v37
    v_exp_f32 v38, v38
    v_exp_f32 v39, v39
    v_exp_f32 v40, v40
    v_exp_f32 v41, v41
    v_exp_f32 v42, v42
    v_smfmac_f32_32x32x32_bf16 v[64:79], v[108:111], v[32:39], v2
    ds_read_b128 v[112:115], v5 offset:4160
    buffer_load_dwordx4 a[64:67], v124, s[4:7], s81 offen offset:0 sc1
    s_add_u32 s80, s80, 4096
TCH2:
    s_cbranch_execz TCH6
    s_add_u32 s86, s86, 4096
    s_mov_b32 m0, s86
    v_exp_f32 v43, v43
    v_exp_f32 v44, v44
    v_exp_f32 v45, v45
    v_exp_f32 v46, v46
    v_exp_f32 v47, v47
    v_exp_f32 v48, v48
    v_exp_f32 v49, v49
    v_smfmac_f32_32x32x32_bf16 v[64:79], v[116:119], v[40:47], v2
    s_waitcnt lgkmcnt(2)
    buffer_load_dwordx4 v1, s[4:7], s80 offen offset:0 sc1 lds
    v_exp_f32 v50, v50
    v_exp_f32 v51, v51
    v_exp_f32 v52, v52
    v_mfma_f32_32x32x16_bf16 v[32:47], v[96:99], v[20:23], 0
    buffer_load_dwordx4 a[72:75], v124, s[4:7], s81 offen offset:1024 sc1
    v_exp_f32 v53, v53
    v_exp_f32 v54, v54
    v_exp_f32 v55, v55
    v_exp_f32 v56, v56
    v_exp_f32 v57, v57
    v_exp_f32 v58, v58
    v_smfmac_f32_32x32x32_bf16 v[80:95], v[108:111], v[48:55], v2
    s_waitcnt lgkmcnt(0)
    buffer_load_dwordx4 v[152:155], v1, s[4:7], s75 offen offset:2048 sc1
    v_exp_f32 v59, v59
    v_exp_f32 v60, v60
    v_exp_f32 v61, v61
    v_exp_f32 v62, v62
    v_exp_f32 v63, v63
    v_exp_f32 v32, v32
    v_exp_f32 v33, v33
    v_smfmac_f32_32x32x32_bf16 v[80:95], v[116:119], v[56:63], v2
    ds_read_b128 v[100:103], v3 offset:6240
    v_exp_f32 v34, v34
    v_exp_f32 v35, v35
    v_exp_f32 v36, v36
    v_mfma_f32_32x32x16_bf16 v[48:63], v[96:99], v[24:27], 0
    ds_read_b128 v[108:111], v4 offset:6240
    s_add_u32 s77, s88, 6144
    v_exp_f32 v37, v37
    v_exp_f32 v38, v38
    v_exp_f32 v39, v39
    v_exp_f32 v40, v40
    v_exp_f32 v41, v41
    v_exp_f32 v42, v42
    v_smfmac_f32_32x32x32_bf16 v[64:79], v[104:107], v[32:39], v2
    ds_read_b128 v[116:119], v5 offset:6240
    buffer_store_dwordx4 a[244:247], v1, s[4:7], s77 offen offset:0 sc1
    v_exp_f32 v43, v43
    v_exp_f32 v44, v44
    v_exp_f32 v45, v45
    v_exp_f32 v46, v46
    v_exp_f32 v47, v47
    v_exp_f32 v48, v48
    v_exp_f32 v49, v49
    v_smfmac_f32_32x32x32_bf16 v[64:79], v[112:115], v[40:47], v2
    s_waitcnt lgkmcnt(2)
    buffer_store_dwordx4 a[244:247], v1, s[4:7], s77 offen offset:1024 sc1
    v_exp_f32 v50, v50
    v_exp_f32 v51, v51
    v_exp_f32 v52, v52
    v_mfma_f32_32x32x16_bf16 v[32:47], v[100:103], v[20:23], 0
    buffer_load_dwordx4 a[80:83], v124, s[4:7], s81 offen offset:2048 sc1
    s_add_u32 m0, s85, 0
    v_exp_f32 v53, v53
    v_exp_f32 v54, v54
    v_exp_f32 v55, v55
    v_exp_f32 v56, v56
    v_exp_f32 v57, v57
    v_exp_f32 v58, v58
    v_smfmac_f32_32x32x32_bf16 v[80:95], v[104:107], v[48:55], v2
    s_waitcnt vmcnt(27) lgkmcnt(0)
    s_barrier
    buffer_load_dwordx4 v126, s[4:7], s84 offen offset:0 sc1 lds
    v_exp_f32 v59, v59
    v_exp_f32 v60, v60
    v_exp_f32 v61, v61
    v_exp_f32 v62, v62
    v_exp_f32 v63, v63
    v_exp_f32 v32, v32
    v_exp_f32 v33, v33
    v_smfmac_f32_32x32x32_bf16 v[80:95], v[112:115], v[56:63], v2
    ds_read_b128 v[96:99], v3 offset:37760
    v_exp_f32 v34, v34
    v_exp_f32 v35, v35
    v_exp_f32 v36, v36
    v_mfma_f32_32x32x16_bf16 v[48:63], v[100:103], v[24:27], 0
    ds_read_b128 v[104:107], v4 offset:37760
    s_mov_b32 m0, s86
    v_exp_f32 v37, v37
    v_exp_f32 v38, v38
    v_exp_f32 v39, v39
    v_exp_f32 v40, v40
    v_exp_f32 v41, v41
    v_exp_f32 v42, v42
    v_smfmac_f32_32x32x32_bf16 v[64:79], v[108:111], v[32:39], v2
    ds_read_b128 v[112:115], v5 offset:37760
    buffer_load_dwordx4 v1, s[4:7], s80 offen offset:1024 sc1 lds
    s_add_u32 m0, s85, 0
    v_exp_f32 v43, v43
    v_exp_f32 v44, v44
    v_exp_f32 v45, v45
    v_exp_f32 v46, v46
    v_exp_f32 v47, v47
    v_exp_f32 v48, v48
    v_exp_f32 v49, v49
    v_smfmac_f32_32x32x32_bf16 v[64:79], v[116:119], v[40:47], v2
    s_waitcnt lgkmcnt(2)
    buffer_load_dwordx4 v126, s[4:7], s84 offen offset:1024 sc1 lds
    s_add_u32 m0, s85, 32
    v_exp_f32 v50, v50
    v_exp_f32 v51, v51
    v_exp_f32 v52, v52
    v_mfma_f32_32x32x16_bf16 v[32:47], v[96:99], v[20:23], 0
    buffer_load_dwordx4 v126, s[4:7], s84 offen offset:2048 sc1 lds
    v_exp_f32 v53, v53
    v_exp_f32 v54, v54
    v_exp_f32 v55, v55
    v_exp_f32 v56, v56
    v_exp_f32 v57, v57
    v_exp_f32 v58, v58
    v_smfmac_f32_32x32x32_bf16 v[80:95], v[108:111], v[48:55], v2
    s_waitcnt lgkmcnt(0)
    buffer_load_dwordx4 v126, s[4:7], s84 offen offset:3072 sc1 lds
    v_exp_f32 v59, v59
    v_exp_f32 v60, v60
    v_exp_f32 v61, v61
    v_exp_f32 v62, v62
    v_exp_f32 v63, v63
    v_exp_f32 v32, v32
    v_exp_f32 v33, v33
    v_smfmac_f32_32x32x32_bf16 v[80:95], v[116:119], v[56:63], v2
    ds_read_b128 v[100:103], v3 offset:39840
    s_add_u32 s84, s84, 0x4000
    s_and_b32 s84, s84, 0x1ffff
    v_exp_f32 v34, v34
    v_exp_f32 v35, v35
    v_exp_f32 v36, v36
    v_mfma_f32_32x32x16_bf16 v[48:63], v[96:99], v[24:27], 0
    ds_read_b128 v[108:111], v4 offset:39840
    v_exp_f32 v37, v37
    v_exp_f32 v38, v38
    v_exp_f32 v39, v39
    v_exp_f32 v40, v40
    v_exp_f32 v41, v41
    v_exp_f32 v42, v42
    v_smfmac_f32_32x32x32_bf16 v[64:79], v[104:107], v[32:39], v2
    ds_read_b128 v[116:119], v5 offset:39840
    buffer_load_dwordx4 v[156:159], v1, s[4:7], s75 offen offset:3072 sc1
    v_exp_f32 v43, v43
    v_exp_f32 v44, v44
    v_exp_f32 v45, v45
    v_exp_f32 v46, v46
    v_exp_f32 v47, v47
    v_exp_f32 v48, v48
    v_exp_f32 v49, v49
    v_smfmac_f32_32x32x32_bf16 v[64:79], v[112:115], v[40:47], v2
    s_waitcnt lgkmcnt(2)
    buffer_load_dwordx4 a[88:91], v124, s[4:7], s81 offen offset:3072 sc1
    s_add_u32 s81, s81, 4096
    v_exp_f32 v50, v50
    v_exp_f32 v51, v51
    v_exp_f32 v52, v52
    v_mfma_f32_32x32x16_bf16 v[32:47], v[100:103], v[20:23], 0
    buffer_load_dwordx4 a[96:99], v124, s[4:7], s81 offen offset:0 sc1
    s_xor_b32 s75, s83, 8192
    v_exp_f32 v53, v53
    v_exp_f32 v54, v54
    v_exp_f32 v55, v55
    v_exp_f32 v56, v56
    v_exp_f32 v57, v57
    v_exp_f32 v58, v58
    v_smfmac_f32_32x32x32_bf16 v[80:95], v[104:107], v[48:55], v2
    s_waitcnt lgkmcnt(0)
    buffer_load_dwordx4 v[160:163], v1, s[4:7], s75 offen offset:0 sc1
    v_exp_f32 v59, v59
    v_exp_f32 v60, v60
    v_exp_f32 v61, v61
    v_exp_f32 v62, v62
    v_exp_f32 v63, v63
    v_exp_f32 v32, v32
    v_exp_f32 v33, v33
    v_smfmac_f32_32x32x32_bf16 v[80:95], v[112:115], v[56:63], v2
    ds_read_b128 v[96:99], v3 offset:41920
    v_exp_f32 v34, v34
    v_exp_f32 v35, v35
    v_exp_f32 v36, v36
    v_mfma_f32_32x32x16_bf16 v[48:63], v[100:103], v[24:27], 0
    ds_read_b128 v[104:107], v4 offset:41920
    s_mov_b32 m0, s86
    v_exp_f32 v37, v37
    v_exp_f32 v38, v38
    v_exp_f32 v39, v39
    v_exp_f32 v40, v40
    v_exp_f32 v41, v41
    v_exp_f32 v42, v42
    v_smfmac_f32_32x32x32_bf16 v[64:79], v[108:111], v[32:39], v2
    ds_read_b128 v[112:115], v5 offset:41920
    buffer_load_dwordx4 v1, s[4:7], s80 offen offset:2048 sc1 lds
    v_exp_f32 v43, v43
    v_exp_f32 v44, v44
    v_exp_f32 v45, v45
    v_exp_f32 v46, v46
    v_exp_f32 v47, v47
    v_exp_f32 v48, v48
    v_exp_f32 v49, v49
    v_smfmac_f32_32x32x32_bf16 v[64:79], v[116:119], v[40:47], v2
    s_waitcnt lgkmcnt(2)
    buffer_load_dwordx4 a[104:107], v124, s[4:7], s81 offen offset:1024 sc1
    v_exp_f32 v50, v50
    v_exp_f32 v51, v51
    v_exp_f32 v52, v52
    v_mfma_f32_32x32x16_bf16 v[32:47], v[96:99], v[20:23], 0
    buffer_load_dwordx4 v[164:167], v1, s[4:7], s75 offen offset:1024 sc1
    v_exp_f32 v53, v53
    v_exp_f32 v54, v54
    v_exp_f32 v55, v55
    v_exp_f32 v56, v56
    v_exp_f32 v57, v57
    v_exp_f32 v58, v58
    v_smfmac_f32_32x32x32_bf16 v[80:95], v[108:111], v[48:55], v2
    s_waitcnt lgkmcnt(0)
    buffer_load_dwordx4 a[112:115], v124, s[4:7], s81 offen offset:2048 sc1
    v_exp_f32 v59, v59
    v_exp_f32 v60, v60
    v_exp_f32 v61, v61
    v_exp_f32 v62, v62
    v_exp_f32 v63, v63
    v_exp_f32 v32, v32
    v_exp_f32 v33, v33
    v_smfmac_f32_32x32x32_bf16 v[80:95], v[116:119], v[56:63], v2
    ds_read_b128 v[100:103], v3 offset:44000
    v_exp_f32 v34, v34
    v_exp_f32 v35, v35
    v_exp_f32 v36, v36
    v_mfma_f32_32x32x16_bf16 v[48:63], v[96:99], v[24:27], 0
    ds_read_b128 v[108:111], v4 offset:44000
    v_exp_f32 v37, v37
    v_exp_f32 v38, v38
    v_exp_f32 v39, v39
    v_exp_f32 v40, v40
    v_exp_f32 v41, v41
    v_exp_f32 v42, v42
    v_smfmac_f32_32x32x32_bf16 v[64:79], v[104:107], v[32:39], v2
    ds_read_b128 v[116:119], v5 offset:44000
    buffer_load_dwordx4 v1, s[4:7], s80 offen offset:3072 sc1 lds
    v_exp_f32 v43, v43
    v_exp_f32 v44, v44
    v_exp_f32 v45, v45
    v_exp_f32 v46, v46
    v_exp_f32 v47, v47
    v_exp_f32 v48, v48
    v_exp_f32 v49, v49
    v_smfmac_f32_32x32x32_bf16 v[64:79], v[112:115], v[40:47], v2
    s_waitcnt lgkmcnt(2)
    buffer_load_dwordx4 a[120:123], v124, s[4:7], s81 offen offset:3072 sc1
    v_exp_f32 v50, v50
    v_exp_f32 v51, v51
    v_exp_f32 v52, v52
    v_mfma_f32_32x32x16_bf16 v[32:47], v[100:103], v[20:23], 0
    buffer_load_dwordx4 v[168:171], v1, s[4:7], s75 offen offset:2048 sc1
    s_add_u32 s81, s81, 4096
    v_exp_f32 v53, v53
    v_exp_f32 v54, v54
    v_exp_f32 v55, v55
    v_exp_f32 v56, v56
    v_exp_f32 v57, v57
    v_exp_f32 v58, v58
    v_smfmac_f32_32x32x32_bf16 v[80:95], v[104:107], v[48:55], v2
    s_waitcnt lgkmcnt(0)
    buffer_load_dwordx4 a[128:131], v124, s[4:7], s81 offen offset:0 sc1
    v_exp_f32 v59, v59
    v_exp_f32 v60, v60
    v_exp_f32 v61, v61
    v_exp_f32 v62, v62
    v_exp_f32 v63, v63
    v_exp_f32 v32, v32
    v_exp_f32 v33, v33
    v_smfmac_f32_32x32x32_bf16 v[80:95], v[112:115], v[56:63], v2
    ds_read_b128 v[96:99], v3 offset:29440
    v_exp_f32 v34, v34
    v_exp_f32 v35, v35
    v_exp_f32 v36, v36
    v_mfma_f32_32x32x16_bf16 v[48:63], v[100:103], v[24:27], 0
    ds_read_b128 v[104:107], v4 offset:29440
    s_add_u32 s80, s80, 4096
    s_add_u32 s86, s86, 4096
    s_mov_b32 m0, s86
    v_exp_f32 v37, v37
    v_exp_f32 v38, v38
    v_exp_f32 v39, v39
    v_exp_f32 v40, v40
    v_exp_f32 v41, v41
    v_exp_f32 v42, v42
    v_smfmac_f32_32x32x32_bf16 v[64:79], v[108:111], v[32:39], v2
    ds_read_b128 v[112:115], v5 offset:29440
    buffer_load_dwordx4 v1, s[4:7], s80 offen offset:0 sc1 lds
    s_add_u32 s77, s88, 8192
    v_exp_f32 v43, v43
    v_exp_f32 v44, v44
    v_exp_f32 v45, v45
    v_exp_f32 v46, v46
    v_exp_f32 v47, v47
    v_exp_f32 v48, v48
    v_exp_f32 v49, v49
    v_smfmac_f32_32x32x32_bf16 v[64:79], v[116:119], v[40:47], v2
    s_waitcnt lgkmcnt(2)
    buffer_store_dwordx4 a[244:247], v1, s[4:7], s77 offen offset:0 sc1
    v_exp_f32 v50, v50
    v_exp_f32 v51, v51
    v_exp_f32 v52, v52
    v_mfma_f32_32x32x16_bf16 v[32:47], v[96:99], v[20:23], 0
    buffer_store_dwordx4 a[244:247], v1, s[4:7], s77 offen offset:1024 sc1
    v_exp_f32 v53, v53
    v_exp_f32 v54, v54
    v_exp_f32 v55, v55
    v_exp_f32 v56, v56
    v_exp_f32 v57, v57
    v_exp_f32 v58, v58
    v_smfmac_f32_32x32x32_bf16 v[80:95], v[108:111], v[48:55], v2
    s_waitcnt lgkmcnt(0)
    buffer_load_dwordx4 v[172:175], v1, s[4:7], s75 offen offset:3072 sc1
    v_exp_f32 v59, v59
    v_exp_f32 v60, v60
    v_exp_f32 v61, v61
    v_exp_f32 v62, v62
    v_exp_f32 v63, v63
    v_exp_f32 v32, v32
    v_exp_f32 v33, v33
    v_smfmac_f32_32x32x32_bf16 v[80:95], v[116:119], v[56:63], v2
    ds_read_b128 v[100:103], v3 offset:31520
    v_exp_f32 v34, v34
    v_exp_f32 v35, v35
    v_exp_f32 v36, v36
    v_mfma_f32_32x32x16_bf16 v[48:63], v[96:99], v[24:27], 0
    ds_read_b128 v[108:111], v4 offset:31520
    v_exp_f32 v37, v37
    v_exp_f32 v38, v38
    v_exp_f32 v39, v39
    v_exp_f32 v40, v40
    v_exp_f32 v41, v41
    v_exp_f32 v42, v42
    v_smfmac_f32_32x32x32_bf16 v[64:79], v[104:107], v[32:39], v2
    ds_read_b128 v[116:119], v5 offset:31520
    buffer_load_dwordx4 a[136:139], v124, s[4:7], s81 offen offset:1024 sc1
    v_exp_f32 v43, v43
    v_exp_f32 v44, v44
    v_exp_f32 v45, v45
    v_exp_f32 v46, v46
    v_exp_f32 v47, v47
    v_exp_f32 v48, v48
    v_exp_f32 v49, v49
    v_smfmac_f32_32x32x32_bf16 v[64:79], v[112:115], v[40:47], v2
    s_waitcnt lgkmcnt(2)
    buffer_load_dwordx4 a[144:147], v124, s[4:7], s81 offen offset:2048 sc1
    s_xor_b32 s75, s83, 12288
    v_exp_f32 v50, v50
    v_exp_f32 v51, v51
    v_exp_f32 v52, v52
    v_mfma_f32_32x32x16_bf16 v[32:47], v[100:103], v[20:23], 0
    buffer_load_dwordx4 v[176:179], v1, s[4:7], s75 offen offset:0 sc1
    v_exp_f32 v53, v53
    v_exp_f32 v54, v54
    v_exp_f32 v55, v55
    v_exp_f32 v56, v56
    v_exp_f32 v57, v57
    v_exp_f32 v58, v58
    v_smfmac_f32_32x32x32_bf16 v[80:95], v[104:107], v[48:55], v2
    s_waitcnt lgkmcnt(0)
    buffer_load_dwordx4 v1, s[4:7], s80 offen offset:1024 sc1 lds
    v_exp_f32 v59, v59
    v_exp_f32 v60, v60
    v_exp_f32 v61, v61
    v_exp_f32 v62, v62
    v_exp_f32 v63, v63
    v_exp_f32 v32, v32
    v_exp_f32 v33, v33
    v_smfmac_f32_32x32x32_bf16 v[80:95], v[112:115], v[56:63], v2
    ds_read_b128 v[96:99], v3 offset:33600
    v_exp_f32 v34, v34
    v_exp_f32 v35, v35
    v_exp_f32 v36, v36
    v_mfma_f32_32x32x16_bf16 v[48:63], v[100:103], v[24:27], 0
    ds_read_b128 v[104:107], v4 offset:33600
    v_exp_f32 v37, v37
    v_exp_f32 v38, v38
    v_exp_f32 v39, v39
    v_exp_f32 v40, v40
    v_exp_f32 v41, v41
    v_exp_f32 v42, v42
    v_smfmac_f32_32x32x32_bf16 v[64:79], v[108:111], v[32:39], v2
    ds_read_b128 v[112:115], v5 offset:33600
    buffer_load_dwordx4 a[152:155], v124, s[4:7], s81 offen offset:3072 sc1
    v_exp_f32 v43, v43
    v_exp_f32 v44, v44
    v_exp_f32 v45, v45
    v_exp_f32 v46, v46
    v_exp_f32 v47, v47
    v_exp_f32 v48, v48
    v_exp_f32 v49, v49
    v_smfmac_f32_32x32x32_bf16 v[64:79], v[116:119], v[40:47], v2
    s_waitcnt lgkmcnt(2)
    buffer_load_dwordx4 v[180:183], v1, s[4:7], s75 offen offset:1024 sc1
    s_add_u32 s81, s81, 4096
    v_exp_f32 v50, v50
    v_exp_f32 v51, v51
    v_exp_f32 v52, v52
    v_mfma_f32_32x32x16_bf16 v[32:47], v[96:99], v[20:23], 0
    buffer_load_dwordx4 a[160:163], v124, s[4:7], s81 offen offset:0 sc1
    v_exp_f32 v53, v53
    v_exp_f32 v54, v54
    v_exp_f32 v55, v55
    v_exp_f32 v56, v56
    v_exp_f32 v57, v57
    v_exp_f32 v58, v58
    v_smfmac_f32_32x32x32_bf16 v[80:95], v[108:111], v[48:55], v2
    s_waitcnt lgkmcnt(0)
    buffer_load_dwordx4 v1, s[4:7], s80 offen offset:2048 sc1 lds
    v_exp_f32 v59, v59
    v_exp_f32 v60, v60
    v_exp_f32 v61, v61
    v_exp_f32 v62, v62
    v_exp_f32 v63, v63
    v_exp_f32 v32, v32
    v_exp_f32 v33, v33
    v_smfmac_f32_32x32x32_bf16 v[80:95], v[116:119], v[56:63], v2
    ds_read_b128 v[100:103], v3 offset:35680
    v_exp_f32 v34, v34
    v_exp_f32 v35, v35
    v_exp_f32 v36, v36
    v_mfma_f32_32x32x16_bf16 v[48:63], v[96:99], v[24:27], 0
    ds_read_b128 v[108:111], v4 offset:35680
    v_exp_f32 v37, v37
    v_exp_f32 v38, v38
    v_exp_f32 v39, v39
    v_exp_f32 v40, v40
    v_exp_f32 v41, v41
    v_exp_f32 v42, v42
    v_smfmac_f32_32x32x32_bf16 v[64:79], v[104:107], v[32:39], v2
    ds_read_b128 v[116:119], v5 offset:35680
    buffer_load_dwordx4 a[168:171], v124, s[4:7], s81 offen offset:1024 sc1
    v_exp_f32 v43, v43
    v_exp_f32 v44, v44
    v_exp_f32 v45, v45
    v_exp_f32 v46, v46
    v_exp_f32 v47, v47
    v_exp_f32 v48, v48
    v_exp_f32 v49, v49
    v_smfmac_f32_32x32x32_bf16 v[64:79], v[112:115], v[40:47], v2
    s_waitcnt lgkmcnt(2)
    buffer_load_dwordx4 v[184:187], v1, s[4:7], s75 offen offset:2048 sc1
    v_exp_f32 v50, v50
    v_exp_f32 v51, v51
    v_exp_f32 v52, v52
    v_mfma_f32_32x32x16_bf16 v[32:47], v[100:103], v[20:23], 0
    buffer_load_dwordx4 a[176:179], v124, s[4:7], s81 offen offset:2048 sc1
    s_add_u32 m0, s85, 29440
    v_exp_f32 v53, v53
    v_exp_f32 v54, v54
    v_exp_f32 v55, v55
    v_exp_f32 v56, v56
    v_exp_f32 v57, v57
    v_exp_f32 v58, v58
    v_smfmac_f32_32x32x32_bf16 v[80:95], v[104:107], v[48:55], v2
    s_waitcnt vmcnt(27) lgkmcnt(0)
    s_barrier
    buffer_load_dwordx4 v126, s[4:7], s84 offen offset:0 sc1 lds
    v_exp_f32 v59, v59
    v_exp_f32 v60, v60
    v_exp_f32 v61, v61
    v_exp_f32 v62, v62
    v_exp_f32 v63, v63
    v_exp_f32 v32, v32
    v_exp_f32 v33, v33
    v_smfmac_f32_32x32x32_bf16 v[80:95], v[112:115], v[56:63], v2
    ds_read_b128 v[96:99], v3 offset:8320
    v_exp_f32 v34, v34
    v_exp_f32 v35, v35
    v_exp_f32 v36, v36
    v_mfma_f32_32x32x16_bf16 v[48:63], v[100:103], v[24:27], 0
    ds_read_b128 v[104:107], v4 offset:8320
    s_mov_b32 m0, s86
    v_exp_f32 v37, v37
    v_exp_f32 v38, v38
    v_exp_f32 v39, v39
    v_exp_f32 v40, v40
    v_exp_f32 v41, v41
    v_exp_f32 v42, v42
    v_smfmac_f32_32x32x32_bf16 v[64:79], v[108:111], v[32:39], v2
    ds_read_b128 v[112:115], v5 offset:8320
    buffer_load_dwordx4 v1, s[4:7], s80 offen offset:3072 sc1 lds
    s_add_u32 m0, s85, 29440
    v_exp_f32 v43, v43
    v_exp_f32 v44, v44
    v_exp_f32 v45, v45
    v_exp_f32 v46, v46
    v_exp_f32 v47, v47
    v_exp_f32 v48, v48
    v_exp_f32 v49, v49
    v_smfmac_f32_32x32x32_bf16 v[64:79], v[116:119], v[40:47], v2
    s_waitcnt lgkmcnt(2)
    buffer_load_dwordx4 v126, s[4:7], s84 offen offset:1024 sc1 lds
    s_add_u32 m0, s85, 29472
    v_exp_f32 v50, v50
    v_exp_f32 v51, v51
    v_exp_f32 v52, v52
    v_mfma_f32_32x32x16_bf16 v[32:47], v[96:99], v[20:23], 0
    buffer_load_dwordx4 v126, s[4:7], s84 offen offset:2048 sc1 lds
    v_exp_f32 v53, v53
    v_exp_f32 v54, v54
    v_exp_f32 v55, v55
    v_exp_f32 v56, v56
    v_exp_f32 v57, v57
    v_exp_f32 v58, v58
    v_smfmac_f32_32x32x32_bf16 v[80:95], v[108:111], v[48:55], v2
    s_waitcnt lgkmcnt(0)
    buffer_load_dwordx4 v126, s[4:7], s84 offen offset:3072 sc1 lds
    v_exp_f32 v59, v59
    v_exp_f32 v60, v60
    v_exp_f32 v61, v61
    v_exp_f32 v62, v62
    v_exp_f32 v63, v63
    v_exp_f32 v32, v32
    v_exp_f32 v33, v33
    v_smfmac_f32_32x32x32_bf16 v[80:95], v[116:119], v[56:63], v2
    ds_read_b128 v[100:103], v3 offset:10400
    s_add_u32 s84, s84, 0x4000
    s_and_b32 s84, s84, 0x1ffff
    v_exp_f32 v34, v34
    v_exp_f32 v35, v35
    v_exp_f32 v36, v36
    v_mfma_f32_32x32x16_bf16 v[48:63], v[96:99], v[24:27], 0
    ds_read_b128 v[108:111], v4 offset:10400
    v_exp_f32 v37, v37
    v_exp_f32 v38, v38
    v_exp_f32 v39, v39
    v_exp_f32 v40, v40
    v_exp_f32 v41, v41
    v_exp_f32 v42, v42
    v_smfmac_f32_32x32x32_bf16 v[64:79], v[104:107], v[32:39], v2
    ds_read_b128 v[116:119], v5 offset:10400
    buffer_load_dwordx4 v[188:191], v1, s[4:7], s75 offen offset:3072 sc1
    v_exp_f32 v43, v43
    v_exp_f32 v44, v44
    v_exp_f32 v45, v45
    v_exp_f32 v46, v46
    v_exp_f32 v47, v47
    v_exp_f32 v48, v48
    v_exp_f32 v49, v49
    v_smfmac_f32_32x32x32_bf16 v[64:79], v[112:115], v[40:47], v2
    s_waitcnt lgkmcnt(2)
    buffer_load_dwordx4 a[184:187], v124, s[4:7], s81 offen offset:3072 sc1
    s_add_u32 s81, s81, 4096
    v_exp_f32 v50, v50
    v_exp_f32 v51, v51
    v_exp_f32 v52, v52
    v_mfma_f32_32x32x16_bf16 v[32:47], v[100:103], v[20:23], 0
    buffer_load_dwordx4 a[192:195], v124, s[4:7], s81 offen offset:0 sc1
    s_add_u32 s80, s80, 4096
    s_add_u32 s86, s86, 4096
    s_mov_b32 m0, s86
    v_exp_f32 v53, v53
    v_exp_f32 v54, v54
    v_exp_f32 v55, v55
    v_exp_f32 v56, v56
    v_exp_f32 v57, v57
    v_exp_f32 v58, v58
    v_smfmac_f32_32x32x32_bf16 v[80:95], v[104:107], v[48:55], v2
    s_waitcnt lgkmcnt(0)
    buffer_load_dwordx4 v1, s[4:7], s80 offen offset:0 sc1 lds
    v_exp_f32 v59, v59
    v_exp_f32 v60, v60
    v_exp_f32 v61, v61
    v_exp_f32 v62, v62
    v_exp_f32 v63, v63
    v_exp_f32 v32, v32
    v_exp_f32 v33, v33
    v_smfmac_f32_32x32x32_bf16 v[80:95], v[112:115], v[56:63], v2
    ds_read_b128 v[96:99], v3 offset:12480
    v_exp_f32 v34, v34
    v_exp_f32 v35, v35
    v_exp_f32 v36, v36
    v_mfma_f32_32x32x16_bf16 v[48:63], v[100:103], v[24:27], 0
    ds_read_b128 v[104:107], v4 offset:12480
    s_add_u32 s77, s88, 10240
    v_exp_f32 v37, v37
    v_exp_f32 v38, v38
    v_exp_f32 v39, v39
    v_exp_f32 v40, v40
    v_exp_f32 v41, v41
    v_exp_f32 v42, v42
    v_smfmac_f32_32x32x32_bf16 v[64:79], v[108:111], v[32:39], v2
    ds_read_b128 v[112:115], v5 offset:12480
    buffer_store_dwordx4 a[244:247], v1, s[4:7], s77 offen offset:0 sc1
    v_exp_f32 v43, v43
    v_exp_f32 v44, v44
    v_exp_f32 v45, v45
    v_exp_f32 v46, v46
    v_exp_f32 v47, v47
    v_exp_f32 v48, v48
    v_exp_f32 v49, v49
    v_smfmac_f32_32x32x32_bf16 v[64:79], v[116:119], v[40:47], v2
    s_waitcnt lgkmcnt(2)
    buffer_store_dwordx4 a[244:247], v1, s[4:7], s77 offen offset:1024 sc1
    s_xor_b32 s75, s83, 16384
    v_exp_f32 v50, v50
    v_exp_f32 v51, v51
    v_exp_f32 v52, v52
    v_mfma_f32_32x32x16_bf16 v[32:47], v[96:99], v[20:23], 0
    buffer_load_dwordx4 v[192:195], v1, s[4:7], s75 offen offset:0 sc1
    v_exp_f32 v53, v53
    v_exp_f32 v54, v54
    v_exp_f32 v55, v55
    v_exp_f32 v56, v56
    v_exp_f32 v57, v57
    v_exp_f32 v58, v58
    v_smfmac_f32_32x32x32_bf16 v[80:95], v[108:111], v[48:55], v2
    s_waitcnt lgkmcnt(0)
    buffer_load_dwordx4 a[200:203], v124, s[4:7], s81 offen offset:1024 sc1
    v_exp_f32 v59, v59
    v_exp_f32 v60, v60
    v_exp_f32 v61, v61
    v_exp_f32 v62, v62
    v_exp_f32 v63, v63
    v_exp_f32 v32, v32
    v_exp_f32 v33, v33
    v_smfmac_f32_32x32x32_bf16 v[80:95], v[116:119], v[56:63], v2
    ds_read_b128 v[100:103], v3 offset:14560
    v_exp_f32 v34, v34
    v_exp_f32 v35, v35
    v_exp_f32 v36, v36
    v_mfma_f32_32x32x16_bf16 v[48:63], v[96:99], v[24:27], 0
    ds_read_b128 v[108:111], v4 offset:14560
    v_exp_f32 v37, v37
    v_exp_f32 v38, v38
    v_exp_f32 v39, v39
    v_exp_f32 v40, v40
    v_exp_f32 v41, v41
    v_exp_f32 v42, v42
    v_smfmac_f32_32x32x32_bf16 v[64:79], v[104:107], v[32:39], v2
    ds_read_b128 v[116:119], v5 offset:14560
    buffer_load_dwordx4 v[196:199], v1, s[4:7], s75 offen offset:1024 sc1
    v_exp_f32 v43, v43
    v_exp_f32 v44, v44
    v_exp_f32 v45, v45
    v_exp_f32 v46, v46
    v_exp_f32 v47, v47
    v_exp_f32 v48, v48
    v_exp_f32 v49, v49
    v_smfmac_f32_32x32x32_bf16 v[64:79], v[112:115], v[40:47], v2
    s_waitcnt lgkmcnt(2)
    buffer_load_dwordx4 a[208:211], v124, s[4:7], s81 offen offset:2048 sc1
    v_exp_f32 v50, v50
    v_exp_f32 v51, v51
    v_exp_f32 v52, v52
    v_mfma_f32_32x32x16_bf16 v[32:47], v[100:103], v[20:23], 0
    buffer_load_dwordx4 v1, s[4:7], s80 offen offset:1024 sc1 lds
    v_exp_f32 v53, v53
    v_exp_f32 v54, v54
    v_exp_f32 v55, v55
    v_exp_f32 v56, v56
    v_exp_f32 v57, v57
    v_exp_f32 v58, v58
    v_smfmac_f32_32x32x32_bf16 v[80:95], v[104:107], v[48:55], v2
    s_waitcnt lgkmcnt(0)
    buffer_load_dwordx4 a[216:219], v124, s[4:7], s81 offen offset:3072 sc1
    v_exp_f32 v59, v59
    v_exp_f32 v60, v60
    v_exp_f32 v61, v61
    v_exp_f32 v62, v62
    v_exp_f32 v63, v63
    v_exp_f32 v32, v32
    v_exp_f32 v33, v33
    v_smfmac_f32_32x32x32_bf16 v[80:95], v[112:115], v[56:63], v2
    ds_read_b128 v[96:99], v3 offset:0
    v_exp_f32 v34, v34
    v_exp_f32 v35, v35
    v_exp_f32 v36, v36
    v_mfma_f32_32x32x16_bf16 v[48:63], v[100:103], v[24:27], 0
    ds_read_b128 v[104:107], v4 offset:0
    v_exp_f32 v37, v37
    v_exp_f32 v38, v38
    v_exp_f32 v39, v39
    v_exp_f32 v40, v40
    v_exp_f32 v41, v41
    v_exp_f32 v42, v42
    v_smfmac_f32_32x32x32_bf16 v[64:79], v[108:111], v[32:39], v2
    ds_read_b128 v[112:115], v5 offset:0
    buffer_load_dwordx4 v[200:203], v1, s[4:7], s75 offen offset:2048 sc1
    v_exp_f32 v43, v43
    v_exp_f32 v44, v44
    v_exp_f32 v45, v45
    v_exp_f32 v46, v46
    v_exp_f32 v47, v47
    v_exp_f32 v48, v48
    v_exp_f32 v49, v49
    v_smfmac_f32_32x32x32_bf16 v[64:79], v[116:119], v[40:47], v2
    s_waitcnt lgkmcnt(2)
    buffer_load_dwordx4 a[4:7], v124, s[4:7], s82 offen offset:0 sc1
    v_exp_f32 v50, v50
    v_exp_f32 v51, v51
    v_exp_f32 v52, v52
    v_mfma_f32_32x32x16_bf16 v[32:47], v[96:99], v[20:23], 0
    buffer_load_dwordx4 v1, s[4:7], s80 offen offset:2048 sc1 lds
    v_exp_f32 v53, v53
    v_exp_f32 v54, v54
    v_exp_f32 v55, v55
    v_exp_f32 v56, v56
    v_exp_f32 v57, v57
    v_exp_f32 v58, v58
    v_smfmac_f32_32x32x32_bf16 v[80:95], v[108:111], v[48:55], v2
    s_waitcnt lgkmcnt(0)
    buffer_load_dwordx4 a[12:15], v124, s[4:7], s82 offen offset:1024 sc1
    v_exp_f32 v59, v59
    v_exp_f32 v60, v60
    v_exp_f32 v61, v61
    v_exp_f32 v62, v62
    v_exp_f32 v63, v63
    v_exp_f32 v32, v32
    v_exp_f32 v33, v33
    v_smfmac_f32_32x32x32_bf16 v[80:95], v[116:119], v[56:63], v2
    ds_read_b128 v[100:103], v3 offset:2080
    v_exp_f32 v34, v34
    v_exp_f32 v35, v35
    v_exp_f32 v36, v36
    v_mfma_f32_32x32x16_bf16 v[48:63], v[96:99], v[24:27], 0
    ds_read_b128 v[108:111], v4 offset:2080
    v_exp_f32 v37, v37
    v_exp_f32 v38, v38
    v_exp_f32 v39, v39
    v_exp_f32 v40, v40
    v_exp_f32 v41, v41
    v_exp_f32 v42, v42
    v_smfmac_f32_32x32x32_bf16 v[64:79], v[104:107], v[32:39], v2
    ds_read_b128 v[116:119], v5 offset:2080
    buffer_load_dwordx4 v[204:207], v1, s[4:7], s75 offen offset:3072 sc1
    v_exp_f32 v43, v43
    v_exp_f32 v44, v44
    v_exp_f32 v45, v45
    v_exp_f32 v46, v46
    v_exp_f32 v47, v47
    v_exp_f32 v48, v48
    v_exp_f32 v49, v49
    v_smfmac_f32_32x32x32_bf16 v[64:79], v[112:115], v[40:47], v2
    s_waitcnt lgkmcnt(2)
    buffer_load_dwordx4 a[20:23], v124, s[4:7], s82 offen offset:2048 sc1
    v_exp_f32 v50, v50
    v_exp_f32 v51, v51
    v_exp_f32 v52, v52
    v_mfma_f32_32x32x16_bf16 v[32:47], v[100:103], v[20:23], 0
    buffer_load_dwordx4 v1, s[4:7], s80 offen offset:3072 sc1 lds
    s_xor_b32 s75, s83, 20480
    v_exp_f32 v53, v53
    v_exp_f32 v54, v54
    v_exp_f32 v55, v55
    v_exp_f32 v56, v56
    v_exp_f32 v57, v57
    v_exp_f32 v58, v58
    v_smfmac_f32_32x32x32_bf16 v[80:95], v[104:107], v[48:55], v2
    s_waitcnt lgkmcnt(0)
    buffer_load_dwordx4 v[208:211], v1, s[4:7], s75 offen offset:0 sc1
    v_exp_f32 v59, v59
    v_exp_f32 v60, v60
    v_exp_f32 v61, v61
    v_exp_f32 v62, v62
    v_exp_f32 v63, v63
    v_exp_f32 v32, v32
    v_exp_f32 v33, v33
    v_smfmac_f32_32x32x32_bf16 v[80:95], v[112:115], v[56:63], v2
    ds_read_b128 v[96:99], v3 offset:4160
    v_exp_f32 v34, v34
    v_exp_f32 v35, v35
    v_exp_f32 v36, v36
    v_mfma_f32_32x32x16_bf16 v[48:63], v[100:103], v[24:27], 0
    ds_read_b128 v[104:107], v4 offset:4160
    v_exp_f32 v37, v37
    v_exp_f32 v38, v38
    v_exp_f32 v39, v39
    v_exp_f32 v40, v40
    v_exp_f32 v41, v41
    v_exp_f32 v42, v42
    v_smfmac_f32_32x32x32_bf16 v[64:79], v[108:111], v[32:39], v2
    ds_read_b128 v[112:115], v5 offset:4160
    buffer_load_dwordx4 a[28:31], v124, s[4:7], s82 offen offset:3072 sc1
    s_add_u32 s82, s82, 4096
    v_exp_f32 v43, v43
    v_exp_f32 v44, v44
    v_exp_f32 v45, v45
    v_exp_f32 v46, v46
TCH3:
    s_cbranch_execz TCH7
    v_exp_f32 v47, v47
    v_exp_f32 v48, v48
    v_exp_f32 v49, v49
    v_smfmac_f32_32x32x32_bf16 v[64:79], v[116:119], v[40:47], v2
    s_waitcnt lgkmcnt(2)
    buffer_load_dwordx4 a[36:39], v124, s[4:7], s82 offen offset:0 sc1
    v_exp_f32 v50, v50
    v_exp_f32 v51, v51
    v_exp_f32 v52, v52
    v_mfma_f32_32x32x16_bf16 v[32:47], v[96:99], v[20:23], 0
    buffer_load_dwordx4 v[212:215], v1, s[4:7], s75 offen offset:1024 sc1
    s_add_u32 s80, s80, 4096
    s_add_u32 s86, s86, 4096
    s_mov_b32 m0, s86
    v_exp_f32 v53, v53
    v_exp_f32 v54, v54
    v_exp_f32 v55, v55
    v_exp_f32 v56, v56
    v_exp_f32 v57, v57
    v_exp_f32 v58, v58
    v_smfmac_f32_32x32x32_bf16 v[80:95], v[108:111], v[48:55], v2
    s_waitcnt lgkmcnt(0)
    buffer_load_dwordx4 v1, s[4:7], s80 offen offset:0 sc1 lds
    v_exp_f32 v59, v59
    v_exp_f32 v60, v60
    v_exp_f32 v61, v61
    v_exp_f32 v62, v62
    v_exp_f32 v63, v63
    v_exp_f32 v32, v32
    v_exp_f32 v33, v33
    v_smfmac_f32_32x32x32_bf16 v[80:95], v[116:119], v[56:63], v2
    ds_read_b128 v[100:103], v3 offset:6240
    v_exp_f32 v34, v34
    v_exp_f32 v35, v35
    v_exp_f32 v36, v36
    v_mfma_f32_32x32x16_bf16 v[48:63], v[96:99], v[24:27], 0
    ds_read_b128 v[108:111], v4 offset:6240
    v_exp_f32 v37, v37
    v_exp_f32 v38, v38
    v_exp_f32 v39, v39
    v_exp_f32 v40, v40
    v_exp_f32 v41, v41
    v_exp_f32 v42, v42
    v_smfmac_f32_32x32x32_bf16 v[64:79], v[104:107], v[32:39], v2
    ds_read_b128 v[116:119], v5 offset:6240
    buffer_load_dwordx4 a[44:47], v124, s[4:7], s82 offen offset:1024 sc1
    v_exp_f32 v43, v43
    v_exp_f32 v44, v44
    v_exp_f32 v45, v45
    v_exp_f32 v46, v46
    v_exp_f32 v47, v47
    v_exp_f32 v48, v48
    v_exp_f32 v49, v49
    v_smfmac_f32_32x32x32_bf16 v[64:79], v[112:115], v[40:47], v2
    s_waitcnt lgkmcnt(2)
    buffer_store_dwordx4 a[244:247], v1, s[12:15], s89 offen offset:0 sc1
    v_exp_f32 v50, v50
    v_exp_f32 v51, v51
    v_exp_f32 v52, v52
    v_mfma_f32_32x32x16_bf16 v[32:47], v[100:103], v[20:23], 0
    buffer_store_dwordx4 a[244:247], v1, s[12:15], s89 offen offset:1024 sc1
    s_add_u32 m0, s85, 0
    v_exp_f32 v53, v53
    v_exp_f32 v54, v54
    v_exp_f32 v55, v55
    v_exp_f32 v56, v56
    v_exp_f32 v57, v57
    v_exp_f32 v58, v58
    v_smfmac_f32_32x32x32_bf16 v[80:95], v[104:107], v[48:55], v2
    s_waitcnt vmcnt(27) lgkmcnt(0)
    s_barrier
    buffer_load_dwordx4 v126, s[4:7], s84 offen offset:0 sc1 lds
    v_exp_f32 v59, v59
    v_exp_f32 v60, v60
    v_exp_f32 v61, v61
    v_exp_f32 v62, v62
    v_exp_f32 v63, v63
    v_exp_f32 v32, v32
    v_exp_f32 v33, v33
    v_smfmac_f32_32x32x32_bf16 v[80:95], v[112:115], v[56:63], v2
    ds_read_b128 v[96:99], v3 offset:37760
    v_exp_f32 v34, v34
    v_exp_f32 v35, v35
    v_exp_f32 v36, v36
    v_mfma_f32_32x32x16_bf16 v[48:63], v[100:103], v[24:27], 0
    ds_read_b128 v[104:107], v4 offset:37760
    v_exp_f32 v37, v37
    v_exp_f32 v38, v38
    v_exp_f32 v39, v39
    v_exp_f32 v40, v40
    v_exp_f32 v41, v41
    v_exp_f32 v42, v42
    v_smfmac_f32_32x32x32_bf16 v[64:79], v[108:111], v[32:39], v2
    ds_read_b128 v[112:115], v5 offset:37760
    buffer_load_dwordx4 v[216:219], v1, s[4:7], s75 offen offset:2048 sc1
    v_exp_f32 v43, v43
    v_exp_f32 v44, v44
    v_exp_f32 v45, v45
    v_exp_f32 v46, v46
    v_exp_f32 v47, v47
    v_exp_f32 v48, v48
    v_exp_f32 v49, v49
    v_smfmac_f32_32x32x32_bf16 v[64:79], v[116:119], v[40:47], v2
    s_waitcnt lgkmcnt(2)
    buffer_load_dwordx4 v126, s[4:7], s84 offen offset:1024 sc1 lds
    s_add_u32 m0, s85, 32
    v_exp_f32 v50, v50
    v_exp_f32 v51, v51
    v_exp_f32 v52, v52
    v_mfma_f32_32x32x16_bf16 v[32:47], v[96:99], v[20:23], 0
    buffer_load_dwordx4 v126, s[4:7], s84 offen offset:2048 sc1 lds
    v_exp_f32 v53, v53
    v_exp_f32 v54, v54
    v_exp_f32 v55, v55
    v_exp_f32 v56, v56
    v_exp_f32 v57, v57
    v_exp_f32 v58, v58
    v_smfmac_f32_32x32x32_bf16 v[80:95], v[108:111], v[48:55], v2
    s_waitcnt lgkmcnt(0)
    buffer_load_dwordx4 v126, s[4:7], s84 offen offset:3072 sc1 lds
    v_exp_f32 v59, v59
    v_exp_f32 v60, v60
    v_exp_f32 v61, v61
    v_exp_f32 v62, v62
    v_exp_f32 v63, v63
    v_exp_f32 v32, v32
    v_exp_f32 v33, v33
    v_smfmac_f32_32x32x32_bf16 v[80:95], v[116:119], v[56:63], v2
    ds_read_b128 v[100:103], v3 offset:39840
    s_add_u32 s84, s84, 0x4000
    s_and_b32 s84, s84, 0x1ffff
    v_exp_f32 v34, v34
    v_exp_f32 v35, v35
    v_exp_f32 v36, v36
    v_mfma_f32_32x32x16_bf16 v[48:63], v[96:99], v[24:27], 0
    ds_read_b128 v[108:111], v4 offset:39840
    v_exp_f32 v37, v37
    v_exp_f32 v38, v38
    v_exp_f32 v39, v39
    v_exp_f32 v40, v40
    v_exp_f32 v41, v41
    v_exp_f32 v42, v42
    v_smfmac_f32_32x32x32_bf16 v[64:79], v[104:107], v[32:39], v2
    ds_read_b128 v[116:119], v5 offset:39840
    buffer_load_dwordx4 a[52:55], v124, s[4:7], s82 offen offset:2048 sc1
    s_mov_b32 m0, s86
    v_exp_f32 v43, v43
    v_exp_f32 v44, v44
    v_exp_f32 v45, v45
    v_exp_f32 v46, v46
    v_exp_f32 v47, v47
    v_exp_f32 v48, v48
    v_exp_f32 v49, v49
    v_smfmac_f32_32x32x32_bf16 v[64:79], v[112:115], v[40:47], v2
    s_waitcnt lgkmcnt(2)
    buffer_load_dwordx4 v1, s[4:7], s80 offen offset:1024 sc1 lds
    v_exp_f32 v50, v50
    v_exp_f32 v51, v51
    v_exp_f32 v52, v52
    v_mfma_f32_32x32x16_bf16 v[32:47], v[100:103], v[20:23], 0
    buffer_load_dwordx4 a[60:63], v124, s[4:7], s82 offen offset:3072 sc1
    v_exp_f32 v53, v53
    v_exp_f32 v54, v54
    v_exp_f32 v55, v55
    v_exp_f32 v56, v56
    v_exp_f32 v57, v57
    v_exp_f32 v58, v58
    v_smfmac_f32_32x32x32_bf16 v[80:95], v[104:107], v[48:55], v2
    s_waitcnt lgkmcnt(0)
    buffer_load_dwordx4 v[220:223], v1, s[4:7], s75 offen offset:3072 sc1
    v_exp_f32 v59, v59
    v_exp_f32 v60, v60
    v_exp_f32 v61, v61
    v_exp_f32 v62, v62
    v_exp_f32 v63, v63
    v_exp_f32 v32, v32
    v_exp_f32 v33, v33
    v_smfmac_f32_32x32x32_bf16 v[80:95], v[112:115], v[56:63], v2
    ds_read_b128 v[96:99], v3 offset:41920
    v_exp_f32 v34, v34
    v_exp_f32 v35, v35
    v_exp_f32 v36, v36
    v_mfma_f32_32x32x16_bf16 v[48:63], v[100:103], v[24:27], 0
    ds_read_b128 v[104:107], v4 offset:41920
    s_add_u32 s82, s82, 4096
    v_exp_f32 v37, v37
    v_exp_f32 v38, v38
    v_exp_f32 v39, v39
    v_exp_f32 v40, v40
    v_exp_f32 v41, v41
    v_exp_f32 v42, v42
    v_smfmac_f32_32x32x32_bf16 v[64:79], v[108:111], v[32:39], v2
    ds_read_b128 v[112:115], v5 offset:41920
    buffer_load_dwordx4 a[68:71], v124, s[4:7], s82 offen offset:0 sc1
    v_exp_f32 v43, v43
    v_exp_f32 v44, v44
    v_exp_f32 v45, v45
    v_exp_f32 v46, v46
    v_exp_f32 v47, v47
    v_exp_f32 v48, v48
    v_exp_f32 v49, v49
    v_smfmac_f32_32x32x32_bf16 v[64:79], v[116:119], v[40:47], v2
    s_waitcnt lgkmcnt(2)
    buffer_load_dwordx4 v1, s[4:7], s80 offen offset:2048 sc1 lds
    s_xor_b32 s75, s83, 24576
    v_exp_f32 v50, v50
    v_exp_f32 v51, v51
    v_exp_f32 v52, v52
    v_mfma_f32_32x32x16_bf16 v[32:47], v[96:99], v[20:23], 0
    buffer_load_dwordx4 v[224:227], v1, s[4:7], s75 offen offset:0 sc1
    v_exp_f32 v53, v53
    v_exp_f32 v54, v54
    v_exp_f32 v55, v55
    v_exp_f32 v56, v56
    v_exp_f32 v57, v57
    v_exp_f32 v58, v58
    v_smfmac_f32_32x32x32_bf16 v[80:95], v[108:111], v[48:55], v2
    s_waitcnt lgkmcnt(0)
    buffer_load_dwordx4 a[76:79], v124, s[4:7], s82 offen offset:1024 sc1
    v_exp_f32 v59, v59
    v_exp_f32 v60, v60
    v_exp_f32 v61, v61
    v_exp_f32 v62, v62
    v_exp_f32 v63, v63
    v_exp_f32 v32, v32
    v_exp_f32 v33, v33
    v_smfmac_f32_32x32x32_bf16 v[80:95], v[116:119], v[56:63], v2
    ds_read_b128 v[100:103], v3 offset:44000
    v_exp_f32 v34, v34
    v_exp_f32 v35, v35
    v_exp_f32 v36, v36
    v_mfma_f32_32x32x16_bf16 v[48:63], v[96:99], v[24:27], 0
    ds_read_b128 v[108:111], v4 offset:44000
    v_exp_f32 v37, v37
    v_exp_f32 v38, v38
    v_exp_f32 v39, v39
    v_exp_f32 v40, v40
    v_exp_f32 v41, v41
    v_exp_f32 v42, v42
    v_smfmac_f32_32x32x32_bf16 v[64:79], v[104:107], v[32:39], v2
    ds_read_b128 v[116:119], v5 offset:44000
    buffer_load_dwordx4 a[84:87], v124, s[4:7], s82 offen offset:2048 sc1
    v_exp_f32 v43, v43
    v_exp_f32 v44, v44
    v_exp_f32 v45, v45
    v_exp_f32 v46, v46
    v_exp_f32 v47, v47
    v_exp_f32 v48, v48
    v_exp_f32 v49, v49
    v_smfmac_f32_32x32x32_bf16 v[64:79], v[112:115], v[40:47], v2
    s_waitcnt lgkmcnt(2)
    buffer_load_dwordx4 v[228:231], v1, s[4:7], s75 offen offset:1024 sc1
    v_exp_f32 v50, v50
    v_exp_f32 v51, v51
    v_exp_f32 v52, v52
    v_mfma_f32_32x32x16_bf16 v[32:47], v[100:103], v[20:23], 0
    buffer_load_dwordx4 v1, s[4:7], s80 offen offset:3072 sc1 lds
    v_exp_f32 v53, v53
    v_exp_f32 v54, v54
    v_exp_f32 v55, v55
    v_exp_f32 v56, v56
    v_exp_f32 v57, v57
    v_exp_f32 v58, v58
    v_smfmac_f32_32x32x32_bf16 v[80:95], v[104:107], v[48:55], v2
    s_waitcnt lgkmcnt(0)
    buffer_load_dwordx4 a[92:95], v124, s[4:7], s82 offen offset:3072 sc1
    v_exp_f32 v59, v59
    v_exp_f32 v60, v60
    v_exp_f32 v61, v61
    v_exp_f32 v62, v62
    v_exp_f32 v63, v63
    v_exp_f32 v32, v32
    v_exp_f32 v33, v33
    v_smfmac_f32_32x32x32_bf16 v[80:95], v[112:115], v[56:63], v2
    ds_read_b128 v[96:99], v3 offset:29440
    v_exp_f32 v34, v34
    v_exp_f32 v35, v35
    v_exp_f32 v36, v36
    v_mfma_f32_32x32x16_bf16 v[48:63], v[100:103], v[24:27], 0
    ds_read_b128 v[104:107], v4 offset:29440
    v_exp_f32 v37, v37
    v_exp_f32 v38, v38
    v_exp_f32 v39, v39
    v_exp_f32 v40, v40
    v_exp_f32 v41, v41
    v_exp_f32 v42, v42
    v_smfmac_f32_32x32x32_bf16 v[64:79], v[108:111], v[32:39], v2
    ds_read_b128 v[112:115], v5 offset:29440
    buffer_load_dwordx4 v[232:235], v1, s[4:7], s75 offen offset:2048 sc1
    s_add_u32 s82, s82, 4096
    v_exp_f32 v43, v43
    v_exp_f32 v44, v44
    v_exp_f32 v45, v45
    v_exp_f32 v46, v46
    v_exp_f32 v47, v47
    v_exp_f32 v48, v48
    v_exp_f32 v49, v49
    v_smfmac_f32_32x32x32_bf16 v[64:79], v[116:119], v[40:47], v2
    s_waitcnt lgkmcnt(2)
    buffer_load_dwordx4 a[100:103], v124, s[4:7], s82 offen offset:0 sc1
    s_add_u32 s80, s80, 4096
    s_add_u32 s86, s86, 4096
    s_mov_b32 m0, s86
    v_exp_f32 v50, v50
    v_exp_f32 v51, v51
    v_exp_f32 v52, v52
    v_mfma_f32_32x32x16_bf16 v[32:47], v[96:99], v[20:23], 0
    buffer_load_dwordx4 v1, s[4:7], s80 offen offset:0 sc1 lds
    v_exp_f32 v53, v53
    v_exp_f32 v54, v54
    v_exp_f32 v55, v55
    v_exp_f32 v56, v56
    v_exp_f32 v57, v57
    v_exp_f32 v58, v58
    v_smfmac_f32_32x32x32_bf16 v[80:95], v[108:111], v[48:55], v2
    s_waitcnt lgkmcnt(0)
    buffer_load_dwordx4 a[108:111], v124, s[4:7], s82 offen offset:1024 sc1
    v_exp_f32 v59, v59
    v_exp_f32 v60, v60
    v_exp_f32 v61, v61
    v_exp_f32 v62, v62
    v_exp_f32 v63, v63
    v_exp_f32 v32, v32
    v_exp_f32 v33, v33
    v_smfmac_f32_32x32x32_bf16 v[80:95], v[116:119], v[56:63], v2
    ds_read_b128 v[100:103], v3 offset:31520
    v_exp_f32 v34, v34
    v_exp_f32 v35, v35
    v_exp_f32 v36, v36
    v_mfma_f32_32x32x16_bf16 v[48:63], v[96:99], v[24:27], 0
    ds_read_b128 v[108:111], v4 offset:31520
    v_exp_f32 v37, v37
    v_exp_f32 v38, v38
    v_exp_f32 v39, v39
    v_exp_f32 v40, v40
    v_exp_f32 v41, v41
    v_exp_f32 v42, v42
    v_smfmac_f32_32x32x32_bf16 v[64:79], v[104:107], v[32:39], v2
    ds_read_b128 v[116:119], v5 offset:31520
    buffer_load_dwordx4 v[236:239], v1, s[4:7], s75 offen offset:3072 sc1
    v_exp_f32 v43, v43
    v_exp_f32 v44, v44
    v_exp_f32 v45, v45
    v_exp_f32 v46, v46
    v_exp_f32 v47, v47
    v_exp_f32 v48, v48
    v_exp_f32 v49, v49
    v_smfmac_f32_32x32x32_bf16 v[64:79], v[112:115], v[40:47], v2
    s_waitcnt lgkmcnt(2)
    buffer_load_dwordx4 a[116:119], v124, s[4:7], s82 offen offset:2048 sc1
    v_exp_f32 v50, v50
    v_exp_f32 v51, v51
    v_exp_f32 v52, v52
    v_mfma_f32_32x32x16_bf16 v[32:47], v[100:103], v[20:23], 0
    buffer_load_dwordx4 v1, s[4:7], s80 offen offset:1024 sc1 lds
    s_xor_b32 s75, s83, 28672
    v_exp_f32 v53, v53
    v_exp_f32 v54, v54
    v_exp_f32 v55, v55
    v_exp_f32 v56, v56
    v_exp_f32 v57, v57
    v_exp_f32 v58, v58
    v_smfmac_f32_32x32x32_bf16 v[80:95], v[104:107], v[48:55], v2
    s_waitcnt lgkmcnt(0)
    buffer_load_dwordx4 v[240:243], v1, s[4:7], s75 offen offset:0 sc1
    v_exp_f32 v59, v59
    v_exp_f32 v60, v60
    v_exp_f32 v61, v61
    v_exp_f32 v62, v62
    v_exp_f32 v63, v63
    v_exp_f32 v32, v32
    v_exp_f32 v33, v33
    v_smfmac_f32_32x32x32_bf16 v[80:95], v[112:115], v[56:63], v2
    ds_read_b128 v[96:99], v3 offset:33600
    v_exp_f32 v34, v34
    v_exp_f32 v35, v35
    v_exp_f32 v36, v36
    v_mfma_f32_32x32x16_bf16 v[48:63], v[100:103], v[24:27], 0
    ds_read_b128 v[104:107], v4 offset:33600
    v_exp_f32 v37, v37
    v_exp_f32 v38, v38
    v_exp_f32 v39, v39
    v_exp_f32 v40, v40
    v_exp_f32 v41, v41
    v_exp_f32 v42, v42
    v_smfmac_f32_32x32x32_bf16 v[64:79], v[108:111], v[32:39], v2
    ds_read_b128 v[112:115], v5 offset:33600
    buffer_load_dwordx4 a[124:127], v124, s[4:7], s82 offen offset:3072 sc1
    s_add_u32 s82, s82, 4096
    v_exp_f32 v43, v43
    v_exp_f32 v44, v44
    v_exp_f32 v45, v45
    v_exp_f32 v46, v46
    v_exp_f32 v47, v47
    v_exp_f32 v48, v48
    v_exp_f32 v49, v49
    v_smfmac_f32_32x32x32_bf16 v[64:79], v[116:119], v[40:47], v2
    s_waitcnt lgkmcnt(2)
    buffer_load_dwordx4 a[132:135], v124, s[4:7], s82 offen offset:0 sc1
    v_exp_f32 v50, v50
    v_exp_f32 v51, v51
    v_exp_f32 v52, v52
    v_mfma_f32_32x32x16_bf16 v[32:47], v[96:99], v[20:23], 0
    buffer_load_dwordx4 v[244:247], v1, s[4:7], s75 offen offset:1024 sc1
    v_exp_f32 v53, v53
    v_exp_f32 v54, v54
    v_exp_f32 v55, v55
    v_exp_f32 v56, v56
    v_exp_f32 v57, v57
    v_exp_f32 v58, v58
    v_smfmac_f32_32x32x32_bf16 v[80:95], v[108:111], v[48:55], v2
    s_waitcnt lgkmcnt(0)
    buffer_load_dwordx4 v1, s[4:7], s80 offen offset:2048 sc1 lds
    v_exp_f32 v59, v59
    v_exp_f32 v60, v60
    v_exp_f32 v61, v61
    v_exp_f32 v62, v62
    v_exp_f32 v63, v63
    v_exp_f32 v32, v32
    v_exp_f32 v33, v33
    v_smfmac_f32_32x32x32_bf16 v[80:95], v[116:119], v[56:63], v2
    ds_read_b128 v[100:103], v3 offset:35680
    v_exp_f32 v34, v34
    v_exp_f32 v35, v35
    v_exp_f32 v36, v36
    v_mfma_f32_32x32x16_bf16 v[48:63], v[96:99], v[24:27], 0
    ds_read_b128 v[108:111], v4 offset:35680
    v_exp_f32 v37, v37
    v_exp_f32 v38, v38
    v_exp_f32 v39, v39
    v_exp_f32 v40, v40
    v_exp_f32 v41, v41
    v_exp_f32 v42, v42
    v_smfmac_f32_32x32x32_bf16 v[64:79], v[104:107], v[32:39], v2
    ds_read_b128 v[116:119], v5 offset:35680
    buffer_load_dwordx4 a[140:143], v124, s[4:7], s82 offen offset:1024 sc1
    v_exp_f32 v43, v43
    v_exp_f32 v44, v44
    v_exp_f32 v45, v45
    v_exp_f32 v46, v46
    v_exp_f32 v47, v47
    v_exp_f32 v48, v48
    v_exp_f32 v49, v49
    v_smfmac_f32_32x32x32_bf16 v[64:79], v[112:115], v[40:47], v2
    s_waitcnt lgkmcnt(2)
    buffer_load_dwordx4 v[248:251], v1, s[4:7], s75 offen offset:2048 sc1
    v_exp_f32 v50, v50
    v_exp_f32 v51, v51
    v_exp_f32 v52, v52
    v_mfma_f32_32x32x16_bf16 v[32:47], v[100:103], v[20:23], 0
    buffer_load_dwordx4 a[148:151], v124, s[4:7], s82 offen offset:2048 sc1
    v_exp_f32 v53, v53
    v_exp_f32 v54, v54
    v_exp_f32 v55, v55
    v_exp_f32 v56, v56
    v_exp_f32 v57, v57
    v_exp_f32 v58, v58
    v_smfmac_f32_32x32x32_bf16 v[80:95], v[104:107], v[48:55], v2
    s_waitcnt vmcnt(32)
    s_cmp_lg_u32 s31, 0
    s_cbranch_scc1 SF_6
SFD_7:
    s_waitcnt vmcnt(27) lgkmcnt(0)
    s_barrier
    buffer_load_dwordx4 v1, s[4:7], s80 offen offset:3072 sc1 lds
    v_exp_f32 v59, v59
    v_exp_f32 v60, v60
    v_exp_f32 v61, v61
    v_exp_f32 v62, v62
    v_exp_f32 v63, v63
    v_exp_f32 v32, v32
    v_exp_f32 v33, v33
    v_smfmac_f32_32x32x32_bf16 v[80:95], v[112:115], v[56:63], v2
    ds_read_b128 v[96:99], v3 offset:8320
    v_exp_f32 v34, v34
    v_exp_f32 v35, v35
    v_exp_f32 v36, v36
    v_mfma_f32_32x32x16_bf16 v[48:63], v[100:103], v[24:27], 0
    ds_read_b128 v[104:107], v4 offset:8320
    s_lshl2_add_u32 s74, s59, s64
    s_cmp_lg_u32 s31, 0
    s_mov_b64 exec, s[94:95]
    s_cbranch_scc1 PFS_20
    buffer_store_dword v6, off, s[4:7], s74
PFD_21:
    s_mov_b64 exec, -1
    v_exp_f32 v37, v37
    v_exp_f32 v38, v38
    v_exp_f32 v39, v39
    v_exp_f32 v40, v40
    v_exp_f32 v41, v41
    v_exp_f32 v42, v42
    v_smfmac_f32_32x32x32_bf16 v[64:79], v[108:111], v[32:39], v2
    ds_read_b128 v[112:115], v5 offset:8320
    buffer_load_dwordx4 a[156:159], v124, s[4:7], s82 offen offset:3072 sc1
    v_exp_f32 v43, v43
    v_exp_f32 v44, v44
    v_exp_f32 v45, v45
    v_exp_f32 v46, v46
    v_exp_f32 v47, v47
    v_exp_f32 v48, v48
    v_exp_f32 v49, v49
    v_smfmac_f32_32x32x32_bf16 v[64:79], v[116:119], v[40:47], v2
    s_waitcnt lgkmcnt(2)
    buffer_load_dwordx4 v[252:255], v1, s[4:7], s75 offen offset:3072 sc1
    s_add_u32 s82, s82, 4096
    v_exp_f32 v50, v50
    v_exp_f32 v51, v51
    v_exp_f32 v52, v52
    v_mfma_f32_32x32x16_bf16 v[32:47], v[96:99], v[20:23], 0
    buffer_load_dwordx4 a[164:167], v124, s[4:7], s82 offen offset:0 sc1
    s_add_u32 s80, s80, 4096
    s_add_u32 s86, s86, 4096
    s_mov_b32 m0, s86
    v_exp_f32 v53, v53
    v_exp_f32 v54, v54
    v_exp_f32 v55, v55
    v_exp_f32 v56, v56
    v_exp_f32 v57, v57
    v_exp_f32 v58, v58
    v_smfmac_f32_32x32x32_bf16 v[80:95], v[108:111], v[48:55], v2
    s_waitcnt lgkmcnt(0)
    buffer_load_dwordx4 v1, s[4:7], s80 offen offset:0 sc1 lds
    v_exp_f32 v59, v59
    v_exp_f32 v60, v60
    v_exp_f32 v61, v61
    v_exp_f32 v62, v62
    v_exp_f32 v63, v63
    v_exp_f32 v32, v32
    v_exp_f32 v33, v33
    v_smfmac_f32_32x32x32_bf16 v[80:95], v[116:119], v[56:63], v2
    ds_read_b128 v[100:103], v3 offset:10400
    v_exp_f32 v34, v34
    v_exp_f32 v35, v35
    v_exp_f32 v36, v36
    v_mfma_f32_32x32x16_bf16 v[48:63], v[96:99], v[24:27], 0
    ds_read_b128 v[108:111], v4 offset:10400
    s_mov_b32 s74, 65536
    v_lshlrev_b32 v127, 1, v125
    v_exp_f32 v37, v37
    v_exp_f32 v38, v38
    v_exp_f32 v39, v39
    v_exp_f32 v40, v40
    v_exp_f32 v41, v41
    v_exp_f32 v42, v42
    v_smfmac_f32_32x32x32_bf16 v[64:79], v[104:107], v[32:39], v2
    ds_read_b128 v[116:119], v5 offset:10400
    buffer_load_dword v28, v127, s[4:7], s74 offen sc1
    v_exp_f32 v43, v43
    v_exp_f32 v44, v44
    v_exp_f32 v45, v45
    v_exp_f32 v46, v46
    v_exp_f32 v47, v47
    v_exp_f32 v48, v48
    v_exp_f32 v49, v49
    v_smfmac_f32_32x32x32_bf16 v[64:79], v[112:115], v[40:47], v2
    s_waitcnt lgkmcnt(2)
    buffer_load_dwordx4 a[172:175], v124, s[4:7], s82 offen offset:1024 sc1
    v_exp_f32 v50, v50
    v_exp_f32 v51, v51
    v_exp_f32 v52, v52
    v_mfma_f32_32x32x16_bf16 v[32:47], v[100:103], v[20:23], 0
    buffer_load_dwordx4 a[180:183], v124, s[4:7], s82 offen offset:2048 sc1
    s_mov_b32 s74, 72704
    v_exp_f32 v53, v53
    v_exp_f32 v54, v54
    v_exp_f32 v55, v55
    v_exp_f32 v56, v56
    v_exp_f32 v57, v57
    v_exp_f32 v58, v58
    v_smfmac_f32_32x32x32_bf16 v[80:95], v[104:107], v[48:55], v2
    s_waitcnt lgkmcnt(0)
    buffer_load_dword v29, v127, s[4:7], s74 offen sc1
    v_exp_f32 v59, v59
    v_exp_f32 v60, v60
    v_exp_f32 v61, v61
    v_exp_f32 v62, v62
    v_exp_f32 v63, v63
    v_exp_f32 v32, v32
    v_exp_f32 v33, v33
    v_smfmac_f32_32x32x32_bf16 v[80:95], v[112:115], v[56:63], v2
    ds_read_b128 v[96:99], v3 offset:12480
    v_exp_f32 v34, v34
    v_exp_f32 v35, v35
    v_exp_f32 v36, v36
    v_mfma_f32_32x32x16_bf16 v[48:63], v[100:103], v[24:27], 0
    ds_read_b128 v[104:107], v4 offset:12480
    v_exp_f32 v37, v37
    v_exp_f32 v38, v38
    v_exp_f32 v39, v39
    v_exp_f32 v40, v40
    v_exp_f32 v41, v41
    v_exp_f32 v42, v42
    v_smfmac_f32_32x32x32_bf16 v[64:79], v[108:111], v[32:39], v2
    ds_read_b128 v[112:115], v5 offset:12480
    buffer_load_dwordx4 v1, s[4:7], s80 offen offset:1024 sc1 lds
    v_bfe_u32 v122, v1, 2, 7
    v_exp_f32 v43, v43
    v_exp_f32 v44, v44
    v_exp_f32 v45, v45
    v_exp_f32 v46, v46
    v_exp_f32 v47, v47
    v_exp_f32 v48, v48
    v_exp_f32 v49, v49
    v_smfmac_f32_32x32x32_bf16 v[64:79], v[116:119], v[40:47], v2
    s_waitcnt lgkmcnt(2)
    buffer_load_dword v121, v122, s[4:7], s64 offen sc1
    v_exp_f32 v50, v50
    v_exp_f32 v51, v51
    v_exp_f32 v52, v52
    v_mfma_f32_32x32x16_bf16 v[32:47], v[96:99], v[20:23], 0
    buffer_load_dwordx4 a[188:191], v124, s[4:7], s82 offen offset:3072 sc1
    s_mov_b32 s74, 79872
    v_exp_f32 v53, v53
    v_exp_f32 v54, v54
    v_exp_f32 v55, v55
    v_exp_f32 v56, v56
    v_exp_f32 v57, v57
    v_exp_f32 v58, v58
    v_smfmac_f32_32x32x32_bf16 v[80:95], v[108:111], v[48:55], v2
    s_waitcnt lgkmcnt(0)
    buffer_load_dword v30, v127, s[4:7], s74 offen sc1
    v_exp_f32 v59, v59
    v_exp_f32 v60, v60
    v_exp_f32 v61, v61
    v_exp_f32 v62, v62
    v_exp_f32 v63, v63
    v_exp_f32 v32, v32
    v_exp_f32 v33, v33
    v_smfmac_f32_32x32x32_bf16 v[80:95], v[116:119], v[56:63], v2
    ds_read_b128 v[100:103], v3 offset:14560
    v_exp_f32 v34, v34
    v_exp_f32 v35, v35
    v_exp_f32 v36, v36
    v_mfma_f32_32x32x16_bf16 v[48:63], v[96:99], v[24:27], 0
    ds_read_b128 v[108:111], v4 offset:14560
    s_add_u32 s82, s82, 4096
    v_exp_f32 v37, v37
    v_exp_f32 v38, v38
    v_exp_f32 v39, v39
    v_exp_f32 v40, v40
    v_exp_f32 v41, v41
    v_exp_f32 v42, v42
    v_smfmac_f32_32x32x32_bf16 v[64:79], v[104:107], v[32:39], v2
    ds_read_b128 v[116:119], v5 offset:14560
    buffer_load_dwordx4 a[196:199], v124, s[4:7], s82 offen offset:0 sc1
    v_exp_f32 v43, v43
    v_exp_f32 v44, v44
    v_exp_f32 v45, v45
    v_exp_f32 v46, v46
    v_exp_f32 v47, v47
    v_exp_f32 v48, v48
    v_exp_f32 v49, v49
    v_smfmac_f32_32x32x32_bf16 v[64:79], v[112:115], v[40:47], v2
    s_waitcnt lgkmcnt(2)
    buffer_load_dwordx4 v1, s[4:7], s80 offen offset:2048 sc1 lds
    v_exp_f32 v50, v50
    v_exp_f32 v51, v51
    v_exp_f32 v52, v52
    v_mfma_f32_32x32x16_bf16 v[32:47], v[100:103], v[20:23], 0
    buffer_load_dwordx4 a[204:207], v124, s[4:7], s82 offen offset:1024 sc1
    s_mov_b32 s74, 87040
    v_exp_f32 v53, v53
    v_exp_f32 v54, v54
    v_exp_f32 v55, v55
    v_exp_f32 v56, v56
    v_exp_f32 v57, v57
    v_exp_f32 v58, v58
    v_smfmac_f32_32x32x32_bf16 v[80:95], v[104:107], v[48:55], v2
    s_waitcnt lgkmcnt(0)
    buffer_load_dword v31, v127, s[4:7], s74 offen sc1
    v_exp_f32 v59, v59
    v_exp_f32 v60, v60
    v_exp_f32 v61, v61
    v_exp_f32 v62, v62
    v_exp_f32 v63, v63
    v_exp_f32 v32, v32
    v_exp_f32 v33, v33
    v_smfmac_f32_32x32x32_bf16 v[80:95], v[112:115], v[56:63], v2
    ds_read_b128 v[96:99], v3 offset:0
    v_exp_f32 v34, v34
    v_exp_f32 v35, v35
    v_exp_f32 v36, v36
    v_mfma_f32_32x32x16_bf16 v[48:63], v[100:103], v[24:27], 0
    ds_read_b128 v[104:107], v4 offset:0
    v_exp_f32 v37, v37
    v_exp_f32 v38, v38
    v_exp_f32 v39, v39
    v_exp_f32 v40, v40
    v_exp_f32 v41, v41
    v_exp_f32 v42, v42
    v_smfmac_f32_32x32x32_bf16 v[64:79], v[108:111], v[32:39], v2
    ds_read_b128 v[112:115], v5 offset:0
    buffer_load_dwordx4 a[212:215], v124, s[4:7], s82 offen offset:2048 sc1
    v_exp_f32 v43, v43
    v_exp_f32 v44, v44
    v_exp_f32 v45, v45
    v_exp_f32 v46, v46
    v_exp_f32 v47, v47
    v_exp_f32 v48, v48
    v_exp_f32 v49, v49
    v_smfmac_f32_32x32x32_bf16 v[64:79], v[116:119], v[40:47], v2
    s_waitcnt lgkmcnt(2)
    buffer_load_dwordx4 v1, s[4:7], s80 offen offset:3072 sc1 lds
    v_exp_f32 v50, v50
    v_exp_f32 v51, v51
    v_exp_f32 v52, v52
    v_mfma_f32_32x32x16_bf16 v[32:47], v[96:99], v[20:23], 0
    buffer_load_ushort v127, v125, s[24:27], 0 offen
    v_exp_f32 v53, v53
    v_exp_f32 v54, v54
    v_exp_f32 v55, v55
    v_exp_f32 v56, v56
    v_exp_f32 v57, v57
    v_exp_f32 v58, v58
    v_smfmac_f32_32x32x32_bf16 v[80:95], v[108:111], v[48:55], v2
    s_waitcnt lgkmcnt(0)
    buffer_load_dwordx4 a[220:223], v124, s[4:7], s82 offen offset:3072 sc1
    v_exp_f32 v59, v59
    v_exp_f32 v60, v60
    v_exp_f32 v61, v61
    v_exp_f32 v62, v62
    v_exp_f32 v63, v63
    v_exp_f32 v32, v32
    v_exp_f32 v33, v33
    v_smfmac_f32_32x32x32_bf16 v[80:95], v[116:119], v[56:63], v2
    ds_read_b128 v[100:103], v3 offset:2080
    v_exp_f32 v34, v34
    v_exp_f32 v35, v35
    v_exp_f32 v36, v36
    v_mfma_f32_32x32x16_bf16 v[48:63], v[96:99], v[24:27], 0
    ds_read_b128 v[108:111], v4 offset:2080
    v_exp_f32 v37, v37
    v_exp_f32 v38, v38
    v_exp_f32 v39, v39
    v_exp_f32 v40, v40
    v_exp_f32 v41, v41
    v_exp_f32 v42, v42
    v_smfmac_f32_32x32x32_bf16 v[64:79], v[104:107], v[32:39], v2
    ds_read_b128 v[116:119], v5 offset:2080
    s_waitcnt vmcnt(10)
    v_cmp_ne_u32 vcc, v121, v6
    s_cbranch_vccnz RT_22
BK_23:
    s_cmp_lg_u32 s31, 0
    s_cbranch_scc1 SF_26
SFD_27:
    v_exp_f32 v43, v43
    v_exp_f32 v44, v44
    v_exp_f32 v45, v45
    v_exp_f32 v46, v46
    v_exp_f32 v47, v47
    v_exp_f32 v48, v48
    v_exp_f32 v49, v49
    v_smfmac_f32_32x32x32_bf16 v[64:79], v[112:115], v[40:47], v2
    s_waitcnt lgkmcnt(2)
    s_lshl2_add_u32 s71, s62, s60
    v_exp_f32 v50, v50
    v_exp_f32 v51, v51
    v_exp_f32 v52, v52
    v_mfma_f32_32x32x16_bf16 v[32:47], v[100:103], v[20:23], 0
    s_lshl_b32 s70, s61, 4
    v_exp_f32 v53, v53
    v_exp_f32 v54, v54
    v_exp_f32 v55, v55
    v_exp_f32 v56, v56
    v_exp_f32 v57, v57
    v_exp_f32 v58, v58
    v_smfmac_f32_32x32x32_bf16 v[80:95], v[104:107], v[48:55], v2
    s_waitcnt lgkmcnt(0)
    s_add_u32 s71, s71, s70
    s_lshl_b32 s70, s71, 11
    v_exp_f32 v59, v59
    v_exp_f32 v60, v60
    v_exp_f32 v61, v61
    v_exp_f32 v62, v62
    v_exp_f32 v63, v63
    v_exp_f32 v32, v32
    v_exp_f32 v33, v33
    v_smfmac_f32_32x32x32_bf16 v[80:95], v[112:115], v[56:63], v2
    ds_read_b128 v[96:99], v3 offset:4160
    v_exp_f32 v34, v34
    v_exp_f32 v35, v35
    v_exp_f32 v36, v36
    v_mfma_f32_32x32x16_bf16 v[48:63], v[100:103], v[24:27], 0
    ds_read_b128 v[104:107], v4 offset:4160
    v_exp_f32 v37, v37
    v_exp_f32 v38, v38
    v_exp_f32 v39, v39
    v_exp_f32 v40, v40
    v_exp_f32 v41, v41
    v_exp_f32 v42, v42
    v_smfmac_f32_32x32x32_bf16 v[64:79], v[108:111], v[32:39], v2
    ds_read_b128 v[112:115], v5 offset:4160
    v_exp_f32 v43, v43
    v_exp_f32 v44, v44
    v_exp_f32 v45, v45
    v_exp_f32 v46, v46
    v_exp_f32 v47, v47
    v_exp_f32 v48, v48
    v_exp_f32 v49, v49
    v_smfmac_f32_32x32x32_bf16 v[64:79], v[116:119], v[40:47], v2
TCH4:
    s_cbranch_execz TCH8
    s_waitcnt lgkmcnt(2)
    s_add_u32 s70, s70, s63
    v_exp_f32 v50, v50
    v_exp_f32 v51, v51
    v_exp_f32 v52, v52
    v_mfma_f32_32x32x16_bf16 v[32:47], v[96:99], v[20:23], 0
    s_lshl_b32 s76, s71, 8
    v_exp_f32 v53, v53
    v_exp_f32 v54, v54
    v_exp_f32 v55, v55
    v_exp_f32 v56, v56
    v_exp_f32 v57, v57
    v_exp_f32 v58, v58
    v_smfmac_f32_32x32x32_bf16 v[80:95], v[108:111], v[48:55], v2
    s_waitcnt lgkmcnt(0)
    s_add_u32 s76, s76, s63
    s_add_u32 s76, s76, 1441792
    v_exp_f32 v59, v59
    v_exp_f32 v60, v60
    v_exp_f32 v61, v61
    v_exp_f32 v62, v62
    v_exp_f32 v63, v63
    v_exp_f32 v32, v32
    v_exp_f32 v33, v33
    v_smfmac_f32_32x32x32_bf16 v[80:95], v[116:119], v[56:63], v2
    ds_read_b128 v[100:103], v3 offset:6240
    v_exp_f32 v34, v34
    v_exp_f32 v35, v35
    v_exp_f32 v36, v36
    v_mfma_f32_32x32x16_bf16 v[48:63], v[96:99], v[24:27], 0
    ds_read_b128 v[108:111], v4 offset:6240
    v_exp_f32 v37, v37
    v_exp_f32 v38, v38
    v_exp_f32 v39, v39
    v_exp_f32 v40, v40
    v_exp_f32 v41, v41
    v_exp_f32 v42, v42
    v_smfmac_f32_32x32x32_bf16 v[64:79], v[104:107], v[32:39], v2
    ds_read_b128 v[116:119], v5 offset:6240
    v_exp_f32 v43, v43
    v_exp_f32 v44, v44
    v_exp_f32 v45, v45
    v_exp_f32 v46, v46
    v_exp_f32 v47, v47
    v_exp_f32 v48, v48
    v_exp_f32 v49, v49
    v_smfmac_f32_32x32x32_bf16 v[64:79], v[112:115], v[40:47], v2
    s_waitcnt lgkmcnt(2)
    s_xor_b32 s33, s70, 8192
    v_exp_f32 v50, v50
    v_exp_f32 v51, v51
    v_exp_f32 v52, v52
    v_mfma_f32_32x32x16_bf16 v[32:47], v[100:103], v[20:23], 0
    s_xor_b32 s34, s70, 16384
    v_exp_f32 v53, v53
    v_exp_f32 v54, v54
    v_exp_f32 v55, v55
    v_exp_f32 v56, v56
    v_exp_f32 v57, v57
    v_exp_f32 v58, v58
    v_smfmac_f32_32x32x32_bf16 v[80:95], v[104:107], v[48:55], v2
    s_waitcnt lgkmcnt(0)
    s_barrier
    s_xor_b32 s35, s70, 24576
    s_lshl_b32 s71, s60, 11
    v_exp_f32 v59, v59
    v_exp_f32 v60, v60
    v_exp_f32 v61, v61
    v_exp_f32 v62, v62
    v_exp_f32 v63, v63
    v_exp_f32 v32, v32
    v_exp_f32 v33, v33
    v_smfmac_f32_32x32x32_bf16 v[80:95], v[112:115], v[56:63], v2
    v_exp_f32 v34, v34
    v_exp_f32 v35, v35
    v_exp_f32 v36, v36
    v_mfma_f32_32x32x16_bf16 v[48:63], v[100:103], v[24:27], 0
    v_exp_f32 v37, v37
    v_exp_f32 v38, v38
    v_exp_f32 v39, v39
    v_exp_f32 v40, v40
    v_exp_f32 v41, v41
    v_exp_f32 v42, v42
    v_smfmac_f32_32x32x32_bf16 v[64:79], v[108:111], v[32:39], v2
    v_exp_f32 v43, v43
    v_exp_f32 v44, v44
    v_exp_f32 v45, v45
    v_exp_f32 v46, v46
    v_exp_f32 v47, v47
    v_exp_f32 v48, v48
    v_exp_f32 v49, v49
    v_smfmac_f32_32x32x32_bf16 v[64:79], v[116:119], v[40:47], v2
    s_mov_b32 s74, 1006632960
    v_exp_f32 v50, v50
    v_exp_f32 v51, v51
    v_exp_f32 v52, v52
    v_add_u32 v123, s71, v3
    v_exp_f32 v53, v53
    v_exp_f32 v54, v54
    v_exp_f32 v55, v55
    v_exp_f32 v56, v56
    v_exp_f32 v57, v57
    v_exp_f32 v58, v58
    v_smfmac_f32_32x32x32_bf16 v[80:95], v[108:111], v[48:55], v2
    v_exp_f32 v59, v59
    v_exp_f32 v60, v60
    v_exp_f32 v61, v61
    v_exp_f32 v62, v62
    v_exp_f32 v63, v63
    v_subrev_u32 v122, 562036736, v72
    v_rcp_f32 v74, v72
    v_smfmac_f32_32x32x32_bf16 v[80:95], v[116:119], v[56:63], v2
    v_mul_f32 v64, v64, v74
    v_mul_f32 v65, v65, v74
    v_mul_f32 v66, v66, v74
    v_mul_f32 v67, v67, v74
    v_mul_f32 v68, v68, v74
    v_mul_f32 v69, v69, v74
    v_mul_f32 v70, v70, v74
    v_mul_f32 v71, v71, v74
    v_cvt_pk_bf16_f32 v64, v64, v65
    v_cvt_pk_bf16_f32 v65, v66, v67
    v_cvt_pk_bf16_f32 v66, v68, v69
    v_cvt_pk_bf16_f32 v67, v70, v71
    v_subrev_u32 v121, 562036736, v88
    v_rcp_f32 v90, v88
    v_max_u32 v122, v122, v121
    v_cmp_lt_u32 vcc, s74, v122
    v_pk_mul_f32 v[80:81], v[80:81], v[90:91] op_sel_hi:[1,0]
    v_pk_mul_f32 v[82:83], v[82:83], v[90:91] op_sel_hi:[1,0]
    v_pk_mul_f32 v[84:85], v[84:85], v[90:91] op_sel_hi:[1,0]
    v_pk_mul_f32 v[86:87], v[86:87], v[90:91] op_sel_hi:[1,0]
    s_cbranch_vccnz SLOW0
SLOW0D:
    buffer_store_dwordx4 v[64:67], v1, s[4:7], s70 offen
    v_cvt_pk_bf16_f32 v80, v80, v81
    v_cvt_pk_bf16_f32 v81, v82, v83
    v_cvt_pk_bf16_f32 v82, v84, v85
    v_cvt_pk_bf16_f32 v83, v86, v87
    buffer_store_dwordx4 v[80:83], v1, s[4:7], s70 offen offset:1024
    s_cmp_lg_u32 s31, 0
    s_cbranch_scc1 SF_28
SFD_29:
    buffer_load_dwordx4 v[96:99], v1, s[4:7], s33 offen offset:0 sc1
    buffer_load_dwordx4 v[100:103], v1, s[4:7], s33 offen offset:1024 sc1
    ds_write_b128 v123, v[64:67] offset:0
    ds_write_b128 v123, v[80:83] offset:1024
    buffer_load_dwordx4 v[104:107], v1, s[4:7], s34 offen offset:0 sc1
    buffer_load_dwordx4 v[108:111], v1, s[4:7], s34 offen offset:1024 sc1
    buffer_load_dwordx4 v[112:115], v1, s[4:7], s35 offen offset:0 sc1
    buffer_load_dwordx4 v[116:119], v1, s[4:7], s35 offen offset:1024 sc1
    s_branch NEAR_30
RT_31:
    s_cmp_eq_u32 s29, 0
    s_cbranch_scc1 BK_32
    s_sub_u32 s29, s29, 1
    s_cmp_lg_u32 s31, 0
    s_cbranch_scc1 SF_34
SFD_35:
    buffer_load_dwordx4 v[96:99], v1, s[4:7], s33 offen offset:0 sc1
    buffer_load_dwordx4 v[100:103], v1, s[4:7], s33 offen offset:1024 sc1
    buffer_load_dwordx4 v[104:107], v1, s[4:7], s34 offen offset:0 sc1
    buffer_load_dwordx4 v[108:111], v1, s[4:7], s34 offen offset:1024 sc1
    buffer_load_dwordx4 v[112:115], v1, s[4:7], s35 offen offset:0 sc1
    buffer_load_dwordx4 v[116:119], v1, s[4:7], s35 offen offset:1024 sc1
    s_branch AG_33
RT_36:
    s_cmp_eq_u32 s29, 0
    s_cbranch_scc1 BK_37
    s_sub_u32 s29, s29, 1
    s_cmp_lg_u32 s31, 0
    s_cbranch_scc1 SF_39
SFD_40:
    buffer_load_dwordx4 v[104:107], v1, s[4:7], s34 offen offset:0 sc1
    buffer_load_dwordx4 v[108:111], v1, s[4:7], s34 offen offset:1024 sc1
    buffer_load_dwordx4 v[112:115], v1, s[4:7], s35 offen offset:0 sc1
    buffer_load_dwordx4 v[116:119], v1, s[4:7], s35 offen offset:1024 sc1
    s_branch AG_38
RT_41:
    s_cmp_eq_u32 s29, 0
    s_cbranch_scc1 BK_42
    s_sub_u32 s29, s29, 1
    s_cmp_lg_u32 s31, 0
    s_cbranch_scc1 SF_44
SFD_45:
    buffer_load_dwordx4 v[112:115], v1, s[4:7], s35 offen offset:0 sc1
    buffer_load_dwordx4 v[116:119], v1, s[4:7], s35 offen offset:1024 sc1
    s_branch AG_43
NEAR_30:
    v_lshlrev_b32 v32, 16, v12
    v_and_b32 v33, s91, v12
    v_lshlrev_b32 v34, 16, v13
    v_and_b32 v35, s91, v13
    v_lshlrev_b32 v36, 16, v14
    v_and_b32 v37, s91, v14
    v_lshlrev_b32 v38, 16, v15
    v_and_b32 v39, s91, v15
    v_lshlrev_b32 v40, 16, v16
    v_and_b32 v41, s91, v16
    v_lshlrev_b32 v42, 16, v17
    v_and_b32 v43, s91, v17
    v_lshlrev_b32 v44, 16, v18
    v_and_b32 v45, s91, v18
    v_lshlrev_b32 v46, 16, v19
    v_and_b32 v47, s91, v19
    s_waitcnt lgkmcnt(0)
    s_barrier
    ds_read_b128 v[48:51], v3 offset:0
    ds_read_b128 v[52:55], v3 offset:1024
    ds_read_b128 v[56:59], v3 offset:2048
    ds_read_b128 v[60:63], v3 offset:3072
    ds_read_b128 v[64:67], v3 offset:4096
    ds_read_b128 v[68:71], v3 offset:5120
    ds_read_b128 v[72:75], v3 offset:6144
    ds_read_b128 v[76:79], v3 offset:7168
    s_waitcnt vmcnt(9)
    v_add_f32 v28, v28, v29
    v_add_f32 v30, v30, v31
    v_lshlrev_b32 v127, 16, v127
    v_add_f32 v28, v28, v30
    s_lshl_b32 s74, s60, 8
    s_add_u32 s74, s74, 115712
    v_bfe_u32 v29, v1, 6, 3
    v_lshl_add_u32 v29, v29, 5, s74
    v_bfe_u32 v30, v1, 4, 2
    v_lshl_add_u32 v29, v30, 2, v29
    ds_write2_b32 v29, v28, v127 offset1:4
    s_waitcnt lgkmcnt(8)
    v_mfma_f32_32x32x16_bf16 v[32:47], v[128:131], v[48:51], v[32:47]
    s_waitcnt lgkmcnt(7)
    v_mfma_f32_32x32x16_bf16 v[32:47], v[132:135], v[52:55], v[32:47]
    s_waitcnt lgkmcnt(6)
    v_mfma_f32_32x32x16_bf16 v[32:47], v[136:139], v[56:59], v[32:47]
    s_waitcnt lgkmcnt(5)
    v_mfma_f32_32x32x16_bf16 v[32:47], v[140:143], v[60:63], v[32:47]
AG_33:
    s_waitcnt vmcnt(4)
    v_max_u32 v120, v96, v100
    v_cmp_eq_u32 vcc, -1, v120
    ds_write_b128 v123, v[96:99] offset:8192
    ds_write_b128 v123, v[100:103] offset:9216
    s_cbranch_vccnz RT_31
BK_32:
    s_waitcnt lgkmcnt(6)
    v_mfma_f32_32x32x16_bf16 v[32:47], v[144:147], v[64:67], v[32:47]
    s_waitcnt lgkmcnt(5)
    v_mfma_f32_32x32x16_bf16 v[32:47], v[148:151], v[68:71], v[32:47]
    s_waitcnt lgkmcnt(0)
    s_barrier
    ds_read_b128 v[48:51], v3 offset:8192
    ds_read_b128 v[52:55], v3 offset:9216
    ds_read_b128 v[56:59], v3 offset:10240
    ds_read_b128 v[60:63], v3 offset:11264
    ds_read_b128 v[64:67], v3 offset:12288
    s_waitcnt lgkmcnt(9)
    v_mfma_f32_32x32x16_bf16 v[32:47], v[152:155], v[72:75], v[32:47]
    ds_read_b128 v[68:71], v3 offset:13312
    s_waitcnt lgkmcnt(9)
    v_mfma_f32_32x32x16_bf16 v[32:47], v[156:159], v[76:79], v[32:47]
    ds_read_b128 v[72:75], v3 offset:14336
AG_38:
    s_waitcnt vmcnt(2)
    v_max_u32 v120, v104, v108
    v_cmp_eq_u32 vcc, -1, v120
    ds_write_b128 v123, v[104:107] offset:16384
    ds_write_b128 v123, v[108:111] offset:17408
    s_cbranch_vccnz RT_36
BK_37:
    s_waitcnt lgkmcnt(8)
    v_mfma_f32_32x32x16_bf16 v[32:47], v[160:163], v[48:51], v[32:47]
    ds_read_b128 v[76:79], v3 offset:15360
    s_waitcnt lgkmcnt(8)
    v_mfma_f32_32x32x16_bf16 v[32:47], v[164:167], v[52:55], v[32:47]
    s_waitcnt lgkmcnt(7)
    v_mfma_f32_32x32x16_bf16 v[32:47], v[168:171], v[56:59], v[32:47]
AG_43:
    s_waitcnt vmcnt(0)
    v_max_u32 v120, v112, v116
    v_cmp_eq_u32 vcc, -1, v120
    ds_write_b128 v123, v[112:115] offset:24576
    ds_write_b128 v123, v[116:119] offset:25600
    s_cbranch_vccnz RT_41
BK_42:
    s_waitcnt lgkmcnt(8)
    v_mfma_f32_32x32x16_bf16 v[32:47], v[172:175], v[60:63], v[32:47]
    s_waitcnt lgkmcnt(3)
    s_barrier
    ds_read_b128 v[48:51], v3 offset:16384
    ds_read_b128 v[52:55], v3 offset:17408
    s_waitcnt lgkmcnt(9)
    v_mfma_f32_32x32x16_bf16 v[32:47], v[176:179], v[64:67], v[32:47]
    ds_read_b128 v[56:59], v3 offset:18432
    v_and_b32 v122, 0xf0, v1
    v_bfe_u32 v121, v1, 8, 1
    v_lshl_add_u32 v122, v121, 3, v122
    s_waitcnt lgkmcnt(9)
    v_mfma_f32_32x32x16_bf16 v[32:47], v[180:183], v[68:71], v[32:47]
    ds_read_b128 v[60:63], v3 offset:19456
    v_lshrrev_b32 v121, 9, v1
    v_lshl_add_u32 v122, v121, 2, v122
    v_mov_b32 v124, 0
    s_waitcnt lgkmcnt(9)
    v_mfma_f32_32x32x16_bf16 v[32:47], v[184:187], v[72:75], v[32:47]
    ds_read_b128 v[64:67], v3 offset:20480
    v_mov_b32 v125, 0
    s_add_u32 s70, s70, 262144
    s_lshr_b32 s75, s59, 4
    s_waitcnt lgkmcnt(7)
    v_mfma_f32_32x32x16_bf16 v[32:47], v[188:191], v[76:79], v[32:47]
    ds_read_b128 v[68:71], v3 offset:21504
    s_lshl2_add_u32 s75, s75, s60
    s_lshl_b32 s40, s75, 15
    s_add_u32 s40, s40, s63
    s_waitcnt lgkmcnt(5)
    v_mfma_f32_32x32x16_bf16 v[32:47], v[192:195], v[48:51], v[32:47]
    ds_read_b128 v[72:75], v3 offset:22528
    s_add_u32 s40, s40, 262144
    s_add_u32 s41, s40, 4096
    s_add_u32 s42, s40, 8192
    s_waitcnt lgkmcnt(5)
    v_mfma_f32_32x32x16_bf16 v[32:47], v[196:199], v[52:55], v[32:47]
    s_waitcnt lgkmcnt(7)
    s_barrier
    ds_read_b128 v[76:79], v3 offset:23552
    s_waitcnt lgkmcnt(5)
    v_mfma_f32_32x32x16_bf16 v[32:47], v[200:203], v[56:59], v[32:47]
    ds_read_b128 v[48:51], v3 offset:24576
    s_add_u32 s43, s40, 12288
    s_add_u32 s44, s40, 16384
    s_add_u32 s45, s40, 20480
    s_waitcnt lgkmcnt(5)
    v_mfma_f32_32x32x16_bf16 v[32:47], v[204:207], v[60:63], v[32:47]
    ds_read_b128 v[52:55], v3 offset:25600
    s_add_u32 s46, s40, 24576
    s_add_u32 s47, s40, 28672
    s_lshl_b32 s74, s75, 12
    s_waitcnt lgkmcnt(5)
    v_mfma_f32_32x32x16_bf16 v[32:47], v[208:211], v[64:67], v[32:47]
    ds_read_b128 v[56:59], v3 offset:26624
    s_add_u32 s74, s74, s63
    s_add_u32 s74, s74, 1441792
    v_add_u32 v88, 0x10000, v1
    s_waitcnt lgkmcnt(5)
    v_mfma_f32_32x32x16_bf16 v[32:47], v[212:215], v[68:71], v[32:47]
    ds_read_b128 v[60:63], v3 offset:27648
    v_lshrrev_b32 v91, 8, v1
    v_and_b32 v89, 0xf0, v1
    v_lshlrev_b32 v4, 4, v89
    s_waitcnt lgkmcnt(5)
    v_mfma_f32_32x32x16_bf16 v[32:47], v[216:219], v[72:75], v[32:47]
    ds_read_b128 v[64:67], v3 offset:28672
    v_lshl_add_u32 v4, v91, 6, v4
    v_lshl_add_u32 v90, v91, 10, v89
    v_lshl_add_u32 v89, v91, 9, v89
    s_waitcnt lgkmcnt(5)
    v_mfma_f32_32x32x16_bf16 v[32:47], v[220:223], v[76:79], v[32:47]
    ds_read_b128 v[68:71], v3 offset:29696
    v_lshlrev_b32 v91, 5, v91
    v_add_u32 v91, 115712, v91
    s_and_b32 s77, s59, 15
    s_waitcnt lgkmcnt(5)
    v_mfma_f32_32x32x16_bf16 v[32:47], v[224:227], v[48:51], v[32:47]
    ds_read_b128 v[72:75], v3 offset:30720
    s_mul_i32 s77, s77, 7168
    s_mul_i32 s75, s75, 114688
    s_add_u32 s77, s77, s75
    s_waitcnt lgkmcnt(5)
    v_mfma_f32_32x32x16_bf16 v[32:47], v[228:231], v[52:55], v[32:47]
    ds_read_b128 v[76:79], v3 offset:31744
    s_add_u32 s77, s77, s63
    s_add_u32 s77, s77, 524288
    s_lshl2_add_u32 s79, s62, s60
    s_waitcnt lgkmcnt(5)
    v_mfma_f32_32x32x16_bf16 v[32:47], v[232:235], v[56:59], v[32:47]
    s_lshl_b32 s79, s79, 15
    s_add_u32 s79, s79, 1048576
    ds_read_b128 v[96:99], v1 offset:0
    s_waitcnt lgkmcnt(5)
    v_mfma_f32_32x32x16_bf16 v[32:47], v[236:239], v[60:63], v[32:47]
    ds_read_b128 v[100:103], v1 offset:16384
    s_waitcnt lgkmcnt(5)
    v_mfma_f32_32x32x16_bf16 v[32:47], v[240:243], v[64:67], v[32:47]
    ds_read_b128 v[104:107], v1 offset:32768
    s_waitcnt lgkmcnt(5)
    v_mfma_f32_32x32x16_bf16 v[32:47], v[244:247], v[68:71], v[32:47]
    ds_read_b128 v[108:111], v1 offset:49152
    s_waitcnt lgkmcnt(5)
    v_mfma_f32_32x32x16_bf16 v[32:47], v[248:251], v[72:75], v[32:47]
    ds_read_b128 v[112:115], v88 offset:0
    s_waitcnt lgkmcnt(5)
    v_mfma_f32_32x32x16_bf16 v[32:47], v[252:255], v[76:79], v[32:47]
    ds_read_b128 v[116:119], v88 offset:16384
    s_nop 10
    v_cvt_pk_bf16_f32 v80, v32, v33
    v_cvt_pk_bf16_f32 v81, v34, v35
    v_cvt_pk_bf16_f32 v82, v36, v37
    v_cvt_pk_bf16_f32 v83, v38, v39
    buffer_store_dwordx4 v[80:83], v1, s[4:7], s70 offen offset:0
    v_cvt_pk_bf16_f32 v84, v40, v41
    v_cvt_pk_bf16_f32 v85, v42, v43
    v_cvt_pk_bf16_f32 v86, v44, v45
    v_cvt_pk_bf16_f32 v87, v46, v47
    buffer_store_dwordx4 v[84:87], v1, s[4:7], s70 offen offset:1024
    v_dot2c_f32_bf16 v124, s68, v80
    v_dot2c_f32_bf16 v125, v80, v80
    v_dot2c_f32_bf16 v124, s68, v81
    v_dot2c_f32_bf16 v125, v81, v81
    v_dot2c_f32_bf16 v124, s68, v82
    v_dot2c_f32_bf16 v125, v82, v82
    v_dot2c_f32_bf16 v124, s68, v83
    v_dot2c_f32_bf16 v125, v83, v83
    v_dot2c_f32_bf16 v124, s68, v84
    v_dot2c_f32_bf16 v125, v84, v84
    v_dot2c_f32_bf16 v124, s68, v85
    v_dot2c_f32_bf16 v125, v85, v85
    v_dot2c_f32_bf16 v124, s68, v86
    v_dot2c_f32_bf16 v125, v86, v86
    v_dot2c_f32_bf16 v124, s68, v87
    v_dot2c_f32_bf16 v125, v87, v87
    s_nop 2
    v_permlane32_swap_b32 v124, v125
    v_add_f32 v124, v124, v125
    buffer_store_dword v124, v122, s[4:7], s76 offen
    s_cmp_lg_u32 s31, 0
    s_cbranch_scc1 SF_46
SFD_47:
AG_48:
    s_cmp_lg_u32 s31, 0
    s_cbranch_scc1 SF_49
SFD_50:
    buffer_load_dword v5, v4, s[4:7], s74 offen sc1
    buffer_load_dwordx4 v[128:131], v89, s[4:7], s40 offen offset:0 sc1
    buffer_load_dwordx4 v[132:135], v89, s[4:7], s40 offen offset:256 sc1
    buffer_load_dwordx4 v[136:139], v89, s[4:7], s40 offen offset:2048 sc1
    buffer_load_dwordx4 v[140:143], v89, s[4:7], s40 offen offset:2304 sc1
    s_cmp_lg_u32 s29, 0
    s_cselect_b32 vcc_lo, -2, -1
    s_subb_u32 s29, s29, 0
    s_waitcnt vmcnt(2)
    v_max3_u32 v5, v5, v128, v132
    s_waitcnt vmcnt(0)
    v_max3_u32 v5, v5, v136, v140
    v_cmp_lt_u32 vcc, vcc_lo, v5
    s_cbranch_vccnz AG_48
    buffer_load_dwordx4 v[144:147], v89, s[4:7], s41 offen offset:0 sc1
    buffer_load_dwordx4 v[148:151], v89, s[4:7], s41 offen offset:256 sc1
    s_waitcnt lgkmcnt(5)
    v_mfma_f32_16x16x32_bf16 v[32:35], v[96:99], v[128:131], 0
    ds_read_b128 v[120:123], v88 offset:32768
    v_mfma_f32_16x16x32_bf16 v[36:39], v[96:99], v[132:135], 0
    buffer_load_dwordx4 v[152:155], v89, s[4:7], s41 offen offset:2048 sc1
    s_waitcnt lgkmcnt(5)
    v_mfma_f32_16x16x32_bf16 v[40:43], v[100:103], v[128:131], 0
    ds_read_b128 v[124:127], v1 offset:1024
    v_mfma_f32_16x16x32_bf16 v[44:47], v[100:103], v[132:135], 0
    s_waitcnt lgkmcnt(5)
    v_mfma_f32_16x16x32_bf16 v[48:51], v[104:107], v[128:131], 0
    ds_read_b128 v[96:99], v1 offset:17408
    v_mfma_f32_16x16x32_bf16 v[52:55], v[104:107], v[132:135], 0
    buffer_load_dwordx4 v[156:159], v89, s[4:7], s41 offen offset:2304 sc1
    s_waitcnt lgkmcnt(5)
    v_mfma_f32_16x16x32_bf16 v[56:59], v[108:111], v[128:131], 0
    ds_read_b128 v[100:103], v1 offset:33792
    v_mfma_f32_16x16x32_bf16 v[60:63], v[108:111], v[132:135], 0
    s_waitcnt lgkmcnt(5)
    v_mfma_f32_16x16x32_bf16 v[64:67], v[112:115], v[128:131], 0
    ds_read_b128 v[104:107], v1 offset:50176
    v_mfma_f32_16x16x32_bf16 v[68:71], v[112:115], v[132:135], 0
    buffer_load_dwordx4 v[12:15], v90, s[4:7], s74 offen offset:0 sc1
    s_waitcnt lgkmcnt(5)
    v_mfma_f32_16x16x32_bf16 v[72:75], v[116:119], v[128:131], 0
    ds_read_b128 v[108:111], v88 offset:1024
    v_mfma_f32_16x16x32_bf16 v[76:79], v[116:119], v[132:135], 0
    s_waitcnt lgkmcnt(5)
    v_mfma_f32_16x16x32_bf16 v[80:83], v[120:123], v[128:131], 0
    ds_read_b128 v[112:115], v88 offset:17408
    v_mfma_f32_16x16x32_bf16 v[84:87], v[120:123], v[132:135], 0
    buffer_load_dwordx4 v[160:163], v89, s[4:7], s42 offen offset:0 sc1
    s_waitcnt lgkmcnt(5)
    v_mfma_f32_16x16x32_bf16 v[32:35], v[124:127], v[136:139], v[32:35]
    ds_read_b128 v[116:119], v88 offset:33792
    v_mfma_f32_16x16x32_bf16 v[36:39], v[124:127], v[140:143], v[36:39]
    buffer_load_dwordx4 v[164:167], v89, s[4:7], s42 offen offset:256 sc1
    s_waitcnt lgkmcnt(5)
    v_mfma_f32_16x16x32_bf16 v[40:43], v[96:99], v[136:139], v[40:43]
    ds_read_b128 v[120:123], v1 offset:2048
    v_mfma_f32_16x16x32_bf16 v[44:47], v[96:99], v[140:143], v[44:47]
    s_waitcnt lgkmcnt(5)
    v_mfma_f32_16x16x32_bf16 v[48:51], v[100:103], v[136:139], v[48:51]
    ds_read_b128 v[124:127], v1 offset:18432
    v_mfma_f32_16x16x32_bf16 v[52:55], v[100:103], v[140:143], v[52:55]
    buffer_load_dwordx4 v[16:19], v90, s[4:7], s74 offen offset:256 sc1
    s_waitcnt lgkmcnt(5)
    v_mfma_f32_16x16x32_bf16 v[56:59], v[104:107], v[136:139], v[56:59]
    ds_read_b128 v[96:99], v1 offset:34816
    v_mfma_f32_16x16x32_bf16 v[60:63], v[104:107], v[140:143], v[60:63]
    s_waitcnt vmcnt(6)
    v_max_u32 v5, v144, v148
    v_cmp_eq_u32 vcc, -1, v5
    s_waitcnt lgkmcnt(5)
    v_mfma_f32_16x16x32_bf16 v[64:67], v[108:111], v[136:139], v[64:67]
    ds_read_b128 v[100:103], v1 offset:51200
    v_mfma_f32_16x16x32_bf16 v[68:71], v[108:111], v[140:143], v[68:71]
    s_cbranch_vccnz RT_51
BK_52:
    buffer_load_dwordx4 v[168:171], v89, s[4:7], s42 offen offset:2048 sc1
    s_waitcnt lgkmcnt(5)
    v_mfma_f32_16x16x32_bf16 v[72:75], v[112:115], v[136:139], v[72:75]
    ds_read_b128 v[104:107], v88 offset:2048
    v_mfma_f32_16x16x32_bf16 v[76:79], v[112:115], v[140:143], v[76:79]
    s_waitcnt lgkmcnt(5)
    v_mfma_f32_16x16x32_bf16 v[80:83], v[116:119], v[136:139], v[80:83]
    ds_read_b128 v[108:111], v88 offset:18432
    v_mfma_f32_16x16x32_bf16 v[84:87], v[116:119], v[140:143], v[84:87]
    buffer_load_dwordx4 v[172:175], v89, s[4:7], s42 offen offset:2304 sc1
    s_waitcnt lgkmcnt(5)
    v_mfma_f32_16x16x32_bf16 v[32:35], v[120:123], v[144:147], v[32:35]
    ds_read_b128 v[112:115], v88 offset:34816
    v_mfma_f32_16x16x32_bf16 v[36:39], v[120:123], v[148:151], v[36:39]
    buffer_load_dwordx4 v[20:23], v90, s[4:7], s74 offen offset:512 sc1
    s_waitcnt lgkmcnt(5)
    v_mfma_f32_16x16x32_bf16 v[40:43], v[124:127], v[144:147], v[40:43]
    ds_read_b128 v[116:119], v1 offset:3072
    v_mfma_f32_16x16x32_bf16 v[44:47], v[124:127], v[148:151], v[44:47]
    s_waitcnt lgkmcnt(5)
    v_mfma_f32_16x16x32_bf16 v[48:51], v[96:99], v[144:147], v[48:51]
    ds_read_b128 v[120:123], v1 offset:19456
    v_mfma_f32_16x16x32_bf16 v[52:55], v[96:99], v[148:151], v[52:55]
    buffer_load_dwordx4 v[24:27], v90, s[4:7], s74 offen offset:768 sc1
    s_waitcnt lgkmcnt(5)
    v_mfma_f32_16x16x32_bf16 v[56:59], v[100:103], v[144:147], v[56:59]
    ds_read_b128 v[124:127], v1 offset:35840
    v_mfma_f32_16x16x32_bf16 v[60:63], v[100:103], v[148:151], v[60:63]
    s_waitcnt vmcnt(8)
    v_max_u32 v5, v152, v156
    v_cmp_eq_u32 vcc, -1, v5
    s_waitcnt lgkmcnt(5)
    v_mfma_f32_16x16x32_bf16 v[64:67], v[104:107], v[144:147], v[64:67]
    ds_read_b128 v[96:99], v1 offset:52224
    v_mfma_f32_16x16x32_bf16 v[68:71], v[104:107], v[148:151], v[68:71]
    s_cbranch_vccnz RT_55
BK_56:
    buffer_load_dwordx4 v[176:179], v89, s[4:7], s43 offen offset:0 sc1
    s_waitcnt lgkmcnt(5)
    v_mfma_f32_16x16x32_bf16 v[72:75], v[108:111], v[144:147], v[72:75]
    ds_read_b128 v[100:103], v88 offset:3072
    v_mfma_f32_16x16x32_bf16 v[76:79], v[108:111], v[148:151], v[76:79]
    s_waitcnt lgkmcnt(5)
    v_mfma_f32_16x16x32_bf16 v[80:83], v[112:115], v[144:147], v[80:83]
    ds_read_b128 v[104:107], v88 offset:19456
    v_mfma_f32_16x16x32_bf16 v[84:87], v[112:115], v[148:151], v[84:87]
    buffer_load_dwordx4 v[180:183], v89, s[4:7], s43 offen offset:256 sc1
    s_waitcnt lgkmcnt(5)
    v_mfma_f32_16x16x32_bf16 v[32:35], v[116:119], v[152:155], v[32:35]
    ds_read_b128 v[108:111], v88 offset:35840
    v_mfma_f32_16x16x32_bf16 v[36:39], v[116:119], v[156:159], v[36:39]
    buffer_load_dwordx4 v[184:187], v89, s[4:7], s43 offen offset:2048 sc1
    s_waitcnt lgkmcnt(5)
    v_mfma_f32_16x16x32_bf16 v[40:43], v[120:123], v[152:155], v[40:43]
    ds_read_b128 v[112:115], v1 offset:4096
    v_mfma_f32_16x16x32_bf16 v[44:47], v[120:123], v[156:159], v[44:47]
    s_waitcnt lgkmcnt(5)
    v_mfma_f32_16x16x32_bf16 v[48:51], v[124:127], v[152:155], v[48:51]
    ds_read_b128 v[116:119], v1 offset:20480
    v_mfma_f32_16x16x32_bf16 v[52:55], v[124:127], v[156:159], v[52:55]
    buffer_load_dwordx4 v[188:191], v89, s[4:7], s43 offen offset:2304 sc1
    s_waitcnt lgkmcnt(5)
    v_mfma_f32_16x16x32_bf16 v[56:59], v[96:99], v[152:155], v[56:59]
    ds_read_b128 v[120:123], v1 offset:36864
    v_mfma_f32_16x16x32_bf16 v[60:63], v[96:99], v[156:159], v[60:63]
    s_waitcnt vmcnt(9)
    v_max_u32 v5, v160, v164
    v_cmp_eq_u32 vcc, -1, v5
    s_waitcnt lgkmcnt(5)
    v_mfma_f32_16x16x32_bf16 v[64:67], v[100:103], v[152:155], v[64:67]
    ds_read_b128 v[124:127], v1 offset:53248
    v_mfma_f32_16x16x32_bf16 v[68:71], v[100:103], v[156:159], v[68:71]
    s_cbranch_vccnz RT_59
BK_60:
    s_waitcnt lgkmcnt(5)
    v_mfma_f32_16x16x32_bf16 v[72:75], v[104:107], v[152:155], v[72:75]
    ds_read_b128 v[96:99], v88 offset:4096
    v_mfma_f32_16x16x32_bf16 v[76:79], v[104:107], v[156:159], v[76:79]
    s_waitcnt lgkmcnt(5)
    v_mfma_f32_16x16x32_bf16 v[80:83], v[108:111], v[152:155], v[80:83]
    ds_read_b128 v[100:103], v88 offset:20480
    v_mfma_f32_16x16x32_bf16 v[84:87], v[108:111], v[156:159], v[84:87]
    buffer_load_dwordx4 v[128:131], v1, s[4:7], s79 offen offset:0 sc1
    s_waitcnt lgkmcnt(5)
    v_mfma_f32_16x16x32_bf16 v[32:35], v[112:115], v[160:163], v[32:35]
    ds_read_b128 v[104:107], v88 offset:36864
    s_waitcnt vmcnt(5)
    v_add_f32 v12, v12, v16
    v_mfma_f32_16x16x32_bf16 v[36:39], v[112:115], v[164:167], v[36:39]
    buffer_load_dwordx4 v[192:195], v89, s[4:7], s44 offen offset:0 sc1
    v_add_f32 v13, v13, v17
    s_waitcnt lgkmcnt(5)
    v_mfma_f32_16x16x32_bf16 v[40:43], v[116:119], v[160:163], v[40:43]
    ds_read_b128 v[108:111], v1 offset:5120
    v_add_f32 v14, v14, v18
    v_mfma_f32_16x16x32_bf16 v[44:47], v[116:119], v[164:167], v[44:47]
    v_add_f32 v15, v15, v19
    v_add_f32 v20, v20, v24
    s_waitcnt lgkmcnt(5)
    v_mfma_f32_16x16x32_bf16 v[48:51], v[120:123], v[160:163], v[48:51]
    ds_read_b128 v[112:115], v1 offset:21504
    v_add_f32 v21, v21, v25
    v_mfma_f32_16x16x32_bf16 v[52:55], v[120:123], v[164:167], v[52:55]
    buffer_load_dwordx4 v[196:199], v89, s[4:7], s44 offen offset:256 sc1
    v_add_f32 v22, v22, v26
    s_waitcnt lgkmcnt(5)
    v_mfma_f32_16x16x32_bf16 v[56:59], v[124:127], v[160:163], v[56:59]
    ds_read_b128 v[116:119], v1 offset:37888
    v_add_f32 v23, v23, v27
    v_mfma_f32_16x16x32_bf16 v[60:63], v[124:127], v[164:167], v[60:63]
    s_waitcnt vmcnt(9)
    v_max_u32 v5, v168, v172
    v_cmp_eq_u32 vcc, -1, v5
    s_waitcnt lgkmcnt(5)
    v_mfma_f32_16x16x32_bf16 v[64:67], v[96:99], v[160:163], v[64:67]
    ds_read_b128 v[120:123], v1 offset:54272
    v_mfma_f32_16x16x32_bf16 v[68:71], v[96:99], v[164:167], v[68:71]
    s_cbranch_vccnz RT_63
BK_64:
    v_add_f32 v12, v12, v20
    v_add_f32 v13, v13, v21
    s_waitcnt lgkmcnt(5)
    v_mfma_f32_16x16x32_bf16 v[72:75], v[100:103], v[160:163], v[72:75]
    ds_read_b128 v[124:127], v88 offset:5120
    v_add_f32 v14, v14, v22
    v_mfma_f32_16x16x32_bf16 v[76:79], v[100:103], v[164:167], v[76:79]
    v_add_f32 v15, v15, v23
    v_permlane32_swap_b32 v12, v14
    s_waitcnt lgkmcnt(5)
    v_mfma_f32_16x16x32_bf16 v[80:83], v[104:107], v[160:163], v[80:83]
    ds_read_b128 v[96:99], v88 offset:21504
    v_permlane32_swap_b32 v13, v15
    v_mfma_f32_16x16x32_bf16 v[84:87], v[104:107], v[164:167], v[84:87]
    buffer_load_dwordx4 v[132:135], v1, s[4:7], s79 offen offset:1024 sc1
    v_add_f32 v12, v12, v14
    s_waitcnt lgkmcnt(5)
    v_mfma_f32_16x16x32_bf16 v[32:35], v[108:111], v[168:171], v[32:35]
    ds_read_b128 v[100:103], v88 offset:37888
    v_add_f32 v13, v13, v15
    v_mfma_f32_16x16x32_bf16 v[36:39], v[108:111], v[172:175], v[36:39]
    buffer_load_dwordx4 v[200:203], v89, s[4:7], s44 offen offset:2048 sc1
    v_cmp_u_f32 vcc, v12, v13
    s_nop 0
    s_cbranch_vccnz RT_107
BK_108:
    s_waitcnt lgkmcnt(5)
    v_mfma_f32_16x16x32_bf16 v[40:43], v[112:115], v[168:171], v[40:43]
    ds_read_b128 v[104:107], v1 offset:6144
    v_mov_b32 v14, v12
    v_mfma_f32_16x16x32_bf16 v[44:47], v[112:115], v[172:175], v[44:47]
    v_mov_b32 v15, v13
    v_permlane16_swap_b32 v12, v14
    s_waitcnt lgkmcnt(5)
    v_mfma_f32_16x16x32_bf16 v[48:51], v[116:119], v[168:171], v[48:51]
    ds_read_b128 v[108:111], v1 offset:22528
    v_permlane16_swap_b32 v13, v15
    v_mfma_f32_16x16x32_bf16 v[52:55], v[116:119], v[172:175], v[52:55]
    buffer_load_dwordx4 v[204:207], v89, s[4:7], s44 offen offset:2304 sc1
    v_add_f32 v12, v12, v14
    s_waitcnt lgkmcnt(5)
    v_mfma_f32_16x16x32_bf16 v[56:59], v[120:123], v[168:171], v[56:59]
    ds_read_b128 v[112:115], v1 offset:38912
    v_add_f32 v13, v13, v15
    v_mfma_f32_16x16x32_bf16 v[60:63], v[120:123], v[172:175], v[60:63]
    s_waitcnt vmcnt(8)
    v_max_u32 v5, v176, v180
    v_cmp_eq_u32 vcc, -1, v5
    s_waitcnt lgkmcnt(5)
    v_mfma_f32_16x16x32_bf16 v[64:67], v[124:127], v[168:171], v[64:67]
    ds_read_b128 v[116:119], v1 offset:55296
    v_mfma_f32_16x16x32_bf16 v[68:71], v[124:127], v[172:175], v[68:71]
    s_cbranch_vccnz RT_67
BK_68:
    v_mul_f32 v94, 3137339392, v12
    v_mul_f32 v13, 989855744, v13
    s_waitcnt lgkmcnt(5)
    v_mfma_f32_16x16x32_bf16 v[72:75], v[96:99], v[168:171], v[72:75]
    ds_read_b128 v[120:123], v88 offset:6144
    v_fma_f32 v13, -v94, v94, v13
    v_mfma_f32_16x16x32_bf16 v[76:79], v[96:99], v[172:175], v[76:79]
    v_max_f32 v13, 0, v13
    v_add_f32 v13, 925353388, v13
    s_waitcnt lgkmcnt(5)
    v_mfma_f32_16x16x32_bf16 v[80:83], v[100:103], v[168:171], v[80:83]
    ds_read_b128 v[124:127], v88 offset:22528
    v_mov_b32 v95, v94
    v_mfma_f32_16x16x32_bf16 v[84:87], v[100:103], v[172:175], v[84:87]
    buffer_load_dwordx4 v[136:139], v1, s[4:7], s79 offen offset:2048 sc1
    v_rsq_f32 v12, v13
    s_waitcnt lgkmcnt(5)
    v_mfma_f32_16x16x32_bf16 v[32:35], v[104:107], v[176:179], v[32:35]
    ds_read_b128 v[96:99], v88 offset:38912
    v_permlane32_swap_b32 v94, v95
    v_mfma_f32_16x16x32_bf16 v[36:39], v[104:107], v[180:183], v[36:39]
    buffer_load_dwordx4 v[208:211], v89, s[4:7], s45 offen offset:0 sc1
    v_mul_f32 v92, v13, v12
    s_waitcnt lgkmcnt(5)
    v_mfma_f32_16x16x32_bf16 v[40:43], v[108:111], v[176:179], v[40:43]
    ds_read_b128 v[100:103], v1 offset:7168
    v_mul_f32 v29, 3222493025, v12
TCH5:
    s_cbranch_execz TCH9
    v_mfma_f32_16x16x32_bf16 v[44:47], v[108:111], v[180:183], v[44:47]
    v_mul_f32 v28, v12, v12
    v_mov_b32 v93, v92
    s_waitcnt lgkmcnt(5)
    v_mfma_f32_16x16x32_bf16 v[48:51], v[112:115], v[176:179], v[48:51]
    ds_read_b128 v[104:107], v1 offset:23552
    v_mul_f32 v28, v28, v12
    v_mfma_f32_16x16x32_bf16 v[52:55], v[112:115], v[180:183], v[52:55]
    buffer_load_dwordx4 v[212:215], v89, s[4:7], s45 offen offset:256 sc1
    v_mov_b32 v31, v29
    s_waitcnt lgkmcnt(5)
    v_mfma_f32_16x16x32_bf16 v[56:59], v[116:119], v[176:179], v[56:59]
    ds_read_b128 v[108:111], v1 offset:39936
    v_mul_f32 v28, 3184710632, v28
    v_mfma_f32_16x16x32_bf16 v[60:63], v[116:119], v[180:183], v[60:63]
    s_waitcnt vmcnt(9)
    v_max_u32 v5, v184, v188
    v_cmp_eq_u32 vcc, -1, v5
    s_waitcnt lgkmcnt(5)
    v_mfma_f32_16x16x32_bf16 v[64:67], v[120:123], v[176:179], v[64:67]
    ds_read_b128 v[112:115], v1 offset:56320
    v_mfma_f32_16x16x32_bf16 v[68:71], v[120:123], v[180:183], v[68:71]
    s_cbranch_vccnz RT_71
BK_72:
    v_permlane32_swap_b32 v92, v93
    v_mov_b32 v30, v28
    s_waitcnt lgkmcnt(5)
    v_mfma_f32_16x16x32_bf16 v[72:75], v[124:127], v[176:179], v[72:75]
    ds_read_b128 v[116:119], v88 offset:7168
    v_permlane32_swap_b32 v29, v31
    v_mfma_f32_16x16x32_bf16 v[76:79], v[124:127], v[180:183], v[76:79]
    s_nop 0
    v_permlane32_swap_b32 v28, v30
    ds_read_b128 v[12:15], v91 offset:16
    s_waitcnt lgkmcnt(6)
    v_mfma_f32_16x16x32_bf16 v[80:83], v[96:99], v[176:179], v[80:83]
    ds_read_b128 v[120:123], v88 offset:23552
    v_mfma_f32_16x16x32_bf16 v[84:87], v[96:99], v[180:183], v[84:87]
    buffer_load_dwordx4 v[140:143], v1, s[4:7], s79 offen offset:3072 sc1
    s_add_u32 s79, s79, 4096
    s_waitcnt lgkmcnt(6)
    v_mfma_f32_16x16x32_bf16 v[32:35], v[100:103], v[184:187], v[32:35]
    ds_read_b128 v[124:127], v88 offset:39936
    v_mfma_f32_16x16x32_bf16 v[36:39], v[100:103], v[188:191], v[36:39]
    buffer_load_dwordx4 v[216:219], v89, s[4:7], s45 offen offset:2048 sc1
    s_waitcnt lgkmcnt(6)
    v_mfma_f32_16x16x32_bf16 v[40:43], v[104:107], v[184:187], v[40:43]
    ds_read_b128 v[96:99], v1 offset:8192
    v_mfma_f32_16x16x32_bf16 v[44:47], v[104:107], v[188:191], v[44:47]
    s_waitcnt lgkmcnt(6)
    v_mfma_f32_16x16x32_bf16 v[48:51], v[108:111], v[184:187], v[48:51]
    ds_read_b128 v[100:103], v1 offset:24576
    s_waitcnt lgkmcnt(4)
    v_fmac_f32 v32, v12, v92
    v_mfma_f32_16x16x32_bf16 v[52:55], v[108:111], v[188:191], v[52:55]
    buffer_load_dwordx4 v[220:223], v89, s[4:7], s45 offen offset:2304 sc1
    v_fmac_f32 v33, v13, v92
    s_waitcnt lgkmcnt(6)
    v_mfma_f32_16x16x32_bf16 v[56:59], v[112:115], v[184:187], v[56:59]
    ds_read_b128 v[104:107], v1 offset:40960
    v_fmac_f32 v34, v14, v92
    v_mfma_f32_16x16x32_bf16 v[60:63], v[112:115], v[188:191], v[60:63]
    s_waitcnt vmcnt(9)
    v_max_u32 v5, v192, v196
    v_cmp_eq_u32 vcc, -1, v5
    s_waitcnt lgkmcnt(6)
    v_mfma_f32_16x16x32_bf16 v[64:67], v[116:119], v[184:187], v[64:67]
    ds_read_b128 v[108:111], v1 offset:57344
    v_fmac_f32 v35, v15, v92
    v_mfma_f32_16x16x32_bf16 v[68:71], v[116:119], v[188:191], v[68:71]
    s_cbranch_vccnz RT_75
BK_76:
    v_fmac_f32 v36, v12, v93
    v_fmac_f32 v37, v13, v93
    s_waitcnt lgkmcnt(5)
    v_mfma_f32_16x16x32_bf16 v[72:75], v[120:123], v[184:187], v[72:75]
    ds_read_b128 v[112:115], v88 offset:8192
    v_fmac_f32 v38, v14, v93
    v_mfma_f32_16x16x32_bf16 v[76:79], v[120:123], v[188:191], v[76:79]
    v_fmac_f32 v39, v15, v93
    ds_read_b128 v[20:23], v91 offset:0
    s_waitcnt lgkmcnt(6)
    v_mfma_f32_16x16x32_bf16 v[80:83], v[124:127], v[184:187], v[80:83]
    ds_read_b128 v[116:119], v88 offset:24576
    v_mfma_f32_16x16x32_bf16 v[84:87], v[124:127], v[188:191], v[84:87]
    buffer_load_dwordx4 v[144:147], v1, s[4:7], s79 offen offset:0 sc1
    ds_read_b128 v[16:19], v91 offset:144
    s_waitcnt lgkmcnt(7)
    v_mfma_f32_16x16x32_bf16 v[32:35], v[96:99], v[192:195], v[32:35]
    ds_read_b128 v[120:123], v88 offset:40960
    v_mfma_f32_16x16x32_bf16 v[36:39], v[96:99], v[196:199], v[36:39]
    buffer_load_dwordx4 v[224:227], v89, s[4:7], s46 offen offset:0 sc1
    s_waitcnt lgkmcnt(7)
    v_mfma_f32_16x16x32_bf16 v[40:43], v[100:103], v[192:195], v[40:43]
    ds_read_b128 v[124:127], v1 offset:9216
    v_mfma_f32_16x16x32_bf16 v[44:47], v[100:103], v[196:199], v[44:47]
    s_waitcnt lgkmcnt(7)
    v_mfma_f32_16x16x32_bf16 v[48:51], v[104:107], v[192:195], v[48:51]
    ds_read_b128 v[96:99], v1 offset:25600
    s_waitcnt lgkmcnt(5)
    v_fmac_f32 v32, v20, v94
    v_mfma_f32_16x16x32_bf16 v[52:55], v[104:107], v[196:199], v[52:55]
    buffer_load_dwordx4 v[228:231], v89, s[4:7], s46 offen offset:256 sc1
    v_fmac_f32 v33, v21, v94
    s_waitcnt lgkmcnt(7)
    v_mfma_f32_16x16x32_bf16 v[56:59], v[108:111], v[192:195], v[56:59]
    ds_read_b128 v[100:103], v1 offset:41984
    v_fmac_f32 v34, v22, v94
    v_mfma_f32_16x16x32_bf16 v[60:63], v[108:111], v[196:199], v[60:63]
    s_waitcnt vmcnt(9)
    v_max_u32 v5, v200, v204
    v_cmp_eq_u32 vcc, -1, v5
    s_waitcnt lgkmcnt(7)
    v_mfma_f32_16x16x32_bf16 v[64:67], v[112:115], v[192:195], v[64:67]
    ds_read_b128 v[104:107], v1 offset:58368
    v_fmac_f32 v35, v23, v94
    v_mfma_f32_16x16x32_bf16 v[68:71], v[112:115], v[196:199], v[68:71]
    s_cbranch_vccnz RT_79
BK_80:
    v_fmac_f32 v36, v20, v95
    v_fmac_f32 v37, v21, v95
    s_waitcnt lgkmcnt(6)
    v_mfma_f32_16x16x32_bf16 v[72:75], v[116:119], v[192:195], v[72:75]
    ds_read_b128 v[108:111], v88 offset:9216
    v_fmac_f32 v38, v22, v95
    v_mfma_f32_16x16x32_bf16 v[76:79], v[116:119], v[196:199], v[76:79]
    v_fmac_f32 v39, v23, v95
    s_waitcnt lgkmcnt(6)
    v_fmac_f32 v40, v16, v92
    s_waitcnt lgkmcnt(5)
    v_mfma_f32_16x16x32_bf16 v[80:83], v[120:123], v[192:195], v[80:83]
    ds_read_b128 v[112:115], v88 offset:25600
    v_fmac_f32 v41, v17, v92
    v_mfma_f32_16x16x32_bf16 v[84:87], v[120:123], v[196:199], v[84:87]
    buffer_load_dwordx4 v[148:151], v1, s[4:7], s79 offen offset:1024 sc1
    v_fmac_f32 v42, v18, v92
    v_fmac_f32 v43, v19, v92
    v_fmac_f32 v44, v16, v93
    v_fmac_f32 v45, v17, v93
    v_fmac_f32 v46, v18, v93
    v_fmac_f32 v47, v19, v93
    ds_read_b128 v[24:27], v91 offset:128
    s_waitcnt lgkmcnt(6)
    v_mfma_f32_16x16x32_bf16 v[32:35], v[124:127], v[200:203], v[32:35]
    ds_read_b128 v[116:119], v88 offset:41984
    v_mfma_f32_16x16x32_bf16 v[36:39], v[124:127], v[204:207], v[36:39]
    buffer_load_dwordx4 v[232:235], v89, s[4:7], s46 offen offset:2048 sc1
    ds_read_b128 v[12:15], v91 offset:272
    s_waitcnt lgkmcnt(7)
    v_mfma_f32_16x16x32_bf16 v[40:43], v[96:99], v[200:203], v[40:43]
    ds_read_b128 v[120:123], v1 offset:10240
    v_mfma_f32_16x16x32_bf16 v[44:47], v[96:99], v[204:207], v[44:47]
    s_waitcnt lgkmcnt(7)
    v_mfma_f32_16x16x32_bf16 v[48:51], v[100:103], v[200:203], v[48:51]
    ds_read_b128 v[124:127], v1 offset:26624
    v_mfma_f32_16x16x32_bf16 v[52:55], v[100:103], v[204:207], v[52:55]
    buffer_load_dwordx4 v[236:239], v89, s[4:7], s46 offen offset:2304 sc1
    s_waitcnt lgkmcnt(7)
    v_mfma_f32_16x16x32_bf16 v[56:59], v[104:107], v[200:203], v[56:59]
    ds_read_b128 v[96:99], v1 offset:43008
    s_waitcnt lgkmcnt(5)
    v_fmac_f32 v40, v24, v94
    v_mfma_f32_16x16x32_bf16 v[60:63], v[104:107], v[204:207], v[60:63]
    s_waitcnt vmcnt(9)
    v_max_u32 v5, v208, v212
    v_cmp_eq_u32 vcc, -1, v5
    s_waitcnt lgkmcnt(7)
    v_mfma_f32_16x16x32_bf16 v[64:67], v[108:111], v[200:203], v[64:67]
    ds_read_b128 v[100:103], v1 offset:59392
    v_fmac_f32 v41, v25, v94
    v_mfma_f32_16x16x32_bf16 v[68:71], v[108:111], v[204:207], v[68:71]
    s_cbranch_vccnz RT_83
BK_84:
    v_fmac_f32 v42, v26, v94
    v_fmac_f32 v43, v27, v94
    s_waitcnt lgkmcnt(7)
    v_mfma_f32_16x16x32_bf16 v[72:75], v[112:115], v[200:203], v[72:75]
    ds_read_b128 v[104:107], v88 offset:10240
    v_fmac_f32 v44, v24, v95
    v_mfma_f32_16x16x32_bf16 v[76:79], v[112:115], v[204:207], v[76:79]
    v_fmac_f32 v45, v25, v95
    v_fmac_f32 v46, v26, v95
    s_waitcnt lgkmcnt(6)
    v_mfma_f32_16x16x32_bf16 v[80:83], v[116:119], v[200:203], v[80:83]
    ds_read_b128 v[108:111], v88 offset:26624
    v_fmac_f32 v47, v27, v95
    v_mfma_f32_16x16x32_bf16 v[84:87], v[116:119], v[204:207], v[84:87]
    buffer_load_dwordx4 v[152:155], v1, s[4:7], s79 offen offset:2048 sc1
    s_waitcnt lgkmcnt(6)
    v_fmac_f32 v48, v12, v92
    s_waitcnt lgkmcnt(5)
    v_mfma_f32_16x16x32_bf16 v[32:35], v[120:123], v[208:211], v[32:35]
    ds_read_b128 v[112:115], v88 offset:43008
    v_fmac_f32 v49, v13, v92
    v_mfma_f32_16x16x32_bf16 v[36:39], v[120:123], v[212:215], v[36:39]
    buffer_load_dwordx4 v[240:243], v89, s[4:7], s47 offen offset:0 sc1
    v_fmac_f32 v50, v14, v92
    v_fmac_f32 v51, v15, v92
    v_fmac_f32 v52, v12, v93
    v_fmac_f32 v53, v13, v93
    v_fmac_f32 v54, v14, v93
    v_fmac_f32 v55, v15, v93
    ds_read_b128 v[20:23], v91 offset:256
    s_waitcnt lgkmcnt(6)
    v_mfma_f32_16x16x32_bf16 v[40:43], v[124:127], v[208:211], v[40:43]
    ds_read_b128 v[116:119], v1 offset:11264
    v_mfma_f32_16x16x32_bf16 v[44:47], v[124:127], v[212:215], v[44:47]
    ds_read_b128 v[16:19], v91 offset:400
    s_waitcnt lgkmcnt(7)
    v_mfma_f32_16x16x32_bf16 v[48:51], v[96:99], v[208:211], v[48:51]
    ds_read_b128 v[120:123], v1 offset:27648
    v_mfma_f32_16x16x32_bf16 v[52:55], v[96:99], v[212:215], v[52:55]
    buffer_load_dwordx4 v[244:247], v89, s[4:7], s47 offen offset:256 sc1
    s_waitcnt lgkmcnt(7)
    v_mfma_f32_16x16x32_bf16 v[56:59], v[100:103], v[208:211], v[56:59]
    ds_read_b128 v[124:127], v1 offset:44032
    v_mfma_f32_16x16x32_bf16 v[60:63], v[100:103], v[212:215], v[60:63]
    s_waitcnt vmcnt(9)
    v_max_u32 v5, v216, v220
    v_cmp_eq_u32 vcc, -1, v5
    s_waitcnt lgkmcnt(7)
    v_mfma_f32_16x16x32_bf16 v[64:67], v[104:107], v[208:211], v[64:67]
    ds_read_b128 v[96:99], v1 offset:60416
    s_waitcnt lgkmcnt(5)
    v_fmac_f32 v48, v20, v94
    v_mfma_f32_16x16x32_bf16 v[68:71], v[104:107], v[212:215], v[68:71]
    s_cbranch_vccnz RT_87
BK_88:
    v_fmac_f32 v49, v21, v94
    v_fmac_f32 v50, v22, v94
    s_waitcnt lgkmcnt(7)
    v_mfma_f32_16x16x32_bf16 v[72:75], v[108:111], v[208:211], v[72:75]
    ds_read_b128 v[100:103], v88 offset:11264
    v_fmac_f32 v51, v23, v94
    v_mfma_f32_16x16x32_bf16 v[76:79], v[108:111], v[212:215], v[76:79]
    v_fmac_f32 v52, v20, v95
    v_fmac_f32 v53, v21, v95
    s_waitcnt lgkmcnt(7)
    v_mfma_f32_16x16x32_bf16 v[80:83], v[112:115], v[208:211], v[80:83]
    ds_read_b128 v[104:107], v88 offset:27648
    v_fmac_f32 v54, v22, v95
    v_mfma_f32_16x16x32_bf16 v[84:87], v[112:115], v[212:215], v[84:87]
    buffer_load_dwordx4 v[156:159], v1, s[4:7], s79 offen offset:3072 sc1
    s_add_u32 s79, s79, 4096
    v_fmac_f32 v55, v23, v95
    s_waitcnt lgkmcnt(6)
    v_mfma_f32_16x16x32_bf16 v[32:35], v[116:119], v[216:219], v[32:35]
    ds_read_b128 v[108:111], v88 offset:44032
    s_waitcnt lgkmcnt(6)
    v_fmac_f32 v56, v16, v92
    v_mfma_f32_16x16x32_bf16 v[36:39], v[116:119], v[220:223], v[36:39]
    buffer_load_dwordx4 v[248:251], v89, s[4:7], s47 offen offset:2048 sc1
    v_fmac_f32 v57, v17, v92
    s_waitcnt lgkmcnt(5)
    v_mfma_f32_16x16x32_bf16 v[40:43], v[120:123], v[216:219], v[40:43]
    ds_read_b128 v[112:115], v1 offset:12288
    v_fmac_f32 v58, v18, v92
    v_mfma_f32_16x16x32_bf16 v[44:47], v[120:123], v[220:223], v[44:47]
    v_fmac_f32 v59, v19, v92
    v_fmac_f32 v60, v16, v93
    v_fmac_f32 v61, v17, v93
    v_fmac_f32 v62, v18, v93
    v_fmac_f32 v63, v19, v93
    ds_read_b128 v[24:27], v91 offset:384
    s_waitcnt lgkmcnt(6)
    v_mfma_f32_16x16x32_bf16 v[48:51], v[124:127], v[216:219], v[48:51]
    ds_read_b128 v[116:119], v1 offset:28672
    v_mfma_f32_16x16x32_bf16 v[52:55], v[124:127], v[220:223], v[52:55]
    buffer_load_dwordx4 v[252:255], v89, s[4:7], s47 offen offset:2304 sc1
    ds_read_b128 v[12:15], v91 offset:528
    s_waitcnt lgkmcnt(7)
    v_mfma_f32_16x16x32_bf16 v[56:59], v[96:99], v[216:219], v[56:59]
    ds_read_b128 v[120:123], v1 offset:45056
    v_mfma_f32_16x16x32_bf16 v[60:63], v[96:99], v[220:223], v[60:63]
    s_waitcnt vmcnt(9)
    v_max_u32 v5, v224, v228
    v_cmp_eq_u32 vcc, -1, v5
    s_waitcnt lgkmcnt(7)
    v_mfma_f32_16x16x32_bf16 v[64:67], v[100:103], v[216:219], v[64:67]
    ds_read_b128 v[124:127], v1 offset:61440
    v_mfma_f32_16x16x32_bf16 v[68:71], v[100:103], v[220:223], v[68:71]
    s_cbranch_vccnz RT_91
BK_92:
    s_waitcnt lgkmcnt(7)
    v_mfma_f32_16x16x32_bf16 v[72:75], v[104:107], v[216:219], v[72:75]
    ds_read_b128 v[96:99], v88 offset:12288
    s_waitcnt lgkmcnt(5)
    v_fmac_f32 v56, v24, v94
    v_mfma_f32_16x16x32_bf16 v[76:79], v[104:107], v[220:223], v[76:79]
    v_fmac_f32 v57, v25, v94
    v_fmac_f32 v58, v26, v94
    s_waitcnt lgkmcnt(7)
    v_mfma_f32_16x16x32_bf16 v[80:83], v[108:111], v[216:219], v[80:83]
    ds_read_b128 v[100:103], v88 offset:28672
    v_fmac_f32 v59, v27, v94
    v_mfma_f32_16x16x32_bf16 v[84:87], v[108:111], v[220:223], v[84:87]
    buffer_load_dwordx4 v[160:163], v1, s[4:7], s79 offen offset:0 sc1
    v_fmac_f32 v60, v24, v95
    s_waitcnt lgkmcnt(7)
    v_mfma_f32_16x16x32_bf16 v[32:35], v[112:115], v[224:227], v[32:35]
    s_lshr_b32 s70, s59, 3
    ds_read_b128 v[104:107], v88 offset:45056
    v_fmac_f32 v61, v25, v95
    v_mfma_f32_16x16x32_bf16 v[36:39], v[112:115], v[228:231], v[36:39]
    s_and_b32 s71, s59, 7
    buffer_load_dwordx4 v[164:167], v1, s[4:7], s79 offen offset:1024 sc1
    v_fmac_f32 v62, v26, v95
    s_waitcnt lgkmcnt(6)
    v_mfma_f32_16x16x32_bf16 v[40:43], v[116:119], v[224:227], v[40:43]
    s_lshl2_add_u32 s71, s71, s60
    ds_read_b128 v[108:111], v1 offset:13312
    v_fmac_f32 v63, v27, v95
    v_mfma_f32_16x16x32_bf16 v[44:47], v[116:119], v[228:231], v[44:47]
    s_mul_i32 s32, s70, 229376
    s_waitcnt lgkmcnt(6)
    v_fmac_f32 v64, v12, v92
    v_fmac_f32 v65, v13, v92
    s_waitcnt lgkmcnt(5)
    v_mfma_f32_16x16x32_bf16 v[48:51], v[120:123], v[224:227], v[48:51]
    s_mul_i32 s75, s60, 28672
    ds_read_b128 v[112:115], v1 offset:29696
    v_fmac_f32 v66, v14, v92
    v_mfma_f32_16x16x32_bf16 v[52:55], v[120:123], v[228:231], v[52:55]
    s_add_u32 s32, s32, s75
    buffer_load_dwordx4 v[168:171], v1, s[4:7], s79 offen offset:2048 sc1
    v_fmac_f32 v67, v15, v92
    v_fmac_f32 v68, v12, v93
    v_fmac_f32 v69, v13, v93
    v_fmac_f32 v70, v14, v93
    v_fmac_f32 v71, v15, v93
    ds_read_b128 v[20:23], v91 offset:512
    s_waitcnt lgkmcnt(6)
    v_mfma_f32_16x16x32_bf16 v[56:59], v[124:127], v[224:227], v[56:59]
    s_add_u32 s32, s32, s63
    ds_read_b128 v[116:119], v1 offset:46080
    v_mfma_f32_16x16x32_bf16 v[60:63], v[124:127], v[228:231], v[60:63]
    s_add_u32 s32, s32, 524288
    s_waitcnt vmcnt(9)
    v_max_u32 v5, v232, v236
    v_cmp_eq_u32 vcc, -1, v5
    ds_read_b128 v[16:19], v91 offset:656
    s_waitcnt lgkmcnt(7)
    v_mfma_f32_16x16x32_bf16 v[64:67], v[96:99], v[224:227], v[64:67]
    s_add_u32 s33, s32, 7168
    ds_read_b128 v[120:123], v1 offset:62464
    v_mfma_f32_16x16x32_bf16 v[68:71], v[96:99], v[228:231], v[68:71]
    s_add_u32 s34, s32, 14336
    s_cbranch_vccnz RT_95
BK_96:
    s_waitcnt lgkmcnt(7)
    v_mfma_f32_16x16x32_bf16 v[72:75], v[100:103], v[224:227], v[72:75]
    s_add_u32 s35, s32, 21504
    ds_read_b128 v[124:127], v88 offset:13312
    v_mfma_f32_16x16x32_bf16 v[76:79], v[100:103], v[228:231], v[76:79]
    s_add_u32 s36, s32, 114688
    s_waitcnt lgkmcnt(7)
    v_mfma_f32_16x16x32_bf16 v[80:83], v[104:107], v[224:227], v[80:83]
    s_add_u32 s37, s32, 121856
    ds_read_b128 v[96:99], v88 offset:29696
    s_waitcnt lgkmcnt(5)
    v_fmac_f32 v64, v20, v94
    v_mfma_f32_16x16x32_bf16 v[84:87], v[104:107], v[228:231], v[84:87]
    s_add_u32 s38, s32, 129024
    buffer_load_dwordx4 v[172:175], v1, s[4:7], s79 offen offset:3072 sc1
    s_add_u32 s79, s79, 4096
    v_fmac_f32 v65, v21, v94
    s_waitcnt lgkmcnt(7)
    v_mfma_f32_16x16x32_bf16 v[32:35], v[108:111], v[232:235], v[32:35]
    s_add_u32 s39, s32, 136192
    ds_read_b128 v[100:103], v88 offset:46080
    v_fmac_f32 v66, v22, v94
    v_mfma_f32_16x16x32_bf16 v[36:39], v[108:111], v[236:239], v[36:39]
    s_lshl_b32 s75, s70, 16
    buffer_load_dwordx4 v[176:179], v1, s[4:7], s79 offen offset:0 sc1
    v_fmac_f32 v67, v23, v94
    s_waitcnt lgkmcnt(7)
    v_mfma_f32_16x16x32_bf16 v[40:43], v[112:115], v[232:235], v[40:43]
    s_lshl_b32 s76, s71, 10
    ds_read_b128 v[104:107], v1 offset:14336
    v_fmac_f32 v68, v20, v95
    v_mfma_f32_16x16x32_bf16 v[44:47], v[112:115], v[236:239], v[44:47]
    s_add_u32 s75, s75, s76
    v_fmac_f32 v69, v21, v95
    v_fmac_f32 v70, v22, v95
    s_waitcnt lgkmcnt(6)
    v_mfma_f32_16x16x32_bf16 v[48:51], v[116:119], v[232:235], v[48:51]
    s_add_u32 s75, s75, s63
    ds_read_b128 v[108:111], v1 offset:30720
    v_fmac_f32 v71, v23, v95
    v_mfma_f32_16x16x32_bf16 v[52:55], v[116:119], v[236:239], v[52:55]
    s_add_u32 s75, s75, 262144
    buffer_load_dwordx4 v[180:183], v1, s[4:7], s79 offen offset:1024 sc1
    s_waitcnt lgkmcnt(6)
    v_fmac_f32 v72, v16, v92
    s_waitcnt lgkmcnt(5)
    v_mfma_f32_16x16x32_bf16 v[56:59], v[120:123], v[232:235], v[56:59]
    s_add_u32 s76, s75, 0x8000
    ds_read_b128 v[112:115], v1 offset:47104
    v_fmac_f32 v73, v17, v92
    v_mfma_f32_16x16x32_bf16 v[60:63], v[120:123], v[236:239], v[60:63]
    s_lshl2_add_u32 s78, s58, s70
    s_waitcnt vmcnt(9)
    v_max_u32 v5, v240, v244
    v_cmp_eq_u32 vcc, -1, v5
    v_fmac_f32 v74, v18, v92
    v_fmac_f32 v75, v19, v92
    v_fmac_f32 v76, v16, v93
    v_fmac_f32 v77, v17, v93
    v_fmac_f32 v78, v18, v93
    v_fmac_f32 v79, v19, v93
    ds_read_b128 v[24:27], v91 offset:640
    s_waitcnt lgkmcnt(6)
    v_mfma_f32_16x16x32_bf16 v[64:67], v[124:127], v[232:235], v[64:67]
    s_lshl_b32 s78, s78, 16
    ds_read_b128 v[116:119], v1 offset:63488
    v_mfma_f32_16x16x32_bf16 v[68:71], v[124:127], v[236:239], v[68:71]
    s_lshl_b32 s71, s71, 5
    s_cbranch_vccnz RT_99
BK_100:
    ds_read_b128 v[12:15], v91 offset:784
    s_waitcnt lgkmcnt(7)
    v_mfma_f32_16x16x32_bf16 v[72:75], v[96:99], v[232:235], v[72:75]
    s_add_u32 s78, s78, s71
    ds_read_b128 v[120:123], v88 offset:14336
    v_mfma_f32_16x16x32_bf16 v[76:79], v[96:99], v[236:239], v[76:79]
    s_waitcnt lgkmcnt(7)
    v_mfma_f32_16x16x32_bf16 v[80:83], v[100:103], v[232:235], v[80:83]
    ds_read_b128 v[124:127], v88 offset:30720
    v_mfma_f32_16x16x32_bf16 v[84:87], v[100:103], v[236:239], v[84:87]
    buffer_load_dwordx4 v[184:187], v1, s[4:7], s79 offen offset:2048 sc1
    s_waitcnt lgkmcnt(7)
    v_mfma_f32_16x16x32_bf16 v[32:35], v[104:107], v[240:243], v[32:35]
    ds_read_b128 v[96:99], v88 offset:47104
    s_waitcnt lgkmcnt(5)
    v_fmac_f32 v72, v24, v94
    v_mfma_f32_16x16x32_bf16 v[36:39], v[104:107], v[244:247], v[36:39]
    buffer_load_dwordx4 v[188:191], v1, s[4:7], s79 offen offset:3072 sc1
    s_add_u32 s79, s79, 4096
    v_fmac_f32 v73, v25, v94
    s_waitcnt lgkmcnt(7)
    v_mfma_f32_16x16x32_bf16 v[40:43], v[108:111], v[240:243], v[40:43]
    ds_read_b128 v[100:103], v1 offset:15360
    v_fmac_f32 v74, v26, v94
    v_mfma_f32_16x16x32_bf16 v[44:47], v[108:111], v[244:247], v[44:47]
    v_fmac_f32 v75, v27, v94
    v_fmac_f32 v76, v24, v95
    s_waitcnt lgkmcnt(7)
    v_mfma_f32_16x16x32_bf16 v[48:51], v[112:115], v[240:243], v[48:51]
    ds_read_b128 v[104:107], v1 offset:31744
    v_fmac_f32 v77, v25, v95
    v_mfma_f32_16x16x32_bf16 v[52:55], v[112:115], v[244:247], v[52:55]
    buffer_load_dwordx4 v[192:195], v1, s[4:7], s79 offen offset:0 sc1
    v_fmac_f32 v78, v26, v95
    s_waitcnt lgkmcnt(6)
    v_mfma_f32_16x16x32_bf16 v[56:59], v[116:119], v[240:243], v[56:59]
    ds_read_b128 v[108:111], v1 offset:48128
    v_fmac_f32 v79, v27, v95
    v_mfma_f32_16x16x32_bf16 v[60:63], v[116:119], v[244:247], v[60:63]
    s_waitcnt vmcnt(9)
    v_max_u32 v5, v248, v252
    v_cmp_eq_u32 vcc, -1, v5
    s_waitcnt lgkmcnt(5)
    v_mfma_f32_16x16x32_bf16 v[64:67], v[120:123], v[240:243], v[64:67]
    ds_read_b128 v[112:115], v1 offset:64512
    s_waitcnt lgkmcnt(7)
    v_fmac_f32 v80, v12, v92
    v_mfma_f32_16x16x32_bf16 v[68:71], v[120:123], v[244:247], v[68:71]
    s_cbranch_vccnz RT_103
BK_104:
    v_fmac_f32 v81, v13, v92
    v_fmac_f32 v82, v14, v92
    v_fmac_f32 v83, v15, v92
    v_fmac_f32 v84, v12, v93
    v_fmac_f32 v85, v13, v93
    v_fmac_f32 v86, v14, v93
    v_fmac_f32 v87, v15, v93
    ds_read_b128 v[20:23], v91 offset:768
    s_waitcnt lgkmcnt(6)
    v_mfma_f32_16x16x32_bf16 v[72:75], v[124:127], v[240:243], v[72:75]
    ds_read_b128 v[116:119], v88 offset:15360
    v_mfma_f32_16x16x32_bf16 v[76:79], v[124:127], v[244:247], v[76:79]
    s_waitcnt lgkmcnt(6)
    v_mfma_f32_16x16x32_bf16 v[80:83], v[96:99], v[240:243], v[80:83]
    ds_read_b128 v[120:123], v88 offset:31744
    v_mfma_f32_16x16x32_bf16 v[84:87], v[96:99], v[244:247], v[84:87]
    buffer_load_dwordx4 v[196:199], v1, s[4:7], s79 offen offset:1024 sc1
    s_waitcnt lgkmcnt(6)
    v_mfma_f32_16x16x32_bf16 v[32:35], v[100:103], v[248:251], v[32:35]
    s_add_u32 s40, s32, 4096
    ds_read_b128 v[124:127], v88 offset:48128
    v_mfma_f32_16x16x32_bf16 v[36:39], v[100:103], v[252:255], v[36:39]
    s_add_u32 s41, s33, 4096
    buffer_load_dwordx4 v[200:203], v1, s[4:7], s79 offen offset:2048 sc1
    s_waitcnt lgkmcnt(6)
    v_mfma_f32_16x16x32_bf16 v[40:43], v[104:107], v[248:251], v[40:43]
    s_add_u32 s42, s34, 4096
    s_waitcnt lgkmcnt(3)
    v_fmac_f32 v80, v20, v94
    v_fmac_f32 v81, v21, v94
    v_mfma_f32_16x16x32_bf16 v[44:47], v[104:107], v[252:255], v[44:47]
    s_add_u32 s43, s35, 4096
    v_fmac_f32 v82, v22, v94
    v_fmac_f32 v83, v23, v94
    s_waitcnt lgkmcnt(5)
    v_mfma_f32_16x16x32_bf16 v[48:51], v[108:111], v[248:251], v[48:51]
    s_add_u32 s44, s36, 4096
    v_fmac_f32 v84, v20, v95
    v_fmac_f32 v85, v21, v95
    v_mfma_f32_16x16x32_bf16 v[52:55], v[108:111], v[252:255], v[52:55]
    s_add_u32 s45, s37, 4096
    buffer_load_dwordx4 v[204:207], v1, s[4:7], s79 offen offset:3072 sc1
    s_add_u32 s79, s79, 4096
    v_fmac_f32 v86, v22, v95
    s_waitcnt lgkmcnt(4)
    v_mfma_f32_16x16x32_bf16 v[56:59], v[112:115], v[248:251], v[56:59]
    s_add_u32 s46, s38, 4096
    v_fmac_f32 v87, v23, v95
    v_mfma_f32_16x16x32_bf16 v[60:63], v[112:115], v[252:255], v[60:63]
    s_add_u32 s47, s39, 4096
    s_waitcnt lgkmcnt(2)
    v_mfma_f32_16x16x32_bf16 v[64:67], v[116:119], v[248:251], v[64:67]
    v_mfma_f32_16x16x32_bf16 v[68:71], v[116:119], v[252:255], v[68:71]
    s_waitcnt lgkmcnt(1)
    v_mfma_f32_16x16x32_bf16 v[72:75], v[120:123], v[248:251], v[72:75]
    v_mfma_f32_16x16x32_bf16 v[76:79], v[120:123], v[252:255], v[76:79]
    s_waitcnt lgkmcnt(0)
    v_mfma_f32_16x16x32_bf16 v[80:83], v[124:127], v[248:251], v[80:83]
    v_mfma_f32_16x16x32_bf16 v[84:87], v[124:127], v[252:255], v[84:87]
    buffer_load_dwordx4 v[208:211], v1, s[4:7], s79 offen offset:0 sc1
    v_pk_mul_f32 v[12:13], v[32:33], v[32:33]
    v_pk_mul_f32 v[14:15], v[34:35], v[34:35]
    v_pk_mul_f32 v[16:17], v[36:37], v[36:37]
    v_pk_mul_f32 v[18:19], v[38:39], v[38:39]
    v_pk_fma_f32 v[12:13], v[12:13], v[28:29], v[28:29] op_sel:[0,0,1] op_sel_hi:[1,0,1]
    v_pk_fma_f32 v[14:15], v[14:15], v[28:29], v[28:29] op_sel:[0,0,1] op_sel_hi:[1,0,1]
    v_pk_fma_f32 v[16:17], v[16:17], v[30:31], v[30:31] op_sel:[0,0,1] op_sel_hi:[1,0,1]
    v_pk_fma_f32 v[18:19], v[18:19], v[30:31], v[30:31] op_sel:[0,0,1] op_sel_hi:[1,0,1]
    v_pk_mul_f32 v[12:13], v[12:13], v[32:33]
    v_pk_mul_f32 v[14:15], v[14:15], v[34:35]
    v_pk_mul_f32 v[16:17], v[16:17], v[36:37]
    v_pk_mul_f32 v[18:19], v[18:19], v[38:39]
    buffer_load_dwordx4 v[212:215], v1, s[4:7], s79 offen offset:1024 sc1
    v_exp_f32 v12, v12
    v_exp_f32 v13, v13
    v_exp_f32 v14, v14
    v_exp_f32 v15, v15
    v_exp_f32 v16, v16
    v_exp_f32 v17, v17
    v_exp_f32 v18, v18
    v_exp_f32 v19, v19
    buffer_load_dwordx4 v[216:219], v1, s[4:7], s79 offen offset:2048 sc1
    v_pk_fma_f32 v[12:13], v[12:13], v[92:93], v[92:93] op_sel:[0,0,0] op_sel_hi:[1,0,0]
    v_pk_fma_f32 v[14:15], v[14:15], v[92:93], v[92:93] op_sel:[0,0,0] op_sel_hi:[1,0,0]
    v_pk_fma_f32 v[16:17], v[16:17], v[92:93], v[92:93] op_sel:[0,1,1] op_sel_hi:[1,1,1]
    v_pk_fma_f32 v[18:19], v[18:19], v[92:93], v[92:93] op_sel:[0,1,1] op_sel_hi:[1,1,1]
    v_rcp_f32 v12, v12
    v_rcp_f32 v13, v13
    v_rcp_f32 v14, v14
    v_rcp_f32 v15, v15
    buffer_load_dwordx4 v[220:223], v1, s[4:7], s79 offen offset:3072 sc1
    s_add_u32 s79, s79, 4096
    v_rcp_f32 v16, v16
    v_rcp_f32 v17, v17
    v_rcp_f32 v18, v18
    v_rcp_f32 v19, v19
    v_pk_mul_f32 v[32:33], v[32:33], v[12:13]
    v_pk_mul_f32 v[34:35], v[34:35], v[14:15]
    v_pk_mul_f32 v[36:37], v[36:37], v[16:17]
    v_pk_mul_f32 v[38:39], v[38:39], v[18:19]
    v_cvt_pk_bf16_f32 v20, v32, v33
    v_cvt_pk_bf16_f32 v22, v36, v37
    v_cvt_pk_bf16_f32 v21, v34, v35
    v_cvt_pk_bf16_f32 v23, v38, v39
    buffer_load_dwordx4 v[224:227], v1, s[4:7], s79 offen offset:0 sc1
    v_permlane16_swap_b32 v20, v22
    v_permlane16_swap_b32 v21, v23
    buffer_store_dwordx4 v[20:23], v1, s[4:7], s77 offen offset:0
    v_pk_mul_f32 v[12:13], v[40:41], v[40:41]
    v_pk_mul_f32 v[14:15], v[42:43], v[42:43]
    v_pk_mul_f32 v[16:17], v[44:45], v[44:45]
    v_pk_mul_f32 v[18:19], v[46:47], v[46:47]
    v_pk_fma_f32 v[12:13], v[12:13], v[28:29], v[28:29] op_sel:[0,0,1] op_sel_hi:[1,0,1]
    v_pk_fma_f32 v[14:15], v[14:15], v[28:29], v[28:29] op_sel:[0,0,1] op_sel_hi:[1,0,1]
    v_pk_fma_f32 v[16:17], v[16:17], v[30:31], v[30:31] op_sel:[0,0,1] op_sel_hi:[1,0,1]
    v_pk_fma_f32 v[18:19], v[18:19], v[30:31], v[30:31] op_sel:[0,0,1] op_sel_hi:[1,0,1]
    v_pk_mul_f32 v[12:13], v[12:13], v[40:41]
    v_pk_mul_f32 v[14:15], v[14:15], v[42:43]
    v_pk_mul_f32 v[16:17], v[16:17], v[44:45]
    v_pk_mul_f32 v[18:19], v[18:19], v[46:47]
    buffer_load_dwordx4 v[228:231], v1, s[4:7], s79 offen offset:1024 sc1
    v_exp_f32 v12, v12
    v_exp_f32 v13, v13
    v_exp_f32 v14, v14
    v_exp_f32 v15, v15
    v_exp_f32 v16, v16
    v_exp_f32 v17, v17
    v_exp_f32 v18, v18
    v_exp_f32 v19, v19
    buffer_load_dwordx4 v[232:235], v1, s[4:7], s79 offen offset:2048 sc1
    v_pk_fma_f32 v[12:13], v[12:13], v[92:93], v[92:93] op_sel:[0,0,0] op_sel_hi:[1,0,0]
    v_pk_fma_f32 v[14:15], v[14:15], v[92:93], v[92:93] op_sel:[0,0,0] op_sel_hi:[1,0,0]
    v_pk_fma_f32 v[16:17], v[16:17], v[92:93], v[92:93] op_sel:[0,1,1] op_sel_hi:[1,1,1]
    v_pk_fma_f32 v[18:19], v[18:19], v[92:93], v[92:93] op_sel:[0,1,1] op_sel_hi:[1,1,1]
    v_rcp_f32 v12, v12
    v_rcp_f32 v13, v13
    v_rcp_f32 v14, v14
    v_rcp_f32 v15, v15
    buffer_load_dwordx4 v[236:239], v1, s[4:7], s79 offen offset:3072 sc1
    s_add_u32 s79, s79, 4096
    v_rcp_f32 v16, v16
    v_rcp_f32 v17, v17
    v_rcp_f32 v18, v18
    v_rcp_f32 v19, v19
    v_pk_mul_f32 v[40:41], v[40:41], v[12:13]
    v_pk_mul_f32 v[42:43], v[42:43], v[14:15]
    v_pk_mul_f32 v[44:45], v[44:45], v[16:17]
    v_pk_mul_f32 v[46:47], v[46:47], v[18:19]
    v_cvt_pk_bf16_f32 v24, v40, v41
    v_cvt_pk_bf16_f32 v26, v44, v45
    v_cvt_pk_bf16_f32 v25, v42, v43
    v_cvt_pk_bf16_f32 v27, v46, v47
    buffer_load_dwordx4 v[240:243], v1, s[4:7], s79 offen offset:0 sc1
    v_permlane16_swap_b32 v24, v26
    v_permlane16_swap_b32 v25, v27
    buffer_store_dwordx4 v[24:27], v1, s[4:7], s77 offen offset:1024
    v_pk_mul_f32 v[12:13], v[48:49], v[48:49]
    v_pk_mul_f32 v[14:15], v[50:51], v[50:51]
    v_pk_mul_f32 v[16:17], v[52:53], v[52:53]
    v_pk_mul_f32 v[18:19], v[54:55], v[54:55]
    v_pk_fma_f32 v[12:13], v[12:13], v[28:29], v[28:29] op_sel:[0,0,1] op_sel_hi:[1,0,1]
    v_pk_fma_f32 v[14:15], v[14:15], v[28:29], v[28:29] op_sel:[0,0,1] op_sel_hi:[1,0,1]
    v_pk_fma_f32 v[16:17], v[16:17], v[30:31], v[30:31] op_sel:[0,0,1] op_sel_hi:[1,0,1]
    v_pk_fma_f32 v[18:19], v[18:19], v[30:31], v[30:31] op_sel:[0,0,1] op_sel_hi:[1,0,1]
    v_pk_mul_f32 v[12:13], v[12:13], v[48:49]
    v_pk_mul_f32 v[14:15], v[14:15], v[50:51]
    v_pk_mul_f32 v[16:17], v[16:17], v[52:53]
    v_pk_mul_f32 v[18:19], v[18:19], v[54:55]
    buffer_load_dwordx4 v[244:247], v1, s[4:7], s79 offen offset:1024 sc1
    v_exp_f32 v12, v12
    v_exp_f32 v13, v13
    v_exp_f32 v14, v14
    v_exp_f32 v15, v15
    v_exp_f32 v16, v16
    v_exp_f32 v17, v17
    v_exp_f32 v18, v18
    v_exp_f32 v19, v19
    buffer_load_dwordx4 v[248:251], v1, s[4:7], s79 offen offset:2048 sc1
    v_pk_fma_f32 v[12:13], v[12:13], v[92:93], v[92:93] op_sel:[0,0,0] op_sel_hi:[1,0,0]
    v_pk_fma_f32 v[14:15], v[14:15], v[92:93], v[92:93] op_sel:[0,0,0] op_sel_hi:[1,0,0]
    v_pk_fma_f32 v[16:17], v[16:17], v[92:93], v[92:93] op_sel:[0,1,1] op_sel_hi:[1,1,1]
    v_pk_fma_f32 v[18:19], v[18:19], v[92:93], v[92:93] op_sel:[0,1,1] op_sel_hi:[1,1,1]
    v_rcp_f32 v12, v12
    v_rcp_f32 v13, v13
    v_rcp_f32 v14, v14
    v_rcp_f32 v15, v15
    buffer_load_dwordx4 v[252:255], v1, s[4:7], s79 offen offset:3072 sc1
    s_add_u32 s79, s79, 4096
    v_rcp_f32 v16, v16
    v_rcp_f32 v17, v17
    v_rcp_f32 v18, v18
    v_rcp_f32 v19, v19
    v_pk_mul_f32 v[48:49], v[48:49], v[12:13]
    v_pk_mul_f32 v[50:51], v[50:51], v[14:15]
    v_pk_mul_f32 v[52:53], v[52:53], v[16:17]
    v_pk_mul_f32 v[54:55], v[54:55], v[18:19]
    v_cvt_pk_bf16_f32 v20, v48, v49
    v_cvt_pk_bf16_f32 v22, v52, v53
    v_cvt_pk_bf16_f32 v21, v50, v51
    v_cvt_pk_bf16_f32 v23, v54, v55
    s_nop 0
    v_permlane16_swap_b32 v20, v22
    v_permlane16_swap_b32 v21, v23
    buffer_store_dwordx4 v[20:23], v1, s[4:7], s77 offen offset:2048
    v_pk_mul_f32 v[12:13], v[56:57], v[56:57]
TCH6:
    s_cbranch_execz TCH10
    v_pk_mul_f32 v[14:15], v[58:59], v[58:59]
    v_pk_mul_f32 v[16:17], v[60:61], v[60:61]
    v_pk_mul_f32 v[18:19], v[62:63], v[62:63]
    v_pk_fma_f32 v[12:13], v[12:13], v[28:29], v[28:29] op_sel:[0,0,1] op_sel_hi:[1,0,1]
    v_pk_fma_f32 v[14:15], v[14:15], v[28:29], v[28:29] op_sel:[0,0,1] op_sel_hi:[1,0,1]
    v_pk_fma_f32 v[16:17], v[16:17], v[30:31], v[30:31] op_sel:[0,0,1] op_sel_hi:[1,0,1]
    v_pk_fma_f32 v[18:19], v[18:19], v[30:31], v[30:31] op_sel:[0,0,1] op_sel_hi:[1,0,1]
    v_pk_mul_f32 v[12:13], v[12:13], v[56:57]
    v_pk_mul_f32 v[14:15], v[14:15], v[58:59]
    v_pk_mul_f32 v[16:17], v[16:17], v[60:61]
    v_pk_mul_f32 v[18:19], v[18:19], v[62:63]
    buffer_load_dwordx4 v[96:99], v1, s[4:7], s32 offen offset:0 sc1
    v_exp_f32 v12, v12
    v_exp_f32 v13, v13
    v_exp_f32 v14, v14
    v_exp_f32 v15, v15
    v_exp_f32 v16, v16
    v_exp_f32 v17, v17
    v_exp_f32 v18, v18
    v_exp_f32 v19, v19
    buffer_load_dwordx4 v[100:103], v1, s[4:7], s36 offen offset:0 sc1
    v_pk_fma_f32 v[12:13], v[12:13], v[92:93], v[92:93] op_sel:[0,0,0] op_sel_hi:[1,0,0]
    v_pk_fma_f32 v[14:15], v[14:15], v[92:93], v[92:93] op_sel:[0,0,0] op_sel_hi:[1,0,0]
    v_pk_fma_f32 v[16:17], v[16:17], v[92:93], v[92:93] op_sel:[0,1,1] op_sel_hi:[1,1,1]
    v_pk_fma_f32 v[18:19], v[18:19], v[92:93], v[92:93] op_sel:[0,1,1] op_sel_hi:[1,1,1]
    v_rcp_f32 v12, v12
    v_rcp_f32 v13, v13
    v_rcp_f32 v14, v14
    v_rcp_f32 v15, v15
    buffer_load_dwordx4 v[104:107], v1, s[4:7], s33 offen offset:0 sc1
    v_rcp_f32 v16, v16
    v_rcp_f32 v17, v17
    v_rcp_f32 v18, v18
    v_rcp_f32 v19, v19
    v_pk_mul_f32 v[56:57], v[56:57], v[12:13]
    v_pk_mul_f32 v[58:59], v[58:59], v[14:15]
    v_pk_mul_f32 v[60:61], v[60:61], v[16:17]
    v_pk_mul_f32 v[62:63], v[62:63], v[18:19]
    v_cvt_pk_bf16_f32 v24, v56, v57
    v_cvt_pk_bf16_f32 v26, v60, v61
    v_cvt_pk_bf16_f32 v25, v58, v59
    v_cvt_pk_bf16_f32 v27, v62, v63
    s_nop 0
    v_permlane16_swap_b32 v24, v26
    v_permlane16_swap_b32 v25, v27
    buffer_store_dwordx4 v[24:27], v1, s[4:7], s77 offen offset:3072
    v_pk_mul_f32 v[12:13], v[64:65], v[64:65]
    v_pk_mul_f32 v[14:15], v[66:67], v[66:67]
    v_pk_mul_f32 v[16:17], v[68:69], v[68:69]
    v_pk_mul_f32 v[18:19], v[70:71], v[70:71]
    v_pk_fma_f32 v[12:13], v[12:13], v[28:29], v[28:29] op_sel:[0,0,1] op_sel_hi:[1,0,1]
    v_pk_fma_f32 v[14:15], v[14:15], v[28:29], v[28:29] op_sel:[0,0,1] op_sel_hi:[1,0,1]
    v_pk_fma_f32 v[16:17], v[16:17], v[30:31], v[30:31] op_sel:[0,0,1] op_sel_hi:[1,0,1]
    v_pk_fma_f32 v[18:19], v[18:19], v[30:31], v[30:31] op_sel:[0,0,1] op_sel_hi:[1,0,1]
    v_pk_mul_f32 v[12:13], v[12:13], v[64:65]
    v_pk_mul_f32 v[14:15], v[14:15], v[66:67]
    v_pk_mul_f32 v[16:17], v[16:17], v[68:69]
    v_pk_mul_f32 v[18:19], v[18:19], v[70:71]
    buffer_load_dwordx4 v[108:111], v1, s[4:7], s37 offen offset:0 sc1
    v_exp_f32 v12, v12
    v_exp_f32 v13, v13
    v_exp_f32 v14, v14
    v_exp_f32 v15, v15
    v_exp_f32 v16, v16
    v_exp_f32 v17, v17
    v_exp_f32 v18, v18
    v_exp_f32 v19, v19
    buffer_load_dwordx4 v[112:115], v1, s[4:7], s34 offen offset:0 sc1
    v_pk_fma_f32 v[12:13], v[12:13], v[92:93], v[92:93] op_sel:[0,0,0] op_sel_hi:[1,0,0]
    v_pk_fma_f32 v[14:15], v[14:15], v[92:93], v[92:93] op_sel:[0,0,0] op_sel_hi:[1,0,0]
    v_pk_fma_f32 v[16:17], v[16:17], v[92:93], v[92:93] op_sel:[0,1,1] op_sel_hi:[1,1,1]
    v_pk_fma_f32 v[18:19], v[18:19], v[92:93], v[92:93] op_sel:[0,1,1] op_sel_hi:[1,1,1]
    v_rcp_f32 v12, v12
    v_rcp_f32 v13, v13
    v_rcp_f32 v14, v14
    v_rcp_f32 v15, v15
    buffer_load_dwordx4 v[116:119], v1, s[4:7], s38 offen offset:0 sc1
    v_rcp_f32 v16, v16
    v_rcp_f32 v17, v17
    v_rcp_f32 v18, v18
    v_rcp_f32 v19, v19
    v_pk_mul_f32 v[64:65], v[64:65], v[12:13]
    v_pk_mul_f32 v[66:67], v[66:67], v[14:15]
    v_pk_mul_f32 v[68:69], v[68:69], v[16:17]
    v_pk_mul_f32 v[70:71], v[70:71], v[18:19]
    v_cvt_pk_bf16_f32 v20, v64, v65
    v_cvt_pk_bf16_f32 v22, v68, v69
    v_cvt_pk_bf16_f32 v21, v66, v67
    v_cvt_pk_bf16_f32 v23, v70, v71
    s_nop 0
    v_permlane16_swap_b32 v20, v22
    v_permlane16_swap_b32 v21, v23
    s_add_u32 s77, s77, 4096
    buffer_store_dwordx4 v[20:23], v1, s[4:7], s77 offen offset:0
    v_pk_mul_f32 v[12:13], v[72:73], v[72:73]
    v_pk_mul_f32 v[14:15], v[74:75], v[74:75]
    v_pk_mul_f32 v[16:17], v[76:77], v[76:77]
    v_pk_mul_f32 v[18:19], v[78:79], v[78:79]
    v_pk_fma_f32 v[12:13], v[12:13], v[28:29], v[28:29] op_sel:[0,0,1] op_sel_hi:[1,0,1]
    v_pk_fma_f32 v[14:15], v[14:15], v[28:29], v[28:29] op_sel:[0,0,1] op_sel_hi:[1,0,1]
    v_pk_fma_f32 v[16:17], v[16:17], v[30:31], v[30:31] op_sel:[0,0,1] op_sel_hi:[1,0,1]
    v_pk_fma_f32 v[18:19], v[18:19], v[30:31], v[30:31] op_sel:[0,0,1] op_sel_hi:[1,0,1]
    v_pk_mul_f32 v[12:13], v[12:13], v[72:73]
    v_pk_mul_f32 v[14:15], v[14:15], v[74:75]
    v_pk_mul_f32 v[16:17], v[16:17], v[76:77]
    v_pk_mul_f32 v[18:19], v[18:19], v[78:79]
    buffer_load_dwordx4 v[120:123], v1, s[4:7], s35 offen offset:0 sc1
    v_exp_f32 v12, v12
    v_exp_f32 v13, v13
    v_exp_f32 v14, v14
    v_exp_f32 v15, v15
    v_exp_f32 v16, v16
    v_exp_f32 v17, v17
    v_exp_f32 v18, v18
    v_exp_f32 v19, v19
    buffer_load_dwordx4 v[124:127], v1, s[4:7], s39 offen offset:0 sc1
    v_pk_fma_f32 v[12:13], v[12:13], v[92:93], v[92:93] op_sel:[0,0,0] op_sel_hi:[1,0,0]
    v_pk_fma_f32 v[14:15], v[14:15], v[92:93], v[92:93] op_sel:[0,0,0] op_sel_hi:[1,0,0]
    v_pk_fma_f32 v[16:17], v[16:17], v[92:93], v[92:93] op_sel:[0,1,1] op_sel_hi:[1,1,1]
    v_pk_fma_f32 v[18:19], v[18:19], v[92:93], v[92:93] op_sel:[0,1,1] op_sel_hi:[1,1,1]
    v_rcp_f32 v12, v12
    v_rcp_f32 v13, v13
    v_rcp_f32 v14, v14
    v_rcp_f32 v15, v15
    v_rcp_f32 v16, v16
    v_rcp_f32 v17, v17
    v_rcp_f32 v18, v18
    v_rcp_f32 v19, v19
    v_pk_mul_f32 v[72:73], v[72:73], v[12:13]
    v_pk_mul_f32 v[74:75], v[74:75], v[14:15]
    v_pk_mul_f32 v[76:77], v[76:77], v[16:17]
    v_pk_mul_f32 v[78:79], v[78:79], v[18:19]
    v_cvt_pk_bf16_f32 v24, v72, v73
    v_cvt_pk_bf16_f32 v26, v76, v77
    v_cvt_pk_bf16_f32 v25, v74, v75
    v_cvt_pk_bf16_f32 v27, v78, v79
    s_nop 0
    v_permlane16_swap_b32 v24, v26
    v_permlane16_swap_b32 v25, v27
    buffer_store_dwordx4 v[24:27], v1, s[4:7], s77 offen offset:1024
    v_pk_mul_f32 v[12:13], v[80:81], v[80:81]
    v_pk_mul_f32 v[14:15], v[82:83], v[82:83]
    v_pk_mul_f32 v[16:17], v[84:85], v[84:85]
    v_pk_mul_f32 v[18:19], v[86:87], v[86:87]
    v_pk_fma_f32 v[12:13], v[12:13], v[28:29], v[28:29] op_sel:[0,0,1] op_sel_hi:[1,0,1]
    v_pk_fma_f32 v[14:15], v[14:15], v[28:29], v[28:29] op_sel:[0,0,1] op_sel_hi:[1,0,1]
    v_pk_fma_f32 v[16:17], v[16:17], v[30:31], v[30:31] op_sel:[0,0,1] op_sel_hi:[1,0,1]
    v_pk_fma_f32 v[18:19], v[18:19], v[30:31], v[30:31] op_sel:[0,0,1] op_sel_hi:[1,0,1]
    v_pk_mul_f32 v[12:13], v[12:13], v[80:81]
    v_pk_mul_f32 v[14:15], v[14:15], v[82:83]
    v_pk_mul_f32 v[16:17], v[16:17], v[84:85]
    v_pk_mul_f32 v[18:19], v[18:19], v[86:87]
    v_exp_f32 v12, v12
    v_exp_f32 v13, v13
    v_exp_f32 v14, v14
    v_exp_f32 v15, v15
    v_exp_f32 v16, v16
    v_exp_f32 v17, v17
    v_exp_f32 v18, v18
    v_exp_f32 v19, v19
    v_pk_fma_f32 v[12:13], v[12:13], v[92:93], v[92:93] op_sel:[0,0,0] op_sel_hi:[1,0,0]
    v_pk_fma_f32 v[14:15], v[14:15], v[92:93], v[92:93] op_sel:[0,0,0] op_sel_hi:[1,0,0]
    v_pk_fma_f32 v[16:17], v[16:17], v[92:93], v[92:93] op_sel:[0,1,1] op_sel_hi:[1,1,1]
    v_pk_fma_f32 v[18:19], v[18:19], v[92:93], v[92:93] op_sel:[0,1,1] op_sel_hi:[1,1,1]
    v_rcp_f32 v12, v12
    v_rcp_f32 v13, v13
    v_rcp_f32 v14, v14
    v_rcp_f32 v15, v15
    v_rcp_f32 v16, v16
    v_rcp_f32 v17, v17
    v_rcp_f32 v18, v18
    v_rcp_f32 v19, v19
    v_pk_mul_f32 v[80:81], v[80:81], v[12:13]
    v_pk_mul_f32 v[82:83], v[82:83], v[14:15]
    v_pk_mul_f32 v[84:85], v[84:85], v[16:17]
    v_pk_mul_f32 v[86:87], v[86:87], v[18:19]
    v_cvt_pk_bf16_f32 v20, v80, v81
    v_cvt_pk_bf16_f32 v22, v84, v85
    v_cvt_pk_bf16_f32 v21, v82, v83
    v_cvt_pk_bf16_f32 v23, v86, v87
    s_nop 0
    v_permlane16_swap_b32 v20, v22
    v_permlane16_swap_b32 v21, v23
    buffer_store_dwordx4 v[20:23], v1, s[4:7], s77 offen offset:2048
    s_cmp_lg_u32 s31, 0
    s_cbranch_scc1 SF_111
SFD_112:
    s_waitcnt vmcnt(11)
    v_cmp_eq_u32 vcc, -1, v96
    v_bfe_u32 v7, v1, 4, 5
    v_lshrrev_b32 v4, 9, v1
    v_lshlrev_b32 v4, 4, v4
    v_lshl_add_u32 v7, v7, 10, v4
    s_lshl_b32 s79, s60, 11
    v_add_u32 v31, s79, v1
    s_cbranch_vccnz RT_113
BK_114:
    v_mfma_f32_32x32x16_bf16 v[32:47], a[0:3], v[96:99], 0
    s_waitcnt vmcnt(10)
    v_cmp_eq_u32 vcc, -1, v100
    buffer_load_dwordx4 v[12:15], v1, s[4:7], s32 offen offset:1024 sc1
    v_xor_b32 v28, 2048, v31
    v_xor_b32 v29, 4096, v31
    v_xor_b32 v30, 6144, v31
    v_mfma_f32_32x32x16_bf16 v[48:63], a[4:7], v[96:99], 0
    buffer_load_dwordx4 v[16:19], v1, s[4:7], s36 offen offset:1024 sc1
    v_add_u32 v28, 117760, v28
    v_add_u32 v29, 117760, v29
    v_add_u32 v30, 117760, v30
    v_add_u32 v31, 117760, v31
    s_cbranch_vccnz RT_117
BK_118:
    v_mfma_f32_32x32x16_bf16 v[64:79], a[0:3], v[100:103], 0
    s_waitcnt vmcnt(11)
    v_cmp_eq_u32 vcc, -1, v104
    buffer_load_dwordx4 v[20:23], v1, s[4:7], s33 offen offset:1024 sc1
    s_lshl_b32 s70, s58, 3
    s_add_u32 s70, s70, s61
    s_lshl2_add_u32 s70, s70, s60
    v_mfma_f32_32x32x16_bf16 v[80:95], a[4:7], v[100:103], 0
    buffer_load_dwordx4 v[24:27], v1, s[4:7], s37 offen offset:1024 sc1
    s_lshl_b32 s70, s70, 13
    v_lshrrev_b32 v2, 7, v1
    v_and_b32 v4, 0x70, v1
    v_lshl_add_u32 v2, v2, 10, v4
    s_cbranch_vccnz RT_121
BK_122:
    v_mfma_f32_32x32x16_bf16 v[32:47], a[56:59], v[104:107], v[32:47]
    s_waitcnt vmcnt(11)
    v_cmp_eq_u32 vcc, -1, v108
    buffer_load_dwordx4 v[96:99], v1, s[4:7], s34 offen offset:1024 sc1
    v_mfma_f32_32x32x16_bf16 v[48:63], a[60:63], v[104:107], v[48:63]
    buffer_load_dwordx4 v[100:103], v1, s[4:7], s38 offen offset:1024 sc1
    s_cbranch_vccnz RT_125
BK_126:
    v_mfma_f32_32x32x16_bf16 v[64:79], a[56:59], v[108:111], v[64:79]
    s_waitcnt vmcnt(12)
    v_cmp_eq_u32 vcc, -1, v112
    buffer_load_dwordx4 v[104:107], v1, s[4:7], s35 offen offset:1024 sc1
    v_mfma_f32_32x32x16_bf16 v[80:95], a[60:63], v[108:111], v[80:95]
    buffer_load_dwordx4 v[108:111], v1, s[4:7], s39 offen offset:1024 sc1
    s_cbranch_vccnz RT_129
BK_130:
    v_mfma_f32_32x32x16_bf16 v[32:47], a[112:115], v[112:115], v[32:47]
    s_waitcnt vmcnt(13)
    v_cmp_eq_u32 vcc, -1, v116
    v_mfma_f32_32x32x16_bf16 v[48:63], a[116:119], v[112:115], v[48:63]
    buffer_load_dwordx4 v[112:115], v1, s[4:7], s32 offen offset:2048 sc1
    s_cbranch_vccnz RT_133
BK_134:
    v_mfma_f32_32x32x16_bf16 v[64:79], a[112:115], v[116:119], v[64:79]
    s_waitcnt vmcnt(12)
    v_cmp_eq_u32 vcc, -1, v120
    v_mfma_f32_32x32x16_bf16 v[80:95], a[116:119], v[116:119], v[80:95]
    buffer_load_dwordx4 v[116:119], v1, s[4:7], s36 offen offset:2048 sc1
    s_cbranch_vccnz RT_137
BK_138:
    v_mfma_f32_32x32x16_bf16 v[32:47], a[168:171], v[120:123], v[32:47]
    s_waitcnt vmcnt(12)
    v_cmp_eq_u32 vcc, -1, v124
    v_mfma_f32_32x32x16_bf16 v[48:63], a[172:175], v[120:123], v[48:63]
    buffer_load_dwordx4 v[120:123], v1, s[4:7], s33 offen offset:2048 sc1
    s_cbranch_vccnz RT_141
BK_142:
    v_mfma_f32_32x32x16_bf16 v[64:79], a[168:171], v[124:127], v[64:79]
    s_waitcnt vmcnt(10)
    v_cmp_eq_u32 vcc, -1, v12
    v_mfma_f32_32x32x16_bf16 v[80:95], a[172:175], v[124:127], v[80:95]
    buffer_load_dwordx4 v[124:127], v1, s[4:7], s37 offen offset:2048 sc1
    s_cbranch_vccnz RT_145
BK_146:
    v_mfma_f32_32x32x16_bf16 v[32:47], a[8:11], v[12:15], v[32:47]
    s_waitcnt vmcnt(10)
    v_cmp_eq_u32 vcc, -1, v16
    v_mfma_f32_32x32x16_bf16 v[48:63], a[12:15], v[12:15], v[48:63]
    buffer_load_dwordx4 v[12:15], v1, s[4:7], s34 offen offset:2048 sc1
    s_cbranch_vccnz RT_149
BK_150:
    v_mfma_f32_32x32x16_bf16 v[64:79], a[8:11], v[16:19], v[64:79]
    s_waitcnt vmcnt(10)
    v_cmp_eq_u32 vcc, -1, v20
    v_mfma_f32_32x32x16_bf16 v[80:95], a[12:15], v[16:19], v[80:95]
    buffer_load_dwordx4 v[16:19], v1, s[4:7], s38 offen offset:2048 sc1
    s_cbranch_vccnz RT_153
BK_154:
    v_mfma_f32_32x32x16_bf16 v[32:47], a[64:67], v[20:23], v[32:47]
    s_waitcnt vmcnt(10)
    v_cmp_eq_u32 vcc, -1, v24
    v_mfma_f32_32x32x16_bf16 v[48:63], a[68:71], v[20:23], v[48:63]
    buffer_load_dwordx4 v[20:23], v1, s[4:7], s35 offen offset:2048 sc1
    s_cbranch_vccnz RT_157
BK_158:
    v_mfma_f32_32x32x16_bf16 v[64:79], a[64:67], v[24:27], v[64:79]
    s_waitcnt vmcnt(10)
    v_cmp_eq_u32 vcc, -1, v96
    v_mfma_f32_32x32x16_bf16 v[80:95], a[68:71], v[24:27], v[80:95]
    buffer_load_dwordx4 v[24:27], v1, s[4:7], s39 offen offset:2048 sc1
    s_cbranch_vccnz RT_161
BK_162:
    v_mfma_f32_32x32x16_bf16 v[32:47], a[120:123], v[96:99], v[32:47]
    s_waitcnt vmcnt(10)
    v_cmp_eq_u32 vcc, -1, v100
    v_mfma_f32_32x32x16_bf16 v[48:63], a[124:127], v[96:99], v[48:63]
    buffer_load_dwordx4 v[96:99], v1, s[4:7], s76 offen sc1
    s_cbranch_vccnz RT_165
BK_166:
    v_mfma_f32_32x32x16_bf16 v[64:79], a[120:123], v[100:103], v[64:79]
    s_waitcnt vmcnt(10)
    v_cmp_eq_u32 vcc, -1, v104
    v_mfma_f32_32x32x16_bf16 v[80:95], a[124:127], v[100:103], v[80:95]
    buffer_load_dwordx4 v[100:103], v1, s[4:7], s32 offen offset:3072 sc1
    s_cbranch_vccnz RT_169
BK_170:
    v_mfma_f32_32x32x16_bf16 v[32:47], a[176:179], v[104:107], v[32:47]
    s_waitcnt vmcnt(10)
    v_cmp_eq_u32 vcc, -1, v108
    v_mfma_f32_32x32x16_bf16 v[48:63], a[180:183], v[104:107], v[48:63]
    buffer_load_dwordx4 v[104:107], v1, s[4:7], s33 offen offset:3072 sc1
    s_cbranch_vccnz RT_173
BK_174:
    v_mfma_f32_32x32x16_bf16 v[64:79], a[176:179], v[108:111], v[64:79]
    s_waitcnt vmcnt(10)
    v_cmp_eq_u32 vcc, -1, v112
    v_mfma_f32_32x32x16_bf16 v[80:95], a[180:183], v[108:111], v[80:95]
    buffer_load_dwordx4 v[108:111], v1, s[4:7], s34 offen offset:3072 sc1
    s_cbranch_vccnz RT_177
BK_178:
    v_mfma_f32_32x32x16_bf16 v[32:47], a[16:19], v[112:115], v[32:47]
    s_waitcnt vmcnt(10)
    v_cmp_eq_u32 vcc, -1, v116
    v_mfma_f32_32x32x16_bf16 v[48:63], a[20:23], v[112:115], v[48:63]
    buffer_load_dwordx4 v[112:115], v1, s[4:7], s35 offen offset:3072 sc1
    s_cbranch_vccnz RT_181
BK_182:
    v_mfma_f32_32x32x16_bf16 v[64:79], a[16:19], v[116:119], v[64:79]
    s_waitcnt vmcnt(10)
    v_cmp_eq_u32 vcc, -1, v120
    v_mfma_f32_32x32x16_bf16 v[80:95], a[20:23], v[116:119], v[80:95]
    buffer_load_dwordx4 v[116:119], v1, s[4:7], s40 offen offset:0 sc1
    s_cbranch_vccnz RT_185
BK_186:
    v_mfma_f32_32x32x16_bf16 v[32:47], a[72:75], v[120:123], v[32:47]
    s_waitcnt vmcnt(10)
    v_cmp_eq_u32 vcc, -1, v124
    v_mfma_f32_32x32x16_bf16 v[48:63], a[76:79], v[120:123], v[48:63]
    buffer_load_dwordx4 v[120:123], v1, s[4:7], s41 offen offset:0 sc1
    s_cbranch_vccnz RT_189
BK_190:
    v_mfma_f32_32x32x16_bf16 v[64:79], a[72:75], v[124:127], v[64:79]
    s_waitcnt vmcnt(10)
    v_cmp_eq_u32 vcc, -1, v12
    v_mfma_f32_32x32x16_bf16 v[80:95], a[76:79], v[124:127], v[80:95]
    buffer_load_dwordx4 v[124:127], v1, s[4:7], s42 offen offset:0 sc1
    s_cbranch_vccnz RT_193
BK_194:
    v_mfma_f32_32x32x16_bf16 v[32:47], a[128:131], v[12:15], v[32:47]
    s_waitcnt vmcnt(10)
    v_cmp_eq_u32 vcc, -1, v16
    v_mfma_f32_32x32x16_bf16 v[48:63], a[132:135], v[12:15], v[48:63]
    buffer_load_dwordx4 v[12:15], v1, s[4:7], s43 offen offset:0 sc1
    s_cbranch_vccnz RT_197
BK_198:
    v_mfma_f32_32x32x16_bf16 v[64:79], a[128:131], v[16:19], v[64:79]
    s_waitcnt vmcnt(10)
    v_cmp_eq_u32 vcc, -1, v20
    v_mfma_f32_32x32x16_bf16 v[80:95], a[132:135], v[16:19], v[80:95]
    buffer_load_dwordx4 v[16:19], v1, s[4:7], s40 offen offset:1024 sc1
    s_cbranch_vccnz RT_201
BK_202:
    v_mfma_f32_32x32x16_bf16 v[32:47], a[184:187], v[20:23], v[32:47]
    s_waitcnt vmcnt(10)
    v_cmp_eq_u32 vcc, -1, v24
    v_mfma_f32_32x32x16_bf16 v[48:63], a[188:191], v[20:23], v[48:63]
    buffer_load_dwordx4 v[20:23], v1, s[4:7], s41 offen offset:1024 sc1
    s_cbranch_vccnz RT_205
BK_206:
    v_mfma_f32_32x32x16_bf16 v[64:79], a[184:187], v[24:27], v[64:79]
    s_waitcnt vmcnt(9)
    v_cmp_eq_u32 vcc, -1, v100
    v_mfma_f32_32x32x16_bf16 v[80:95], a[188:191], v[24:27], v[80:95]
    buffer_load_dwordx4 v[24:27], v1, s[4:7], s42 offen offset:1024 sc1
    s_cbranch_vccnz RT_209
BK_210:
    v_mfma_f32_32x32x16_bf16 v[32:47], a[24:27], v[100:103], v[32:47]
    s_waitcnt vmcnt(9)
    v_cmp_eq_u32 vcc, -1, v104
    v_mfma_f32_32x32x16_bf16 v[48:63], a[28:31], v[100:103], v[48:63]
    s_cbranch_vccnz RT_213
BK_214:
    v_mfma_f32_32x32x16_bf16 v[32:47], a[80:83], v[104:107], v[32:47]
    s_waitcnt vmcnt(8)
    v_cmp_eq_u32 vcc, -1, v108
    s_waitcnt vmcnt(11)
    v_lshlrev_b32 v4, 16, v96
    v_and_b32 v5, s91, v96
    v_add_f32 v64, v64, v4
    v_mfma_f32_32x32x16_bf16 v[48:63], a[84:87], v[104:107], v[48:63]
    v_add_f32 v65, v65, v5
    v_lshlrev_b32 v4, 16, v97
    v_and_b32 v5, s91, v97
    v_add_f32 v66, v66, v4
    v_add_f32 v67, v67, v5
    s_cbranch_vccnz RT_217
BK_218:
    v_mfma_f32_32x32x16_bf16 v[32:47], a[136:139], v[108:111], v[32:47]
    s_waitcnt vmcnt(7)
    v_cmp_eq_u32 vcc, -1, v112
    v_lshlrev_b32 v4, 16, v98
    v_and_b32 v5, s91, v98
    v_add_f32 v68, v68, v4
    v_add_f32 v69, v69, v5
    v_mfma_f32_32x32x16_bf16 v[48:63], a[140:143], v[108:111], v[48:63]
    v_lshlrev_b32 v4, 16, v99
    v_and_b32 v5, s91, v99
    v_add_f32 v70, v70, v4
    v_add_f32 v71, v71, v5
    v_accvgpr_read_b32 v5, a240
    s_cbranch_vccnz RT_221
BK_222:
    v_mfma_f32_32x32x16_bf16 v[32:47], a[192:195], v[112:115], v[32:47]
    s_waitcnt vmcnt(6)
    v_cmp_eq_u32 vcc, -1, v116
    buffer_load_dwordx4 v[96:99], v1, s[4:7], s43 offen offset:1024 sc1
    v_lshlrev_b32 v4, 16, v5
    v_and_b32 v5, s91, v5
    v_add_f32 v64, v64, v4
    v_mfma_f32_32x32x16_bf16 v[48:63], a[196:199], v[112:115], v[48:63]
    buffer_load_dwordx4 v[100:103], v1, s[4:7], s40 offen offset:2048 sc1
    v_add_f32 v65, v65, v5
    v_accvgpr_read_b32 v5, a241
    v_lshlrev_b32 v4, 16, v5
    v_and_b32 v5, s91, v5
    s_cbranch_vccnz RT_225
BK_226:
    v_mfma_f32_32x32x16_bf16 v[32:47], a[32:35], v[116:119], v[32:47]
    s_waitcnt vmcnt(7)
    v_cmp_eq_u32 vcc, -1, v120
    buffer_load_dwordx4 v[104:107], v1, s[4:7], s41 offen offset:2048 sc1
    v_add_f32 v66, v66, v4
    v_add_f32 v67, v67, v5
    v_accvgpr_read_b32 v5, a242
    v_mfma_f32_32x32x16_bf16 v[48:63], a[36:39], v[116:119], v[48:63]
    buffer_load_dwordx4 v[108:111], v1, s[4:7], s42 offen offset:2048 sc1
    v_lshlrev_b32 v4, 16, v5
    v_and_b32 v5, s91, v5
    v_add_f32 v68, v68, v4
    v_add_f32 v69, v69, v5
    s_cbranch_vccnz RT_229
BK_230:
    v_mfma_f32_32x32x16_bf16 v[32:47], a[88:91], v[120:123], v[32:47]
    s_waitcnt vmcnt(8)
    v_cmp_eq_u32 vcc, -1, v124
    buffer_load_dwordx4 v[112:115], v1, s[4:7], s43 offen offset:2048 sc1
    v_accvgpr_read_b32 v5, a243
    v_lshlrev_b32 v4, 16, v5
    v_and_b32 v5, s91, v5
    v_mfma_f32_32x32x16_bf16 v[48:63], a[92:95], v[120:123], v[48:63]
    buffer_load_dwordx4 v[116:119], v1, s[4:7], s75 offen sc1
    v_add_f32 v70, v70, v4
    v_add_f32 v71, v71, v5
    s_cbranch_vccnz RT_233
BK_234:
    v_mfma_f32_32x32x16_bf16 v[32:47], a[144:147], v[124:127], v[32:47]
    s_waitcnt vmcnt(9)
    v_cmp_eq_u32 vcc, -1, v12
    buffer_load_dwordx4 v[120:123], v1, s[4:7], s36 offen offset:3072 sc1
    v_mfma_f32_32x32x16_bf16 v[48:63], a[148:151], v[124:127], v[48:63]
    buffer_load_dwordx4 v[124:127], v1, s[4:7], s37 offen offset:3072 sc1
    s_cbranch_vccnz RT_237
BK_238:
    v_mfma_f32_32x32x16_bf16 v[32:47], a[200:203], v[12:15], v[32:47]
    s_waitcnt vmcnt(10)
    v_cmp_eq_u32 vcc, -1, v16
    v_mfma_f32_32x32x16_bf16 v[48:63], a[204:207], v[12:15], v[48:63]
    buffer_load_dwordx4 v[12:15], v1, s[4:7], s38 offen offset:3072 sc1
    s_cbranch_vccnz RT_241
BK_242:
    v_mfma_f32_32x32x16_bf16 v[32:47], a[40:43], v[16:19], v[32:47]
    s_waitcnt vmcnt(10)
    v_cmp_eq_u32 vcc, -1, v20
    v_mfma_f32_32x32x16_bf16 v[48:63], a[44:47], v[16:19], v[48:63]
    buffer_load_dwordx4 v[16:19], v1, s[4:7], s39 offen offset:3072 sc1
    s_cbranch_vccnz RT_245
BK_246:
    v_mfma_f32_32x32x16_bf16 v[32:47], a[96:99], v[20:23], v[32:47]
    s_waitcnt vmcnt(10)
    v_cmp_eq_u32 vcc, -1, v24
    v_mfma_f32_32x32x16_bf16 v[48:63], a[100:103], v[20:23], v[48:63]
    buffer_load_dwordx4 v[20:23], v1, s[4:7], s44 offen offset:0 sc1
    s_cbranch_vccnz RT_249
BK_250:
    v_mfma_f32_32x32x16_bf16 v[32:47], a[152:155], v[24:27], v[32:47]
    s_waitcnt vmcnt(10)
    v_cmp_eq_u32 vcc, -1, v96
    v_mfma_f32_32x32x16_bf16 v[48:63], a[156:159], v[24:27], v[48:63]
    buffer_load_dwordx4 v[24:27], v1, s[4:7], s45 offen offset:0 sc1
    s_cbranch_vccnz RT_253
BK_254:
    v_mfma_f32_32x32x16_bf16 v[32:47], a[208:211], v[96:99], v[32:47]
    s_waitcnt vmcnt(10)
    v_cmp_eq_u32 vcc, -1, v100
    v_mfma_f32_32x32x16_bf16 v[48:63], a[212:215], v[96:99], v[48:63]
    buffer_load_dwordx4 v[96:99], v1, s[4:7], s46 offen offset:0 sc1
    s_cbranch_vccnz RT_257
BK_258:
    v_mfma_f32_32x32x16_bf16 v[32:47], a[48:51], v[100:103], v[32:47]
    s_waitcnt vmcnt(10)
    v_cmp_eq_u32 vcc, -1, v104
    v_mfma_f32_32x32x16_bf16 v[48:63], a[52:55], v[100:103], v[48:63]
    buffer_load_dwordx4 v[100:103], v1, s[4:7], s47 offen offset:0 sc1
    s_cbranch_vccnz RT_261
BK_262:
    v_mfma_f32_32x32x16_bf16 v[32:47], a[104:107], v[104:107], v[32:47]
    s_waitcnt vmcnt(10)
    v_cmp_eq_u32 vcc, -1, v108
    v_mfma_f32_32x32x16_bf16 v[48:63], a[108:111], v[104:107], v[48:63]
    buffer_load_dwordx4 v[104:107], v1, s[4:7], s44 offen offset:1024 sc1
    s_cbranch_vccnz RT_265
BK_266:
    v_mfma_f32_32x32x16_bf16 v[32:47], a[160:163], v[108:111], v[32:47]
    s_waitcnt vmcnt(10)
    v_cmp_eq_u32 vcc, -1, v112
    v_mfma_f32_32x32x16_bf16 v[48:63], a[164:167], v[108:111], v[48:63]
    buffer_load_dwordx4 v[108:111], v1, s[4:7], s45 offen offset:1024 sc1
    s_cbranch_vccnz RT_269
BK_270:
    v_mfma_f32_32x32x16_bf16 v[32:47], a[216:219], v[112:115], v[32:47]
    s_waitcnt vmcnt(9)
    v_cmp_eq_u32 vcc, -1, v120
    v_mfma_f32_32x32x16_bf16 v[48:63], a[220:223], v[112:115], v[48:63]
    buffer_load_dwordx4 v[112:115], v1, s[4:7], s46 offen offset:1024 sc1
    s_cbranch_vccnz RT_273
BK_274:
    v_mfma_f32_32x32x16_bf16 v[64:79], a[24:27], v[120:123], v[64:79]
    s_waitcnt vmcnt(9)
    v_cmp_eq_u32 vcc, -1, v124
    v_mfma_f32_32x32x16_bf16 v[80:95], a[28:31], v[120:123], v[80:95]
    s_cbranch_vccnz RT_277
BK_278:
    v_mfma_f32_32x32x16_bf16 v[64:79], a[80:83], v[124:127], v[64:79]
    s_waitcnt vmcnt(8)
    v_cmp_eq_u32 vcc, -1, v12
    s_waitcnt vmcnt(11)
    ds_write_b128 v28, v[40:43] offset:0
    v_lshlrev_b32 v4, 16, v116
    v_and_b32 v5, s91, v116
    v_mfma_f32_32x32x16_bf16 v[80:95], a[84:87], v[124:127], v[80:95]
    v_add_f32 v32, v32, v4
    v_add_f32 v33, v33, v5
    v_lshlrev_b32 v4, 16, v117
    v_and_b32 v5, s91, v117
    s_cbranch_vccnz RT_281
BK_282:
    v_mfma_f32_32x32x16_bf16 v[64:79], a[136:139], v[12:15], v[64:79]
    s_waitcnt vmcnt(7)
    v_cmp_eq_u32 vcc, -1, v16
    ds_write_b128 v28, v[44:47] offset:1024
    v_add_f32 v34, v34, v4
    v_add_f32 v35, v35, v5
    v_mfma_f32_32x32x16_bf16 v[80:95], a[140:143], v[12:15], v[80:95]
    v_lshlrev_b32 v4, 16, v118
    v_and_b32 v5, s91, v118
    v_add_f32 v36, v36, v4
    v_add_f32 v37, v37, v5
    s_cbranch_vccnz RT_285
BK_286:
    v_mfma_f32_32x32x16_bf16 v[64:79], a[192:195], v[16:19], v[64:79]
    s_waitcnt vmcnt(6)
    v_cmp_eq_u32 vcc, -1, v20
    ds_write_b128 v29, v[48:51] offset:8192
    v_lshlrev_b32 v4, 16, v119
    v_and_b32 v5, s91, v119
    v_mfma_f32_32x32x16_bf16 v[80:95], a[196:199], v[16:19], v[80:95]
    v_add_f32 v38, v38, v4
    v_add_f32 v39, v39, v5
    v_accvgpr_read_b32 v5, a240
    v_lshlrev_b32 v4, 16, v5
    s_cbranch_vccnz RT_289
BK_290:
    v_mfma_f32_32x32x16_bf16 v[64:79], a[32:35], v[20:23], v[64:79]
    s_waitcnt vmcnt(5)
    v_cmp_eq_u32 vcc, -1, v24
    buffer_load_dwordx4 v[116:119], v1, s[4:7], s47 offen offset:1024 sc1
    ds_write_b128 v29, v[52:55] offset:9216
    v_and_b32 v5, s91, v5
    v_add_f32 v32, v32, v4
    v_mfma_f32_32x32x16_bf16 v[80:95], a[36:39], v[20:23], v[80:95]
    buffer_load_dwordx4 v[120:123], v1, s[4:7], s44 offen offset:2048 sc1
    v_add_f32 v33, v33, v5
    v_accvgpr_read_b32 v5, a241
    v_lshlrev_b32 v4, 16, v5
    v_and_b32 v5, s91, v5
    s_cbranch_vccnz RT_293
BK_294:
    v_mfma_f32_32x32x16_bf16 v[64:79], a[88:91], v[24:27], v[64:79]
    s_waitcnt vmcnt(6)
    v_cmp_eq_u32 vcc, -1, v96
    buffer_load_dwordx4 v[124:127], v1, s[4:7], s45 offen offset:2048 sc1
    ds_write_b128 v30, v[56:59] offset:16384
    v_add_f32 v34, v34, v4
    v_add_f32 v35, v35, v5
    v_mfma_f32_32x32x16_bf16 v[80:95], a[92:95], v[24:27], v[80:95]
    buffer_load_dwordx4 v[12:15], v1, s[4:7], s46 offen offset:2048 sc1
    v_accvgpr_read_b32 v5, a242
    v_lshlrev_b32 v4, 16, v5
    v_and_b32 v5, s91, v5
    v_add_f32 v36, v36, v4
    s_cbranch_vccnz RT_297
BK_298:
    v_mfma_f32_32x32x16_bf16 v[64:79], a[144:147], v[96:99], v[64:79]
    s_waitcnt vmcnt(7)
    v_cmp_eq_u32 vcc, -1, v100
    buffer_load_dwordx4 v[16:19], v1, s[4:7], s47 offen offset:2048 sc1
    ds_write_b128 v30, v[60:63] offset:17408
    v_add_f32 v37, v37, v5
    v_accvgpr_read_b32 v5, a243
    v_mfma_f32_32x32x16_bf16 v[80:95], a[148:151], v[96:99], v[80:95]
    v_lshlrev_b32 v4, 16, v5
    v_and_b32 v5, s91, v5
    v_add_f32 v38, v38, v4
    v_add_f32 v39, v39, v5
    s_cbranch_vccnz RT_301
BK_302:
    v_mfma_f32_32x32x16_bf16 v[64:79], a[200:203], v[100:103], v[64:79]
    s_waitcnt vmcnt(7)
    v_cmp_eq_u32 vcc, -1, v104
    v_mfma_f32_32x32x16_bf16 v[80:95], a[204:207], v[100:103], v[80:95]
    s_waitcnt lgkmcnt(0)
    s_barrier
    ds_read_b128 v[40:43], v31 offset:0
    ds_read_b128 v[44:47], v31 offset:1024
    ds_read_b128 v[48:51], v31 offset:8192
    s_cbranch_vccnz RT_305
BK_306:
    v_mfma_f32_32x32x16_bf16 v[64:79], a[40:43], v[104:107], v[64:79]
    s_waitcnt vmcnt(6)
    v_cmp_eq_u32 vcc, -1, v108
    ds_read_b128 v[52:55], v31 offset:9216
    ds_read_b128 v[56:59], v31 offset:16384
    ds_read_b128 v[60:63], v31 offset:17408
    v_mfma_f32_32x32x16_bf16 v[80:95], a[44:47], v[104:107], v[80:95]
    s_cbranch_vccnz RT_309
BK_310:
    v_mfma_f32_32x32x16_bf16 v[64:79], a[96:99], v[108:111], v[64:79]
    s_waitcnt vmcnt(5)
    v_cmp_eq_u32 vcc, -1, v112
    s_waitcnt lgkmcnt(4)
    v_add_f32 v32, v32, v40
    v_add_f32 v33, v33, v41
    v_add_f32 v34, v34, v42
    v_mfma_f32_32x32x16_bf16 v[80:95], a[100:103], v[108:111], v[80:95]
    v_add_f32 v35, v35, v43
    v_add_f32 v36, v36, v44
    v_add_f32 v37, v37, v45
    s_cbranch_vccnz RT_313
BK_314:
    s_waitcnt vmcnt(4)
    v_cmp_eq_u32 vcc, -1, v116
    v_mfma_f32_32x32x16_bf16 v[80:95], a[156:159], v[112:115], v[80:95]
    v_add_f32 v38, v38, v46
    v_add_f32 v39, v39, v47
    s_waitcnt lgkmcnt(2)
    s_cbranch_vccnz RT_317
BK_318:
    s_waitcnt vmcnt(3)
    v_cmp_eq_u32 vcc, -1, v120
    v_mfma_f32_32x32x16_bf16 v[80:95], a[212:215], v[116:119], v[80:95]
    v_add_f32 v32, v32, v48
    v_add_f32 v33, v33, v49
    v_add_f32 v34, v34, v50
    s_cbranch_vccnz RT_321
BK_322:
    s_waitcnt vmcnt(2)
    v_cmp_eq_u32 vcc, -1, v124
    v_mfma_f32_32x32x16_bf16 v[80:95], a[52:55], v[120:123], v[80:95]
    v_add_f32 v35, v35, v51
    v_add_f32 v36, v36, v52
    v_add_f32 v37, v37, v53
    s_cbranch_vccnz RT_325
BK_326:
    s_waitcnt vmcnt(1)
    v_cmp_eq_u32 vcc, -1, v12
    v_mfma_f32_32x32x16_bf16 v[80:95], a[108:111], v[124:127], v[80:95]
    v_add_f32 v38, v38, v54
    v_add_f32 v39, v39, v55
    s_waitcnt lgkmcnt(0)
    s_cbranch_vccnz RT_329
BK_330:
    s_waitcnt vmcnt(0)
    v_cmp_eq_u32 vcc, -1, v16
    v_mfma_f32_32x32x16_bf16 v[80:95], a[164:167], v[12:15], v[80:95]
    s_barrier
    v_add_f32 v32, v32, v56
    v_add_f32 v33, v33, v57
    v_add_f32 v34, v34, v58
    v_add_f32 v35, v35, v59
    s_cbranch_vccnz RT_333
BK_334:
    v_mfma_f32_32x32x16_bf16 v[80:95], a[220:223], v[16:19], v[80:95]
    v_add_f32 v36, v36, v60
    v_add_f32 v37, v37, v61
    v_add_f32 v38, v38, v62
    v_add_f32 v39, v39, v63
    v_cvt_pk_bf16_f32 v32, v32, v33
    v_cvt_pk_bf16_f32 v33, v34, v35
    v_mfma_f32_32x32x16_bf16 v[64:79], a[152:155], v[112:115], v[64:79]
    v_cvt_pk_bf16_f32 v34, v36, v37
    v_cvt_pk_bf16_f32 v35, v38, v39
    buffer_store_dwordx4 v[32:35], v7, s[12:15], s78 offen
    s_add_u32 s78, s78, 0x8000
    s_nop 0
    ds_write_b128 v29, v[80:83] offset:8192
    v_mfma_f32_32x32x16_bf16 v[64:79], a[208:211], v[116:119], v[64:79]
    ds_write_b128 v29, v[84:87] offset:9216
    v_mfma_f32_32x32x16_bf16 v[64:79], a[48:51], v[120:123], v[64:79]
    ds_write_b128 v30, v[88:91] offset:16384
    v_mfma_f32_32x32x16_bf16 v[64:79], a[104:107], v[124:127], v[64:79]
    ds_write_b128 v30, v[92:95] offset:17408
    v_mfma_f32_32x32x16_bf16 v[64:79], a[160:163], v[12:15], v[64:79]
    v_mfma_f32_32x32x16_bf16 v[64:79], a[216:219], v[16:19], v[64:79]
    s_nop 11
    ds_write_b128 v28, v[72:75] offset:0
    ds_write_b128 v28, v[76:79] offset:1024
    s_waitcnt lgkmcnt(0)
    s_barrier
    ds_read_b128 v[80:83], v31 offset:8192
    ds_read_b128 v[84:87], v31 offset:9216
    ds_read_b128 v[88:91], v31 offset:16384
    ds_read_b128 v[92:95], v31 offset:17408
    ds_read_b128 v[72:75], v31 offset:0
    ds_read_b128 v[76:79], v31 offset:1024
    s_waitcnt lgkmcnt(4)
    v_pk_add_f32 v[64:65], v[64:65], v[80:81]
    v_pk_add_f32 v[66:67], v[66:67], v[82:83]
    v_pk_add_f32 v[68:69], v[68:69], v[84:85]
    v_pk_add_f32 v[70:71], v[70:71], v[86:87]
    s_waitcnt lgkmcnt(2)
    v_pk_add_f32 v[64:65], v[64:65], v[88:89]
    v_pk_add_f32 v[66:67], v[66:67], v[90:91]
    v_pk_add_f32 v[68:69], v[68:69], v[92:93]
    v_pk_add_f32 v[70:71], v[70:71], v[94:95]
    s_waitcnt lgkmcnt(0)
    v_pk_add_f32 v[64:65], v[64:65], v[72:73]
    v_pk_add_f32 v[66:67], v[66:67], v[74:75]
    v_pk_add_f32 v[68:69], v[68:69], v[76:77]
    v_pk_add_f32 v[70:71], v[70:71], v[78:79]
    v_cvt_pk_bf16_f32 v64, v64, v65
    v_cvt_pk_bf16_f32 v65, v66, v67
TCH7:
    s_cbranch_execz TCH11
    v_cvt_pk_bf16_f32 v66, v68, v69
    v_cvt_pk_bf16_f32 v67, v70, v71
    buffer_store_dwordx4 v[64:67], v7, s[12:15], s78 offen
    s_cmp_lg_u32 s31, 0
    s_cbranch_scc1 SF_337
SFD_338:
    buffer_load_dwordx4 v[32:35], v2, s[12:15], s70 offen offset:0 sc1
    buffer_load_dwordx4 v[36:39], v2, s[12:15], s70 offen offset:128 sc1
    buffer_load_dwordx4 v[40:43], v2, s[12:15], s70 offen offset:256 sc1
    buffer_load_dwordx4 v[44:47], v2, s[12:15], s70 offen offset:384 sc1
    buffer_load_dwordx4 v[48:51], v2, s[12:15], s70 offen offset:512 sc1
    buffer_load_dwordx4 v[52:55], v2, s[12:15], s70 offen offset:640 sc1
    buffer_load_dwordx4 v[56:59], v2, s[12:15], s70 offen offset:768 sc1
    buffer_load_dwordx4 v[60:63], v2, s[12:15], s70 offen offset:896 sc1
    s_add_u32 s65, s65, 0x20000
    s_add_u32 s66, s66, 0x8000
    s_add_u32 s64, s64, 1024
    s_mul_i32 s77, s60, 8320
    s_add_u32 s77, s77, 117760
    v_lshrrev_b32 v96, 7, v1
    v_mul_u32_u24 v112, 1040, v96
    v_and_b32 v97, 0x70, v1
    v_add3_u32 v112, v112, v97, s77
    s_lshl_b32 s77, s60, 5
    s_add_u32 s77, s77, 114688
    v_lshl_add_u32 v114, v96, 2, s77
    s_lshr_b32 s78, s62, 1
    s_mul_i32 s77, s78, 16640
    s_lshl_b32 s79, s60, 8
    s_add_u32 s77, s77, s79
    s_add_u32 s77, s77, 117760
    v_bfe_u32 v96, v1, 4, 4
    v_lshrrev_b32 v97, 8, v1
    v_mul_u32_u24 v113, 1040, v96
    v_lshl_add_u32 v113, v97, 4, v113
    v_add_u32 v113, s77, v113
    s_lshl_b32 s77, s60, 10
    v_add_u32 v120, 151360, v1
    v_add_u32 v115, s77, v120
    s_bitcmp1_b32 s62, 0
    s_cselect_b64 vcc, -1, 0
    s_cselect_b32 s79, 4, 0
    s_lshl_b32 s77, s78, 6
    s_add_u32 s77, s77, 114688
    v_lshlrev_b32 v98, 2, v97
    v_cndmask_b32 v98, v96, v98, vcc
    v_lshl_add_u32 v116, v98, 2, s77
    v_add_u32 v117, s79, v116
    v_add_u32 v118, s79, v117
    v_add_u32 v119, s79, v118
    v_lshrrev_b32 v100, 1, v97
    v_and_b32 v101, 1, v97
    v_lshlrev_b32 v101, 3, v101
    v_lshl_add_u32 v98, v100, 9, v101
    v_lshl_add_u32 v98, v96, 4, v98
    v_lshl_add_u32 v99, v100, 8, v101
    v_and_b32 v100, 0x30, v1
    v_add_u32 v99, v99, v100
    v_bfe_u32 v100, v1, 6, 1
    v_lshl_add_u32 v99, v100, 7, v99
    v_bfe_u32 v100, v1, 7, 1
    v_lshl_add_u32 v99, v100, 6, v99
    v_cndmask_b32 v121, v98, v99, vcc
    s_mul_i32 s77, s60, 2080
    s_add_u32 s77, s77, 117760
    v_add_u32 v126, s77, v98
    v_add_u32 v127, s77, v99
    v_bfe_u32 v96, v1, 4, 5
    v_lshrrev_b32 v97, 9, v1
    v_mul_u32_u24 v7, 1040, v96
    v_lshl_add_u32 v7, v97, 4, v7
    v_add_u32 v7, 117760, v7
    s_lshl2_add_u32 s77, s62, s60
    s_lshl_b32 s77, s77, 6
    v_add_u32 v122, s77, v7
    v_lshlrev_b32 v96, 2, v96
    v_add_u32 v123, 114688, v96
    s_lshl_b32 s77, s60, 7
    s_add_u32 s77, s77, 114944
    v_lshl_add_u32 v125, v97, 4, s77
    s_lshl_b32 s77, s78, 8
    s_lshl_b32 s78, s78, 9
    s_add_u32 s78, s78, 1024
    s_bitcmp1_b32 s62, 0
    s_cselect_b32 s77, s78, s77
    s_lshl_b32 s78, s58, 3
    s_add_u32 s78, s78, s61
    s_lshl_b32 s78, s78, 11
    s_add_u32 s78, s78, s65
    s_add_u32 s78, s78, s77
    s_lshl_b32 s39, s58, 12
    s_add_u32 s39, s39, 131072
    s_lshl_b32 s79, s59, 7
    s_add_u32 s79, s79, s39
    s_add_u32 s33, s63, 1507328
    s_lshl_b32 s32, s59, 10
    s_add_u32 s32, s32, s33
    s_cmp_eq_u32 s60, 0
    s_cselect_b32 s32, s32, 536870912
    s_cselect_b32 s78, s78, 536870912
    s_lshl_b32 s34, s60, 13
    s_add_u32 s33, s33, s34
    s_add_u32 s34, s33, 4096
    s_add_u32 s35, s28, 34
    s_lshl_b32 s42, s58, 15
    s_add_u32 s43, s42, 0x8000
    s_and_b32 s43, s43, 0x3ffff
    s_lshl_b32 s41, s59, 10
    s_add_u32 s41, s41, s42
    s_add_u32 s41, s41, 1835008
    s_cmp_eq_u32 s60, 1
    s_cselect_b32 s41, s41, 536870912
    s_lshl_b32 s44, s60, 13
    s_add_u32 s44, s44, 1835008
    s_add_u32 s42, s42, s44
    s_add_u32 s43, s43, s44
    s_add_u32 s44, s43, 4096
    v_mov_b32 v84, 0
    v_mov_b32 v85, 0
    v_mov_b32 v86, 0
    v_mov_b32 v87, 0
    s_barrier
    s_branch NEAR_339
RT_340:
    s_cmp_eq_u32 s29, 0
    s_cbranch_scc1 BK_341
    s_sub_u32 s29, s29, 1
    s_cmp_lg_u32 s31, 0
    s_cbranch_scc1 SF_343
SFD_344:
    buffer_load_dwordx4 v[32:35], v2, s[12:15], s70 offen offset:0 sc1
    buffer_load_dwordx4 v[36:39], v2, s[12:15], s70 offen offset:128 sc1
    buffer_load_dwordx4 v[40:43], v2, s[12:15], s70 offen offset:256 sc1
    buffer_load_dwordx4 v[44:47], v2, s[12:15], s70 offen offset:384 sc1
    buffer_load_dwordx4 v[48:51], v2, s[12:15], s70 offen offset:512 sc1
    buffer_load_dwordx4 v[52:55], v2, s[12:15], s70 offen offset:640 sc1
    buffer_load_dwordx4 v[56:59], v2, s[12:15], s70 offen offset:768 sc1
    buffer_load_dwordx4 v[60:63], v2, s[12:15], s70 offen offset:896 sc1
    s_branch AG_342
RT_345:
    s_cmp_eq_u32 s29, 0
    s_cbranch_scc1 BK_346
    s_sub_u32 s29, s29, 1
    s_cmp_lg_u32 s31, 0
    s_cbranch_scc1 SF_348
SFD_349:
    buffer_load_dwordx4 v[40:43], v2, s[12:15], s70 offen offset:256 sc1
    buffer_load_dwordx4 v[44:47], v2, s[12:15], s70 offen offset:384 sc1
    buffer_load_dwordx4 v[48:51], v2, s[12:15], s70 offen offset:512 sc1
    buffer_load_dwordx4 v[52:55], v2, s[12:15], s70 offen offset:640 sc1
    buffer_load_dwordx4 v[56:59], v2, s[12:15], s70 offen offset:768 sc1
    buffer_load_dwordx4 v[60:63], v2, s[12:15], s70 offen offset:896 sc1
    s_branch AG_347
RT_350:
    s_cmp_eq_u32 s29, 0
    s_cbranch_scc1 BK_351
    s_sub_u32 s29, s29, 1
    s_cmp_lg_u32 s31, 0
    s_cbranch_scc1 SF_353
SFD_354:
    buffer_load_dwordx4 v[48:51], v2, s[12:15], s70 offen offset:512 sc1
    buffer_load_dwordx4 v[52:55], v2, s[12:15], s70 offen offset:640 sc1
    buffer_load_dwordx4 v[56:59], v2, s[12:15], s70 offen offset:768 sc1
    buffer_load_dwordx4 v[60:63], v2, s[12:15], s70 offen offset:896 sc1
    s_branch AG_352
RT_355:
    s_cmp_eq_u32 s29, 0
    s_cbranch_scc1 BK_356
    s_sub_u32 s29, s29, 1
    s_cmp_lg_u32 s31, 0
    s_cbranch_scc1 SF_358
SFD_359:
    buffer_load_dwordx4 v[56:59], v2, s[12:15], s70 offen offset:768 sc1
    buffer_load_dwordx4 v[60:63], v2, s[12:15], s70 offen offset:896 sc1
    s_branch AG_357
NEAR_339:
AG_342:
    s_waitcnt vmcnt(6)
    v_max_u32 v5, v32, v36
    v_cmp_eq_u32 vcc, -1, v5
    ds_write_b128 v112, v[32:35] offset:0
    ds_write_b128 v112, v[36:39] offset:128
    s_cbranch_vccnz RT_340
BK_341:
    v_dot2c_f32_bf16 v84, s68, v32
    v_dot2c_f32_bf16 v86, v32, v32
    v_dot2c_f32_bf16 v85, s68, v33
    v_dot2c_f32_bf16 v87, v33, v33
    v_dot2c_f32_bf16 v84, s68, v34
    v_dot2c_f32_bf16 v86, v34, v34
    v_dot2c_f32_bf16 v85, s68, v35
    v_dot2c_f32_bf16 v87, v35, v35
    v_dot2c_f32_bf16 v84, s68, v36
    v_dot2c_f32_bf16 v86, v36, v36
    v_dot2c_f32_bf16 v85, s68, v37
    v_dot2c_f32_bf16 v87, v37, v37
    v_dot2c_f32_bf16 v84, s68, v38
    v_dot2c_f32_bf16 v86, v38, v38
    v_dot2c_f32_bf16 v85, s68, v39
    v_dot2c_f32_bf16 v87, v39, v39
AG_347:
    s_waitcnt vmcnt(4)
    v_max_u32 v5, v40, v44
    v_cmp_eq_u32 vcc, -1, v5
    ds_write_b128 v112, v[40:43] offset:256
    ds_write_b128 v112, v[44:47] offset:384
    s_cbranch_vccnz RT_345
BK_346:
    v_dot2c_f32_bf16 v84, s68, v40
    v_dot2c_f32_bf16 v86, v40, v40
    v_dot2c_f32_bf16 v85, s68, v41
    v_dot2c_f32_bf16 v87, v41, v41
    v_dot2c_f32_bf16 v84, s68, v42
    v_dot2c_f32_bf16 v86, v42, v42
    v_dot2c_f32_bf16 v85, s68, v43
    v_dot2c_f32_bf16 v87, v43, v43
    v_dot2c_f32_bf16 v84, s68, v44
    v_dot2c_f32_bf16 v86, v44, v44
    v_dot2c_f32_bf16 v85, s68, v45
    v_dot2c_f32_bf16 v87, v45, v45
    v_dot2c_f32_bf16 v84, s68, v46
    v_dot2c_f32_bf16 v86, v46, v46
    v_dot2c_f32_bf16 v85, s68, v47
    v_dot2c_f32_bf16 v87, v47, v47
AG_352:
    s_waitcnt vmcnt(2)
    v_max_u32 v5, v48, v52
    v_cmp_eq_u32 vcc, -1, v5
    ds_write_b128 v112, v[48:51] offset:512
    ds_write_b128 v112, v[52:55] offset:640
    s_cbranch_vccnz RT_350
BK_351:
    v_dot2c_f32_bf16 v84, s68, v48
    v_dot2c_f32_bf16 v86, v48, v48
    v_dot2c_f32_bf16 v85, s68, v49
    v_dot2c_f32_bf16 v87, v49, v49
    v_dot2c_f32_bf16 v84, s68, v50
    v_dot2c_f32_bf16 v86, v50, v50
    v_dot2c_f32_bf16 v85, s68, v51
    v_dot2c_f32_bf16 v87, v51, v51
    v_dot2c_f32_bf16 v84, s68, v52
    v_dot2c_f32_bf16 v86, v52, v52
    v_dot2c_f32_bf16 v85, s68, v53
    v_dot2c_f32_bf16 v87, v53, v53
    v_dot2c_f32_bf16 v84, s68, v54
    v_dot2c_f32_bf16 v86, v54, v54
    v_dot2c_f32_bf16 v85, s68, v55
    v_dot2c_f32_bf16 v87, v55, v55
AG_357:
    s_waitcnt vmcnt(0)
    v_max_u32 v5, v56, v60
    v_cmp_eq_u32 vcc, -1, v5
    ds_write_b128 v112, v[56:59] offset:768
    ds_write_b128 v112, v[60:63] offset:896
    s_cbranch_vccnz RT_355
BK_356:
    v_dot2c_f32_bf16 v84, s68, v56
    v_dot2c_f32_bf16 v86, v56, v56
    v_dot2c_f32_bf16 v85, s68, v57
    v_dot2c_f32_bf16 v87, v57, v57
    v_dot2c_f32_bf16 v84, s68, v58
    v_dot2c_f32_bf16 v86, v58, v58
    v_dot2c_f32_bf16 v85, s68, v59
    v_dot2c_f32_bf16 v87, v59, v59
    s_waitcnt lgkmcnt(0)
    s_barrier
    ds_read_b128 v[64:67], v113 offset:0
    ds_read_b128 v[68:71], v113 offset:64
    ds_read_b128 v[72:75], v113 offset:128
    ds_read_b128 v[76:79], v113 offset:192
    v_dot2c_f32_bf16 v84, s68, v60
    v_dot2c_f32_bf16 v86, v60, v60
    v_dot2c_f32_bf16 v85, s68, v61
    v_dot2c_f32_bf16 v87, v61, v61
    v_dot2c_f32_bf16 v84, s68, v62
    v_dot2c_f32_bf16 v86, v62, v62
    v_dot2c_f32_bf16 v85, s68, v63
    v_dot2c_f32_bf16 v87, v63, v63
    s_bitcmp1_b32 s62, 0
    s_nop 0
    v_add_f32 v84, v84, v85
    v_add_f32 v86, v86, v87
    s_nop 0
    v_add_f32_dpp v84, v84, v84 quad_perm:[1,0,3,2] row_mask:0xf bank_mask:0xf
    v_add_f32_dpp v86, v86, v86 quad_perm:[1,0,3,2] row_mask:0xf bank_mask:0xf
    s_nop 0
    v_add_f32_dpp v84, v84, v84 quad_perm:[2,3,0,1] row_mask:0xf bank_mask:0xf
    v_add_f32_dpp v86, v86, v86 quad_perm:[2,3,0,1] row_mask:0xf bank_mask:0xf
    s_nop 0
    v_add_f32_dpp v84, v84, v84 row_half_mirror row_mask:0xf bank_mask:0xf
    v_add_f32_dpp v86, v86, v86 row_half_mirror row_mask:0xf bank_mask:0xf
    s_cbranch_scc1 KVV_360
    s_waitcnt lgkmcnt(3)
    v_mfma_f32_16x16x32_bf16 v[80:83], a[224:227], v[64:67], 0
    s_waitcnt lgkmcnt(2)
    v_mfma_f32_16x16x32_bf16 v[80:83], a[228:231], v[68:71], v[80:83]
    s_waitcnt lgkmcnt(1)
    v_mfma_f32_16x16x32_bf16 v[80:83], a[232:235], v[72:75], v[80:83]
    s_waitcnt lgkmcnt(0)
    v_mfma_f32_16x16x32_bf16 v[80:83], a[236:239], v[76:79], v[80:83]
KVD_361:
    v_mul_f32 v84, 989855744, v84
    v_mul_f32 v86, 989855744, v86
    v_fma_f32 v86, -v84, v84, v86
    v_max_f32 v86, 0, v86
    v_add_f32 v86, 925353388, v86
    v_rsq_f32 v86, v86
    s_nop 0
    ds_write2_b32 v114, v84, v86 offset1:32
    ds_write_b128 v115, v[80:83]
    ds_read_b128 v[48:51], v7 offset:0
    ds_read_b128 v[52:55], v7 offset:32
    s_waitcnt lgkmcnt(2)
    s_barrier
    ds_read_b128 v[96:99], v120 offset:0
    ds_read_b128 v[100:103], v120 offset:1024
    ds_read_b128 v[104:107], v120 offset:2048
    ds_read_b128 v[108:111], v120 offset:3072
    ds_read2_b32 v[88:89], v116 offset1:32
    ds_read2_b32 v[90:91], v117 offset1:32
    ds_read2_b32 v[92:93], v118 offset1:32
    ds_read2_b32 v[94:95], v119 offset1:32
    v_mov_b32 v82, s35
    v_mov_b32 v83, s35
    ds_read_b128 v[56:59], v7 offset:64
    ds_read_b128 v[60:63], v7 offset:96
    ds_read_b128 v[64:67], v7 offset:128
    ds_read_b128 v[68:71], v7 offset:160
    s_waitcnt lgkmcnt(13)
    v_mfma_f32_32x32x16_bf16 v[32:47], v[128:131], v[48:51], 0
    ds_read_b128 v[72:75], v7 offset:192
    s_waitcnt lgkmcnt(11)
    v_add_f32 v96, v96, v100
    v_add_f32 v97, v97, v101
    v_add_f32 v98, v98, v102
    v_add_f32 v99, v99, v103
    s_waitcnt lgkmcnt(9)
    v_add_f32 v104, v104, v108
    s_waitcnt lgkmcnt(13)
    v_mfma_f32_32x32x16_bf16 v[32:47], v[132:135], v[52:55], v[32:47]
    ds_read_b128 v[76:79], v7 offset:224
    v_add_f32 v105, v105, v109
    v_add_f32 v106, v106, v110
    v_add_f32 v107, v107, v111
    v_add_f32 v96, v96, v104
    v_add_f32 v97, v97, v105
    s_waitcnt lgkmcnt(5)
    v_mfma_f32_32x32x16_bf16 v[32:47], v[136:139], v[56:59], v[32:47]
    ds_read_b128 v[48:51], v7 offset:256
    v_add_f32 v98, v98, v106
    v_add_f32 v99, v99, v107
    s_waitcnt lgkmcnt(7)
    v_fma_f32 v96, -v88, v8, v96
    v_fma_f32 v97, -v90, v9, v97
    v_fma_f32 v98, -v92, v10, v98
    s_waitcnt lgkmcnt(5)
    v_mfma_f32_32x32x16_bf16 v[32:47], v[140:143], v[60:63], v[32:47]
    ds_read_b128 v[52:55], v7 offset:288
    v_fma_f32 v99, -v94, v11, v99
    v_mul_f32 v96, v96, v89
    v_mul_f32 v97, v97, v91
    v_mul_f32 v98, v98, v93
    v_mul_f32 v99, v99, v95
    s_waitcnt lgkmcnt(5)
    v_mfma_f32_32x32x16_bf16 v[32:47], v[144:147], v[64:67], v[32:47]
    ds_read_b128 v[56:59], v7 offset:320
    v_cvt_pk_bf16_f32 v80, v96, v97
    v_cvt_pk_bf16_f32 v81, v98, v99
    buffer_store_dwordx4 v[80:83], v1, s[4:7], s32 offen
    buffer_store_dwordx4 v[80:83], v1, s[4:7], s41 offen sc1
    buffer_store_dwordx2 v[80:81], v121, s[4:7], s78 offen sc1
    s_waitcnt lgkmcnt(5)
    v_mfma_f32_32x32x16_bf16 v[32:47], v[148:151], v[68:71], v[32:47]
    ds_read_b128 v[60:63], v7 offset:352
    v_mov_b32 v2, 0xdddddddd
    v_lshrrev_b32 v112, 9, v1
    v_and_b32 v4, 0xf0, v1
    v_lshl_add_u32 v4, v112, 8, v4
    s_waitcnt lgkmcnt(5)
    v_mfma_f32_32x32x16_bf16 v[32:47], v[152:155], v[72:75], v[32:47]
    ds_read_b128 v[64:67], v7 offset:384
    v_add_u32 v4, 118784, v4
    v_add_u32 v5, 512, v4
    v_mov_b32 v113, 119808
    v_and_b32 v112, 0xb0, v1
    s_waitcnt lgkmcnt(5)
    v_mfma_f32_32x32x16_bf16 v[32:47], v[156:159], v[76:79], v[32:47]
    ds_read_b128 v[68:71], v7 offset:416
    v_cmp_ne_u32 vcc, 0, v112
    v_mov_b32 v112, 119824
    s_nop 0
    v_cndmask_b32 v113, v113, v112, vcc
    v_and_b32 v112, 0x100, v1
    s_waitcnt lgkmcnt(5)
    v_mfma_f32_32x32x16_bf16 v[32:47], v[160:163], v[48:51], v[32:47]
    ds_read_b128 v[72:75], v7 offset:448
    v_cmp_ne_u32 vcc, 0, v112
    s_nop 0
    s_nop 0
    v_cndmask_b32 v4, v4, v113, vcc
    v_cndmask_b32 v5, v5, v113, vcc
    s_waitcnt lgkmcnt(5)
    v_mfma_f32_32x32x16_bf16 v[32:47], v[164:167], v[52:55], v[32:47]
    ds_read_b128 v[76:79], v7 offset:480
    v_bfe_u32 v120, v1, 4, 3
    v_mul_u32_u24 v120, 2080, v120
    v_lshrrev_b32 v112, 4, v112
    v_bfe_u32 v113, v1, 7, 1
    s_waitcnt lgkmcnt(5)
    v_mfma_f32_32x32x16_bf16 v[32:47], v[168:171], v[56:59], v[32:47]
    ds_read_b128 v[48:51], v7 offset:512
    v_mul_u32_u24 v113, 29440, v113
    v_add_u32 v120, v113, v120
    v_add_u32 v120, 119808, v120
    v_add_u32 v120, v112, v120
    s_waitcnt lgkmcnt(5)
    v_mfma_f32_32x32x16_bf16 v[32:47], v[172:175], v[60:63], v[32:47]
    ds_read_b128 v[52:55], v7 offset:544
    v_mov_b32 v112, s68
    v_cndmask_b32 v24, v112, 0, vcc
    v_cndmask_b32 v25, v112, 0, vcc
    v_cndmask_b32 v26, v112, 0, vcc
    s_waitcnt lgkmcnt(5)
    v_mfma_f32_32x32x16_bf16 v[32:47], v[176:179], v[64:67], v[32:47]
    ds_read_b128 v[56:59], v7 offset:576
    v_cndmask_b32 v27, v112, 0, vcc
    s_waitcnt lgkmcnt(5)
    v_mfma_f32_32x32x16_bf16 v[32:47], v[180:183], v[68:71], v[32:47]
    ds_read_b128 v[60:63], v7 offset:608
    s_waitcnt lgkmcnt(5)
    v_mfma_f32_32x32x16_bf16 v[32:47], v[184:187], v[72:75], v[32:47]
    ds_read_b128 v[64:67], v7 offset:640
    s_waitcnt lgkmcnt(5)
    v_mfma_f32_32x32x16_bf16 v[32:47], v[188:191], v[76:79], v[32:47]
    ds_read_b128 v[68:71], v7 offset:672
    buffer_load_dwordx4 v[80:83], v1, s[4:7], s33 offen offset:0 sc1
    s_waitcnt lgkmcnt(5)
    v_mfma_f32_32x32x16_bf16 v[32:47], v[192:195], v[48:51], v[32:47]
    ds_read_b128 v[72:75], v7 offset:704
    buffer_load_dwordx4 v[84:87], v1, s[4:7], s33 offen offset:1024 sc1
    s_waitcnt lgkmcnt(5)
    v_mfma_f32_32x32x16_bf16 v[32:47], v[196:199], v[52:55], v[32:47]
    ds_read_b128 v[76:79], v7 offset:736
    buffer_load_dwordx4 v[88:91], v1, s[4:7], s33 offen offset:2048 sc1
    s_waitcnt lgkmcnt(5)
    v_mfma_f32_32x32x16_bf16 v[32:47], v[200:203], v[56:59], v[32:47]
    ds_read_b128 v[48:51], v7 offset:768
    buffer_load_dwordx4 v[92:95], v1, s[4:7], s33 offen offset:3072 sc1
    s_waitcnt lgkmcnt(5)
    v_mfma_f32_32x32x16_bf16 v[32:47], v[204:207], v[60:63], v[32:47]
    ds_read_b128 v[52:55], v7 offset:800
    buffer_load_dwordx4 v[96:99], v1, s[4:7], s34 offen offset:0 sc1
    s_waitcnt lgkmcnt(5)
    v_mfma_f32_32x32x16_bf16 v[32:47], v[208:211], v[64:67], v[32:47]
    ds_read_b128 v[56:59], v7 offset:832
    buffer_load_dwordx4 v[100:103], v1, s[4:7], s34 offen offset:1024 sc1
    s_waitcnt lgkmcnt(5)
    v_mfma_f32_32x32x16_bf16 v[32:47], v[212:215], v[68:71], v[32:47]
    ds_read_b128 v[60:63], v7 offset:864
    buffer_load_dwordx4 v[104:107], v1, s[4:7], s34 offen offset:2048 sc1
    s_waitcnt lgkmcnt(5)
    v_mfma_f32_32x32x16_bf16 v[32:47], v[216:219], v[72:75], v[32:47]
    ds_read_b128 v[64:67], v7 offset:896
    buffer_load_dwordx4 v[108:111], v1, s[4:7], s34 offen offset:3072 sc1
    s_waitcnt lgkmcnt(5)
    v_mfma_f32_32x32x16_bf16 v[32:47], v[220:223], v[76:79], v[32:47]
    ds_read_b128 v[68:71], v7 offset:928
    s_waitcnt lgkmcnt(5)
    v_mfma_f32_32x32x16_bf16 v[32:47], v[224:227], v[48:51], v[32:47]
    ds_read_b128 v[72:75], v7 offset:960
    s_waitcnt lgkmcnt(5)
    v_mfma_f32_32x32x16_bf16 v[32:47], v[228:231], v[52:55], v[32:47]
    ds_read_b128 v[76:79], v7 offset:992
    s_waitcnt lgkmcnt(5)
    v_mfma_f32_32x32x16_bf16 v[32:47], v[232:235], v[56:59], v[32:47]
    ds_read_b128 v[12:15], v122
    ds_read_b128 v[16:19], v122 offset:32
    ds_read2_b32 v[28:29], v123 offset1:32
    s_waitcnt lgkmcnt(7)
    v_mfma_f32_32x32x16_bf16 v[32:47], v[236:239], v[60:63], v[32:47]
    s_branch NEAR_364
TAGRT_362:
    s_cmp_eq_u32 s29, 0
    s_cbranch_scc1 TAGBK_363
    s_sub_u32 s29, s29, 1
    s_and_b32 s37, s29, 3
    s_cselect_b32 s36, s33, s42
    s_add_u32 s37, s36, 4096
    buffer_load_dwordx4 v[80:83], v1, s[4:7], s36 offen offset:0 sc1
    buffer_load_dwordx4 v[84:87], v1, s[4:7], s36 offen offset:1024 sc1
    buffer_load_dwordx4 v[88:91], v1, s[4:7], s36 offen offset:2048 sc1
    buffer_load_dwordx4 v[92:95], v1, s[4:7], s36 offen offset:3072 sc1
    buffer_load_dwordx4 v[96:99], v1, s[4:7], s37 offen offset:0 sc1
    buffer_load_dwordx4 v[100:103], v1, s[4:7], s37 offen offset:1024 sc1
    buffer_load_dwordx4 v[104:107], v1, s[4:7], s37 offen offset:2048 sc1
    buffer_load_dwordx4 v[108:111], v1, s[4:7], s37 offen offset:3072 sc1
    s_waitcnt vmcnt(0)
    v_sad_u32 v83, v82, s35, 0
    v_sad_u32 v83, v86, s35, v83 clamp
    v_sad_u32 v83, v90, s35, v83 clamp
    v_sad_u32 v83, v94, s35, v83 clamp
    v_sad_u32 v83, v98, s35, v83 clamp
    v_sad_u32 v83, v102, s35, v83 clamp
    v_sad_u32 v83, v106, s35, v83 clamp
    v_sad_u32 v83, v110, s35, v83 clamp
    v_cmp_ne_u32 vcc, 0, v83
    s_cbranch_vccnz TAGRT_362
    s_branch TAGBK_363
RT_367:
    s_cmp_eq_u32 s29, 0
    s_cbranch_scc1 BK_368
    s_sub_u32 s29, s29, 1
    s_cmp_lg_u32 s31, 0
    s_cbranch_scc1 SF_369
SFD_370:
    s_mov_b64 exec, vcc
    buffer_load_dword v160, v123, s[4:7], s66 offen sc1
    s_waitcnt vmcnt(0)
    v_sad_u32 v160, v160, s30, 0
    v_cmp_lt_u32 vcc, 15, v160
    s_mov_b64 exec, -1
    s_cbranch_vccnz RT_367
    s_branch BK_368
RT_371:
    s_cmp_eq_u32 s29, 0
    s_cbranch_scc1 BK_372
    s_sub_u32 s29, s29, 1
    s_cmp_lg_u32 s31, 0
    s_cbranch_scc1 SF_373
SFD_374:
    buffer_load_dwordx4 v[128:131], v1, s[4:7], s43 offen offset:0 sc1
    buffer_load_dwordx4 v[132:135], v1, s[4:7], s43 offen offset:1024 sc1
    buffer_load_dwordx4 v[136:139], v1, s[4:7], s43 offen offset:2048 sc1
    buffer_load_dwordx4 v[140:143], v1, s[4:7], s43 offen offset:3072 sc1
    buffer_load_dwordx4 v[144:147], v1, s[4:7], s44 offen offset:0 sc1
    buffer_load_dwordx4 v[148:151], v1, s[4:7], s44 offen offset:1024 sc1
    buffer_load_dwordx4 v[152:155], v1, s[4:7], s44 offen offset:2048 sc1
    buffer_load_dwordx4 v[156:159], v1, s[4:7], s44 offen offset:3072 sc1
    s_waitcnt vmcnt(0)
    v_sad_u32 v131, v130, s35, 0
    v_sad_u32 v131, v134, s35, v131 clamp
    v_sad_u32 v131, v138, s35, v131 clamp
    v_sad_u32 v131, v142, s35, v131 clamp
    v_sad_u32 v131, v146, s35, v131 clamp
    v_sad_u32 v131, v150, s35, v131 clamp
    v_sad_u32 v131, v154, s35, v131 clamp
    v_sad_u32 v131, v158, s35, v131 clamp
    v_cmp_ne_u32 vcc, 0, v131
    s_cbranch_vccnz RT_371
    s_branch BK_372
NEAR_364:
    s_waitcnt lgkmcnt(6)
    v_mfma_f32_32x32x16_bf16 v[32:47], v[240:243], v[64:67], v[32:47]
    ds_read_b128 v[48:51], v125 offset:0
    ds_read_b128 v[52:55], v125 offset:32
    ds_read_b128 v[56:59], v125 offset:64
    ds_read_b128 v[60:63], v125 offset:96
    s_waitcnt vmcnt(0)
    v_sad_u32 v83, v82, s35, 0
    v_sad_u32 v83, v86, s35, v83 clamp
    v_sad_u32 v83, v90, s35, v83 clamp
    v_sad_u32 v83, v94, s35, v83 clamp
    v_sad_u32 v83, v98, s35, v83 clamp
    s_waitcnt lgkmcnt(9)
    v_mfma_f32_32x32x16_bf16 v[32:47], v[244:247], v[68:71], v[32:47]
    v_sad_u32 v83, v102, s35, v83 clamp
    v_sad_u32 v83, v106, s35, v83 clamp
    v_sad_u32 v83, v110, s35, v83 clamp
    v_cmp_ne_u32 vcc, 0, v83
    s_waitcnt lgkmcnt(8)
    v_mfma_f32_32x32x16_bf16 v[32:47], v[248:251], v[72:75], v[32:47]
    s_cbranch_vccnz TAGRT_362
TAGBK_363:
    ds_write_b64 v126, v[96:97] offset:37760
    ds_write_b64 v127, v[100:101] offset:38784
    ds_write_b64 v126, v[104:105] offset:38016
    ds_write_b64 v127, v[108:109] offset:39296
    s_waitcnt lgkmcnt(11)
    v_mfma_f32_32x32x16_bf16 v[32:47], v[252:255], v[76:79], v[32:47]
    v_mov_b32 v121, s30
    s_waitcnt lgkmcnt(0)
    s_barrier
    ds_read_b128 v[96:99], v3 offset:37760
    ds_read_b128 v[104:107], v4 offset:37760
    ds_read_b128 v[112:115], v5 offset:37760
    ds_write_b64 v126, v[80:81] offset:29440
    ds_write_b64 v127, v[84:85] offset:30464
    ds_write_b64 v126, v[88:89] offset:29696
    ds_write_b64 v127, v[92:93] offset:30976
    ds_write_b128 v120, v[24:27]
    s_mov_b64 exec, s[94:95]
    buffer_store_dword v121, off, s[4:7], s79 sc1
    s_mov_b64 exec, -1
    v_mul_f32 v29, 1052289595, v29
    v_pk_fma_f32 v[32:33], v[48:49], v[28:29], v[32:33] op_sel_hi:[1,0,1] neg_lo:[0,1,0] neg_hi:[0,1,0]
    v_pk_fma_f32 v[34:35], v[50:51], v[28:29], v[34:35] op_sel_hi:[1,0,1] neg_lo:[0,1,0] neg_hi:[0,1,0]
    v_pk_fma_f32 v[36:37], v[52:53], v[28:29], v[36:37] op_sel_hi:[1,0,1] neg_lo:[0,1,0] neg_hi:[0,1,0]
    v_pk_fma_f32 v[38:39], v[54:55], v[28:29], v[38:39] op_sel_hi:[1,0,1] neg_lo:[0,1,0] neg_hi:[0,1,0]
    v_pk_fma_f32 v[40:41], v[56:57], v[28:29], v[40:41] op_sel_hi:[1,0,1] neg_lo:[0,1,0] neg_hi:[0,1,0]
    v_pk_fma_f32 v[42:43], v[58:59], v[28:29], v[42:43] op_sel_hi:[1,0,1] neg_lo:[0,1,0] neg_hi:[0,1,0]
    v_pk_fma_f32 v[44:45], v[60:61], v[28:29], v[44:45] op_sel_hi:[1,0,1] neg_lo:[0,1,0] neg_hi:[0,1,0]
    v_pk_fma_f32 v[46:47], v[62:63], v[28:29], v[46:47] op_sel_hi:[1,0,1] neg_lo:[0,1,0] neg_hi:[0,1,0]
    v_pk_mul_f32 v[32:33], v[32:33], v[28:29] op_sel:[0,1]
    v_pk_mul_f32 v[34:35], v[34:35], v[28:29] op_sel:[0,1]
    v_pk_mul_f32 v[36:37], v[36:37], v[28:29] op_sel:[0,1]
    v_pk_mul_f32 v[38:39], v[38:39], v[28:29] op_sel:[0,1]
    v_pk_mul_f32 v[40:41], v[40:41], v[28:29] op_sel:[0,1]
    v_pk_mul_f32 v[42:43], v[42:43], v[28:29] op_sel:[0,1]
    v_pk_mul_f32 v[44:45], v[44:45], v[28:29] op_sel:[0,1]
    v_pk_mul_f32 v[46:47], v[46:47], v[28:29] op_sel:[0,1]
    v_cvt_pk_bf16_f32 v20, v32, v33
    v_cvt_pk_bf16_f32 v21, v34, v35
    v_cvt_pk_bf16_f32 v22, v36, v37
    v_cvt_pk_bf16_f32 v23, v38, v39
    s_waitcnt lgkmcnt(0)
    v_cvt_pk_bf16_f32 v24, v40, v41
    v_cvt_pk_bf16_f32 v25, v42, v43
    v_cvt_pk_bf16_f32 v26, v44, v45
    v_cvt_pk_bf16_f32 v27, v46, v47
    v_mov_b32 v64, 0
    v_mov_b32 v65, 0
    v_mov_b32 v66, 0
    v_mov_b32 v67, 0
    v_mov_b32 v68, 0
    v_mov_b32 v69, 0
    v_mov_b32 v70, 0
    v_mov_b32 v71, 0
    v_mov_b32 v72, 0
    v_mov_b32 v73, 0
    v_mov_b32 v74, 0
    v_mov_b32 v75, 0
    v_mov_b32 v76, 0
    v_mov_b32 v77, 0
    v_mov_b32 v78, 0
    v_mov_b32 v79, 0
    s_waitcnt lgkmcnt(7)
    v_mfma_f32_32x32x16_bf16 v[32:47], v[96:99], v[20:23], 0
    v_mov_b32 v80, 0
    v_mov_b32 v81, 0
    v_mov_b32 v82, 0
    v_mov_b32 v83, 0
    v_mov_b32 v84, 0
    v_mov_b32 v85, 0
    v_mov_b32 v86, 0
    v_mov_b32 v87, 0
    v_mov_b32 v88, 0
    v_mov_b32 v89, 0
    v_mov_b32 v90, 0
    v_mov_b32 v91, 0
    v_mov_b32 v92, 0
    v_mov_b32 v93, 0
    v_mov_b32 v94, 0
    v_mov_b32 v95, 0
    s_lshl2_add_u32 s83, s62, s60
    s_lshl2_add_u32 s83, s83, s62
    s_lshl_b32 s83, s83, 13
    s_add_u32 s83, s83, 524288
    s_lshl2_add_u32 s70, s59, s60
    s_mul_i32 s88, s70, 11520
    s_add_u32 s88, s88, s63
    s_waitcnt lgkmcnt(0)
    v_exp_f32 v32, v32
    v_exp_f32 v33, v33
    ds_read_b128 v[100:103], v3 offset:39840
    v_exp_f32 v34, v34
    v_exp_f32 v35, v35
    v_exp_f32 v36, v36
    v_mfma_f32_32x32x16_bf16 v[48:63], v[96:99], v[24:27], 0
    ds_read_b128 v[108:111], v4 offset:39840
    v_exp_f32 v37, v37
    v_exp_f32 v38, v38
    v_exp_f32 v39, v39
    v_exp_f32 v40, v40
    v_exp_f32 v41, v41
    v_exp_f32 v42, v42
    v_smfmac_f32_32x32x32_bf16 v[64:79], v[104:107], v[32:39], v2
    ds_read_b128 v[116:119], v5 offset:39840
    v_exp_f32 v43, v43
    v_exp_f32 v44, v44
    v_exp_f32 v45, v45
    v_exp_f32 v46, v46
    v_exp_f32 v47, v47
    v_exp_f32 v48, v48
    v_exp_f32 v49, v49
    v_smfmac_f32_32x32x32_bf16 v[64:79], v[112:115], v[40:47], v2
    s_waitcnt lgkmcnt(2)
    v_exp_f32 v50, v50
    v_exp_f32 v51, v51
    v_exp_f32 v52, v52
    v_mfma_f32_32x32x16_bf16 v[32:47], v[100:103], v[20:23], 0
    v_exp_f32 v53, v53
    v_exp_f32 v54, v54
    v_exp_f32 v55, v55
    v_exp_f32 v56, v56
    v_exp_f32 v57, v57
    v_exp_f32 v58, v58
    v_smfmac_f32_32x32x32_bf16 v[80:95], v[104:107], v[48:55], v2
    s_waitcnt lgkmcnt(0)
    v_exp_f32 v59, v59
    v_exp_f32 v60, v60
    v_exp_f32 v61, v61
    v_exp_f32 v62, v62
    v_exp_f32 v63, v63
    v_exp_f32 v32, v32
    v_exp_f32 v33, v33
    v_smfmac_f32_32x32x32_bf16 v[80:95], v[112:115], v[56:63], v2
    ds_read_b128 v[96:99], v3 offset:41920
    v_exp_f32 v34, v34
    v_exp_f32 v35, v35
    v_exp_f32 v36, v36
    v_mfma_f32_32x32x16_bf16 v[48:63], v[100:103], v[24:27], 0
    ds_read_b128 v[104:107], v4 offset:41920
    v_exp_f32 v37, v37
    v_exp_f32 v38, v38
    v_exp_f32 v39, v39
    v_exp_f32 v40, v40
    v_exp_f32 v41, v41
    v_exp_f32 v42, v42
    v_smfmac_f32_32x32x32_bf16 v[64:79], v[108:111], v[32:39], v2
    ds_read_b128 v[112:115], v5 offset:41920
    v_exp_f32 v43, v43
    v_exp_f32 v44, v44
    v_exp_f32 v45, v45
    v_exp_f32 v46, v46
    v_exp_f32 v47, v47
    v_exp_f32 v48, v48
    v_exp_f32 v49, v49
    v_smfmac_f32_32x32x32_bf16 v[64:79], v[116:119], v[40:47], v2
    s_waitcnt lgkmcnt(2)
    v_exp_f32 v50, v50
TCH8:
    s_cbranch_execz TCH12
    v_exp_f32 v51, v51
    v_exp_f32 v52, v52
    v_mfma_f32_32x32x16_bf16 v[32:47], v[96:99], v[20:23], 0
    buffer_load_dwordx4 v[128:131], v1, s[4:7], s43 offen offset:0 sc1
    v_exp_f32 v53, v53
    v_exp_f32 v54, v54
    v_exp_f32 v55, v55
    v_exp_f32 v56, v56
    v_exp_f32 v57, v57
    v_exp_f32 v58, v58
    v_smfmac_f32_32x32x32_bf16 v[80:95], v[108:111], v[48:55], v2
    buffer_load_dwordx4 v[132:135], v1, s[4:7], s43 offen offset:1024 sc1
    s_waitcnt lgkmcnt(0)
    v_exp_f32 v59, v59
    v_exp_f32 v60, v60
    v_exp_f32 v61, v61
    v_exp_f32 v62, v62
    v_exp_f32 v63, v63
    v_exp_f32 v32, v32
    v_exp_f32 v33, v33
    v_smfmac_f32_32x32x32_bf16 v[80:95], v[116:119], v[56:63], v2
    ds_read_b128 v[100:103], v3 offset:44000
    v_exp_f32 v34, v34
    v_exp_f32 v35, v35
    v_exp_f32 v36, v36
    v_mfma_f32_32x32x16_bf16 v[48:63], v[96:99], v[24:27], 0
    buffer_load_dwordx4 v[136:139], v1, s[4:7], s43 offen offset:2048 sc1
    ds_read_b128 v[108:111], v4 offset:44000
    v_exp_f32 v37, v37
    v_exp_f32 v38, v38
    v_exp_f32 v39, v39
    v_exp_f32 v40, v40
    v_exp_f32 v41, v41
    v_exp_f32 v42, v42
    v_smfmac_f32_32x32x32_bf16 v[64:79], v[104:107], v[32:39], v2
    buffer_load_dwordx4 v[140:143], v1, s[4:7], s43 offen offset:3072 sc1
    ds_read_b128 v[116:119], v5 offset:44000
    v_exp_f32 v43, v43
    v_exp_f32 v44, v44
    v_exp_f32 v45, v45
    v_exp_f32 v46, v46
    v_exp_f32 v47, v47
    v_exp_f32 v48, v48
    v_exp_f32 v49, v49
    v_smfmac_f32_32x32x32_bf16 v[64:79], v[112:115], v[40:47], v2
    s_waitcnt lgkmcnt(2)
    v_exp_f32 v50, v50
    v_exp_f32 v51, v51
    v_exp_f32 v52, v52
    v_mfma_f32_32x32x16_bf16 v[32:47], v[100:103], v[20:23], 0
    buffer_load_dwordx4 v[144:147], v1, s[4:7], s44 offen offset:0 sc1
    v_exp_f32 v53, v53
    v_exp_f32 v54, v54
    v_exp_f32 v55, v55
    v_exp_f32 v56, v56
    v_exp_f32 v57, v57
    v_exp_f32 v58, v58
    v_smfmac_f32_32x32x32_bf16 v[80:95], v[104:107], v[48:55], v2
    buffer_load_dwordx4 v[148:151], v1, s[4:7], s44 offen offset:1024 sc1
    s_waitcnt lgkmcnt(0)
    s_barrier
    v_exp_f32 v59, v59
    v_exp_f32 v60, v60
    v_exp_f32 v61, v61
    v_exp_f32 v62, v62
    v_exp_f32 v63, v63
    v_exp_f32 v32, v32
    v_exp_f32 v33, v33
    v_smfmac_f32_32x32x32_bf16 v[80:95], v[112:115], v[56:63], v2
    ds_read_b128 v[96:99], v3 offset:29440
    v_exp_f32 v34, v34
    v_exp_f32 v35, v35
    v_exp_f32 v36, v36
    v_mfma_f32_32x32x16_bf16 v[48:63], v[100:103], v[24:27], 0
    buffer_load_dwordx4 v[152:155], v1, s[4:7], s44 offen offset:2048 sc1
    ds_read_b128 v[104:107], v4 offset:29440
    v_exp_f32 v37, v37
    v_exp_f32 v38, v38
    v_exp_f32 v39, v39
    v_exp_f32 v40, v40
    v_exp_f32 v41, v41
    v_exp_f32 v42, v42
    v_smfmac_f32_32x32x32_bf16 v[64:79], v[108:111], v[32:39], v2
    buffer_load_dwordx4 v[156:159], v1, s[4:7], s44 offen offset:3072 sc1
    ds_read_b128 v[112:115], v5 offset:29440
    v_exp_f32 v43, v43
    v_exp_f32 v44, v44
    v_exp_f32 v45, v45
    v_exp_f32 v46, v46
    v_exp_f32 v47, v47
    v_exp_f32 v48, v48
    v_exp_f32 v49, v49
    v_smfmac_f32_32x32x32_bf16 v[64:79], v[116:119], v[40:47], v2
    s_waitcnt lgkmcnt(2)
    v_exp_f32 v50, v50
    v_exp_f32 v51, v51
    v_exp_f32 v52, v52
    v_mfma_f32_32x32x16_bf16 v[32:47], v[96:99], v[20:23], 0
    v_exp_f32 v53, v53
    v_exp_f32 v54, v54
    v_exp_f32 v55, v55
    v_exp_f32 v56, v56
    v_exp_f32 v57, v57
    v_exp_f32 v58, v58
    v_smfmac_f32_32x32x32_bf16 v[80:95], v[108:111], v[48:55], v2
    s_waitcnt lgkmcnt(0)
    v_exp_f32 v59, v59
    v_exp_f32 v60, v60
    v_exp_f32 v61, v61
    v_exp_f32 v62, v62
    v_exp_f32 v63, v63
    v_exp_f32 v32, v32
    v_exp_f32 v33, v33
    v_smfmac_f32_32x32x32_bf16 v[80:95], v[116:119], v[56:63], v2
    ds_read_b128 v[100:103], v3 offset:31520
    v_exp_f32 v34, v34
    v_exp_f32 v35, v35
    v_exp_f32 v36, v36
    v_mfma_f32_32x32x16_bf16 v[48:63], v[96:99], v[24:27], 0
    ds_read_b128 v[108:111], v4 offset:31520
    v_exp_f32 v37, v37
    v_exp_f32 v38, v38
    v_exp_f32 v39, v39
    v_exp_f32 v40, v40
    v_exp_f32 v41, v41
    v_exp_f32 v42, v42
    v_smfmac_f32_32x32x32_bf16 v[64:79], v[104:107], v[32:39], v2
    ds_read_b128 v[116:119], v5 offset:31520
    v_exp_f32 v43, v43
    v_exp_f32 v44, v44
    v_exp_f32 v45, v45
    v_exp_f32 v46, v46
    v_exp_f32 v47, v47
    v_exp_f32 v48, v48
    v_exp_f32 v49, v49
    v_smfmac_f32_32x32x32_bf16 v[64:79], v[112:115], v[40:47], v2
    s_waitcnt lgkmcnt(2)
    v_exp_f32 v50, v50
    v_exp_f32 v51, v51
    v_exp_f32 v52, v52
    v_mfma_f32_32x32x16_bf16 v[32:47], v[100:103], v[20:23], 0
    v_exp_f32 v53, v53
    v_exp_f32 v54, v54
    v_exp_f32 v55, v55
    v_exp_f32 v56, v56
    v_exp_f32 v57, v57
    v_exp_f32 v58, v58
    v_smfmac_f32_32x32x32_bf16 v[80:95], v[104:107], v[48:55], v2
    s_waitcnt lgkmcnt(0)
    v_exp_f32 v59, v59
    v_exp_f32 v60, v60
    v_exp_f32 v61, v61
    v_exp_f32 v62, v62
    v_exp_f32 v63, v63
    v_exp_f32 v32, v32
    v_exp_f32 v33, v33
    v_smfmac_f32_32x32x32_bf16 v[80:95], v[112:115], v[56:63], v2
    ds_read_b128 v[96:99], v3 offset:33600
    v_exp_f32 v34, v34
    v_exp_f32 v35, v35
    v_exp_f32 v36, v36
    v_mfma_f32_32x32x16_bf16 v[48:63], v[100:103], v[24:27], 0
    ds_read_b128 v[104:107], v4 offset:33600
    v_exp_f32 v37, v37
    v_exp_f32 v38, v38
    v_exp_f32 v39, v39
    v_exp_f32 v40, v40
    v_exp_f32 v41, v41
    v_exp_f32 v42, v42
    v_smfmac_f32_32x32x32_bf16 v[64:79], v[108:111], v[32:39], v2
    ds_read_b128 v[112:115], v5 offset:33600
    v_exp_f32 v43, v43
    v_exp_f32 v44, v44
    v_exp_f32 v45, v45
    v_exp_f32 v46, v46
    v_exp_f32 v47, v47
    v_exp_f32 v48, v48
    v_exp_f32 v49, v49
    v_smfmac_f32_32x32x32_bf16 v[64:79], v[116:119], v[40:47], v2
    s_waitcnt lgkmcnt(2)
    v_exp_f32 v50, v50
    v_exp_f32 v51, v51
    v_exp_f32 v52, v52
    v_mfma_f32_32x32x16_bf16 v[32:47], v[96:99], v[20:23], 0
    s_waitcnt vmcnt(0)
    v_sad_u32 v131, v130, s35, 0
    v_sad_u32 v131, v134, s35, v131 clamp
    v_sad_u32 v131, v138, s35, v131 clamp
    v_sad_u32 v131, v142, s35, v131 clamp
    v_exp_f32 v53, v53
    v_exp_f32 v54, v54
    v_exp_f32 v55, v55
    v_exp_f32 v56, v56
    v_exp_f32 v57, v57
    v_exp_f32 v58, v58
    v_smfmac_f32_32x32x32_bf16 v[80:95], v[108:111], v[48:55], v2
    s_waitcnt lgkmcnt(0)
    v_sad_u32 v131, v146, s35, v131 clamp
    v_sad_u32 v131, v150, s35, v131 clamp
    v_sad_u32 v131, v154, s35, v131 clamp
    v_sad_u32 v131, v158, s35, v131 clamp
    v_cmp_ne_u32 vcc, 0, v131
    v_exp_f32 v59, v59
    v_exp_f32 v60, v60
    v_exp_f32 v61, v61
    v_exp_f32 v62, v62
    v_exp_f32 v63, v63
    v_exp_f32 v32, v32
    v_exp_f32 v33, v33
    v_smfmac_f32_32x32x32_bf16 v[80:95], v[116:119], v[56:63], v2
    ds_read_b128 v[100:103], v3 offset:35680
    s_cbranch_vccnz RT_371
BK_372:
    ds_write_b64 v126, v[128:129] offset:0
    ds_write_b64 v127, v[132:133] offset:1024
    v_exp_f32 v34, v34
    v_exp_f32 v35, v35
    v_exp_f32 v36, v36
    v_mfma_f32_32x32x16_bf16 v[48:63], v[96:99], v[24:27], 0
    ds_read_b128 v[108:111], v4 offset:35680
    ds_write_b64 v126, v[136:137] offset:256
    ds_write_b64 v127, v[140:141] offset:1536
    v_exp_f32 v37, v37
    v_exp_f32 v38, v38
    v_exp_f32 v39, v39
    v_exp_f32 v40, v40
    v_exp_f32 v41, v41
    v_exp_f32 v42, v42
    v_smfmac_f32_32x32x32_bf16 v[64:79], v[104:107], v[32:39], v2
    ds_read_b128 v[116:119], v5 offset:35680
    ds_write_b64 v126, v[144:145] offset:8320
    ds_write_b64 v127, v[148:149] offset:9344
    v_lshlrev_b32 v123, 3, v1
    v_exp_f32 v43, v43
    v_exp_f32 v44, v44
    v_exp_f32 v45, v45
    v_exp_f32 v46, v46
    v_exp_f32 v47, v47
    v_exp_f32 v48, v48
    v_exp_f32 v49, v49
    v_smfmac_f32_32x32x32_bf16 v[64:79], v[112:115], v[40:47], v2
    s_waitcnt lgkmcnt(8)
    ds_write_b64 v126, v[152:153] offset:8576
    ds_write_b64 v127, v[156:157] offset:9856
    buffer_load_dword v160, v123, s[4:7], s66 offen sc1
    v_exp_f32 v50, v50
    v_exp_f32 v51, v51
    v_exp_f32 v52, v52
    v_mfma_f32_32x32x16_bf16 v[32:47], v[100:103], v[20:23], 0
    v_exp_f32 v53, v53
    v_exp_f32 v54, v54
    v_exp_f32 v55, v55
    v_exp_f32 v56, v56
    v_exp_f32 v57, v57
    v_exp_f32 v58, v58
    v_smfmac_f32_32x32x32_bf16 v[80:95], v[104:107], v[48:55], v2
    s_waitcnt lgkmcnt(0)
    s_barrier
    v_exp_f32 v59, v59
    v_exp_f32 v60, v60
    v_exp_f32 v61, v61
    v_exp_f32 v62, v62
    v_exp_f32 v63, v63
    v_exp_f32 v32, v32
    v_exp_f32 v33, v33
    v_smfmac_f32_32x32x32_bf16 v[80:95], v[112:115], v[56:63], v2
    ds_read_b128 v[96:99], v3 offset:8320
    v_exp_f32 v34, v34
    v_exp_f32 v35, v35
    v_exp_f32 v36, v36
    v_mfma_f32_32x32x16_bf16 v[48:63], v[100:103], v[24:27], 0
    ds_read_b128 v[104:107], v4 offset:8320
    v_exp_f32 v37, v37
    v_exp_f32 v38, v38
    v_exp_f32 v39, v39
    v_exp_f32 v40, v40
    v_exp_f32 v41, v41
    v_exp_f32 v42, v42
    v_smfmac_f32_32x32x32_bf16 v[64:79], v[108:111], v[32:39], v2
    ds_read_b128 v[112:115], v5 offset:8320
    s_add_u32 s77, s88, 0
    v_exp_f32 v43, v43
    v_exp_f32 v44, v44
    v_exp_f32 v45, v45
    v_exp_f32 v46, v46
    v_exp_f32 v47, v47
    v_exp_f32 v48, v48
    v_exp_f32 v49, v49
    v_smfmac_f32_32x32x32_bf16 v[64:79], v[116:119], v[40:47], v2
    s_waitcnt lgkmcnt(2)
    buffer_store_dwordx4 a[244:247], v1, s[4:7], s77 offen offset:0
    v_exp_f32 v50, v50
    v_exp_f32 v51, v51
    v_exp_f32 v52, v52
    v_mfma_f32_32x32x16_bf16 v[32:47], v[96:99], v[20:23], 0
    buffer_store_dwordx4 a[244:247], v1, s[4:7], s77 offen offset:1024
    v_exp_f32 v53, v53
    v_exp_f32 v54, v54
    v_exp_f32 v55, v55
    v_exp_f32 v56, v56
    v_exp_f32 v57, v57
    v_exp_f32 v58, v58
    v_smfmac_f32_32x32x32_bf16 v[80:95], v[108:111], v[48:55], v2
    s_waitcnt lgkmcnt(0)
    v_exp_f32 v59, v59
    v_exp_f32 v60, v60
    v_exp_f32 v61, v61
    v_exp_f32 v62, v62
    v_exp_f32 v63, v63
    v_exp_f32 v32, v32
    v_exp_f32 v33, v33
    v_smfmac_f32_32x32x32_bf16 v[80:95], v[116:119], v[56:63], v2
    ds_read_b128 v[100:103], v3 offset:10400
    v_exp_f32 v34, v34
    v_exp_f32 v35, v35
    v_exp_f32 v36, v36
    v_mfma_f32_32x32x16_bf16 v[48:63], v[96:99], v[24:27], 0
    ds_read_b128 v[108:111], v4 offset:10400
    v_exp_f32 v37, v37
    v_exp_f32 v38, v38
    v_exp_f32 v39, v39
    v_exp_f32 v40, v40
    v_exp_f32 v41, v41
    v_exp_f32 v42, v42
    v_smfmac_f32_32x32x32_bf16 v[64:79], v[104:107], v[32:39], v2
    ds_read_b128 v[116:119], v5 offset:10400
    s_add_u32 s77, s88, 2048
    v_exp_f32 v43, v43
    v_exp_f32 v44, v44
    v_exp_f32 v45, v45
    v_exp_f32 v46, v46
    v_exp_f32 v47, v47
    v_exp_f32 v48, v48
    v_exp_f32 v49, v49
    v_smfmac_f32_32x32x32_bf16 v[64:79], v[112:115], v[40:47], v2
    s_waitcnt lgkmcnt(2)
    buffer_store_dwordx4 a[244:247], v1, s[4:7], s77 offen offset:0
    v_exp_f32 v50, v50
    v_exp_f32 v51, v51
    v_exp_f32 v52, v52
    v_mfma_f32_32x32x16_bf16 v[32:47], v[100:103], v[20:23], 0
    buffer_store_dwordx4 a[244:247], v1, s[4:7], s77 offen offset:1024
    v_exp_f32 v53, v53
    v_exp_f32 v54, v54
    v_exp_f32 v55, v55
    v_exp_f32 v56, v56
    v_exp_f32 v57, v57
    v_exp_f32 v58, v58
    v_smfmac_f32_32x32x32_bf16 v[80:95], v[104:107], v[48:55], v2
    s_waitcnt lgkmcnt(0)
    v_exp_f32 v59, v59
    v_exp_f32 v60, v60
    v_exp_f32 v61, v61
    v_exp_f32 v62, v62
    v_exp_f32 v63, v63
    v_exp_f32 v32, v32
    v_exp_f32 v33, v33
    v_smfmac_f32_32x32x32_bf16 v[80:95], v[112:115], v[56:63], v2
    ds_read_b128 v[96:99], v3 offset:12480
    v_exp_f32 v34, v34
    v_exp_f32 v35, v35
    v_exp_f32 v36, v36
    v_mfma_f32_32x32x16_bf16 v[48:63], v[100:103], v[24:27], 0
    ds_read_b128 v[104:107], v4 offset:12480
    v_exp_f32 v37, v37
    v_exp_f32 v38, v38
    v_exp_f32 v39, v39
    v_exp_f32 v40, v40
    v_exp_f32 v41, v41
    v_exp_f32 v42, v42
    v_smfmac_f32_32x32x32_bf16 v[64:79], v[108:111], v[32:39], v2
    ds_read_b128 v[112:115], v5 offset:12480
    s_add_u32 s77, s88, 4096
    v_exp_f32 v43, v43
    v_exp_f32 v44, v44
    v_exp_f32 v45, v45
    v_exp_f32 v46, v46
    v_exp_f32 v47, v47
    v_exp_f32 v48, v48
    v_exp_f32 v49, v49
    v_smfmac_f32_32x32x32_bf16 v[64:79], v[116:119], v[40:47], v2
    s_waitcnt lgkmcnt(2)
    buffer_store_dwordx4 a[244:247], v1, s[4:7], s77 offen offset:0
    v_exp_f32 v50, v50
    v_exp_f32 v51, v51
    v_exp_f32 v52, v52
    v_mfma_f32_32x32x16_bf16 v[32:47], v[96:99], v[20:23], 0
    s_waitcnt vmcnt(5)
    v_sad_u32 v160, v160, s30, 0
    v_cmp_lt_u32 vcc, 15, v160
    buffer_store_dwordx4 a[244:247], v1, s[4:7], s77 offen offset:1024
    v_exp_f32 v53, v53
    v_exp_f32 v54, v54
    v_exp_f32 v55, v55
    v_exp_f32 v56, v56
    v_exp_f32 v57, v57
    v_exp_f32 v58, v58
    v_smfmac_f32_32x32x32_bf16 v[80:95], v[108:111], v[48:55], v2
    s_waitcnt lgkmcnt(0)
    s_cbranch_vccnz RT_367
BK_368:
    s_barrier
    s_lshl_b32 s70, s60, 12
    s_add_u32 s70, s70, s65
    v_add_u32 v126, s70, v1
    s_add_u32 s84, s58, 2
    s_and_b32 s84, s84, 7
    s_lshl_b32 s84, s84, 14
    v_exp_f32 v59, v59
    v_exp_f32 v60, v60
    v_exp_f32 v61, v61
    v_exp_f32 v62, v62
    v_exp_f32 v63, v63
    v_exp_f32 v32, v32
    v_exp_f32 v33, v33
    v_smfmac_f32_32x32x32_bf16 v[80:95], v[116:119], v[56:63], v2
    ds_read_b128 v[100:103], v3 offset:14560
    v_exp_f32 v34, v34
    v_exp_f32 v35, v35
    v_exp_f32 v36, v36
    v_mfma_f32_32x32x16_bf16 v[48:63], v[96:99], v[24:27], 0
    ds_read_b128 v[108:111], v4 offset:14560
    s_add_u32 m0, s85, 29440
    v_exp_f32 v37, v37
    v_exp_f32 v38, v38
    v_exp_f32 v39, v39
    v_exp_f32 v40, v40
    v_exp_f32 v41, v41
    v_exp_f32 v42, v42
    v_smfmac_f32_32x32x32_bf16 v[64:79], v[104:107], v[32:39], v2
    ds_read_b128 v[116:119], v5 offset:14560
    buffer_load_dwordx4 v126, s[4:7], s84 offen offset:0 sc1 lds
    v_exp_f32 v43, v43
    v_exp_f32 v44, v44
    v_exp_f32 v45, v45
    v_exp_f32 v46, v46
    v_exp_f32 v47, v47
    v_exp_f32 v48, v48
    v_exp_f32 v49, v49
    v_smfmac_f32_32x32x32_bf16 v[64:79], v[112:115], v[40:47], v2
    s_waitcnt lgkmcnt(2)
    buffer_load_dwordx4 v126, s[4:7], s84 offen offset:1024 sc1 lds
    s_add_u32 m0, s85, 29472
    v_exp_f32 v50, v50
    v_exp_f32 v51, v51
    v_exp_f32 v52, v52
    v_mfma_f32_32x32x16_bf16 v[32:47], v[100:103], v[20:23], 0
    buffer_load_dwordx4 v126, s[4:7], s84 offen offset:2048 sc1 lds
    v_exp_f32 v53, v53
    v_exp_f32 v54, v54
    v_exp_f32 v55, v55
    v_exp_f32 v56, v56
    v_exp_f32 v57, v57
    v_exp_f32 v58, v58
    v_smfmac_f32_32x32x32_bf16 v[80:95], v[104:107], v[48:55], v2
    s_waitcnt lgkmcnt(0)
    buffer_load_dwordx4 v126, s[4:7], s84 offen offset:3072 sc1 lds
    v_exp_f32 v59, v59
    v_exp_f32 v60, v60
    v_exp_f32 v61, v61
    v_exp_f32 v62, v62
    v_exp_f32 v63, v63
    v_exp_f32 v32, v32
    v_exp_f32 v33, v33
    v_smfmac_f32_32x32x32_bf16 v[80:95], v[112:115], v[56:63], v2
    ds_read_b128 v[96:99], v3 offset:0
    s_add_u32 s84, s84, 0x4000
    s_and_b32 s84, s84, 0x1ffff
    v_exp_f32 v34, v34
    v_exp_f32 v35, v35
    v_exp_f32 v36, v36
    v_mfma_f32_32x32x16_bf16 v[48:63], v[100:103], v[24:27], 0
    ds_read_b128 v[104:107], v4 offset:0
    v_exp_f32 v37, v37
    v_exp_f32 v38, v38
    v_exp_f32 v39, v39
    v_exp_f32 v40, v40
    v_exp_f32 v41, v41
    v_exp_f32 v42, v42
    v_smfmac_f32_32x32x32_bf16 v[64:79], v[108:111], v[32:39], v2
    ds_read_b128 v[112:115], v5 offset:0
    s_add_u32 s77, s88, 6144
    v_exp_f32 v43, v43
    v_exp_f32 v44, v44
    v_exp_f32 v45, v45
    v_exp_f32 v46, v46
    v_exp_f32 v47, v47
    v_exp_f32 v48, v48
    v_exp_f32 v49, v49
    v_smfmac_f32_32x32x32_bf16 v[64:79], v[116:119], v[40:47], v2
    s_waitcnt lgkmcnt(2)
    buffer_store_dwordx4 a[244:247], v1, s[4:7], s77 offen offset:0
    v_exp_f32 v50, v50
    v_exp_f32 v51, v51
    v_exp_f32 v52, v52
    v_mfma_f32_32x32x16_bf16 v[32:47], v[96:99], v[20:23], 0
    buffer_store_dwordx4 a[244:247], v1, s[4:7], s77 offen offset:1024
    s_add_u32 s77, s88, 8192
    v_exp_f32 v53, v53
    v_exp_f32 v54, v54
    v_exp_f32 v55, v55
    v_exp_f32 v56, v56
    v_exp_f32 v57, v57
    v_exp_f32 v58, v58
    v_smfmac_f32_32x32x32_bf16 v[80:95], v[108:111], v[48:55], v2
    s_waitcnt lgkmcnt(0)
    buffer_store_dwordx4 a[244:247], v1, s[4:7], s77 offen offset:0
    v_exp_f32 v59, v59
    v_exp_f32 v60, v60
    v_exp_f32 v61, v61
    v_exp_f32 v62, v62
    v_exp_f32 v63, v63
    v_exp_f32 v32, v32
    v_exp_f32 v33, v33
    v_smfmac_f32_32x32x32_bf16 v[80:95], v[116:119], v[56:63], v2
    ds_read_b128 v[100:103], v3 offset:2080
    v_exp_f32 v34, v34
    v_exp_f32 v35, v35
    v_exp_f32 v36, v36
    v_mfma_f32_32x32x16_bf16 v[48:63], v[96:99], v[24:27], 0
    ds_read_b128 v[108:111], v4 offset:2080
    v_exp_f32 v37, v37
    v_exp_f32 v38, v38
    v_exp_f32 v39, v39
    v_exp_f32 v40, v40
    v_exp_f32 v41, v41
    v_exp_f32 v42, v42
    v_smfmac_f32_32x32x32_bf16 v[64:79], v[104:107], v[32:39], v2
    ds_read_b128 v[116:119], v5 offset:2080
    v_exp_f32 v43, v43
    v_exp_f32 v44, v44
    v_exp_f32 v45, v45
    v_exp_f32 v46, v46
    v_exp_f32 v47, v47
    v_exp_f32 v48, v48
    v_exp_f32 v49, v49
    v_smfmac_f32_32x32x32_bf16 v[64:79], v[112:115], v[40:47], v2
    s_waitcnt lgkmcnt(2)
    buffer_store_dwordx4 a[244:247], v1, s[4:7], s77 offen offset:1024
    s_add_u32 s77, s88, 10240
    v_exp_f32 v50, v50
    v_exp_f32 v51, v51
    v_exp_f32 v52, v52
    v_mfma_f32_32x32x16_bf16 v[32:47], v[100:103], v[20:23], 0
    buffer_store_dwordx4 a[244:247], v1, s[4:7], s77 offen offset:0
    v_exp_f32 v53, v53
    v_exp_f32 v54, v54
    v_exp_f32 v55, v55
    v_exp_f32 v56, v56
    v_exp_f32 v57, v57
    v_exp_f32 v58, v58
    v_smfmac_f32_32x32x32_bf16 v[80:95], v[104:107], v[48:55], v2
    s_waitcnt lgkmcnt(0)
    buffer_store_dwordx4 a[244:247], v1, s[4:7], s77 offen offset:1024
    v_exp_f32 v59, v59
    v_exp_f32 v60, v60
    v_exp_f32 v61, v61
    v_exp_f32 v62, v62
    v_exp_f32 v63, v63
    v_exp_f32 v32, v32
    v_exp_f32 v33, v33
    v_smfmac_f32_32x32x32_bf16 v[80:95], v[112:115], v[56:63], v2
    ds_read_b128 v[96:99], v3 offset:4160
    v_exp_f32 v34, v34
    v_exp_f32 v35, v35
    v_exp_f32 v36, v36
    v_mfma_f32_32x32x16_bf16 v[48:63], v[100:103], v[24:27], 0
    ds_read_b128 v[104:107], v4 offset:4160
    v_exp_f32 v37, v37
    v_exp_f32 v38, v38
    v_exp_f32 v39, v39
    v_exp_f32 v40, v40
    v_exp_f32 v41, v41
    v_exp_f32 v42, v42
    v_smfmac_f32_32x32x32_bf16 v[64:79], v[108:111], v[32:39], v2
    ds_read_b128 v[112:115], v5 offset:4160
    v_exp_f32 v43, v43
    v_exp_f32 v44, v44
    v_exp_f32 v45, v45
    v_exp_f32 v46, v46
    v_exp_f32 v47, v47
    v_exp_f32 v48, v48
    v_exp_f32 v49, v49
    v_smfmac_f32_32x32x32_bf16 v[64:79], v[116:119], v[40:47], v2
    s_waitcnt lgkmcnt(2)
    v_exp_f32 v50, v50
    v_exp_f32 v51, v51
    v_exp_f32 v52, v52
    v_mfma_f32_32x32x16_bf16 v[32:47], v[96:99], v[20:23], 0
    v_exp_f32 v53, v53
    v_exp_f32 v54, v54
    v_exp_f32 v55, v55
    v_exp_f32 v56, v56
    v_exp_f32 v57, v57
    v_exp_f32 v58, v58
    v_smfmac_f32_32x32x32_bf16 v[80:95], v[108:111], v[48:55], v2
    s_waitcnt lgkmcnt(0)
    v_exp_f32 v59, v59
    v_exp_f32 v60, v60
    v_exp_f32 v61, v61
    v_exp_f32 v62, v62
    v_exp_f32 v63, v63
    v_exp_f32 v32, v32
    v_exp_f32 v33, v33
    v_smfmac_f32_32x32x32_bf16 v[80:95], v[116:119], v[56:63], v2
    ds_read_b128 v[100:103], v3 offset:6240
    v_exp_f32 v34, v34
    v_exp_f32 v35, v35
    v_exp_f32 v36, v36
    v_mfma_f32_32x32x16_bf16 v[48:63], v[96:99], v[24:27], 0
    ds_read_b128 v[108:111], v4 offset:6240
    v_exp_f32 v37, v37
    v_exp_f32 v38, v38
    v_exp_f32 v39, v39
    v_exp_f32 v40, v40
    v_exp_f32 v41, v41
    v_exp_f32 v42, v42
    v_smfmac_f32_32x32x32_bf16 v[64:79], v[104:107], v[32:39], v2
    ds_read_b128 v[116:119], v5 offset:6240
    v_exp_f32 v43, v43
    v_exp_f32 v44, v44
    v_exp_f32 v45, v45
    v_exp_f32 v46, v46
    v_exp_f32 v47, v47
    v_exp_f32 v48, v48
    v_exp_f32 v49, v49
    v_smfmac_f32_32x32x32_bf16 v[64:79], v[112:115], v[40:47], v2
    s_waitcnt lgkmcnt(2)
    v_exp_f32 v50, v50
    v_exp_f32 v51, v51
    v_exp_f32 v52, v52
    v_mfma_f32_32x32x16_bf16 v[32:47], v[100:103], v[20:23], 0
    s_add_u32 m0, s85, 0
    v_exp_f32 v53, v53
    v_exp_f32 v54, v54
    v_exp_f32 v55, v55
    v_exp_f32 v56, v56
    v_exp_f32 v57, v57
    v_exp_f32 v58, v58
    v_smfmac_f32_32x32x32_bf16 v[80:95], v[104:107], v[48:55], v2
    s_waitcnt vmcnt(6) lgkmcnt(0)
    s_barrier
    buffer_load_dwordx4 v126, s[4:7], s84 offen offset:0 sc1 lds
    v_exp_f32 v59, v59
    v_exp_f32 v60, v60
    v_exp_f32 v61, v61
    v_exp_f32 v62, v62
    v_exp_f32 v63, v63
    v_exp_f32 v32, v32
    v_exp_f32 v33, v33
    v_smfmac_f32_32x32x32_bf16 v[80:95], v[112:115], v[56:63], v2
    ds_read_b128 v[96:99], v3 offset:37760
    v_exp_f32 v34, v34
    v_exp_f32 v35, v35
    v_exp_f32 v36, v36
    v_mfma_f32_32x32x16_bf16 v[48:63], v[100:103], v[24:27], 0
    ds_read_b128 v[104:107], v4 offset:37760
    v_exp_f32 v37, v37
    v_exp_f32 v38, v38
    v_exp_f32 v39, v39
    v_exp_f32 v40, v40
    v_exp_f32 v41, v41
    v_exp_f32 v42, v42
    v_smfmac_f32_32x32x32_bf16 v[64:79], v[108:111], v[32:39], v2
    ds_read_b128 v[112:115], v5 offset:37760
    v_exp_f32 v43, v43
    v_exp_f32 v44, v44
    v_exp_f32 v45, v45
    v_exp_f32 v46, v46
    v_exp_f32 v47, v47
    v_exp_f32 v48, v48
    v_exp_f32 v49, v49
    v_smfmac_f32_32x32x32_bf16 v[64:79], v[116:119], v[40:47], v2
    s_waitcnt lgkmcnt(2)
    buffer_load_dwordx4 v126, s[4:7], s84 offen offset:1024 sc1 lds
    s_add_u32 m0, s85, 32
    v_exp_f32 v50, v50
    v_exp_f32 v51, v51
    v_exp_f32 v52, v52
    v_mfma_f32_32x32x16_bf16 v[32:47], v[96:99], v[20:23], 0
    buffer_load_dwordx4 v126, s[4:7], s84 offen offset:2048 sc1 lds
    v_exp_f32 v53, v53
    v_exp_f32 v54, v54
    v_exp_f32 v55, v55
    v_exp_f32 v56, v56
    v_exp_f32 v57, v57
    v_exp_f32 v58, v58
    v_smfmac_f32_32x32x32_bf16 v[80:95], v[108:111], v[48:55], v2
    s_waitcnt lgkmcnt(0)
    buffer_load_dwordx4 v126, s[4:7], s84 offen offset:3072 sc1 lds
    v_exp_f32 v59, v59
    v_exp_f32 v60, v60
    v_exp_f32 v61, v61
    v_exp_f32 v62, v62
    v_exp_f32 v63, v63
    v_exp_f32 v32, v32
    v_exp_f32 v33, v33
    v_smfmac_f32_32x32x32_bf16 v[80:95], v[116:119], v[56:63], v2
    ds_read_b128 v[100:103], v3 offset:39840
    s_add_u32 s84, s84, 0x4000
    s_and_b32 s84, s84, 0x1ffff
    v_exp_f32 v34, v34
    v_exp_f32 v35, v35
    v_exp_f32 v36, v36
    v_mfma_f32_32x32x16_bf16 v[48:63], v[96:99], v[24:27], 0
    ds_read_b128 v[108:111], v4 offset:39840
    v_exp_f32 v37, v37
    v_exp_f32 v38, v38
    v_exp_f32 v39, v39
    v_exp_f32 v40, v40
    v_exp_f32 v41, v41
    v_exp_f32 v42, v42
    v_smfmac_f32_32x32x32_bf16 v[64:79], v[104:107], v[32:39], v2
    ds_read_b128 v[116:119], v5 offset:39840
    v_exp_f32 v43, v43
    v_exp_f32 v44, v44
    v_exp_f32 v45, v45
    v_exp_f32 v46, v46
    v_exp_f32 v47, v47
    v_exp_f32 v48, v48
    v_exp_f32 v49, v49
    v_smfmac_f32_32x32x32_bf16 v[64:79], v[112:115], v[40:47], v2
    s_waitcnt lgkmcnt(2)
    v_exp_f32 v50, v50
    v_exp_f32 v51, v51
    v_exp_f32 v52, v52
    v_mfma_f32_32x32x16_bf16 v[32:47], v[100:103], v[20:23], 0
    v_exp_f32 v53, v53
    v_exp_f32 v54, v54
    v_exp_f32 v55, v55
    v_exp_f32 v56, v56
    v_exp_f32 v57, v57
    v_exp_f32 v58, v58
    v_smfmac_f32_32x32x32_bf16 v[80:95], v[104:107], v[48:55], v2
    s_waitcnt lgkmcnt(0)
    v_exp_f32 v59, v59
    v_exp_f32 v60, v60
    v_exp_f32 v61, v61
    v_exp_f32 v62, v62
    v_exp_f32 v63, v63
    v_exp_f32 v32, v32
    v_exp_f32 v33, v33
    v_smfmac_f32_32x32x32_bf16 v[80:95], v[112:115], v[56:63], v2
    ds_read_b128 v[96:99], v3 offset:41920
    v_exp_f32 v34, v34
    v_exp_f32 v35, v35
    v_exp_f32 v36, v36
    v_mfma_f32_32x32x16_bf16 v[48:63], v[100:103], v[24:27], 0
    ds_read_b128 v[104:107], v4 offset:41920
    v_exp_f32 v37, v37
    v_exp_f32 v38, v38
    v_exp_f32 v39, v39
    v_exp_f32 v40, v40
    v_exp_f32 v41, v41
    v_exp_f32 v42, v42
    v_smfmac_f32_32x32x32_bf16 v[64:79], v[108:111], v[32:39], v2
    ds_read_b128 v[112:115], v5 offset:41920
    s_xor_b32 s75, s83, 0
    v_exp_f32 v43, v43
    v_exp_f32 v44, v44
    v_exp_f32 v45, v45
    v_exp_f32 v46, v46
    v_exp_f32 v47, v47
    v_exp_f32 v48, v48
    v_exp_f32 v49, v49
    v_smfmac_f32_32x32x32_bf16 v[64:79], v[116:119], v[40:47], v2
    s_waitcnt lgkmcnt(2)
    buffer_load_dwordx4 v[128:131], v1, s[4:7], s75 offen offset:0 sc1
    v_exp_f32 v50, v50
    v_exp_f32 v51, v51
    v_exp_f32 v52, v52
    v_mfma_f32_32x32x16_bf16 v[32:47], v[96:99], v[20:23], 0
    v_exp_f32 v53, v53
    v_exp_f32 v54, v54
    v_exp_f32 v55, v55
    v_exp_f32 v56, v56
    v_exp_f32 v57, v57
    v_exp_f32 v58, v58
    v_smfmac_f32_32x32x32_bf16 v[80:95], v[108:111], v[48:55], v2
    s_waitcnt lgkmcnt(0)
    v_exp_f32 v59, v59
    v_exp_f32 v60, v60
    v_exp_f32 v61, v61
    v_exp_f32 v62, v62
    v_exp_f32 v63, v63
    v_exp_f32 v32, v32
    v_exp_f32 v33, v33
    v_smfmac_f32_32x32x32_bf16 v[80:95], v[116:119], v[56:63], v2
    ds_read_b128 v[100:103], v3 offset:44000
    v_exp_f32 v34, v34
    v_exp_f32 v35, v35
    v_exp_f32 v36, v36
    v_mfma_f32_32x32x16_bf16 v[48:63], v[96:99], v[24:27], 0
    ds_read_b128 v[108:111], v4 offset:44000
    v_exp_f32 v37, v37
    v_exp_f32 v38, v38
    v_exp_f32 v39, v39
    v_exp_f32 v40, v40
    v_exp_f32 v41, v41
    v_exp_f32 v42, v42
    v_smfmac_f32_32x32x32_bf16 v[64:79], v[104:107], v[32:39], v2
    ds_read_b128 v[116:119], v5 offset:44000
    v_exp_f32 v43, v43
    v_exp_f32 v44, v44
    v_exp_f32 v45, v45
    v_exp_f32 v46, v46
    v_exp_f32 v47, v47
    v_exp_f32 v48, v48
    v_exp_f32 v49, v49
    v_smfmac_f32_32x32x32_bf16 v[64:79], v[112:115], v[40:47], v2
    s_waitcnt lgkmcnt(2)
    v_exp_f32 v50, v50
    v_exp_f32 v51, v51
    v_exp_f32 v52, v52
TCH9:
    s_cbranch_execz TCH13
    v_mfma_f32_32x32x16_bf16 v[32:47], v[100:103], v[20:23], 0
    buffer_load_dwordx4 v[132:135], v1, s[4:7], s75 offen offset:1024 sc1
    v_exp_f32 v53, v53
    v_exp_f32 v54, v54
    v_exp_f32 v55, v55
    v_exp_f32 v56, v56
    v_exp_f32 v57, v57
    v_exp_f32 v58, v58
    v_smfmac_f32_32x32x32_bf16 v[80:95], v[104:107], v[48:55], v2
    s_waitcnt lgkmcnt(0)
    v_exp_f32 v59, v59
    v_exp_f32 v60, v60
    v_exp_f32 v61, v61
    v_exp_f32 v62, v62
    v_exp_f32 v63, v63
    v_exp_f32 v32, v32
    v_exp_f32 v33, v33
    v_smfmac_f32_32x32x32_bf16 v[80:95], v[112:115], v[56:63], v2
    ds_read_b128 v[96:99], v3 offset:29440
    v_exp_f32 v34, v34
    v_exp_f32 v35, v35
    v_exp_f32 v36, v36
    v_mfma_f32_32x32x16_bf16 v[48:63], v[100:103], v[24:27], 0
    ds_read_b128 v[104:107], v4 offset:29440
    v_exp_f32 v37, v37
    v_exp_f32 v38, v38
    v_exp_f32 v39, v39
    v_exp_f32 v40, v40
    v_exp_f32 v41, v41
    v_exp_f32 v42, v42
    v_smfmac_f32_32x32x32_bf16 v[64:79], v[108:111], v[32:39], v2
    ds_read_b128 v[112:115], v5 offset:29440
    v_exp_f32 v43, v43
    v_exp_f32 v44, v44
    v_exp_f32 v45, v45
    v_exp_f32 v46, v46
    v_exp_f32 v47, v47
    v_exp_f32 v48, v48
    v_exp_f32 v49, v49
    v_smfmac_f32_32x32x32_bf16 v[64:79], v[116:119], v[40:47], v2
    s_waitcnt lgkmcnt(2)
    v_exp_f32 v50, v50
    v_exp_f32 v51, v51
    v_exp_f32 v52, v52
    v_mfma_f32_32x32x16_bf16 v[32:47], v[96:99], v[20:23], 0
    buffer_load_dwordx4 v[136:139], v1, s[4:7], s75 offen offset:2048 sc1
    v_exp_f32 v53, v53
    v_exp_f32 v54, v54
    v_exp_f32 v55, v55
    v_exp_f32 v56, v56
    v_exp_f32 v57, v57
    v_exp_f32 v58, v58
    v_smfmac_f32_32x32x32_bf16 v[80:95], v[108:111], v[48:55], v2
    s_waitcnt lgkmcnt(0)
    v_exp_f32 v59, v59
    v_exp_f32 v60, v60
    v_exp_f32 v61, v61
    v_exp_f32 v62, v62
    v_exp_f32 v63, v63
    v_exp_f32 v32, v32
    v_exp_f32 v33, v33
    v_smfmac_f32_32x32x32_bf16 v[80:95], v[116:119], v[56:63], v2
    ds_read_b128 v[100:103], v3 offset:31520
    v_exp_f32 v34, v34
    v_exp_f32 v35, v35
    v_exp_f32 v36, v36
    v_mfma_f32_32x32x16_bf16 v[48:63], v[96:99], v[24:27], 0
    ds_read_b128 v[108:111], v4 offset:31520
    v_exp_f32 v37, v37
    v_exp_f32 v38, v38
    v_exp_f32 v39, v39
    v_exp_f32 v40, v40
    v_exp_f32 v41, v41
    v_exp_f32 v42, v42
    v_smfmac_f32_32x32x32_bf16 v[64:79], v[104:107], v[32:39], v2
    ds_read_b128 v[116:119], v5 offset:31520
    v_exp_f32 v43, v43
    v_exp_f32 v44, v44
    v_exp_f32 v45, v45
    v_exp_f32 v46, v46
    v_exp_f32 v47, v47
    v_exp_f32 v48, v48
    v_exp_f32 v49, v49
    v_smfmac_f32_32x32x32_bf16 v[64:79], v[112:115], v[40:47], v2
    s_waitcnt lgkmcnt(2)
    v_exp_f32 v50, v50
    v_exp_f32 v51, v51
    v_exp_f32 v52, v52
    v_mfma_f32_32x32x16_bf16 v[32:47], v[100:103], v[20:23], 0
    v_exp_f32 v53, v53
    v_exp_f32 v54, v54
    v_exp_f32 v55, v55
    v_exp_f32 v56, v56
    v_exp_f32 v57, v57
    v_exp_f32 v58, v58
    v_smfmac_f32_32x32x32_bf16 v[80:95], v[104:107], v[48:55], v2
    s_waitcnt lgkmcnt(0)
    buffer_load_dwordx4 v[140:143], v1, s[4:7], s75 offen offset:3072 sc1
    v_exp_f32 v59, v59
    v_exp_f32 v60, v60
    v_exp_f32 v61, v61
    v_exp_f32 v62, v62
    v_exp_f32 v63, v63
    v_exp_f32 v32, v32
    v_exp_f32 v33, v33
    v_smfmac_f32_32x32x32_bf16 v[80:95], v[112:115], v[56:63], v2
    ds_read_b128 v[96:99], v3 offset:33600
    v_exp_f32 v34, v34
    v_exp_f32 v35, v35
    v_exp_f32 v36, v36
    v_mfma_f32_32x32x16_bf16 v[48:63], v[100:103], v[24:27], 0
    ds_read_b128 v[104:107], v4 offset:33600
    v_exp_f32 v37, v37
    v_exp_f32 v38, v38
    v_exp_f32 v39, v39
    v_exp_f32 v40, v40
    v_exp_f32 v41, v41
    v_exp_f32 v42, v42
    v_smfmac_f32_32x32x32_bf16 v[64:79], v[108:111], v[32:39], v2
    ds_read_b128 v[112:115], v5 offset:33600
    v_exp_f32 v43, v43
    v_exp_f32 v44, v44
    v_exp_f32 v45, v45
    v_exp_f32 v46, v46
    v_exp_f32 v47, v47
    v_exp_f32 v48, v48
    v_exp_f32 v49, v49
    v_smfmac_f32_32x32x32_bf16 v[64:79], v[116:119], v[40:47], v2
    s_waitcnt lgkmcnt(2)
    v_exp_f32 v50, v50
    v_exp_f32 v51, v51
    v_exp_f32 v52, v52
    v_mfma_f32_32x32x16_bf16 v[32:47], v[96:99], v[20:23], 0
    s_xor_b32 s75, s83, 4096
    v_exp_f32 v53, v53
    v_exp_f32 v54, v54
    v_exp_f32 v55, v55
    v_exp_f32 v56, v56
    v_exp_f32 v57, v57
    v_exp_f32 v58, v58
    v_smfmac_f32_32x32x32_bf16 v[80:95], v[108:111], v[48:55], v2
    s_waitcnt lgkmcnt(0)
    buffer_load_dwordx4 v[144:147], v1, s[4:7], s75 offen offset:0 sc1
    v_exp_f32 v59, v59
    v_exp_f32 v60, v60
    v_exp_f32 v61, v61
    v_exp_f32 v62, v62
    v_exp_f32 v63, v63
    v_exp_f32 v32, v32
    v_exp_f32 v33, v33
    v_smfmac_f32_32x32x32_bf16 v[80:95], v[116:119], v[56:63], v2
    ds_read_b128 v[100:103], v3 offset:35680
    v_exp_f32 v34, v34
    v_exp_f32 v35, v35
    v_exp_f32 v36, v36
    v_mfma_f32_32x32x16_bf16 v[48:63], v[96:99], v[24:27], 0
    ds_read_b128 v[108:111], v4 offset:35680
    v_exp_f32 v37, v37
    v_exp_f32 v38, v38
    v_exp_f32 v39, v39
    v_exp_f32 v40, v40
    v_exp_f32 v41, v41
    v_exp_f32 v42, v42
    v_smfmac_f32_32x32x32_bf16 v[64:79], v[104:107], v[32:39], v2
    ds_read_b128 v[116:119], v5 offset:35680
    v_exp_f32 v43, v43
    v_exp_f32 v44, v44
    v_exp_f32 v45, v45
    v_exp_f32 v46, v46
    v_exp_f32 v47, v47
    v_exp_f32 v48, v48
    v_exp_f32 v49, v49
    v_smfmac_f32_32x32x32_bf16 v[64:79], v[112:115], v[40:47], v2
    s_waitcnt lgkmcnt(2)
    v_exp_f32 v50, v50
    v_exp_f32 v51, v51
    v_exp_f32 v52, v52
    v_mfma_f32_32x32x16_bf16 v[32:47], v[100:103], v[20:23], 0
    s_add_u32 m0, s85, 29440
    v_exp_f32 v53, v53
    v_exp_f32 v54, v54
    v_exp_f32 v55, v55
    v_exp_f32 v56, v56
    v_exp_f32 v57, v57
    v_exp_f32 v58, v58
    v_smfmac_f32_32x32x32_bf16 v[80:95], v[104:107], v[48:55], v2
    s_waitcnt vmcnt(9)
    s_cmp_lg_u32 s31, 0
    s_cbranch_scc1 SF_365
SFD_366:
    s_waitcnt vmcnt(5) lgkmcnt(0)
    s_barrier
    buffer_load_dwordx4 v126, s[4:7], s84 offen offset:0 sc1 lds
    v_exp_f32 v59, v59
    v_exp_f32 v60, v60
    v_exp_f32 v61, v61
    v_exp_f32 v62, v62
    v_exp_f32 v63, v63
    v_exp_f32 v32, v32
    v_exp_f32 v33, v33
    v_smfmac_f32_32x32x32_bf16 v[80:95], v[112:115], v[56:63], v2
    ds_read_b128 v[96:99], v3 offset:8320
    v_exp_f32 v34, v34
    v_exp_f32 v35, v35
    v_exp_f32 v36, v36
    v_mfma_f32_32x32x16_bf16 v[48:63], v[100:103], v[24:27], 0
    ds_read_b128 v[104:107], v4 offset:8320
    s_lshl2_add_u32 s74, s59, s64
    s_cmp_lg_u32 s31, 0
    s_mov_b64 exec, s[94:95]
    s_cbranch_scc1 PFS_375
    buffer_store_dword v6, off, s[4:7], s74
PFD_376:
    s_mov_b64 exec, -1
    v_exp_f32 v37, v37
    v_exp_f32 v38, v38
    v_exp_f32 v39, v39
    v_exp_f32 v40, v40
    v_exp_f32 v41, v41
    v_exp_f32 v42, v42
    v_smfmac_f32_32x32x32_bf16 v[64:79], v[108:111], v[32:39], v2
    ds_read_b128 v[112:115], v5 offset:8320
    v_exp_f32 v43, v43
    v_exp_f32 v44, v44
    v_exp_f32 v45, v45
    v_exp_f32 v46, v46
    v_exp_f32 v47, v47
    v_exp_f32 v48, v48
    v_exp_f32 v49, v49
    v_smfmac_f32_32x32x32_bf16 v[64:79], v[116:119], v[40:47], v2
    s_waitcnt lgkmcnt(2)
    buffer_load_dwordx4 v126, s[4:7], s84 offen offset:1024 sc1 lds
    s_add_u32 m0, s85, 29472
    v_exp_f32 v50, v50
    v_exp_f32 v51, v51
    v_exp_f32 v52, v52
    v_mfma_f32_32x32x16_bf16 v[32:47], v[96:99], v[20:23], 0
    buffer_load_dwordx4 v126, s[4:7], s84 offen offset:2048 sc1 lds
    v_exp_f32 v53, v53
    v_exp_f32 v54, v54
    v_exp_f32 v55, v55
    v_exp_f32 v56, v56
    v_exp_f32 v57, v57
    v_exp_f32 v58, v58
    v_smfmac_f32_32x32x32_bf16 v[80:95], v[108:111], v[48:55], v2
    s_waitcnt lgkmcnt(0)
    buffer_load_dwordx4 v126, s[4:7], s84 offen offset:3072 sc1 lds
    v_exp_f32 v59, v59
    v_exp_f32 v60, v60
    v_exp_f32 v61, v61
    v_exp_f32 v62, v62
    v_exp_f32 v63, v63
    v_exp_f32 v32, v32
    v_exp_f32 v33, v33
    v_smfmac_f32_32x32x32_bf16 v[80:95], v[116:119], v[56:63], v2
    ds_read_b128 v[100:103], v3 offset:10400
    s_add_u32 s84, s84, 0x4000
    s_and_b32 s84, s84, 0x1ffff
    v_exp_f32 v34, v34
    v_exp_f32 v35, v35
    v_exp_f32 v36, v36
    v_mfma_f32_32x32x16_bf16 v[48:63], v[96:99], v[24:27], 0
    ds_read_b128 v[108:111], v4 offset:10400
    v_exp_f32 v37, v37
    v_exp_f32 v38, v38
    v_exp_f32 v39, v39
    v_exp_f32 v40, v40
    v_exp_f32 v41, v41
    v_exp_f32 v42, v42
    v_smfmac_f32_32x32x32_bf16 v[64:79], v[104:107], v[32:39], v2
    ds_read_b128 v[116:119], v5 offset:10400
    v_exp_f32 v43, v43
    v_exp_f32 v44, v44
    v_exp_f32 v45, v45
    v_exp_f32 v46, v46
    v_exp_f32 v47, v47
    v_exp_f32 v48, v48
    v_exp_f32 v49, v49
    v_smfmac_f32_32x32x32_bf16 v[64:79], v[112:115], v[40:47], v2
    s_waitcnt lgkmcnt(2)
    v_exp_f32 v50, v50
    v_exp_f32 v51, v51
    v_exp_f32 v52, v52
    v_mfma_f32_32x32x16_bf16 v[32:47], v[100:103], v[20:23], 0
    buffer_load_dwordx4 v[148:151], v1, s[4:7], s75 offen offset:1024 sc1
    v_exp_f32 v53, v53
    v_exp_f32 v54, v54
    v_exp_f32 v55, v55
    v_exp_f32 v56, v56
    v_exp_f32 v57, v57
    v_exp_f32 v58, v58
    v_smfmac_f32_32x32x32_bf16 v[80:95], v[104:107], v[48:55], v2
    s_waitcnt lgkmcnt(0)
    v_exp_f32 v59, v59
    v_exp_f32 v60, v60
    v_exp_f32 v61, v61
    v_exp_f32 v62, v62
    v_exp_f32 v63, v63
    v_exp_f32 v32, v32
    v_exp_f32 v33, v33
    v_smfmac_f32_32x32x32_bf16 v[80:95], v[112:115], v[56:63], v2
    ds_read_b128 v[96:99], v3 offset:12480
    v_exp_f32 v34, v34
    v_exp_f32 v35, v35
    v_exp_f32 v36, v36
    v_mfma_f32_32x32x16_bf16 v[48:63], v[100:103], v[24:27], 0
    ds_read_b128 v[104:107], v4 offset:12480
    v_exp_f32 v37, v37
    v_exp_f32 v38, v38
    v_exp_f32 v39, v39
    v_exp_f32 v40, v40
    v_exp_f32 v41, v41
    v_exp_f32 v42, v42
    v_smfmac_f32_32x32x32_bf16 v[64:79], v[108:111], v[32:39], v2
    ds_read_b128 v[112:115], v5 offset:12480
    v_exp_f32 v43, v43
    v_exp_f32 v44, v44
    v_exp_f32 v45, v45
    v_exp_f32 v46, v46
    v_exp_f32 v47, v47
    v_exp_f32 v48, v48
    v_exp_f32 v49, v49
    v_smfmac_f32_32x32x32_bf16 v[64:79], v[116:119], v[40:47], v2
    s_waitcnt lgkmcnt(2)
    v_exp_f32 v50, v50
    v_exp_f32 v51, v51
    v_exp_f32 v52, v52
    v_mfma_f32_32x32x16_bf16 v[32:47], v[96:99], v[20:23], 0
    v_exp_f32 v53, v53
    v_exp_f32 v54, v54
    v_exp_f32 v55, v55
    v_exp_f32 v56, v56
    v_exp_f32 v57, v57
    v_exp_f32 v58, v58
    v_smfmac_f32_32x32x32_bf16 v[80:95], v[108:111], v[48:55], v2
    s_waitcnt lgkmcnt(0)
    buffer_load_dwordx4 v[152:155], v1, s[4:7], s75 offen offset:2048 sc1
    v_exp_f32 v59, v59
    v_exp_f32 v60, v60
    v_exp_f32 v61, v61
    v_exp_f32 v62, v62
    v_exp_f32 v63, v63
    v_exp_f32 v32, v32
    v_exp_f32 v33, v33
    v_smfmac_f32_32x32x32_bf16 v[80:95], v[116:119], v[56:63], v2
    ds_read_b128 v[100:103], v3 offset:14560
    v_exp_f32 v34, v34
    v_exp_f32 v35, v35
    v_exp_f32 v36, v36
    v_mfma_f32_32x32x16_bf16 v[48:63], v[96:99], v[24:27], 0
    ds_read_b128 v[108:111], v4 offset:14560
    v_exp_f32 v37, v37
    v_exp_f32 v38, v38
    v_exp_f32 v39, v39
    v_exp_f32 v40, v40
    v_exp_f32 v41, v41
    v_exp_f32 v42, v42
    v_smfmac_f32_32x32x32_bf16 v[64:79], v[104:107], v[32:39], v2
    ds_read_b128 v[116:119], v5 offset:14560
    v_exp_f32 v43, v43
    v_exp_f32 v44, v44
    v_exp_f32 v45, v45
    v_exp_f32 v46, v46
    v_exp_f32 v47, v47
    v_exp_f32 v48, v48
    v_exp_f32 v49, v49
    v_smfmac_f32_32x32x32_bf16 v[64:79], v[112:115], v[40:47], v2
    s_waitcnt lgkmcnt(2)
    v_exp_f32 v50, v50
    v_exp_f32 v51, v51
    v_exp_f32 v52, v52
    v_mfma_f32_32x32x16_bf16 v[32:47], v[100:103], v[20:23], 0
    v_exp_f32 v53, v53
    v_exp_f32 v54, v54
    v_exp_f32 v55, v55
    v_exp_f32 v56, v56
    v_exp_f32 v57, v57
    v_exp_f32 v58, v58
    v_smfmac_f32_32x32x32_bf16 v[80:95], v[104:107], v[48:55], v2
    s_waitcnt lgkmcnt(0)
    buffer_load_dwordx4 v[156:159], v1, s[4:7], s75 offen offset:3072 sc1
    v_exp_f32 v59, v59
    v_exp_f32 v60, v60
    v_exp_f32 v61, v61
    v_exp_f32 v62, v62
    v_exp_f32 v63, v63
    v_exp_f32 v32, v32
    v_exp_f32 v33, v33
    v_smfmac_f32_32x32x32_bf16 v[80:95], v[112:115], v[56:63], v2
    ds_read_b128 v[96:99], v3 offset:0
    v_exp_f32 v34, v34
    v_exp_f32 v35, v35
    v_exp_f32 v36, v36
    v_mfma_f32_32x32x16_bf16 v[48:63], v[100:103], v[24:27], 0
    ds_read_b128 v[104:107], v4 offset:0
    v_exp_f32 v37, v37
    v_exp_f32 v38, v38
    v_exp_f32 v39, v39
    v_exp_f32 v40, v40
    v_exp_f32 v41, v41
    v_exp_f32 v42, v42
    v_smfmac_f32_32x32x32_bf16 v[64:79], v[108:111], v[32:39], v2
    ds_read_b128 v[112:115], v5 offset:0
    v_exp_f32 v43, v43
    v_exp_f32 v44, v44
    v_exp_f32 v45, v45
    v_exp_f32 v46, v46
    v_exp_f32 v47, v47
    v_exp_f32 v48, v48
    v_exp_f32 v49, v49
    v_smfmac_f32_32x32x32_bf16 v[64:79], v[116:119], v[40:47], v2
    s_waitcnt lgkmcnt(2)
    v_exp_f32 v50, v50
    v_exp_f32 v51, v51
    v_exp_f32 v52, v52
    v_mfma_f32_32x32x16_bf16 v[32:47], v[96:99], v[20:23], 0
    v_exp_f32 v53, v53
    v_exp_f32 v54, v54
    v_exp_f32 v55, v55
    v_exp_f32 v56, v56
    v_exp_f32 v57, v57
    v_exp_f32 v58, v58
    v_smfmac_f32_32x32x32_bf16 v[80:95], v[108:111], v[48:55], v2
    s_waitcnt lgkmcnt(0)
    v_exp_f32 v59, v59
    v_exp_f32 v60, v60
    v_exp_f32 v61, v61
    v_exp_f32 v62, v62
    v_exp_f32 v63, v63
    v_exp_f32 v32, v32
    v_exp_f32 v33, v33
    v_smfmac_f32_32x32x32_bf16 v[80:95], v[116:119], v[56:63], v2
    ds_read_b128 v[100:103], v3 offset:2080
    v_exp_f32 v34, v34
    v_exp_f32 v35, v35
    v_exp_f32 v36, v36
    v_mfma_f32_32x32x16_bf16 v[48:63], v[96:99], v[24:27], 0
    ds_read_b128 v[108:111], v4 offset:2080
    v_exp_f32 v37, v37
    v_exp_f32 v38, v38
    v_exp_f32 v39, v39
    v_exp_f32 v40, v40
    v_exp_f32 v41, v41
    v_exp_f32 v42, v42
    v_smfmac_f32_32x32x32_bf16 v[64:79], v[104:107], v[32:39], v2
    ds_read_b128 v[116:119], v5 offset:2080
    s_xor_b32 s75, s83, 8192
    v_exp_f32 v43, v43
    v_exp_f32 v44, v44
    v_exp_f32 v45, v45
    v_exp_f32 v46, v46
    v_exp_f32 v47, v47
    v_exp_f32 v48, v48
    v_exp_f32 v49, v49
    v_smfmac_f32_32x32x32_bf16 v[64:79], v[112:115], v[40:47], v2
    s_waitcnt lgkmcnt(2)
    buffer_load_dwordx4 v[160:163], v1, s[4:7], s75 offen offset:0 sc1
    v_exp_f32 v50, v50
    v_exp_f32 v51, v51
    v_exp_f32 v52, v52
    v_mfma_f32_32x32x16_bf16 v[32:47], v[100:103], v[20:23], 0
    v_exp_f32 v53, v53
    v_exp_f32 v54, v54
    v_exp_f32 v55, v55
    v_exp_f32 v56, v56
    v_exp_f32 v57, v57
    v_exp_f32 v58, v58
    v_smfmac_f32_32x32x32_bf16 v[80:95], v[104:107], v[48:55], v2
    s_waitcnt lgkmcnt(0)
    v_exp_f32 v59, v59
    v_exp_f32 v60, v60
    v_exp_f32 v61, v61
    v_exp_f32 v62, v62
    v_exp_f32 v63, v63
    v_exp_f32 v32, v32
    v_exp_f32 v33, v33
    v_smfmac_f32_32x32x32_bf16 v[80:95], v[112:115], v[56:63], v2
    ds_read_b128 v[96:99], v3 offset:4160
    v_exp_f32 v34, v34
    v_exp_f32 v35, v35
    v_exp_f32 v36, v36
    v_mfma_f32_32x32x16_bf16 v[48:63], v[100:103], v[24:27], 0
    ds_read_b128 v[104:107], v4 offset:4160
    v_exp_f32 v37, v37
    v_exp_f32 v38, v38
    v_exp_f32 v39, v39
    v_exp_f32 v40, v40
    v_exp_f32 v41, v41
    v_exp_f32 v42, v42
    v_smfmac_f32_32x32x32_bf16 v[64:79], v[108:111], v[32:39], v2
    ds_read_b128 v[112:115], v5 offset:4160
    v_exp_f32 v43, v43
    v_exp_f32 v44, v44
    v_exp_f32 v45, v45
    v_exp_f32 v46, v46
    v_exp_f32 v47, v47
    v_exp_f32 v48, v48
    v_exp_f32 v49, v49
    v_smfmac_f32_32x32x32_bf16 v[64:79], v[116:119], v[40:47], v2
    s_waitcnt lgkmcnt(2)
    buffer_load_dwordx4 v[164:167], v1, s[4:7], s75 offen offset:1024 sc1
    v_exp_f32 v50, v50
    v_exp_f32 v51, v51
    v_exp_f32 v52, v52
    v_mfma_f32_32x32x16_bf16 v[32:47], v[96:99], v[20:23], 0
    v_exp_f32 v53, v53
    v_exp_f32 v54, v54
    v_exp_f32 v55, v55
    v_exp_f32 v56, v56
    v_exp_f32 v57, v57
    v_exp_f32 v58, v58
    v_smfmac_f32_32x32x32_bf16 v[80:95], v[108:111], v[48:55], v2
    s_waitcnt lgkmcnt(0)
    v_exp_f32 v59, v59
    v_exp_f32 v60, v60
    v_exp_f32 v61, v61
    v_exp_f32 v62, v62
    v_exp_f32 v63, v63
    v_exp_f32 v32, v32
    v_exp_f32 v33, v33
    v_smfmac_f32_32x32x32_bf16 v[80:95], v[116:119], v[56:63], v2
    ds_read_b128 v[100:103], v3 offset:6240
    v_exp_f32 v34, v34
    v_exp_f32 v35, v35
    v_exp_f32 v36, v36
    v_mfma_f32_32x32x16_bf16 v[48:63], v[96:99], v[24:27], 0
    ds_read_b128 v[108:111], v4 offset:6240
    v_exp_f32 v37, v37
    v_exp_f32 v38, v38
    v_exp_f32 v39, v39
    v_exp_f32 v40, v40
    v_exp_f32 v41, v41
    v_exp_f32 v42, v42
    v_smfmac_f32_32x32x32_bf16 v[64:79], v[104:107], v[32:39], v2
    ds_read_b128 v[116:119], v5 offset:6240
    v_exp_f32 v43, v43
    v_exp_f32 v44, v44
    v_exp_f32 v45, v45
    v_exp_f32 v46, v46
    v_exp_f32 v47, v47
    v_exp_f32 v48, v48
    v_exp_f32 v49, v49
    v_smfmac_f32_32x32x32_bf16 v[64:79], v[112:115], v[40:47], v2
    s_waitcnt lgkmcnt(2)
    v_exp_f32 v50, v50
    v_exp_f32 v51, v51
    v_exp_f32 v52, v52
    v_mfma_f32_32x32x16_bf16 v[32:47], v[100:103], v[20:23], 0
    buffer_load_dwordx4 v[168:171], v1, s[4:7], s75 offen offset:2048 sc1
    s_add_u32 m0, s85, 0
    v_exp_f32 v53, v53
    v_exp_f32 v54, v54
    v_exp_f32 v55, v55
    v_exp_f32 v56, v56
    v_exp_f32 v57, v57
    v_exp_f32 v58, v58
    v_smfmac_f32_32x32x32_bf16 v[80:95], v[104:107], v[48:55], v2
    s_waitcnt vmcnt(6) lgkmcnt(0)
    s_barrier
    buffer_load_dwordx4 v126, s[4:7], s84 offen offset:0 sc1 lds
    v_exp_f32 v59, v59
    v_exp_f32 v60, v60
    v_exp_f32 v61, v61
    v_exp_f32 v62, v62
    v_exp_f32 v63, v63
    v_exp_f32 v32, v32
    v_exp_f32 v33, v33
    v_smfmac_f32_32x32x32_bf16 v[80:95], v[112:115], v[56:63], v2
    ds_read_b128 v[96:99], v3 offset:37760
    v_exp_f32 v34, v34
    v_exp_f32 v35, v35
    v_exp_f32 v36, v36
    v_mfma_f32_32x32x16_bf16 v[48:63], v[100:103], v[24:27], 0
    ds_read_b128 v[104:107], v4 offset:37760
    v_exp_f32 v37, v37
    v_exp_f32 v38, v38
    v_exp_f32 v39, v39
    v_exp_f32 v40, v40
    v_exp_f32 v41, v41
    v_exp_f32 v42, v42
    v_smfmac_f32_32x32x32_bf16 v[64:79], v[108:111], v[32:39], v2
    ds_read_b128 v[112:115], v5 offset:37760
    v_exp_f32 v43, v43
    v_exp_f32 v44, v44
    v_exp_f32 v45, v45
    v_exp_f32 v46, v46
    v_exp_f32 v47, v47
    v_exp_f32 v48, v48
    v_exp_f32 v49, v49
    v_smfmac_f32_32x32x32_bf16 v[64:79], v[116:119], v[40:47], v2
    s_waitcnt lgkmcnt(2)
    buffer_load_dwordx4 v126, s[4:7], s84 offen offset:1024 sc1 lds
    s_add_u32 m0, s85, 32
    v_exp_f32 v50, v50
    v_exp_f32 v51, v51
    v_exp_f32 v52, v52
    v_mfma_f32_32x32x16_bf16 v[32:47], v[96:99], v[20:23], 0
    buffer_load_dwordx4 v126, s[4:7], s84 offen offset:2048 sc1 lds
    v_exp_f32 v53, v53
    v_exp_f32 v54, v54
    v_exp_f32 v55, v55
    v_exp_f32 v56, v56
    v_exp_f32 v57, v57
    v_exp_f32 v58, v58
    v_smfmac_f32_32x32x32_bf16 v[80:95], v[108:111], v[48:55], v2
    s_waitcnt lgkmcnt(0)
    buffer_load_dwordx4 v126, s[4:7], s84 offen offset:3072 sc1 lds
    v_exp_f32 v59, v59
    v_exp_f32 v60, v60
    v_exp_f32 v61, v61
    v_exp_f32 v62, v62
    v_exp_f32 v63, v63
    v_exp_f32 v32, v32
    v_exp_f32 v33, v33
    v_smfmac_f32_32x32x32_bf16 v[80:95], v[116:119], v[56:63], v2
    ds_read_b128 v[100:103], v3 offset:39840
    s_add_u32 s84, s84, 0x4000
    s_and_b32 s84, s84, 0x1ffff
    v_exp_f32 v34, v34
    v_exp_f32 v35, v35
    v_exp_f32 v36, v36
    v_mfma_f32_32x32x16_bf16 v[48:63], v[96:99], v[24:27], 0
    ds_read_b128 v[108:111], v4 offset:39840
    v_exp_f32 v37, v37
    v_exp_f32 v38, v38
    v_exp_f32 v39, v39
    v_exp_f32 v40, v40
    v_exp_f32 v41, v41
    v_exp_f32 v42, v42
    v_smfmac_f32_32x32x32_bf16 v[64:79], v[104:107], v[32:39], v2
    ds_read_b128 v[116:119], v5 offset:39840
    v_exp_f32 v43, v43
    v_exp_f32 v44, v44
    v_exp_f32 v45, v45
    v_exp_f32 v46, v46
    v_exp_f32 v47, v47
    v_exp_f32 v48, v48
    v_exp_f32 v49, v49
    v_smfmac_f32_32x32x32_bf16 v[64:79], v[112:115], v[40:47], v2
    s_waitcnt lgkmcnt(2)
    v_exp_f32 v50, v50
    v_exp_f32 v51, v51
    v_exp_f32 v52, v52
    v_mfma_f32_32x32x16_bf16 v[32:47], v[100:103], v[20:23], 0
    v_exp_f32 v53, v53
    v_exp_f32 v54, v54
    v_exp_f32 v55, v55
    v_exp_f32 v56, v56
    v_exp_f32 v57, v57
    v_exp_f32 v58, v58
    v_smfmac_f32_32x32x32_bf16 v[80:95], v[104:107], v[48:55], v2
    s_waitcnt lgkmcnt(0)
    v_exp_f32 v59, v59
    v_exp_f32 v60, v60
    v_exp_f32 v61, v61
    v_exp_f32 v62, v62
    v_exp_f32 v63, v63
    v_exp_f32 v32, v32
    v_exp_f32 v33, v33
    v_smfmac_f32_32x32x32_bf16 v[80:95], v[112:115], v[56:63], v2
    ds_read_b128 v[96:99], v3 offset:41920
    v_exp_f32 v34, v34
    v_exp_f32 v35, v35
    v_exp_f32 v36, v36
    v_mfma_f32_32x32x16_bf16 v[48:63], v[100:103], v[24:27], 0
    ds_read_b128 v[104:107], v4 offset:41920
    v_exp_f32 v37, v37
    v_exp_f32 v38, v38
    v_exp_f32 v39, v39
    v_exp_f32 v40, v40
    v_exp_f32 v41, v41
    v_exp_f32 v42, v42
    v_smfmac_f32_32x32x32_bf16 v[64:79], v[108:111], v[32:39], v2
    ds_read_b128 v[112:115], v5 offset:41920
    v_exp_f32 v43, v43
    v_exp_f32 v44, v44
    v_exp_f32 v45, v45
    v_exp_f32 v46, v46
    v_exp_f32 v47, v47
    v_exp_f32 v48, v48
    v_exp_f32 v49, v49
    v_smfmac_f32_32x32x32_bf16 v[64:79], v[116:119], v[40:47], v2
    s_waitcnt lgkmcnt(2)
    buffer_load_dwordx4 v[172:175], v1, s[4:7], s75 offen offset:3072 sc1
    v_exp_f32 v50, v50
    v_exp_f32 v51, v51
    v_exp_f32 v52, v52
    v_mfma_f32_32x32x16_bf16 v[32:47], v[96:99], v[20:23], 0
    v_exp_f32 v53, v53
    v_exp_f32 v54, v54
    v_exp_f32 v55, v55
    v_exp_f32 v56, v56
    v_exp_f32 v57, v57
    v_exp_f32 v58, v58
    v_smfmac_f32_32x32x32_bf16 v[80:95], v[108:111], v[48:55], v2
    s_waitcnt lgkmcnt(0)
    v_exp_f32 v59, v59
    v_exp_f32 v60, v60
    v_exp_f32 v61, v61
    v_exp_f32 v62, v62
    v_exp_f32 v63, v63
    v_exp_f32 v32, v32
    v_exp_f32 v33, v33
    v_smfmac_f32_32x32x32_bf16 v[80:95], v[116:119], v[56:63], v2
    ds_read_b128 v[100:103], v3 offset:44000
    v_exp_f32 v34, v34
    v_exp_f32 v35, v35
    v_exp_f32 v36, v36
    v_mfma_f32_32x32x16_bf16 v[48:63], v[96:99], v[24:27], 0
    ds_read_b128 v[108:111], v4 offset:44000
    v_exp_f32 v37, v37
    v_exp_f32 v38, v38
    v_exp_f32 v39, v39
    v_exp_f32 v40, v40
    v_exp_f32 v41, v41
    v_exp_f32 v42, v42
    v_smfmac_f32_32x32x32_bf16 v[64:79], v[104:107], v[32:39], v2
    ds_read_b128 v[116:119], v5 offset:44000
    s_xor_b32 s75, s83, 12288
    v_exp_f32 v43, v43
    v_exp_f32 v44, v44
    v_exp_f32 v45, v45
    v_exp_f32 v46, v46
    v_exp_f32 v47, v47
    v_exp_f32 v48, v48
    v_exp_f32 v49, v49
    v_smfmac_f32_32x32x32_bf16 v[64:79], v[112:115], v[40:47], v2
    s_waitcnt lgkmcnt(2)
    buffer_load_dwordx4 v[176:179], v1, s[4:7], s75 offen offset:0 sc1
    v_exp_f32 v50, v50
    v_exp_f32 v51, v51
    v_exp_f32 v52, v52
    v_mfma_f32_32x32x16_bf16 v[32:47], v[100:103], v[20:23], 0
    v_exp_f32 v53, v53
    v_exp_f32 v54, v54
    v_exp_f32 v55, v55
    v_exp_f32 v56, v56
    v_exp_f32 v57, v57
    v_exp_f32 v58, v58
    v_smfmac_f32_32x32x32_bf16 v[80:95], v[104:107], v[48:55], v2
    s_waitcnt lgkmcnt(0)
    v_exp_f32 v59, v59
    v_exp_f32 v60, v60
    v_exp_f32 v61, v61
    v_exp_f32 v62, v62
    v_exp_f32 v63, v63
    v_exp_f32 v32, v32
    v_exp_f32 v33, v33
    v_smfmac_f32_32x32x32_bf16 v[80:95], v[112:115], v[56:63], v2
    ds_read_b128 v[96:99], v3 offset:29440
    v_exp_f32 v34, v34
    v_exp_f32 v35, v35
    v_exp_f32 v36, v36
    v_mfma_f32_32x32x16_bf16 v[48:63], v[100:103], v[24:27], 0
    ds_read_b128 v[104:107], v4 offset:29440
    v_exp_f32 v37, v37
    v_exp_f32 v38, v38
    v_exp_f32 v39, v39
    v_exp_f32 v40, v40
    v_exp_f32 v41, v41
    v_exp_f32 v42, v42
    v_smfmac_f32_32x32x32_bf16 v[64:79], v[108:111], v[32:39], v2
    ds_read_b128 v[112:115], v5 offset:29440
    v_exp_f32 v43, v43
    v_exp_f32 v44, v44
    v_exp_f32 v45, v45
    v_exp_f32 v46, v46
    v_exp_f32 v47, v47
    v_exp_f32 v48, v48
    v_exp_f32 v49, v49
    v_smfmac_f32_32x32x32_bf16 v[64:79], v[116:119], v[40:47], v2
    s_waitcnt lgkmcnt(2)
    v_exp_f32 v50, v50
    v_exp_f32 v51, v51
    v_exp_f32 v52, v52
    v_mfma_f32_32x32x16_bf16 v[32:47], v[96:99], v[20:23], 0
    buffer_load_dwordx4 v[180:183], v1, s[4:7], s75 offen offset:1024 sc1
    v_exp_f32 v53, v53
    v_exp_f32 v54, v54
    v_exp_f32 v55, v55
    v_exp_f32 v56, v56
    v_exp_f32 v57, v57
    v_exp_f32 v58, v58
    v_smfmac_f32_32x32x32_bf16 v[80:95], v[108:111], v[48:55], v2
    s_waitcnt lgkmcnt(0)
    v_exp_f32 v59, v59
    v_exp_f32 v60, v60
    v_exp_f32 v61, v61
    v_exp_f32 v62, v62
    v_exp_f32 v63, v63
    v_exp_f32 v32, v32
    v_exp_f32 v33, v33
    v_smfmac_f32_32x32x32_bf16 v[80:95], v[116:119], v[56:63], v2
    ds_read_b128 v[100:103], v3 offset:31520
    v_exp_f32 v34, v34
    v_exp_f32 v35, v35
    v_exp_f32 v36, v36
    v_mfma_f32_32x32x16_bf16 v[48:63], v[96:99], v[24:27], 0
    ds_read_b128 v[108:111], v4 offset:31520
    v_exp_f32 v37, v37
    v_exp_f32 v38, v38
    v_exp_f32 v39, v39
    v_exp_f32 v40, v40
    v_exp_f32 v41, v41
    v_exp_f32 v42, v42
    v_smfmac_f32_32x32x32_bf16 v[64:79], v[104:107], v[32:39], v2
    ds_read_b128 v[116:119], v5 offset:31520
    v_exp_f32 v43, v43
    v_exp_f32 v44, v44
    v_exp_f32 v45, v45
    v_exp_f32 v46, v46
    v_exp_f32 v47, v47
    v_exp_f32 v48, v48
    v_exp_f32 v49, v49
    v_smfmac_f32_32x32x32_bf16 v[64:79], v[112:115], v[40:47], v2
    s_waitcnt lgkmcnt(2)
    v_exp_f32 v50, v50
    v_exp_f32 v51, v51
    v_exp_f32 v52, v52
    v_mfma_f32_32x32x16_bf16 v[32:47], v[100:103], v[20:23], 0
    buffer_load_dwordx4 v[184:187], v1, s[4:7], s75 offen offset:2048 sc1
    v_exp_f32 v53, v53
    v_exp_f32 v54, v54
    v_exp_f32 v55, v55
    v_exp_f32 v56, v56
    v_exp_f32 v57, v57
    v_exp_f32 v58, v58
    v_smfmac_f32_32x32x32_bf16 v[80:95], v[104:107], v[48:55], v2
    s_waitcnt lgkmcnt(0)
TCH10:
    s_cbranch_execz TCH14
    v_exp_f32 v59, v59
    v_exp_f32 v60, v60
    v_exp_f32 v61, v61
    v_exp_f32 v62, v62
    v_exp_f32 v63, v63
    v_exp_f32 v32, v32
    v_exp_f32 v33, v33
    v_smfmac_f32_32x32x32_bf16 v[80:95], v[112:115], v[56:63], v2
    ds_read_b128 v[96:99], v3 offset:33600
    v_exp_f32 v34, v34
    v_exp_f32 v35, v35
    v_exp_f32 v36, v36
    v_mfma_f32_32x32x16_bf16 v[48:63], v[100:103], v[24:27], 0
    ds_read_b128 v[104:107], v4 offset:33600
    v_exp_f32 v37, v37
    v_exp_f32 v38, v38
    v_exp_f32 v39, v39
    v_exp_f32 v40, v40
    v_exp_f32 v41, v41
    v_exp_f32 v42, v42
    v_smfmac_f32_32x32x32_bf16 v[64:79], v[108:111], v[32:39], v2
    ds_read_b128 v[112:115], v5 offset:33600
    v_exp_f32 v43, v43
    v_exp_f32 v44, v44
    v_exp_f32 v45, v45
    v_exp_f32 v46, v46
    v_exp_f32 v47, v47
    v_exp_f32 v48, v48
    v_exp_f32 v49, v49
    v_smfmac_f32_32x32x32_bf16 v[64:79], v[116:119], v[40:47], v2
    s_waitcnt lgkmcnt(2)
    v_exp_f32 v50, v50
    v_exp_f32 v51, v51
    v_exp_f32 v52, v52
    v_mfma_f32_32x32x16_bf16 v[32:47], v[96:99], v[20:23], 0
    v_exp_f32 v53, v53
    v_exp_f32 v54, v54
    v_exp_f32 v55, v55
    v_exp_f32 v56, v56
    v_exp_f32 v57, v57
    v_exp_f32 v58, v58
    v_smfmac_f32_32x32x32_bf16 v[80:95], v[108:111], v[48:55], v2
    s_waitcnt lgkmcnt(0)
    buffer_load_dwordx4 v[188:191], v1, s[4:7], s75 offen offset:3072 sc1
    v_exp_f32 v59, v59
    v_exp_f32 v60, v60
    v_exp_f32 v61, v61
    v_exp_f32 v62, v62
    v_exp_f32 v63, v63
    v_exp_f32 v32, v32
    v_exp_f32 v33, v33
    v_smfmac_f32_32x32x32_bf16 v[80:95], v[116:119], v[56:63], v2
    ds_read_b128 v[100:103], v3 offset:35680
    v_exp_f32 v34, v34
    v_exp_f32 v35, v35
    v_exp_f32 v36, v36
    v_mfma_f32_32x32x16_bf16 v[48:63], v[96:99], v[24:27], 0
    ds_read_b128 v[108:111], v4 offset:35680
    v_exp_f32 v37, v37
    v_exp_f32 v38, v38
    v_exp_f32 v39, v39
    v_exp_f32 v40, v40
    v_exp_f32 v41, v41
    v_exp_f32 v42, v42
    v_smfmac_f32_32x32x32_bf16 v[64:79], v[104:107], v[32:39], v2
    ds_read_b128 v[116:119], v5 offset:35680
    v_exp_f32 v43, v43
    v_exp_f32 v44, v44
    v_exp_f32 v45, v45
    v_exp_f32 v46, v46
    v_exp_f32 v47, v47
    v_exp_f32 v48, v48
    v_exp_f32 v49, v49
    v_smfmac_f32_32x32x32_bf16 v[64:79], v[112:115], v[40:47], v2
    s_waitcnt lgkmcnt(2)
    v_exp_f32 v50, v50
    v_exp_f32 v51, v51
    v_exp_f32 v52, v52
    v_mfma_f32_32x32x16_bf16 v[32:47], v[100:103], v[20:23], 0
    s_add_u32 m0, s85, 29440
    v_exp_f32 v53, v53
    v_exp_f32 v54, v54
    v_exp_f32 v55, v55
    v_exp_f32 v56, v56
    v_exp_f32 v57, v57
    v_exp_f32 v58, v58
    v_smfmac_f32_32x32x32_bf16 v[80:95], v[104:107], v[48:55], v2
    s_waitcnt vmcnt(5) lgkmcnt(0)
    s_barrier
    buffer_load_dwordx4 v126, s[4:7], s84 offen offset:0 sc1 lds
    v_exp_f32 v59, v59
    v_exp_f32 v60, v60
    v_exp_f32 v61, v61
    v_exp_f32 v62, v62
    v_exp_f32 v63, v63
    v_exp_f32 v32, v32
    v_exp_f32 v33, v33
    v_smfmac_f32_32x32x32_bf16 v[80:95], v[112:115], v[56:63], v2
    ds_read_b128 v[96:99], v3 offset:8320
    v_exp_f32 v34, v34
    v_exp_f32 v35, v35
    v_exp_f32 v36, v36
    v_mfma_f32_32x32x16_bf16 v[48:63], v[100:103], v[24:27], 0
    ds_read_b128 v[104:107], v4 offset:8320
    v_exp_f32 v37, v37
    v_exp_f32 v38, v38
    v_exp_f32 v39, v39
    v_exp_f32 v40, v40
    v_exp_f32 v41, v41
    v_exp_f32 v42, v42
    v_smfmac_f32_32x32x32_bf16 v[64:79], v[108:111], v[32:39], v2
    ds_read_b128 v[112:115], v5 offset:8320
    v_exp_f32 v43, v43
    v_exp_f32 v44, v44
    v_exp_f32 v45, v45
    v_exp_f32 v46, v46
    v_exp_f32 v47, v47
    v_exp_f32 v48, v48
    v_exp_f32 v49, v49
    v_smfmac_f32_32x32x32_bf16 v[64:79], v[116:119], v[40:47], v2
    s_waitcnt lgkmcnt(2)
    buffer_load_dwordx4 v126, s[4:7], s84 offen offset:1024 sc1 lds
    s_add_u32 m0, s85, 29472
    v_exp_f32 v50, v50
    v_exp_f32 v51, v51
    v_exp_f32 v52, v52
    v_mfma_f32_32x32x16_bf16 v[32:47], v[96:99], v[20:23], 0
    buffer_load_dwordx4 v126, s[4:7], s84 offen offset:2048 sc1 lds
    v_exp_f32 v53, v53
    v_exp_f32 v54, v54
    v_exp_f32 v55, v55
    v_exp_f32 v56, v56
    v_exp_f32 v57, v57
    v_exp_f32 v58, v58
    v_smfmac_f32_32x32x32_bf16 v[80:95], v[108:111], v[48:55], v2
    s_waitcnt lgkmcnt(0)
    buffer_load_dwordx4 v126, s[4:7], s84 offen offset:3072 sc1 lds
    v_exp_f32 v59, v59
    v_exp_f32 v60, v60
    v_exp_f32 v61, v61
    v_exp_f32 v62, v62
    v_exp_f32 v63, v63
    v_exp_f32 v32, v32
    v_exp_f32 v33, v33
    v_smfmac_f32_32x32x32_bf16 v[80:95], v[116:119], v[56:63], v2
    ds_read_b128 v[100:103], v3 offset:10400
    s_add_u32 s84, s84, 0x4000
    s_and_b32 s84, s84, 0x1ffff
    v_exp_f32 v34, v34
    v_exp_f32 v35, v35
    v_exp_f32 v36, v36
    v_mfma_f32_32x32x16_bf16 v[48:63], v[96:99], v[24:27], 0
    ds_read_b128 v[108:111], v4 offset:10400
    v_exp_f32 v37, v37
    v_exp_f32 v38, v38
    v_exp_f32 v39, v39
    v_exp_f32 v40, v40
    v_exp_f32 v41, v41
    v_exp_f32 v42, v42
    v_smfmac_f32_32x32x32_bf16 v[64:79], v[104:107], v[32:39], v2
    ds_read_b128 v[116:119], v5 offset:10400
    v_exp_f32 v43, v43
    v_exp_f32 v44, v44
    v_exp_f32 v45, v45
    v_exp_f32 v46, v46
    v_exp_f32 v47, v47
    v_exp_f32 v48, v48
    v_exp_f32 v49, v49
    v_smfmac_f32_32x32x32_bf16 v[64:79], v[112:115], v[40:47], v2
    s_waitcnt lgkmcnt(2)
    s_xor_b32 s75, s83, 16384
    v_exp_f32 v50, v50
    v_exp_f32 v51, v51
    v_exp_f32 v52, v52
    v_mfma_f32_32x32x16_bf16 v[32:47], v[100:103], v[20:23], 0
    buffer_load_dwordx4 v[192:195], v1, s[4:7], s75 offen offset:0 sc1
    v_exp_f32 v53, v53
    v_exp_f32 v54, v54
    v_exp_f32 v55, v55
    v_exp_f32 v56, v56
    v_exp_f32 v57, v57
    v_exp_f32 v58, v58
    v_smfmac_f32_32x32x32_bf16 v[80:95], v[104:107], v[48:55], v2
    s_waitcnt lgkmcnt(0)
    v_exp_f32 v59, v59
    v_exp_f32 v60, v60
    v_exp_f32 v61, v61
    v_exp_f32 v62, v62
    v_exp_f32 v63, v63
    v_exp_f32 v32, v32
    v_exp_f32 v33, v33
    v_smfmac_f32_32x32x32_bf16 v[80:95], v[112:115], v[56:63], v2
    ds_read_b128 v[96:99], v3 offset:12480
    v_exp_f32 v34, v34
    v_exp_f32 v35, v35
    v_exp_f32 v36, v36
    v_mfma_f32_32x32x16_bf16 v[48:63], v[100:103], v[24:27], 0
    ds_read_b128 v[104:107], v4 offset:12480
    v_exp_f32 v37, v37
    v_exp_f32 v38, v38
    v_exp_f32 v39, v39
    v_exp_f32 v40, v40
    v_exp_f32 v41, v41
    v_exp_f32 v42, v42
    v_smfmac_f32_32x32x32_bf16 v[64:79], v[108:111], v[32:39], v2
    ds_read_b128 v[112:115], v5 offset:12480
    v_exp_f32 v43, v43
    v_exp_f32 v44, v44
    v_exp_f32 v45, v45
    v_exp_f32 v46, v46
    v_exp_f32 v47, v47
    v_exp_f32 v48, v48
    v_exp_f32 v49, v49
    v_smfmac_f32_32x32x32_bf16 v[64:79], v[116:119], v[40:47], v2
    s_waitcnt lgkmcnt(2)
    v_exp_f32 v50, v50
    v_exp_f32 v51, v51
    v_exp_f32 v52, v52
    v_mfma_f32_32x32x16_bf16 v[32:47], v[96:99], v[20:23], 0
    buffer_load_dwordx4 v[196:199], v1, s[4:7], s75 offen offset:1024 sc1
    v_exp_f32 v53, v53
    v_exp_f32 v54, v54
    v_exp_f32 v55, v55
    v_exp_f32 v56, v56
    v_exp_f32 v57, v57
    v_exp_f32 v58, v58
    v_smfmac_f32_32x32x32_bf16 v[80:95], v[108:111], v[48:55], v2
    s_waitcnt lgkmcnt(0)
    v_exp_f32 v59, v59
    v_exp_f32 v60, v60
    v_exp_f32 v61, v61
    v_exp_f32 v62, v62
    v_exp_f32 v63, v63
    v_exp_f32 v32, v32
    v_exp_f32 v33, v33
    v_smfmac_f32_32x32x32_bf16 v[80:95], v[116:119], v[56:63], v2
    ds_read_b128 v[100:103], v3 offset:14560
    v_exp_f32 v34, v34
    v_exp_f32 v35, v35
    v_exp_f32 v36, v36
    v_mfma_f32_32x32x16_bf16 v[48:63], v[96:99], v[24:27], 0
    ds_read_b128 v[108:111], v4 offset:14560
    v_exp_f32 v37, v37
    v_exp_f32 v38, v38
    v_exp_f32 v39, v39
    v_exp_f32 v40, v40
    v_exp_f32 v41, v41
    v_exp_f32 v42, v42
    v_smfmac_f32_32x32x32_bf16 v[64:79], v[104:107], v[32:39], v2
    ds_read_b128 v[116:119], v5 offset:14560
    v_exp_f32 v43, v43
    v_exp_f32 v44, v44
    v_exp_f32 v45, v45
    v_exp_f32 v46, v46
    v_exp_f32 v47, v47
    v_exp_f32 v48, v48
    v_exp_f32 v49, v49
    v_smfmac_f32_32x32x32_bf16 v[64:79], v[112:115], v[40:47], v2
    s_waitcnt lgkmcnt(2)
    v_exp_f32 v50, v50
    v_exp_f32 v51, v51
    v_exp_f32 v52, v52
    v_mfma_f32_32x32x16_bf16 v[32:47], v[100:103], v[20:23], 0
    v_exp_f32 v53, v53
    v_exp_f32 v54, v54
    v_exp_f32 v55, v55
    v_exp_f32 v56, v56
    v_exp_f32 v57, v57
    v_exp_f32 v58, v58
    v_smfmac_f32_32x32x32_bf16 v[80:95], v[104:107], v[48:55], v2
    s_waitcnt lgkmcnt(0)
    buffer_load_dwordx4 v[200:203], v1, s[4:7], s75 offen offset:2048 sc1
    v_exp_f32 v59, v59
    v_exp_f32 v60, v60
    v_exp_f32 v61, v61
    v_exp_f32 v62, v62
    v_exp_f32 v63, v63
    v_exp_f32 v32, v32
    v_exp_f32 v33, v33
    v_smfmac_f32_32x32x32_bf16 v[80:95], v[112:115], v[56:63], v2
    ds_read_b128 v[96:99], v3 offset:0
    v_exp_f32 v34, v34
    v_exp_f32 v35, v35
    v_exp_f32 v36, v36
    v_mfma_f32_32x32x16_bf16 v[48:63], v[100:103], v[24:27], 0
    ds_read_b128 v[104:107], v4 offset:0
    v_exp_f32 v37, v37
    v_exp_f32 v38, v38
    v_exp_f32 v39, v39
    v_exp_f32 v40, v40
    v_exp_f32 v41, v41
    v_exp_f32 v42, v42
    v_smfmac_f32_32x32x32_bf16 v[64:79], v[108:111], v[32:39], v2
    ds_read_b128 v[112:115], v5 offset:0
    v_exp_f32 v43, v43
    v_exp_f32 v44, v44
    v_exp_f32 v45, v45
    v_exp_f32 v46, v46
    v_exp_f32 v47, v47
    v_exp_f32 v48, v48
    v_exp_f32 v49, v49
    v_smfmac_f32_32x32x32_bf16 v[64:79], v[116:119], v[40:47], v2
    s_waitcnt lgkmcnt(2)
    v_exp_f32 v50, v50
    v_exp_f32 v51, v51
    v_exp_f32 v52, v52
    v_mfma_f32_32x32x16_bf16 v[32:47], v[96:99], v[20:23], 0
    v_exp_f32 v53, v53
    v_exp_f32 v54, v54
    v_exp_f32 v55, v55
    v_exp_f32 v56, v56
    v_exp_f32 v57, v57
    v_exp_f32 v58, v58
    v_smfmac_f32_32x32x32_bf16 v[80:95], v[108:111], v[48:55], v2
    s_waitcnt lgkmcnt(0)
    buffer_load_dwordx4 v[204:207], v1, s[4:7], s75 offen offset:3072 sc1
    v_exp_f32 v59, v59
    v_exp_f32 v60, v60
    v_exp_f32 v61, v61
    v_exp_f32 v62, v62
    v_exp_f32 v63, v63
    v_exp_f32 v32, v32
    v_exp_f32 v33, v33
    v_smfmac_f32_32x32x32_bf16 v[80:95], v[116:119], v[56:63], v2
    ds_read_b128 v[100:103], v3 offset:2080
    v_exp_f32 v34, v34
    v_exp_f32 v35, v35
    v_exp_f32 v36, v36
    v_mfma_f32_32x32x16_bf16 v[48:63], v[96:99], v[24:27], 0
    ds_read_b128 v[108:111], v4 offset:2080
    v_exp_f32 v37, v37
    v_exp_f32 v38, v38
    v_exp_f32 v39, v39
    v_exp_f32 v40, v40
    v_exp_f32 v41, v41
    v_exp_f32 v42, v42
    v_smfmac_f32_32x32x32_bf16 v[64:79], v[104:107], v[32:39], v2
    ds_read_b128 v[116:119], v5 offset:2080
    v_exp_f32 v43, v43
    v_exp_f32 v44, v44
    v_exp_f32 v45, v45
    v_exp_f32 v46, v46
    v_exp_f32 v47, v47
    v_exp_f32 v48, v48
    v_exp_f32 v49, v49
    v_smfmac_f32_32x32x32_bf16 v[64:79], v[112:115], v[40:47], v2
    s_waitcnt lgkmcnt(2)
    v_exp_f32 v50, v50
    v_exp_f32 v51, v51
    v_exp_f32 v52, v52
    v_mfma_f32_32x32x16_bf16 v[32:47], v[100:103], v[20:23], 0
    v_exp_f32 v53, v53
    v_exp_f32 v54, v54
    v_exp_f32 v55, v55
    v_exp_f32 v56, v56
    v_exp_f32 v57, v57
    v_exp_f32 v58, v58
    v_smfmac_f32_32x32x32_bf16 v[80:95], v[104:107], v[48:55], v2
    s_waitcnt lgkmcnt(0)
    v_exp_f32 v59, v59
    v_exp_f32 v60, v60
    v_exp_f32 v61, v61
    v_exp_f32 v62, v62
    v_exp_f32 v63, v63
    v_exp_f32 v32, v32
    v_exp_f32 v33, v33
    v_smfmac_f32_32x32x32_bf16 v[80:95], v[112:115], v[56:63], v2
    ds_read_b128 v[96:99], v3 offset:4160
    v_exp_f32 v34, v34
    v_exp_f32 v35, v35
    v_exp_f32 v36, v36
    v_mfma_f32_32x32x16_bf16 v[48:63], v[100:103], v[24:27], 0
    ds_read_b128 v[104:107], v4 offset:4160
    v_exp_f32 v37, v37
    v_exp_f32 v38, v38
    v_exp_f32 v39, v39
    v_exp_f32 v40, v40
    v_exp_f32 v41, v41
    v_exp_f32 v42, v42
    v_smfmac_f32_32x32x32_bf16 v[64:79], v[108:111], v[32:39], v2
    ds_read_b128 v[112:115], v5 offset:4160
    s_xor_b32 s75, s83, 20480
    v_exp_f32 v43, v43
    v_exp_f32 v44, v44
    v_exp_f32 v45, v45
    v_exp_f32 v46, v46
    v_exp_f32 v47, v47
    v_exp_f32 v48, v48
    v_exp_f32 v49, v49
    v_smfmac_f32_32x32x32_bf16 v[64:79], v[116:119], v[40:47], v2
    s_waitcnt lgkmcnt(2)
    buffer_load_dwordx4 v[208:211], v1, s[4:7], s75 offen offset:0 sc1
    v_exp_f32 v50, v50
    v_exp_f32 v51, v51
    v_exp_f32 v52, v52
    v_mfma_f32_32x32x16_bf16 v[32:47], v[96:99], v[20:23], 0
    v_exp_f32 v53, v53
    v_exp_f32 v54, v54
    v_exp_f32 v55, v55
    v_exp_f32 v56, v56
    v_exp_f32 v57, v57
    v_exp_f32 v58, v58
    v_smfmac_f32_32x32x32_bf16 v[80:95], v[108:111], v[48:55], v2
    s_waitcnt lgkmcnt(0)
    v_exp_f32 v59, v59
    v_exp_f32 v60, v60
    v_exp_f32 v61, v61
    v_exp_f32 v62, v62
    v_exp_f32 v63, v63
    v_exp_f32 v32, v32
    v_exp_f32 v33, v33
    v_smfmac_f32_32x32x32_bf16 v[80:95], v[116:119], v[56:63], v2
    ds_read_b128 v[100:103], v3 offset:6240
    v_exp_f32 v34, v34
    v_exp_f32 v35, v35
    v_exp_f32 v36, v36
    v_mfma_f32_32x32x16_bf16 v[48:63], v[96:99], v[24:27], 0
    ds_read_b128 v[108:111], v4 offset:6240
    v_exp_f32 v37, v37
    v_exp_f32 v38, v38
    v_exp_f32 v39, v39
    v_exp_f32 v40, v40
    v_exp_f32 v41, v41
    v_exp_f32 v42, v42
    v_smfmac_f32_32x32x32_bf16 v[64:79], v[104:107], v[32:39], v2
    ds_read_b128 v[116:119], v5 offset:6240
    v_exp_f32 v43, v43
    v_exp_f32 v44, v44
    v_exp_f32 v45, v45
    v_exp_f32 v46, v46
    v_exp_f32 v47, v47
    v_exp_f32 v48, v48
    v_exp_f32 v49, v49
    v_smfmac_f32_32x32x32_bf16 v[64:79], v[112:115], v[40:47], v2
    s_waitcnt lgkmcnt(2)
    v_exp_f32 v50, v50
    v_exp_f32 v51, v51
    v_exp_f32 v52, v52
    v_mfma_f32_32x32x16_bf16 v[32:47], v[100:103], v[20:23], 0
    buffer_load_dwordx4 v[212:215], v1, s[4:7], s75 offen offset:1024 sc1
    s_add_u32 m0, s85, 0
    v_exp_f32 v53, v53
    v_exp_f32 v54, v54
    v_exp_f32 v55, v55
    v_exp_f32 v56, v56
    v_exp_f32 v57, v57
    v_exp_f32 v58, v58
    v_smfmac_f32_32x32x32_bf16 v[80:95], v[104:107], v[48:55], v2
    s_waitcnt vmcnt(6) lgkmcnt(0)
    s_barrier
    buffer_load_dwordx4 v126, s[4:7], s84 offen offset:0 sc1 lds
    v_exp_f32 v59, v59
    v_exp_f32 v60, v60
    v_exp_f32 v61, v61
    v_exp_f32 v62, v62
    v_exp_f32 v63, v63
    v_exp_f32 v32, v32
    v_exp_f32 v33, v33
    v_smfmac_f32_32x32x32_bf16 v[80:95], v[112:115], v[56:63], v2
    ds_read_b128 v[96:99], v3 offset:37760
    v_exp_f32 v34, v34
    v_exp_f32 v35, v35
    v_exp_f32 v36, v36
    v_mfma_f32_32x32x16_bf16 v[48:63], v[100:103], v[24:27], 0
    ds_read_b128 v[104:107], v4 offset:37760
    v_exp_f32 v37, v37
    v_exp_f32 v38, v38
    v_exp_f32 v39, v39
    v_exp_f32 v40, v40
    v_exp_f32 v41, v41
    v_exp_f32 v42, v42
    v_smfmac_f32_32x32x32_bf16 v[64:79], v[108:111], v[32:39], v2
    ds_read_b128 v[112:115], v5 offset:37760
    v_exp_f32 v43, v43
    v_exp_f32 v44, v44
    v_exp_f32 v45, v45
    v_exp_f32 v46, v46
    v_exp_f32 v47, v47
    v_exp_f32 v48, v48
    v_exp_f32 v49, v49
    v_smfmac_f32_32x32x32_bf16 v[64:79], v[116:119], v[40:47], v2
    s_waitcnt lgkmcnt(2)
    buffer_load_dwordx4 v126, s[4:7], s84 offen offset:1024 sc1 lds
    s_add_u32 m0, s85, 32
    v_exp_f32 v50, v50
    v_exp_f32 v51, v51
    v_exp_f32 v52, v52
    v_mfma_f32_32x32x16_bf16 v[32:47], v[96:99], v[20:23], 0
    buffer_load_dwordx4 v126, s[4:7], s84 offen offset:2048 sc1 lds
    v_exp_f32 v53, v53
    v_exp_f32 v54, v54
    v_exp_f32 v55, v55
    v_exp_f32 v56, v56
    v_exp_f32 v57, v57
    v_exp_f32 v58, v58
    v_smfmac_f32_32x32x32_bf16 v[80:95], v[108:111], v[48:55], v2
    s_waitcnt lgkmcnt(0)
    buffer_load_dwordx4 v126, s[4:7], s84 offen offset:3072 sc1 lds
    v_exp_f32 v59, v59
    v_exp_f32 v60, v60
    v_exp_f32 v61, v61
    v_exp_f32 v62, v62
    v_exp_f32 v63, v63
    v_exp_f32 v32, v32
    v_exp_f32 v33, v33
    v_smfmac_f32_32x32x32_bf16 v[80:95], v[116:119], v[56:63], v2
    ds_read_b128 v[100:103], v3 offset:39840
    s_add_u32 s84, s84, 0x4000
    s_and_b32 s84, s84, 0x1ffff
    v_exp_f32 v34, v34
    v_exp_f32 v35, v35
    v_exp_f32 v36, v36
    v_mfma_f32_32x32x16_bf16 v[48:63], v[96:99], v[24:27], 0
    ds_read_b128 v[108:111], v4 offset:39840
    v_exp_f32 v37, v37
    v_exp_f32 v38, v38
    v_exp_f32 v39, v39
    v_exp_f32 v40, v40
    v_exp_f32 v41, v41
    v_exp_f32 v42, v42
    v_smfmac_f32_32x32x32_bf16 v[64:79], v[104:107], v[32:39], v2
    ds_read_b128 v[116:119], v5 offset:39840
    v_exp_f32 v43, v43
    v_exp_f32 v44, v44
    v_exp_f32 v45, v45
    v_exp_f32 v46, v46
    v_exp_f32 v47, v47
    v_exp_f32 v48, v48
    v_exp_f32 v49, v49
    v_smfmac_f32_32x32x32_bf16 v[64:79], v[112:115], v[40:47], v2
    s_waitcnt lgkmcnt(2)
    v_exp_f32 v50, v50
    v_exp_f32 v51, v51
    v_exp_f32 v52, v52
    v_mfma_f32_32x32x16_bf16 v[32:47], v[100:103], v[20:23], 0
    v_exp_f32 v53, v53
    v_exp_f32 v54, v54
    v_exp_f32 v55, v55
    v_exp_f32 v56, v56
    v_exp_f32 v57, v57
    v_exp_f32 v58, v58
    v_smfmac_f32_32x32x32_bf16 v[80:95], v[104:107], v[48:55], v2
    s_waitcnt lgkmcnt(0)
    buffer_load_dwordx4 v[216:219], v1, s[4:7], s75 offen offset:2048 sc1
    v_exp_f32 v59, v59
    v_exp_f32 v60, v60
    v_exp_f32 v61, v61
    v_exp_f32 v62, v62
    v_exp_f32 v63, v63
    v_exp_f32 v32, v32
    v_exp_f32 v33, v33
    v_smfmac_f32_32x32x32_bf16 v[80:95], v[112:115], v[56:63], v2
    ds_read_b128 v[96:99], v3 offset:41920
    v_exp_f32 v34, v34
    v_exp_f32 v35, v35
    v_exp_f32 v36, v36
    v_mfma_f32_32x32x16_bf16 v[48:63], v[100:103], v[24:27], 0
    ds_read_b128 v[104:107], v4 offset:41920
    v_exp_f32 v37, v37
    v_exp_f32 v38, v38
    v_exp_f32 v39, v39
    v_exp_f32 v40, v40
    v_exp_f32 v41, v41
    v_exp_f32 v42, v42
    v_smfmac_f32_32x32x32_bf16 v[64:79], v[108:111], v[32:39], v2
    ds_read_b128 v[112:115], v5 offset:41920
    v_exp_f32 v43, v43
    v_exp_f32 v44, v44
    v_exp_f32 v45, v45
    v_exp_f32 v46, v46
    v_exp_f32 v47, v47
    v_exp_f32 v48, v48
    v_exp_f32 v49, v49
    v_smfmac_f32_32x32x32_bf16 v[64:79], v[116:119], v[40:47], v2
    s_waitcnt lgkmcnt(2)
    v_exp_f32 v50, v50
    v_exp_f32 v51, v51
    v_exp_f32 v52, v52
    v_mfma_f32_32x32x16_bf16 v[32:47], v[96:99], v[20:23], 0
    v_exp_f32 v53, v53
    v_exp_f32 v54, v54
    v_exp_f32 v55, v55
    v_exp_f32 v56, v56
    v_exp_f32 v57, v57
    v_exp_f32 v58, v58
    v_smfmac_f32_32x32x32_bf16 v[80:95], v[108:111], v[48:55], v2
    s_waitcnt lgkmcnt(0)
    v_exp_f32 v59, v59
    v_exp_f32 v60, v60
    v_exp_f32 v61, v61
    v_exp_f32 v62, v62
    v_exp_f32 v63, v63
    v_exp_f32 v32, v32
    v_exp_f32 v33, v33
    v_smfmac_f32_32x32x32_bf16 v[80:95], v[116:119], v[56:63], v2
    ds_read_b128 v[100:103], v3 offset:44000
    v_exp_f32 v34, v34
    v_exp_f32 v35, v35
    v_exp_f32 v36, v36
    v_mfma_f32_32x32x16_bf16 v[48:63], v[96:99], v[24:27], 0
    ds_read_b128 v[108:111], v4 offset:44000
    v_exp_f32 v37, v37
    v_exp_f32 v38, v38
    v_exp_f32 v39, v39
    v_exp_f32 v40, v40
    v_exp_f32 v41, v41
    v_exp_f32 v42, v42
    v_smfmac_f32_32x32x32_bf16 v[64:79], v[104:107], v[32:39], v2
    ds_read_b128 v[116:119], v5 offset:44000
    v_exp_f32 v43, v43
    v_exp_f32 v44, v44
    v_exp_f32 v45, v45
    v_exp_f32 v46, v46
    v_exp_f32 v47, v47
    v_exp_f32 v48, v48
    v_exp_f32 v49, v49
    v_smfmac_f32_32x32x32_bf16 v[64:79], v[112:115], v[40:47], v2
    s_waitcnt lgkmcnt(2)
    buffer_load_dwordx4 v[220:223], v1, s[4:7], s75 offen offset:3072 sc1
    v_exp_f32 v50, v50
    v_exp_f32 v51, v51
    v_exp_f32 v52, v52
    v_mfma_f32_32x32x16_bf16 v[32:47], v[100:103], v[20:23], 0
    v_exp_f32 v53, v53
    v_exp_f32 v54, v54
    v_exp_f32 v55, v55
    v_exp_f32 v56, v56
    v_exp_f32 v57, v57
    v_exp_f32 v58, v58
    v_smfmac_f32_32x32x32_bf16 v[80:95], v[104:107], v[48:55], v2
    s_waitcnt lgkmcnt(0)
    v_exp_f32 v59, v59
    v_exp_f32 v60, v60
    v_exp_f32 v61, v61
    v_exp_f32 v62, v62
    v_exp_f32 v63, v63
    v_exp_f32 v32, v32
    v_exp_f32 v33, v33
    v_smfmac_f32_32x32x32_bf16 v[80:95], v[112:115], v[56:63], v2
    ds_read_b128 v[96:99], v3 offset:29440
    v_exp_f32 v34, v34
    v_exp_f32 v35, v35
    v_exp_f32 v36, v36
    v_mfma_f32_32x32x16_bf16 v[48:63], v[100:103], v[24:27], 0
    ds_read_b128 v[104:107], v4 offset:29440
    v_exp_f32 v37, v37
    v_exp_f32 v38, v38
    v_exp_f32 v39, v39
    v_exp_f32 v40, v40
    v_exp_f32 v41, v41
    v_exp_f32 v42, v42
    v_smfmac_f32_32x32x32_bf16 v[64:79], v[108:111], v[32:39], v2
    ds_read_b128 v[112:115], v5 offset:29440
    s_xor_b32 s75, s83, 24576
    v_exp_f32 v43, v43
    v_exp_f32 v44, v44
    v_exp_f32 v45, v45
    v_exp_f32 v46, v46
    v_exp_f32 v47, v47
    v_exp_f32 v48, v48
    v_exp_f32 v49, v49
    v_smfmac_f32_32x32x32_bf16 v[64:79], v[116:119], v[40:47], v2
    s_waitcnt lgkmcnt(2)
    buffer_load_dwordx4 v[224:227], v1, s[4:7], s75 offen offset:0 sc1
    v_exp_f32 v50, v50
    v_exp_f32 v51, v51
    v_exp_f32 v52, v52
    v_mfma_f32_32x32x16_bf16 v[32:47], v[96:99], v[20:23], 0
    v_exp_f32 v53, v53
    v_exp_f32 v54, v54
    v_exp_f32 v55, v55
    v_exp_f32 v56, v56
    v_exp_f32 v57, v57
    v_exp_f32 v58, v58
    v_smfmac_f32_32x32x32_bf16 v[80:95], v[108:111], v[48:55], v2
    s_waitcnt lgkmcnt(0)
    v_exp_f32 v59, v59
    v_exp_f32 v60, v60
    v_exp_f32 v61, v61
    v_exp_f32 v62, v62
    v_exp_f32 v63, v63
    v_exp_f32 v32, v32
    v_exp_f32 v33, v33
    v_smfmac_f32_32x32x32_bf16 v[80:95], v[116:119], v[56:63], v2
    ds_read_b128 v[100:103], v3 offset:31520
    v_exp_f32 v34, v34
    v_exp_f32 v35, v35
    v_exp_f32 v36, v36
    v_mfma_f32_32x32x16_bf16 v[48:63], v[96:99], v[24:27], 0
    ds_read_b128 v[108:111], v4 offset:31520
    v_exp_f32 v37, v37
    v_exp_f32 v38, v38
    v_exp_f32 v39, v39
    v_exp_f32 v40, v40
    v_exp_f32 v41, v41
    v_exp_f32 v42, v42
    v_smfmac_f32_32x32x32_bf16 v[64:79], v[104:107], v[32:39], v2
    ds_read_b128 v[116:119], v5 offset:31520
    v_exp_f32 v43, v43
    v_exp_f32 v44, v44
    v_exp_f32 v45, v45
    v_exp_f32 v46, v46
    v_exp_f32 v47, v47
    v_exp_f32 v48, v48
    v_exp_f32 v49, v49
    v_smfmac_f32_32x32x32_bf16 v[64:79], v[112:115], v[40:47], v2
    s_waitcnt lgkmcnt(2)
    v_exp_f32 v50, v50
    v_exp_f32 v51, v51
    v_exp_f32 v52, v52
    v_mfma_f32_32x32x16_bf16 v[32:47], v[100:103], v[20:23], 0
    buffer_load_dwordx4 v[228:231], v1, s[4:7], s75 offen offset:1024 sc1
    v_exp_f32 v53, v53
    v_exp_f32 v54, v54
    v_exp_f32 v55, v55
    v_exp_f32 v56, v56
    v_exp_f32 v57, v57
    v_exp_f32 v58, v58
    v_smfmac_f32_32x32x32_bf16 v[80:95], v[104:107], v[48:55], v2
    s_waitcnt lgkmcnt(0)
    v_exp_f32 v59, v59
    v_exp_f32 v60, v60
    v_exp_f32 v61, v61
    v_exp_f32 v62, v62
    v_exp_f32 v63, v63
    v_exp_f32 v32, v32
    v_exp_f32 v33, v33
    v_smfmac_f32_32x32x32_bf16 v[80:95], v[112:115], v[56:63], v2
    ds_read_b128 v[96:99], v3 offset:33600
    v_exp_f32 v34, v34
    v_exp_f32 v35, v35
    v_exp_f32 v36, v36
    v_mfma_f32_32x32x16_bf16 v[48:63], v[100:103], v[24:27], 0
    ds_read_b128 v[104:107], v4 offset:33600
    v_exp_f32 v37, v37
    v_exp_f32 v38, v38
    v_exp_f32 v39, v39
    v_exp_f32 v40, v40
    v_exp_f32 v41, v41
    v_exp_f32 v42, v42
    v_smfmac_f32_32x32x32_bf16 v[64:79], v[108:111], v[32:39], v2
    ds_read_b128 v[112:115], v5 offset:33600
    v_exp_f32 v43, v43
    v_exp_f32 v44, v44
    v_exp_f32 v45, v45
    v_exp_f32 v46, v46
    v_exp_f32 v47, v47
    v_exp_f32 v48, v48
    v_exp_f32 v49, v49
    v_smfmac_f32_32x32x32_bf16 v[64:79], v[116:119], v[40:47], v2
    s_waitcnt lgkmcnt(2)
    v_exp_f32 v50, v50
    v_exp_f32 v51, v51
    v_exp_f32 v52, v52
    v_mfma_f32_32x32x16_bf16 v[32:47], v[96:99], v[20:23], 0
    v_exp_f32 v53, v53
    v_exp_f32 v54, v54
    v_exp_f32 v55, v55
    v_exp_f32 v56, v56
    v_exp_f32 v57, v57
    v_exp_f32 v58, v58
    v_smfmac_f32_32x32x32_bf16 v[80:95], v[108:111], v[48:55], v2
    s_waitcnt lgkmcnt(0)
    buffer_load_dwordx4 v[232:235], v1, s[4:7], s75 offen offset:2048 sc1
    v_exp_f32 v59, v59
    v_exp_f32 v60, v60
    v_exp_f32 v61, v61
    v_exp_f32 v62, v62
    v_exp_f32 v63, v63
    v_exp_f32 v32, v32
    v_exp_f32 v33, v33
    v_smfmac_f32_32x32x32_bf16 v[80:95], v[116:119], v[56:63], v2
    ds_read_b128 v[100:103], v3 offset:35680
    v_exp_f32 v34, v34
    v_exp_f32 v35, v35
    v_exp_f32 v36, v36
    v_mfma_f32_32x32x16_bf16 v[48:63], v[96:99], v[24:27], 0
    ds_read_b128 v[108:111], v4 offset:35680
    v_exp_f32 v37, v37
    v_exp_f32 v38, v38
    v_exp_f32 v39, v39
    v_exp_f32 v40, v40
    v_exp_f32 v41, v41
    v_exp_f32 v42, v42
    v_smfmac_f32_32x32x32_bf16 v[64:79], v[104:107], v[32:39], v2
    ds_read_b128 v[116:119], v5 offset:35680
    v_exp_f32 v43, v43
    v_exp_f32 v44, v44
    v_exp_f32 v45, v45
    v_exp_f32 v46, v46
    v_exp_f32 v47, v47
    v_exp_f32 v48, v48
    v_exp_f32 v49, v49
    v_smfmac_f32_32x32x32_bf16 v[64:79], v[112:115], v[40:47], v2
    s_waitcnt lgkmcnt(2)
    v_exp_f32 v50, v50
    v_exp_f32 v51, v51
    v_exp_f32 v52, v52
    v_mfma_f32_32x32x16_bf16 v[32:47], v[100:103], v[20:23], 0
    v_exp_f32 v53, v53
    v_exp_f32 v54, v54
    v_exp_f32 v55, v55
    v_exp_f32 v56, v56
    v_exp_f32 v57, v57
    v_exp_f32 v58, v58
    v_smfmac_f32_32x32x32_bf16 v[80:95], v[104:107], v[48:55], v2
    s_waitcnt vmcnt(5) lgkmcnt(0)
    s_barrier
    buffer_load_dwordx4 v[236:239], v1, s[4:7], s75 offen offset:3072 sc1
    v_exp_f32 v59, v59
    v_exp_f32 v60, v60
    v_exp_f32 v61, v61
    v_exp_f32 v62, v62
    v_exp_f32 v63, v63
    v_exp_f32 v32, v32
    v_exp_f32 v33, v33
    v_smfmac_f32_32x32x32_bf16 v[80:95], v[112:115], v[56:63], v2
    ds_read_b128 v[96:99], v3 offset:8320
    v_exp_f32 v34, v34
    v_exp_f32 v35, v35
    v_exp_f32 v36, v36
    v_mfma_f32_32x32x16_bf16 v[48:63], v[100:103], v[24:27], 0
    ds_read_b128 v[104:107], v4 offset:8320
    v_exp_f32 v37, v37
    v_exp_f32 v38, v38
    v_exp_f32 v39, v39
    v_exp_f32 v40, v40
TCH11:
    s_cbranch_execz TCHRET
    v_exp_f32 v41, v41
    v_exp_f32 v42, v42
    v_smfmac_f32_32x32x32_bf16 v[64:79], v[108:111], v[32:39], v2
    ds_read_b128 v[112:115], v5 offset:8320
    v_exp_f32 v43, v43
    v_exp_f32 v44, v44
    v_exp_f32 v45, v45
    v_exp_f32 v46, v46
    v_exp_f32 v47, v47
    v_exp_f32 v48, v48
    v_exp_f32 v49, v49
    v_smfmac_f32_32x32x32_bf16 v[64:79], v[116:119], v[40:47], v2
    s_waitcnt lgkmcnt(2)
    v_exp_f32 v50, v50
    v_exp_f32 v51, v51
    v_exp_f32 v52, v52
    v_mfma_f32_32x32x16_bf16 v[32:47], v[96:99], v[20:23], 0
    v_exp_f32 v53, v53
    v_exp_f32 v54, v54
    v_exp_f32 v55, v55
    v_exp_f32 v56, v56
    v_exp_f32 v57, v57
    v_exp_f32 v58, v58
    v_smfmac_f32_32x32x32_bf16 v[80:95], v[108:111], v[48:55], v2
    s_waitcnt lgkmcnt(0)
    v_exp_f32 v59, v59
    v_exp_f32 v60, v60
    v_exp_f32 v61, v61
    v_exp_f32 v62, v62
    v_exp_f32 v63, v63
    v_exp_f32 v32, v32
    v_exp_f32 v33, v33
    v_smfmac_f32_32x32x32_bf16 v[80:95], v[116:119], v[56:63], v2
    ds_read_b128 v[100:103], v3 offset:10400
    v_exp_f32 v34, v34
    v_exp_f32 v35, v35
    v_exp_f32 v36, v36
    v_mfma_f32_32x32x16_bf16 v[48:63], v[96:99], v[24:27], 0
    ds_read_b128 v[108:111], v4 offset:10400
    v_exp_f32 v37, v37
    v_exp_f32 v38, v38
    v_exp_f32 v39, v39
    v_exp_f32 v40, v40
    v_exp_f32 v41, v41
    v_exp_f32 v42, v42
    v_smfmac_f32_32x32x32_bf16 v[64:79], v[104:107], v[32:39], v2
    ds_read_b128 v[116:119], v5 offset:10400
    s_xor_b32 s75, s83, 28672
    v_exp_f32 v43, v43
    v_exp_f32 v44, v44
    v_exp_f32 v45, v45
    v_exp_f32 v46, v46
    v_exp_f32 v47, v47
    v_exp_f32 v48, v48
    v_exp_f32 v49, v49
    v_smfmac_f32_32x32x32_bf16 v[64:79], v[112:115], v[40:47], v2
    s_waitcnt lgkmcnt(2)
    buffer_load_dwordx4 v[240:243], v1, s[4:7], s75 offen offset:0 sc1
    v_exp_f32 v50, v50
    v_exp_f32 v51, v51
    v_exp_f32 v52, v52
    v_mfma_f32_32x32x16_bf16 v[32:47], v[100:103], v[20:23], 0
    v_exp_f32 v53, v53
    v_exp_f32 v54, v54
    v_exp_f32 v55, v55
    v_exp_f32 v56, v56
    v_exp_f32 v57, v57
    v_exp_f32 v58, v58
    v_smfmac_f32_32x32x32_bf16 v[80:95], v[104:107], v[48:55], v2
    s_waitcnt lgkmcnt(0)
    v_exp_f32 v59, v59
    v_exp_f32 v60, v60
    v_exp_f32 v61, v61
    v_exp_f32 v62, v62
    v_exp_f32 v63, v63
    v_exp_f32 v32, v32
    v_exp_f32 v33, v33
    v_smfmac_f32_32x32x32_bf16 v[80:95], v[112:115], v[56:63], v2
    ds_read_b128 v[96:99], v3 offset:12480
    v_exp_f32 v34, v34
    v_exp_f32 v35, v35
    v_exp_f32 v36, v36
    v_mfma_f32_32x32x16_bf16 v[48:63], v[100:103], v[24:27], 0
    ds_read_b128 v[104:107], v4 offset:12480
    v_exp_f32 v37, v37
    v_exp_f32 v38, v38
    v_exp_f32 v39, v39
    v_exp_f32 v40, v40
    v_exp_f32 v41, v41
    v_exp_f32 v42, v42
    v_smfmac_f32_32x32x32_bf16 v[64:79], v[108:111], v[32:39], v2
    ds_read_b128 v[112:115], v5 offset:12480
    v_bfe_u32 v122, v1, 2, 7
    v_exp_f32 v43, v43
    v_exp_f32 v44, v44
    v_exp_f32 v45, v45
    v_exp_f32 v46, v46
    v_exp_f32 v47, v47
    v_exp_f32 v48, v48
    v_exp_f32 v49, v49
    v_smfmac_f32_32x32x32_bf16 v[64:79], v[116:119], v[40:47], v2
    s_waitcnt lgkmcnt(2)
    buffer_load_dword v121, v122, s[4:7], s64 offen sc1
    v_exp_f32 v50, v50
    v_exp_f32 v51, v51
    v_exp_f32 v52, v52
    v_mfma_f32_32x32x16_bf16 v[32:47], v[96:99], v[20:23], 0
    buffer_load_dwordx4 v[244:247], v1, s[4:7], s75 offen offset:1024 sc1
    v_exp_f32 v53, v53
    v_exp_f32 v54, v54
    v_exp_f32 v55, v55
    v_exp_f32 v56, v56
    v_exp_f32 v57, v57
    v_exp_f32 v58, v58
    v_smfmac_f32_32x32x32_bf16 v[80:95], v[108:111], v[48:55], v2
    s_waitcnt lgkmcnt(0)
    v_exp_f32 v59, v59
    v_exp_f32 v60, v60
    v_exp_f32 v61, v61
    v_exp_f32 v62, v62
    v_exp_f32 v63, v63
    v_exp_f32 v32, v32
    v_exp_f32 v33, v33
    v_smfmac_f32_32x32x32_bf16 v[80:95], v[116:119], v[56:63], v2
    ds_read_b128 v[100:103], v3 offset:14560
    v_exp_f32 v34, v34
    v_exp_f32 v35, v35
    v_exp_f32 v36, v36
    v_mfma_f32_32x32x16_bf16 v[48:63], v[96:99], v[24:27], 0
    ds_read_b128 v[108:111], v4 offset:14560
    v_exp_f32 v37, v37
    v_exp_f32 v38, v38
    v_exp_f32 v39, v39
    v_exp_f32 v40, v40
    v_exp_f32 v41, v41
    v_exp_f32 v42, v42
    v_smfmac_f32_32x32x32_bf16 v[64:79], v[104:107], v[32:39], v2
    ds_read_b128 v[116:119], v5 offset:14560
    v_exp_f32 v43, v43
    v_exp_f32 v44, v44
    v_exp_f32 v45, v45
    v_exp_f32 v46, v46
    v_exp_f32 v47, v47
    v_exp_f32 v48, v48
    v_exp_f32 v49, v49
    v_smfmac_f32_32x32x32_bf16 v[64:79], v[112:115], v[40:47], v2
    s_waitcnt lgkmcnt(2)
    v_exp_f32 v50, v50
    v_exp_f32 v51, v51
    v_exp_f32 v52, v52
    v_mfma_f32_32x32x16_bf16 v[32:47], v[100:103], v[20:23], 0
    v_exp_f32 v53, v53
    v_exp_f32 v54, v54
    v_exp_f32 v55, v55
    v_exp_f32 v56, v56
    v_exp_f32 v57, v57
    v_exp_f32 v58, v58
    v_smfmac_f32_32x32x32_bf16 v[80:95], v[104:107], v[48:55], v2
    s_waitcnt lgkmcnt(0)
    buffer_load_dwordx4 v[248:251], v1, s[4:7], s75 offen offset:2048 sc1
    v_exp_f32 v59, v59
    v_exp_f32 v60, v60
    v_exp_f32 v61, v61
    v_exp_f32 v62, v62
    v_exp_f32 v63, v63
    v_exp_f32 v32, v32
    v_exp_f32 v33, v33
    v_smfmac_f32_32x32x32_bf16 v[80:95], v[112:115], v[56:63], v2
    ds_read_b128 v[96:99], v3 offset:0
    v_exp_f32 v34, v34
    v_exp_f32 v35, v35
    v_exp_f32 v36, v36
    v_mfma_f32_32x32x16_bf16 v[48:63], v[100:103], v[24:27], 0
    ds_read_b128 v[104:107], v4 offset:0
    v_exp_f32 v37, v37
    v_exp_f32 v38, v38
    v_exp_f32 v39, v39
    v_exp_f32 v40, v40
    v_exp_f32 v41, v41
    v_exp_f32 v42, v42
    v_smfmac_f32_32x32x32_bf16 v[64:79], v[108:111], v[32:39], v2
    ds_read_b128 v[112:115], v5 offset:0
    v_exp_f32 v43, v43
    v_exp_f32 v44, v44
    v_exp_f32 v45, v45
    v_exp_f32 v46, v46
    v_exp_f32 v47, v47
    v_exp_f32 v48, v48
    v_exp_f32 v49, v49
    v_smfmac_f32_32x32x32_bf16 v[64:79], v[116:119], v[40:47], v2
    s_waitcnt lgkmcnt(2)
    v_exp_f32 v50, v50
    v_exp_f32 v51, v51
    v_exp_f32 v52, v52
    v_mfma_f32_32x32x16_bf16 v[32:47], v[96:99], v[20:23], 0
    v_exp_f32 v53, v53
    v_exp_f32 v54, v54
    v_exp_f32 v55, v55
    v_exp_f32 v56, v56
    v_exp_f32 v57, v57
    v_exp_f32 v58, v58
    v_smfmac_f32_32x32x32_bf16 v[80:95], v[108:111], v[48:55], v2
    s_waitcnt lgkmcnt(0)
    buffer_load_dwordx4 v[252:255], v1, s[4:7], s75 offen offset:3072 sc1
    v_exp_f32 v59, v59
    v_exp_f32 v60, v60
    v_exp_f32 v61, v61
    v_exp_f32 v62, v62
    v_exp_f32 v63, v63
    v_exp_f32 v32, v32
    v_exp_f32 v33, v33
    v_smfmac_f32_32x32x32_bf16 v[80:95], v[116:119], v[56:63], v2
    ds_read_b128 v[100:103], v3 offset:2080
    v_exp_f32 v34, v34
    v_exp_f32 v35, v35
    v_exp_f32 v36, v36
    v_mfma_f32_32x32x16_bf16 v[48:63], v[96:99], v[24:27], 0
    ds_read_b128 v[108:111], v4 offset:2080
    v_exp_f32 v37, v37
    v_exp_f32 v38, v38
    v_exp_f32 v39, v39
    v_exp_f32 v40, v40
    v_exp_f32 v41, v41
    v_exp_f32 v42, v42
    v_smfmac_f32_32x32x32_bf16 v[64:79], v[104:107], v[32:39], v2
    ds_read_b128 v[116:119], v5 offset:2080
    s_waitcnt vmcnt(3)
    v_cmp_ne_u32 vcc, v121, v6
    s_cbranch_vccnz RT_377
BK_378:
    s_cmp_lg_u32 s31, 0
    s_cbranch_scc1 SF_381
SFD_382:
    v_exp_f32 v43, v43
    v_exp_f32 v44, v44
    v_exp_f32 v45, v45
    v_exp_f32 v46, v46
    v_exp_f32 v47, v47
    v_exp_f32 v48, v48
    v_exp_f32 v49, v49
    v_smfmac_f32_32x32x32_bf16 v[64:79], v[112:115], v[40:47], v2
    s_waitcnt lgkmcnt(2)
    s_lshl2_add_u32 s71, s62, s60
    v_exp_f32 v50, v50
    v_exp_f32 v51, v51
    v_exp_f32 v52, v52
    v_mfma_f32_32x32x16_bf16 v[32:47], v[100:103], v[20:23], 0
    s_lshl_b32 s70, s61, 4
    v_exp_f32 v53, v53
    v_exp_f32 v54, v54
    v_exp_f32 v55, v55
    v_exp_f32 v56, v56
    v_exp_f32 v57, v57
    v_exp_f32 v58, v58
    v_smfmac_f32_32x32x32_bf16 v[80:95], v[104:107], v[48:55], v2
    s_waitcnt lgkmcnt(0)
    s_add_u32 s71, s71, s70
    s_lshl_b32 s70, s71, 11
    v_exp_f32 v59, v59
    v_exp_f32 v60, v60
    v_exp_f32 v61, v61
    v_exp_f32 v62, v62
    v_exp_f32 v63, v63
    v_exp_f32 v32, v32
    v_exp_f32 v33, v33
    v_smfmac_f32_32x32x32_bf16 v[80:95], v[112:115], v[56:63], v2
    ds_read_b128 v[96:99], v3 offset:4160
    v_exp_f32 v34, v34
    v_exp_f32 v35, v35
    v_exp_f32 v36, v36
    v_mfma_f32_32x32x16_bf16 v[48:63], v[100:103], v[24:27], 0
    ds_read_b128 v[104:107], v4 offset:4160
    v_exp_f32 v37, v37
    v_exp_f32 v38, v38
    v_exp_f32 v39, v39
    v_exp_f32 v40, v40
    v_exp_f32 v41, v41
    v_exp_f32 v42, v42
    v_smfmac_f32_32x32x32_bf16 v[64:79], v[108:111], v[32:39], v2
    ds_read_b128 v[112:115], v5 offset:4160
    v_exp_f32 v43, v43
    v_exp_f32 v44, v44
    v_exp_f32 v45, v45
    v_exp_f32 v46, v46
    v_exp_f32 v47, v47
    v_exp_f32 v48, v48
    v_exp_f32 v49, v49
    v_smfmac_f32_32x32x32_bf16 v[64:79], v[116:119], v[40:47], v2
    s_waitcnt lgkmcnt(2)
    s_add_u32 s70, s70, s63
    v_exp_f32 v50, v50
    v_exp_f32 v51, v51
    v_exp_f32 v52, v52
    v_mfma_f32_32x32x16_bf16 v[32:47], v[96:99], v[20:23], 0
    s_lshl_b32 s76, s71, 8
    v_exp_f32 v53, v53
    v_exp_f32 v54, v54
    v_exp_f32 v55, v55
    v_exp_f32 v56, v56
    v_exp_f32 v57, v57
    v_exp_f32 v58, v58
    v_smfmac_f32_32x32x32_bf16 v[80:95], v[108:111], v[48:55], v2
    s_waitcnt lgkmcnt(0)
    s_add_u32 s76, s76, s63
    s_add_u32 s76, s76, 1441792
    v_exp_f32 v59, v59
    v_exp_f32 v60, v60
    v_exp_f32 v61, v61
    v_exp_f32 v62, v62
    v_exp_f32 v63, v63
    v_exp_f32 v32, v32
    v_exp_f32 v33, v33
    v_smfmac_f32_32x32x32_bf16 v[80:95], v[116:119], v[56:63], v2
    ds_read_b128 v[100:103], v3 offset:6240
    v_exp_f32 v34, v34
    v_exp_f32 v35, v35
    v_exp_f32 v36, v36
    v_mfma_f32_32x32x16_bf16 v[48:63], v[96:99], v[24:27], 0
    ds_read_b128 v[108:111], v4 offset:6240
    v_exp_f32 v37, v37
    v_exp_f32 v38, v38
    v_exp_f32 v39, v39
    v_exp_f32 v40, v40
    v_exp_f32 v41, v41
    v_exp_f32 v42, v42
    v_smfmac_f32_32x32x32_bf16 v[64:79], v[104:107], v[32:39], v2
    ds_read_b128 v[116:119], v5 offset:6240
    v_exp_f32 v43, v43
    v_exp_f32 v44, v44
    v_exp_f32 v45, v45
    v_exp_f32 v46, v46
    v_exp_f32 v47, v47
    v_exp_f32 v48, v48
    v_exp_f32 v49, v49
    v_smfmac_f32_32x32x32_bf16 v[64:79], v[112:115], v[40:47], v2
    s_waitcnt lgkmcnt(2)
    s_xor_b32 s33, s70, 8192
    v_exp_f32 v50, v50
    v_exp_f32 v51, v51
    v_exp_f32 v52, v52
    v_mfma_f32_32x32x16_bf16 v[32:47], v[100:103], v[20:23], 0
    s_xor_b32 s34, s70, 16384
    v_exp_f32 v53, v53
    v_exp_f32 v54, v54
    v_exp_f32 v55, v55
    v_exp_f32 v56, v56
    v_exp_f32 v57, v57
    v_exp_f32 v58, v58
    v_smfmac_f32_32x32x32_bf16 v[80:95], v[104:107], v[48:55], v2
    s_waitcnt lgkmcnt(0)
    s_barrier
    s_xor_b32 s35, s70, 24576
    s_lshl_b32 s71, s60, 11
    v_exp_f32 v59, v59
    v_exp_f32 v60, v60
    v_exp_f32 v61, v61
    v_exp_f32 v62, v62
    v_exp_f32 v63, v63
    v_exp_f32 v32, v32
    v_exp_f32 v33, v33
    v_smfmac_f32_32x32x32_bf16 v[80:95], v[112:115], v[56:63], v2
    v_exp_f32 v34, v34
    v_exp_f32 v35, v35
    v_exp_f32 v36, v36
    v_mfma_f32_32x32x16_bf16 v[48:63], v[100:103], v[24:27], 0
    v_exp_f32 v37, v37
    v_exp_f32 v38, v38
    v_exp_f32 v39, v39
    v_exp_f32 v40, v40
    v_exp_f32 v41, v41
    v_exp_f32 v42, v42
    v_smfmac_f32_32x32x32_bf16 v[64:79], v[108:111], v[32:39], v2
    v_exp_f32 v43, v43
    v_exp_f32 v44, v44
    v_exp_f32 v45, v45
    v_exp_f32 v46, v46
    v_exp_f32 v47, v47
    v_exp_f32 v48, v48
    v_exp_f32 v49, v49
    v_smfmac_f32_32x32x32_bf16 v[64:79], v[116:119], v[40:47], v2
    s_mov_b32 s74, 1006632960
    v_exp_f32 v50, v50
    v_exp_f32 v51, v51
    v_exp_f32 v52, v52
    v_add_u32 v123, s71, v3
    v_exp_f32 v53, v53
    v_exp_f32 v54, v54
    v_exp_f32 v55, v55
    v_exp_f32 v56, v56
    v_exp_f32 v57, v57
    v_exp_f32 v58, v58
    v_smfmac_f32_32x32x32_bf16 v[80:95], v[108:111], v[48:55], v2
    v_exp_f32 v59, v59
    v_exp_f32 v60, v60
    v_exp_f32 v61, v61
    v_exp_f32 v62, v62
    v_exp_f32 v63, v63
    v_subrev_u32 v122, 562036736, v72
    v_rcp_f32 v74, v72
    v_smfmac_f32_32x32x32_bf16 v[80:95], v[116:119], v[56:63], v2
    v_mul_f32 v64, v64, v74
    v_mul_f32 v65, v65, v74
    v_mul_f32 v66, v66, v74
    v_mul_f32 v67, v67, v74
    v_mul_f32 v68, v68, v74
    v_mul_f32 v69, v69, v74
    v_mul_f32 v70, v70, v74
    v_mul_f32 v71, v71, v74
    v_cvt_pk_bf16_f32 v64, v64, v65
    v_cvt_pk_bf16_f32 v65, v66, v67
    v_cvt_pk_bf16_f32 v66, v68, v69
    v_cvt_pk_bf16_f32 v67, v70, v71
    v_subrev_u32 v121, 562036736, v88
    v_rcp_f32 v90, v88
    v_max_u32 v122, v122, v121
    v_cmp_lt_u32 vcc, s74, v122
    v_pk_mul_f32 v[80:81], v[80:81], v[90:91] op_sel_hi:[1,0]
    v_pk_mul_f32 v[82:83], v[82:83], v[90:91] op_sel_hi:[1,0]
    v_pk_mul_f32 v[84:85], v[84:85], v[90:91] op_sel_hi:[1,0]
    v_pk_mul_f32 v[86:87], v[86:87], v[90:91] op_sel_hi:[1,0]
    s_cbranch_vccnz SLOW1
SLOW1D:
    buffer_store_dwordx4 v[64:67], v1, s[4:7], s70 offen
    v_cvt_pk_bf16_f32 v80, v80, v81
    v_cvt_pk_bf16_f32 v81, v82, v83
    v_cvt_pk_bf16_f32 v82, v84, v85
    v_cvt_pk_bf16_f32 v83, v86, v87
    buffer_store_dwordx4 v[80:83], v1, s[4:7], s70 offen offset:1024
    s_cmp_lg_u32 s31, 0
    s_cbranch_scc1 SF_383
SFD_384:
    buffer_load_dwordx4 v[96:99], v1, s[4:7], s33 offen offset:0 sc1
    buffer_load_dwordx4 v[100:103], v1, s[4:7], s33 offen offset:1024 sc1
    ds_write_b128 v123, v[64:67] offset:0
    ds_write_b128 v123, v[80:83] offset:1024
    buffer_load_dwordx4 v[104:107], v1, s[4:7], s34 offen offset:0 sc1
    buffer_load_dwordx4 v[108:111], v1, s[4:7], s34 offen offset:1024 sc1
    buffer_load_dwordx4 v[112:115], v1, s[4:7], s35 offen offset:0 sc1
    buffer_load_dwordx4 v[116:119], v1, s[4:7], s35 offen offset:1024 sc1
    s_branch NEAR_385
RT_386:
    s_cmp_eq_u32 s29, 0
    s_cbranch_scc1 BK_387
    s_sub_u32 s29, s29, 1
    s_cmp_lg_u32 s31, 0
    s_cbranch_scc1 SF_389
SFD_390:
    buffer_load_dwordx4 v[96:99], v1, s[4:7], s33 offen offset:0 sc1
    buffer_load_dwordx4 v[100:103], v1, s[4:7], s33 offen offset:1024 sc1
    buffer_load_dwordx4 v[104:107], v1, s[4:7], s34 offen offset:0 sc1
    buffer_load_dwordx4 v[108:111], v1, s[4:7], s34 offen offset:1024 sc1
    buffer_load_dwordx4 v[112:115], v1, s[4:7], s35 offen offset:0 sc1
    buffer_load_dwordx4 v[116:119], v1, s[4:7], s35 offen offset:1024 sc1
    s_branch AG_388
RT_391:
    s_cmp_eq_u32 s29, 0
    s_cbranch_scc1 BK_392
    s_sub_u32 s29, s29, 1
    s_cmp_lg_u32 s31, 0
    s_cbranch_scc1 SF_394
SFD_395:
    buffer_load_dwordx4 v[104:107], v1, s[4:7], s34 offen offset:0 sc1
    buffer_load_dwordx4 v[108:111], v1, s[4:7], s34 offen offset:1024 sc1
    buffer_load_dwordx4 v[112:115], v1, s[4:7], s35 offen offset:0 sc1
    buffer_load_dwordx4 v[116:119], v1, s[4:7], s35 offen offset:1024 sc1
    s_branch AG_393
RT_396:
    s_cmp_eq_u32 s29, 0
    s_cbranch_scc1 BK_397
    s_sub_u32 s29, s29, 1
    s_cmp_lg_u32 s31, 0
    s_cbranch_scc1 SF_399
SFD_400:
    buffer_load_dwordx4 v[112:115], v1, s[4:7], s35 offen offset:0 sc1
    buffer_load_dwordx4 v[116:119], v1, s[4:7], s35 offen offset:1024 sc1
    s_branch AG_398
NEAR_385:
    v_lshlrev_b32 v32, 16, v12
    v_and_b32 v33, s91, v12
    v_lshlrev_b32 v34, 16, v13
    v_and_b32 v35, s91, v13
    v_lshlrev_b32 v36, 16, v14
    v_and_b32 v37, s91, v14
    v_lshlrev_b32 v38, 16, v15
    v_and_b32 v39, s91, v15
    v_lshlrev_b32 v40, 16, v16
    v_and_b32 v41, s91, v16
    v_lshlrev_b32 v42, 16, v17
    v_and_b32 v43, s91, v17
    v_lshlrev_b32 v44, 16, v18
    v_and_b32 v45, s91, v18
    v_lshlrev_b32 v46, 16, v19
    v_and_b32 v47, s91, v19
    s_waitcnt lgkmcnt(0)
    s_barrier
    ds_read_b128 v[48:51], v3 offset:0
    ds_read_b128 v[52:55], v3 offset:1024
    ds_read_b128 v[56:59], v3 offset:2048
    ds_read_b128 v[60:63], v3 offset:3072
    ds_read_b128 v[64:67], v3 offset:4096
    ds_read_b128 v[68:71], v3 offset:5120
    ds_read_b128 v[72:75], v3 offset:6144
    ds_read_b128 v[76:79], v3 offset:7168
    s_waitcnt lgkmcnt(7)
    v_mfma_f32_32x32x16_bf16 v[32:47], v[128:131], v[48:51], v[32:47]
    s_waitcnt lgkmcnt(6)
    v_mfma_f32_32x32x16_bf16 v[32:47], v[132:135], v[52:55], v[32:47]
    s_waitcnt lgkmcnt(5)
    v_mfma_f32_32x32x16_bf16 v[32:47], v[136:139], v[56:59], v[32:47]
    s_waitcnt lgkmcnt(4)
    v_mfma_f32_32x32x16_bf16 v[32:47], v[140:143], v[60:63], v[32:47]
AG_388:
    s_waitcnt vmcnt(4)
    v_max_u32 v120, v96, v100
    v_cmp_eq_u32 vcc, -1, v120
    ds_write_b128 v123, v[96:99] offset:8192
    ds_write_b128 v123, v[100:103] offset:9216
    s_cbranch_vccnz RT_386
BK_387:
    s_waitcnt lgkmcnt(5)
    v_mfma_f32_32x32x16_bf16 v[32:47], v[144:147], v[64:67], v[32:47]
    s_waitcnt lgkmcnt(4)
    v_mfma_f32_32x32x16_bf16 v[32:47], v[148:151], v[68:71], v[32:47]
    s_waitcnt lgkmcnt(0)
    s_barrier
    ds_read_b128 v[48:51], v3 offset:8192
    ds_read_b128 v[52:55], v3 offset:9216
    ds_read_b128 v[56:59], v3 offset:10240
    ds_read_b128 v[60:63], v3 offset:11264
    ds_read_b128 v[64:67], v3 offset:12288
    s_waitcnt lgkmcnt(8)
    v_mfma_f32_32x32x16_bf16 v[32:47], v[152:155], v[72:75], v[32:47]
    ds_read_b128 v[68:71], v3 offset:13312
    s_waitcnt lgkmcnt(8)
    v_mfma_f32_32x32x16_bf16 v[32:47], v[156:159], v[76:79], v[32:47]
    ds_read_b128 v[72:75], v3 offset:14336
AG_393:
    s_waitcnt vmcnt(2)
    v_max_u32 v120, v104, v108
    v_cmp_eq_u32 vcc, -1, v120
    ds_write_b128 v123, v[104:107] offset:16384
    ds_write_b128 v123, v[108:111] offset:17408
    s_cbranch_vccnz RT_391
BK_392:
    s_waitcnt lgkmcnt(8)
    v_mfma_f32_32x32x16_bf16 v[32:47], v[160:163], v[48:51], v[32:47]
    ds_read_b128 v[76:79], v3 offset:15360
    s_waitcnt lgkmcnt(8)
    v_mfma_f32_32x32x16_bf16 v[32:47], v[164:167], v[52:55], v[32:47]
    s_waitcnt lgkmcnt(7)
    v_mfma_f32_32x32x16_bf16 v[32:47], v[168:171], v[56:59], v[32:47]
AG_398:
    s_waitcnt vmcnt(0)
    v_max_u32 v120, v112, v116
    v_cmp_eq_u32 vcc, -1, v120
    ds_write_b128 v123, v[112:115] offset:24576
    ds_write_b128 v123, v[116:119] offset:25600
    s_cbranch_vccnz RT_396
BK_397:
    s_waitcnt lgkmcnt(8)
    v_mfma_f32_32x32x16_bf16 v[32:47], v[172:175], v[60:63], v[32:47]
    s_waitcnt lgkmcnt(3)
    s_barrier
    ds_read_b128 v[48:51], v3 offset:16384
    ds_read_b128 v[52:55], v3 offset:17408
    s_waitcnt lgkmcnt(9)
    v_mfma_f32_32x32x16_bf16 v[32:47], v[176:179], v[64:67], v[32:47]
    ds_read_b128 v[56:59], v3 offset:18432
    v_and_b32 v122, 0xf0, v1
    v_bfe_u32 v121, v1, 8, 1
    v_lshl_add_u32 v122, v121, 3, v122
    s_waitcnt lgkmcnt(9)
    v_mfma_f32_32x32x16_bf16 v[32:47], v[180:183], v[68:71], v[32:47]
    ds_read_b128 v[60:63], v3 offset:19456
    v_lshrrev_b32 v121, 9, v1
    v_lshl_add_u32 v122, v121, 2, v122
    v_mov_b32 v124, 0
    s_waitcnt lgkmcnt(9)
    v_mfma_f32_32x32x16_bf16 v[32:47], v[184:187], v[72:75], v[32:47]
    ds_read_b128 v[64:67], v3 offset:20480
    v_mov_b32 v125, 0
    s_add_u32 s70, s70, 262144
    s_lshr_b32 s75, s59, 4
    s_waitcnt lgkmcnt(7)
    v_mfma_f32_32x32x16_bf16 v[32:47], v[188:191], v[76:79], v[32:47]
    ds_read_b128 v[68:71], v3 offset:21504
    s_lshl2_add_u32 s75, s75, s60
    s_lshl_b32 s40, s75, 15
    s_add_u32 s40, s40, s63
    s_waitcnt lgkmcnt(5)
    v_mfma_f32_32x32x16_bf16 v[32:47], v[192:195], v[48:51], v[32:47]
    ds_read_b128 v[72:75], v3 offset:22528
    s_add_u32 s40, s40, 262144
    s_add_u32 s41, s40, 4096
    s_add_u32 s42, s40, 8192
    s_waitcnt lgkmcnt(5)
    v_mfma_f32_32x32x16_bf16 v[32:47], v[196:199], v[52:55], v[32:47]
    s_waitcnt lgkmcnt(7)
    s_barrier
    ds_read_b128 v[76:79], v3 offset:23552
    s_waitcnt lgkmcnt(5)
    v_mfma_f32_32x32x16_bf16 v[32:47], v[200:203], v[56:59], v[32:47]
    ds_read_b128 v[48:51], v3 offset:24576
    s_add_u32 s43, s40, 12288
    s_add_u32 s44, s40, 16384
    s_add_u32 s45, s40, 20480
    s_waitcnt lgkmcnt(5)
    v_mfma_f32_32x32x16_bf16 v[32:47], v[204:207], v[60:63], v[32:47]
    ds_read_b128 v[52:55], v3 offset:25600
    s_add_u32 s46, s40, 24576
    s_add_u32 s47, s40, 28672
    s_lshl_b32 s74, s75, 12
    s_waitcnt lgkmcnt(5)
    v_mfma_f32_32x32x16_bf16 v[32:47], v[208:211], v[64:67], v[32:47]
    ds_read_b128 v[56:59], v3 offset:26624
    s_add_u32 s74, s74, s63
    s_add_u32 s74, s74, 1441792
    v_add_u32 v88, 0x10000, v1
    s_waitcnt lgkmcnt(5)
    v_mfma_f32_32x32x16_bf16 v[32:47], v[212:215], v[68:71], v[32:47]
    ds_read_b128 v[60:63], v3 offset:27648
    v_lshrrev_b32 v91, 8, v1
    v_and_b32 v89, 0xf0, v1
    v_lshlrev_b32 v4, 4, v89
    s_waitcnt lgkmcnt(5)
    v_mfma_f32_32x32x16_bf16 v[32:47], v[216:219], v[72:75], v[32:47]
    ds_read_b128 v[64:67], v3 offset:28672
    v_lshl_add_u32 v4, v91, 6, v4
    v_lshl_add_u32 v90, v91, 10, v89
    v_lshl_add_u32 v89, v91, 9, v89
    s_waitcnt lgkmcnt(5)
    v_mfma_f32_32x32x16_bf16 v[32:47], v[220:223], v[76:79], v[32:47]
    ds_read_b128 v[68:71], v3 offset:29696
    v_lshlrev_b32 v91, 5, v91
    v_add_u32 v91, 115712, v91
    s_and_b32 s77, s59, 15
    s_waitcnt lgkmcnt(5)
    v_mfma_f32_32x32x16_bf16 v[32:47], v[224:227], v[48:51], v[32:47]
    ds_read_b128 v[72:75], v3 offset:30720
    s_mul_i32 s77, s77, 7168
    s_mul_i32 s75, s75, 114688
    s_add_u32 s77, s77, s75
    s_waitcnt lgkmcnt(5)
    v_mfma_f32_32x32x16_bf16 v[32:47], v[228:231], v[52:55], v[32:47]
    ds_read_b128 v[76:79], v3 offset:31744
    s_add_u32 s77, s77, s63
    s_add_u32 s77, s77, 524288
    s_lshl2_add_u32 s79, s62, s60
    s_waitcnt lgkmcnt(5)
    v_mfma_f32_32x32x16_bf16 v[32:47], v[232:235], v[56:59], v[32:47]
    s_lshl_b32 s79, s79, 15
    s_add_u32 s79, s79, 1048576
    ds_read_b128 v[96:99], v1 offset:0
    s_waitcnt lgkmcnt(5)
    v_mfma_f32_32x32x16_bf16 v[32:47], v[236:239], v[60:63], v[32:47]
    ds_read_b128 v[100:103], v1 offset:16384
    s_waitcnt lgkmcnt(5)
    v_mfma_f32_32x32x16_bf16 v[32:47], v[240:243], v[64:67], v[32:47]
    ds_read_b128 v[104:107], v1 offset:32768
    s_waitcnt lgkmcnt(5)
    v_mfma_f32_32x32x16_bf16 v[32:47], v[244:247], v[68:71], v[32:47]
    ds_read_b128 v[108:111], v1 offset:49152
    s_waitcnt lgkmcnt(5)
    v_mfma_f32_32x32x16_bf16 v[32:47], v[248:251], v[72:75], v[32:47]
    ds_read_b128 v[112:115], v88 offset:0
    s_waitcnt lgkmcnt(5)
    v_mfma_f32_32x32x16_bf16 v[32:47], v[252:255], v[76:79], v[32:47]
    ds_read_b128 v[116:119], v88 offset:16384
    s_nop 10
    v_cvt_pk_bf16_f32 v80, v32, v33
    v_cvt_pk_bf16_f32 v81, v34, v35
    v_cvt_pk_bf16_f32 v82, v36, v37
    v_cvt_pk_bf16_f32 v83, v38, v39
    buffer_store_dwordx4 v[80:83], v1, s[4:7], s70 offen offset:0
    v_cvt_pk_bf16_f32 v84, v40, v41
    v_cvt_pk_bf16_f32 v85, v42, v43
    v_cvt_pk_bf16_f32 v86, v44, v45
    v_cvt_pk_bf16_f32 v87, v46, v47
    buffer_store_dwordx4 v[84:87], v1, s[4:7], s70 offen offset:1024
    v_dot2c_f32_bf16 v124, s68, v80
    v_dot2c_f32_bf16 v125, v80, v80
    v_dot2c_f32_bf16 v124, s68, v81
    v_dot2c_f32_bf16 v125, v81, v81
    v_dot2c_f32_bf16 v124, s68, v82
    v_dot2c_f32_bf16 v125, v82, v82
    v_dot2c_f32_bf16 v124, s68, v83
    v_dot2c_f32_bf16 v125, v83, v83
    v_dot2c_f32_bf16 v124, s68, v84
    v_dot2c_f32_bf16 v125, v84, v84
    v_dot2c_f32_bf16 v124, s68, v85
    v_dot2c_f32_bf16 v125, v85, v85
    v_dot2c_f32_bf16 v124, s68, v86
    v_dot2c_f32_bf16 v125, v86, v86
    v_dot2c_f32_bf16 v124, s68, v87
    v_dot2c_f32_bf16 v125, v87, v87
    s_nop 2
    v_permlane32_swap_b32 v124, v125
    v_add_f32 v124, v124, v125
    buffer_store_dword v124, v122, s[4:7], s76 offen
    s_cmp_lg_u32 s31, 0
    s_cbranch_scc1 SF_401
SFD_402:
AG_403:
    s_cmp_lg_u32 s31, 0
    s_cbranch_scc1 SF_404
SFD_405:
    buffer_load_dword v5, v4, s[4:7], s74 offen sc1
    buffer_load_dwordx4 v[128:131], v89, s[4:7], s40 offen offset:0 sc1
    buffer_load_dwordx4 v[132:135], v89, s[4:7], s40 offen offset:256 sc1
    buffer_load_dwordx4 v[136:139], v89, s[4:7], s40 offen offset:2048 sc1
    buffer_load_dwordx4 v[140:143], v89, s[4:7], s40 offen offset:2304 sc1
    s_cmp_lg_u32 s29, 0
    s_cselect_b32 vcc_lo, -2, -1
    s_subb_u32 s29, s29, 0
    s_waitcnt vmcnt(2)
    v_max3_u32 v5, v5, v128, v132
    s_waitcnt vmcnt(0)
    v_max3_u32 v5, v5, v136, v140
    v_cmp_lt_u32 vcc, vcc_lo, v5
    s_cbranch_vccnz AG_403
    buffer_load_dwordx4 v[144:147], v89, s[4:7], s41 offen offset:0 sc1
    buffer_load_dwordx4 v[148:151], v89, s[4:7], s41 offen offset:256 sc1
    s_waitcnt lgkmcnt(5)
    v_mfma_f32_16x16x32_bf16 v[32:35], v[96:99], v[128:131], 0
    ds_read_b128 v[120:123], v88 offset:32768
    v_mfma_f32_16x16x32_bf16 v[36:39], v[96:99], v[132:135], 0
    buffer_load_dwordx4 v[152:155], v89, s[4:7], s41 offen offset:2048 sc1
    s_waitcnt lgkmcnt(5)
    v_mfma_f32_16x16x32_bf16 v[40:43], v[100:103], v[128:131], 0
    ds_read_b128 v[124:127], v1 offset:1024
    v_mfma_f32_16x16x32_bf16 v[44:47], v[100:103], v[132:135], 0
    s_waitcnt lgkmcnt(5)
    v_mfma_f32_16x16x32_bf16 v[48:51], v[104:107], v[128:131], 0
    ds_read_b128 v[96:99], v1 offset:17408
    v_mfma_f32_16x16x32_bf16 v[52:55], v[104:107], v[132:135], 0
    buffer_load_dwordx4 v[156:159], v89, s[4:7], s41 offen offset:2304 sc1
    s_waitcnt lgkmcnt(5)
    v_mfma_f32_16x16x32_bf16 v[56:59], v[108:111], v[128:131], 0
    ds_read_b128 v[100:103], v1 offset:33792
    v_mfma_f32_16x16x32_bf16 v[60:63], v[108:111], v[132:135], 0
    s_waitcnt lgkmcnt(5)
    v_mfma_f32_16x16x32_bf16 v[64:67], v[112:115], v[128:131], 0
    ds_read_b128 v[104:107], v1 offset:50176
    v_mfma_f32_16x16x32_bf16 v[68:71], v[112:115], v[132:135], 0
    buffer_load_dwordx4 v[12:15], v90, s[4:7], s74 offen offset:0 sc1
    s_waitcnt lgkmcnt(5)
    v_mfma_f32_16x16x32_bf16 v[72:75], v[116:119], v[128:131], 0
    ds_read_b128 v[108:111], v88 offset:1024
    v_mfma_f32_16x16x32_bf16 v[76:79], v[116:119], v[132:135], 0
    s_waitcnt lgkmcnt(5)
    v_mfma_f32_16x16x32_bf16 v[80:83], v[120:123], v[128:131], 0
    ds_read_b128 v[112:115], v88 offset:17408
    v_mfma_f32_16x16x32_bf16 v[84:87], v[120:123], v[132:135], 0
    buffer_load_dwordx4 v[160:163], v89, s[4:7], s42 offen offset:0 sc1
    s_waitcnt lgkmcnt(5)
    v_mfma_f32_16x16x32_bf16 v[32:35], v[124:127], v[136:139], v[32:35]
    ds_read_b128 v[116:119], v88 offset:33792
    v_mfma_f32_16x16x32_bf16 v[36:39], v[124:127], v[140:143], v[36:39]
    buffer_load_dwordx4 v[164:167], v89, s[4:7], s42 offen offset:256 sc1
    s_waitcnt lgkmcnt(5)
    v_mfma_f32_16x16x32_bf16 v[40:43], v[96:99], v[136:139], v[40:43]
    ds_read_b128 v[120:123], v1 offset:2048
    v_mfma_f32_16x16x32_bf16 v[44:47], v[96:99], v[140:143], v[44:47]
    s_waitcnt lgkmcnt(5)
    v_mfma_f32_16x16x32_bf16 v[48:51], v[100:103], v[136:139], v[48:51]
    ds_read_b128 v[124:127], v1 offset:18432
    v_mfma_f32_16x16x32_bf16 v[52:55], v[100:103], v[140:143], v[52:55]
TCH12:
    s_cbranch_execz TCHRET
    buffer_load_dwordx4 v[16:19], v90, s[4:7], s74 offen offset:256 sc1
    s_waitcnt lgkmcnt(5)
    v_mfma_f32_16x16x32_bf16 v[56:59], v[104:107], v[136:139], v[56:59]
    ds_read_b128 v[96:99], v1 offset:34816
    v_mfma_f32_16x16x32_bf16 v[60:63], v[104:107], v[140:143], v[60:63]
    s_waitcnt vmcnt(6)
    v_max_u32 v5, v144, v148
    v_cmp_eq_u32 vcc, -1, v5
    s_waitcnt lgkmcnt(5)
    v_mfma_f32_16x16x32_bf16 v[64:67], v[108:111], v[136:139], v[64:67]
    ds_read_b128 v[100:103], v1 offset:51200
    v_mfma_f32_16x16x32_bf16 v[68:71], v[108:111], v[140:143], v[68:71]
    s_cbranch_vccnz RT_406
BK_407:
    buffer_load_dwordx4 v[168:171], v89, s[4:7], s42 offen offset:2048 sc1
    s_waitcnt lgkmcnt(5)
    v_mfma_f32_16x16x32_bf16 v[72:75], v[112:115], v[136:139], v[72:75]
    ds_read_b128 v[104:107], v88 offset:2048
    v_mfma_f32_16x16x32_bf16 v[76:79], v[112:115], v[140:143], v[76:79]
    s_waitcnt lgkmcnt(5)
    v_mfma_f32_16x16x32_bf16 v[80:83], v[116:119], v[136:139], v[80:83]
    ds_read_b128 v[108:111], v88 offset:18432
    v_mfma_f32_16x16x32_bf16 v[84:87], v[116:119], v[140:143], v[84:87]
    buffer_load_dwordx4 v[172:175], v89, s[4:7], s42 offen offset:2304 sc1
    s_waitcnt lgkmcnt(5)
    v_mfma_f32_16x16x32_bf16 v[32:35], v[120:123], v[144:147], v[32:35]
    ds_read_b128 v[112:115], v88 offset:34816
    v_mfma_f32_16x16x32_bf16 v[36:39], v[120:123], v[148:151], v[36:39]
    buffer_load_dwordx4 v[20:23], v90, s[4:7], s74 offen offset:512 sc1
    s_waitcnt lgkmcnt(5)
    v_mfma_f32_16x16x32_bf16 v[40:43], v[124:127], v[144:147], v[40:43]
    ds_read_b128 v[116:119], v1 offset:3072
    v_mfma_f32_16x16x32_bf16 v[44:47], v[124:127], v[148:151], v[44:47]
    s_waitcnt lgkmcnt(5)
    v_mfma_f32_16x16x32_bf16 v[48:51], v[96:99], v[144:147], v[48:51]
    ds_read_b128 v[120:123], v1 offset:19456
    v_mfma_f32_16x16x32_bf16 v[52:55], v[96:99], v[148:151], v[52:55]
    buffer_load_dwordx4 v[24:27], v90, s[4:7], s74 offen offset:768 sc1
    s_waitcnt lgkmcnt(5)
    v_mfma_f32_16x16x32_bf16 v[56:59], v[100:103], v[144:147], v[56:59]
    ds_read_b128 v[124:127], v1 offset:35840
    v_mfma_f32_16x16x32_bf16 v[60:63], v[100:103], v[148:151], v[60:63]
    s_waitcnt vmcnt(8)
    v_max_u32 v5, v152, v156
    v_cmp_eq_u32 vcc, -1, v5
    s_waitcnt lgkmcnt(5)
    v_mfma_f32_16x16x32_bf16 v[64:67], v[104:107], v[144:147], v[64:67]
    ds_read_b128 v[96:99], v1 offset:52224
    v_mfma_f32_16x16x32_bf16 v[68:71], v[104:107], v[148:151], v[68:71]
    s_cbranch_vccnz RT_410
BK_411:
    buffer_load_dwordx4 v[176:179], v89, s[4:7], s43 offen offset:0 sc1
    s_waitcnt lgkmcnt(5)
    v_mfma_f32_16x16x32_bf16 v[72:75], v[108:111], v[144:147], v[72:75]
    ds_read_b128 v[100:103], v88 offset:3072
    v_mfma_f32_16x16x32_bf16 v[76:79], v[108:111], v[148:151], v[76:79]
    s_waitcnt lgkmcnt(5)
    v_mfma_f32_16x16x32_bf16 v[80:83], v[112:115], v[144:147], v[80:83]
    ds_read_b128 v[104:107], v88 offset:19456
    v_mfma_f32_16x16x32_bf16 v[84:87], v[112:115], v[148:151], v[84:87]
    buffer_load_dwordx4 v[180:183], v89, s[4:7], s43 offen offset:256 sc1
    s_waitcnt lgkmcnt(5)
    v_mfma_f32_16x16x32_bf16 v[32:35], v[116:119], v[152:155], v[32:35]
    ds_read_b128 v[108:111], v88 offset:35840
    v_mfma_f32_16x16x32_bf16 v[36:39], v[116:119], v[156:159], v[36:39]
    buffer_load_dwordx4 v[184:187], v89, s[4:7], s43 offen offset:2048 sc1
    s_waitcnt lgkmcnt(5)
    v_mfma_f32_16x16x32_bf16 v[40:43], v[120:123], v[152:155], v[40:43]
    ds_read_b128 v[112:115], v1 offset:4096
    v_mfma_f32_16x16x32_bf16 v[44:47], v[120:123], v[156:159], v[44:47]
    s_waitcnt lgkmcnt(5)
    v_mfma_f32_16x16x32_bf16 v[48:51], v[124:127], v[152:155], v[48:51]
    ds_read_b128 v[116:119], v1 offset:20480
    v_mfma_f32_16x16x32_bf16 v[52:55], v[124:127], v[156:159], v[52:55]
    buffer_load_dwordx4 v[188:191], v89, s[4:7], s43 offen offset:2304 sc1
    s_waitcnt lgkmcnt(5)
    v_mfma_f32_16x16x32_bf16 v[56:59], v[96:99], v[152:155], v[56:59]
    ds_read_b128 v[120:123], v1 offset:36864
    v_mfma_f32_16x16x32_bf16 v[60:63], v[96:99], v[156:159], v[60:63]
    s_waitcnt vmcnt(9)
    v_max_u32 v5, v160, v164
    v_cmp_eq_u32 vcc, -1, v5
    s_waitcnt lgkmcnt(5)
    v_mfma_f32_16x16x32_bf16 v[64:67], v[100:103], v[152:155], v[64:67]
    ds_read_b128 v[124:127], v1 offset:53248
    v_mfma_f32_16x16x32_bf16 v[68:71], v[100:103], v[156:159], v[68:71]
    s_cbranch_vccnz RT_414
BK_415:
    s_waitcnt lgkmcnt(5)
    v_mfma_f32_16x16x32_bf16 v[72:75], v[104:107], v[152:155], v[72:75]
    ds_read_b128 v[96:99], v88 offset:4096
    v_mfma_f32_16x16x32_bf16 v[76:79], v[104:107], v[156:159], v[76:79]
    s_waitcnt lgkmcnt(5)
    v_mfma_f32_16x16x32_bf16 v[80:83], v[108:111], v[152:155], v[80:83]
    ds_read_b128 v[100:103], v88 offset:20480
    v_mfma_f32_16x16x32_bf16 v[84:87], v[108:111], v[156:159], v[84:87]
    s_waitcnt lgkmcnt(5)
    v_mfma_f32_16x16x32_bf16 v[32:35], v[112:115], v[160:163], v[32:35]
    ds_read_b128 v[104:107], v88 offset:36864
    s_waitcnt vmcnt(4)
    v_add_f32 v12, v12, v16
    v_mfma_f32_16x16x32_bf16 v[36:39], v[112:115], v[164:167], v[36:39]
    buffer_load_dwordx4 v[192:195], v89, s[4:7], s44 offen offset:0 sc1
    v_add_f32 v13, v13, v17
    s_waitcnt lgkmcnt(5)
    v_mfma_f32_16x16x32_bf16 v[40:43], v[116:119], v[160:163], v[40:43]
    ds_read_b128 v[108:111], v1 offset:5120
    v_add_f32 v14, v14, v18
    v_mfma_f32_16x16x32_bf16 v[44:47], v[116:119], v[164:167], v[44:47]
    v_add_f32 v15, v15, v19
    v_add_f32 v20, v20, v24
    s_waitcnt lgkmcnt(5)
    v_mfma_f32_16x16x32_bf16 v[48:51], v[120:123], v[160:163], v[48:51]
    ds_read_b128 v[112:115], v1 offset:21504
    v_add_f32 v21, v21, v25
    v_mfma_f32_16x16x32_bf16 v[52:55], v[120:123], v[164:167], v[52:55]
    buffer_load_dwordx4 v[196:199], v89, s[4:7], s44 offen offset:256 sc1
    v_add_f32 v22, v22, v26
    s_waitcnt lgkmcnt(5)
    v_mfma_f32_16x16x32_bf16 v[56:59], v[124:127], v[160:163], v[56:59]
    ds_read_b128 v[116:119], v1 offset:37888
    v_add_f32 v23, v23, v27
    v_mfma_f32_16x16x32_bf16 v[60:63], v[124:127], v[164:167], v[60:63]
    s_waitcnt vmcnt(8)
    v_max_u32 v5, v168, v172
    v_cmp_eq_u32 vcc, -1, v5
    s_waitcnt lgkmcnt(5)
    v_mfma_f32_16x16x32_bf16 v[64:67], v[96:99], v[160:163], v[64:67]
    ds_read_b128 v[120:123], v1 offset:54272
    v_mfma_f32_16x16x32_bf16 v[68:71], v[96:99], v[164:167], v[68:71]
    s_cbranch_vccnz RT_418
BK_419:
    v_add_f32 v12, v12, v20
    v_add_f32 v13, v13, v21
    s_waitcnt lgkmcnt(5)
    v_mfma_f32_16x16x32_bf16 v[72:75], v[100:103], v[160:163], v[72:75]
    ds_read_b128 v[124:127], v88 offset:5120
    v_add_f32 v14, v14, v22
    v_mfma_f32_16x16x32_bf16 v[76:79], v[100:103], v[164:167], v[76:79]
    v_add_f32 v15, v15, v23
    v_permlane32_swap_b32 v12, v14
    s_waitcnt lgkmcnt(5)
    v_mfma_f32_16x16x32_bf16 v[80:83], v[104:107], v[160:163], v[80:83]
    ds_read_b128 v[96:99], v88 offset:21504
    v_permlane32_swap_b32 v13, v15
    v_mfma_f32_16x16x32_bf16 v[84:87], v[104:107], v[164:167], v[84:87]
    v_add_f32 v12, v12, v14
    v_add_f32 v13, v13, v15
    s_waitcnt lgkmcnt(5)
    v_mfma_f32_16x16x32_bf16 v[32:35], v[108:111], v[168:171], v[32:35]
    ds_read_b128 v[100:103], v88 offset:37888
    v_cmp_u_f32 vcc, v12, v13
    s_nop 0
    s_cbranch_vccnz RT_462
BK_463:
    v_mfma_f32_16x16x32_bf16 v[36:39], v[108:111], v[172:175], v[36:39]
    buffer_load_dwordx4 v[200:203], v89, s[4:7], s44 offen offset:2048 sc1
    v_mov_b32 v14, v12
    s_waitcnt lgkmcnt(5)
    v_mfma_f32_16x16x32_bf16 v[40:43], v[112:115], v[168:171], v[40:43]
    ds_read_b128 v[104:107], v1 offset:6144
    v_mov_b32 v15, v13
    v_mfma_f32_16x16x32_bf16 v[44:47], v[112:115], v[172:175], v[44:47]
    v_permlane16_swap_b32 v12, v14
    v_permlane16_swap_b32 v13, v15
    s_waitcnt lgkmcnt(5)
    v_mfma_f32_16x16x32_bf16 v[48:51], v[116:119], v[168:171], v[48:51]
    ds_read_b128 v[108:111], v1 offset:22528
    v_add_f32 v12, v12, v14
    v_mfma_f32_16x16x32_bf16 v[52:55], v[116:119], v[172:175], v[52:55]
    buffer_load_dwordx4 v[204:207], v89, s[4:7], s44 offen offset:2304 sc1
    v_add_f32 v13, v13, v15
    s_waitcnt lgkmcnt(5)
    v_mfma_f32_16x16x32_bf16 v[56:59], v[120:123], v[168:171], v[56:59]
    ds_read_b128 v[112:115], v1 offset:38912
    v_mul_f32 v94, 3137339392, v12
    v_mfma_f32_16x16x32_bf16 v[60:63], v[120:123], v[172:175], v[60:63]
    s_waitcnt vmcnt(6)
    v_max_u32 v5, v176, v180
    v_cmp_eq_u32 vcc, -1, v5
    s_waitcnt lgkmcnt(5)
    v_mfma_f32_16x16x32_bf16 v[64:67], v[124:127], v[168:171], v[64:67]
    ds_read_b128 v[116:119], v1 offset:55296
    v_mfma_f32_16x16x32_bf16 v[68:71], v[124:127], v[172:175], v[68:71]
    s_cbranch_vccnz RT_422
BK_423:
    v_mul_f32 v13, 989855744, v13
    v_fma_f32 v13, -v94, v94, v13
    s_waitcnt lgkmcnt(5)
    v_mfma_f32_16x16x32_bf16 v[72:75], v[96:99], v[168:171], v[72:75]
    ds_read_b128 v[120:123], v88 offset:6144
    v_max_f32 v13, 0, v13
    v_mfma_f32_16x16x32_bf16 v[76:79], v[96:99], v[172:175], v[76:79]
    v_add_f32 v13, 925353388, v13
    v_mov_b32 v95, v94
    s_waitcnt lgkmcnt(5)
    v_mfma_f32_16x16x32_bf16 v[80:83], v[100:103], v[168:171], v[80:83]
    ds_read_b128 v[124:127], v88 offset:22528
    v_rsq_f32 v12, v13
    v_mfma_f32_16x16x32_bf16 v[84:87], v[100:103], v[172:175], v[84:87]
    v_permlane32_swap_b32 v94, v95
    v_mul_f32 v92, v13, v12
    s_waitcnt lgkmcnt(5)
    v_mfma_f32_16x16x32_bf16 v[32:35], v[104:107], v[176:179], v[32:35]
    ds_read_b128 v[96:99], v88 offset:38912
    v_mul_f32 v29, 3222493025, v12
    v_mfma_f32_16x16x32_bf16 v[36:39], v[104:107], v[180:183], v[36:39]
    buffer_load_dwordx4 v[208:211], v89, s[4:7], s45 offen offset:0 sc1
    v_mul_f32 v28, v12, v12
    s_waitcnt lgkmcnt(5)
    v_mfma_f32_16x16x32_bf16 v[40:43], v[108:111], v[176:179], v[40:43]
    ds_read_b128 v[100:103], v1 offset:7168
    v_mov_b32 v93, v92
    v_mfma_f32_16x16x32_bf16 v[44:47], v[108:111], v[180:183], v[44:47]
    v_mul_f32 v28, v28, v12
    v_mov_b32 v31, v29
    s_waitcnt lgkmcnt(5)
    v_mfma_f32_16x16x32_bf16 v[48:51], v[112:115], v[176:179], v[48:51]
    ds_read_b128 v[104:107], v1 offset:23552
    v_mul_f32 v28, 3184710632, v28
    v_mfma_f32_16x16x32_bf16 v[52:55], v[112:115], v[180:183], v[52:55]
    buffer_load_dwordx4 v[212:215], v89, s[4:7], s45 offen offset:256 sc1
    v_permlane32_swap_b32 v92, v93
    s_waitcnt lgkmcnt(5)
    v_mfma_f32_16x16x32_bf16 v[56:59], v[116:119], v[176:179], v[56:59]
    ds_read_b128 v[108:111], v1 offset:39936
    v_mov_b32 v30, v28
    v_mfma_f32_16x16x32_bf16 v[60:63], v[116:119], v[180:183], v[60:63]
    s_waitcnt vmcnt(6)
    v_max_u32 v5, v184, v188
    v_cmp_eq_u32 vcc, -1, v5
    s_waitcnt lgkmcnt(5)
    v_mfma_f32_16x16x32_bf16 v[64:67], v[120:123], v[176:179], v[64:67]
    ds_read_b128 v[112:115], v1 offset:56320
    v_mfma_f32_16x16x32_bf16 v[68:71], v[120:123], v[180:183], v[68:71]
    s_cbranch_vccnz RT_426
BK_427:
    v_permlane32_swap_b32 v29, v31
    s_nop 0
    s_waitcnt lgkmcnt(5)
    v_mfma_f32_16x16x32_bf16 v[72:75], v[124:127], v[176:179], v[72:75]
    ds_read_b128 v[116:119], v88 offset:7168
    v_permlane32_swap_b32 v28, v30
    v_mfma_f32_16x16x32_bf16 v[76:79], v[124:127], v[180:183], v[76:79]
    ds_read_b128 v[12:15], v91 offset:16
    s_waitcnt lgkmcnt(6)
    v_mfma_f32_16x16x32_bf16 v[80:83], v[96:99], v[176:179], v[80:83]
    ds_read_b128 v[120:123], v88 offset:23552
    v_mfma_f32_16x16x32_bf16 v[84:87], v[96:99], v[180:183], v[84:87]
    s_waitcnt lgkmcnt(6)
    v_mfma_f32_16x16x32_bf16 v[32:35], v[100:103], v[184:187], v[32:35]
    ds_read_b128 v[124:127], v88 offset:39936
    v_mfma_f32_16x16x32_bf16 v[36:39], v[100:103], v[188:191], v[36:39]
    buffer_load_dwordx4 v[216:219], v89, s[4:7], s45 offen offset:2048 sc1
    s_waitcnt lgkmcnt(6)
    v_mfma_f32_16x16x32_bf16 v[40:43], v[104:107], v[184:187], v[40:43]
    ds_read_b128 v[96:99], v1 offset:8192
    v_mfma_f32_16x16x32_bf16 v[44:47], v[104:107], v[188:191], v[44:47]
    s_waitcnt lgkmcnt(6)
    v_mfma_f32_16x16x32_bf16 v[48:51], v[108:111], v[184:187], v[48:51]
    ds_read_b128 v[100:103], v1 offset:24576
    s_waitcnt lgkmcnt(4)
    v_fmac_f32 v32, v12, v92
    v_mfma_f32_16x16x32_bf16 v[52:55], v[108:111], v[188:191], v[52:55]
    buffer_load_dwordx4 v[220:223], v89, s[4:7], s45 offen offset:2304 sc1
    v_fmac_f32 v33, v13, v92
    s_waitcnt lgkmcnt(6)
    v_mfma_f32_16x16x32_bf16 v[56:59], v[112:115], v[184:187], v[56:59]
    ds_read_b128 v[104:107], v1 offset:40960
    v_fmac_f32 v34, v14, v92
    v_mfma_f32_16x16x32_bf16 v[60:63], v[112:115], v[188:191], v[60:63]
    s_waitcnt vmcnt(6)
    v_max_u32 v5, v192, v196
    v_cmp_eq_u32 vcc, -1, v5
    s_waitcnt lgkmcnt(6)
    v_mfma_f32_16x16x32_bf16 v[64:67], v[116:119], v[184:187], v[64:67]
    ds_read_b128 v[108:111], v1 offset:57344
    v_fmac_f32 v35, v15, v92
    v_mfma_f32_16x16x32_bf16 v[68:71], v[116:119], v[188:191], v[68:71]
    s_cbranch_vccnz RT_430
BK_431:
    v_fmac_f32 v36, v12, v93
    v_fmac_f32 v37, v13, v93
    s_waitcnt lgkmcnt(5)
    v_mfma_f32_16x16x32_bf16 v[72:75], v[120:123], v[184:187], v[72:75]
    ds_read_b128 v[112:115], v88 offset:8192
    v_fmac_f32 v38, v14, v93
    v_mfma_f32_16x16x32_bf16 v[76:79], v[120:123], v[188:191], v[76:79]
    v_fmac_f32 v39, v15, v93
    ds_read_b128 v[20:23], v91 offset:0
    s_waitcnt lgkmcnt(6)
    v_mfma_f32_16x16x32_bf16 v[80:83], v[124:127], v[184:187], v[80:83]
    ds_read_b128 v[116:119], v88 offset:24576
    v_mfma_f32_16x16x32_bf16 v[84:87], v[124:127], v[188:191], v[84:87]
    ds_read_b128 v[16:19], v91 offset:144
    s_waitcnt lgkmcnt(7)
    v_mfma_f32_16x16x32_bf16 v[32:35], v[96:99], v[192:195], v[32:35]
    ds_read_b128 v[120:123], v88 offset:40960
    v_mfma_f32_16x16x32_bf16 v[36:39], v[96:99], v[196:199], v[36:39]
    buffer_load_dwordx4 v[224:227], v89, s[4:7], s46 offen offset:0 sc1
    s_waitcnt lgkmcnt(7)
    v_mfma_f32_16x16x32_bf16 v[40:43], v[100:103], v[192:195], v[40:43]
    ds_read_b128 v[124:127], v1 offset:9216
    v_mfma_f32_16x16x32_bf16 v[44:47], v[100:103], v[196:199], v[44:47]
    s_waitcnt lgkmcnt(7)
    v_mfma_f32_16x16x32_bf16 v[48:51], v[104:107], v[192:195], v[48:51]
    ds_read_b128 v[96:99], v1 offset:25600
    s_waitcnt lgkmcnt(5)
    v_fmac_f32 v32, v20, v94
    v_mfma_f32_16x16x32_bf16 v[52:55], v[104:107], v[196:199], v[52:55]
    buffer_load_dwordx4 v[228:231], v89, s[4:7], s46 offen offset:256 sc1
    v_fmac_f32 v33, v21, v94
    s_waitcnt lgkmcnt(7)
    v_mfma_f32_16x16x32_bf16 v[56:59], v[108:111], v[192:195], v[56:59]
    ds_read_b128 v[100:103], v1 offset:41984
    v_fmac_f32 v34, v22, v94
    v_mfma_f32_16x16x32_bf16 v[60:63], v[108:111], v[196:199], v[60:63]
    s_waitcnt vmcnt(6)
    v_max_u32 v5, v200, v204
    v_cmp_eq_u32 vcc, -1, v5
    s_waitcnt lgkmcnt(7)
    v_mfma_f32_16x16x32_bf16 v[64:67], v[112:115], v[192:195], v[64:67]
    ds_read_b128 v[104:107], v1 offset:58368
    v_fmac_f32 v35, v23, v94
    v_mfma_f32_16x16x32_bf16 v[68:71], v[112:115], v[196:199], v[68:71]
    s_cbranch_vccnz RT_434
BK_435:
    v_fmac_f32 v36, v20, v95
    v_fmac_f32 v37, v21, v95
    s_waitcnt lgkmcnt(6)
    v_mfma_f32_16x16x32_bf16 v[72:75], v[116:119], v[192:195], v[72:75]
    ds_read_b128 v[108:111], v88 offset:9216
    v_fmac_f32 v38, v22, v95
    v_mfma_f32_16x16x32_bf16 v[76:79], v[116:119], v[196:199], v[76:79]
    v_fmac_f32 v39, v23, v95
    s_waitcnt lgkmcnt(6)
    v_fmac_f32 v40, v16, v92
    s_waitcnt lgkmcnt(5)
    v_mfma_f32_16x16x32_bf16 v[80:83], v[120:123], v[192:195], v[80:83]
    ds_read_b128 v[112:115], v88 offset:25600
    v_fmac_f32 v41, v17, v92
    v_mfma_f32_16x16x32_bf16 v[84:87], v[120:123], v[196:199], v[84:87]
    v_fmac_f32 v42, v18, v92
    v_fmac_f32 v43, v19, v92
    v_fmac_f32 v44, v16, v93
    v_fmac_f32 v45, v17, v93
    v_fmac_f32 v46, v18, v93
    v_fmac_f32 v47, v19, v93
    ds_read_b128 v[24:27], v91 offset:128
    s_waitcnt lgkmcnt(6)
    v_mfma_f32_16x16x32_bf16 v[32:35], v[124:127], v[200:203], v[32:35]
    ds_read_b128 v[116:119], v88 offset:41984
    v_mfma_f32_16x16x32_bf16 v[36:39], v[124:127], v[204:207], v[36:39]
    buffer_load_dwordx4 v[232:235], v89, s[4:7], s46 offen offset:2048 sc1
    ds_read_b128 v[12:15], v91 offset:272
    s_waitcnt lgkmcnt(7)
    v_mfma_f32_16x16x32_bf16 v[40:43], v[96:99], v[200:203], v[40:43]
    ds_read_b128 v[120:123], v1 offset:10240
    v_mfma_f32_16x16x32_bf16 v[44:47], v[96:99], v[204:207], v[44:47]
    s_waitcnt lgkmcnt(7)
    v_mfma_f32_16x16x32_bf16 v[48:51], v[100:103], v[200:203], v[48:51]
    ds_read_b128 v[124:127], v1 offset:26624
    v_mfma_f32_16x16x32_bf16 v[52:55], v[100:103], v[204:207], v[52:55]
    buffer_load_dwordx4 v[236:239], v89, s[4:7], s46 offen offset:2304 sc1
    s_waitcnt lgkmcnt(7)
    v_mfma_f32_16x16x32_bf16 v[56:59], v[104:107], v[200:203], v[56:59]
    ds_read_b128 v[96:99], v1 offset:43008
    s_waitcnt lgkmcnt(5)
    v_fmac_f32 v40, v24, v94
    v_mfma_f32_16x16x32_bf16 v[60:63], v[104:107], v[204:207], v[60:63]
    s_waitcnt vmcnt(6)
    v_max_u32 v5, v208, v212
    v_cmp_eq_u32 vcc, -1, v5
    s_waitcnt lgkmcnt(7)
    v_mfma_f32_16x16x32_bf16 v[64:67], v[108:111], v[200:203], v[64:67]
    ds_read_b128 v[100:103], v1 offset:59392
    v_fmac_f32 v41, v25, v94
    v_mfma_f32_16x16x32_bf16 v[68:71], v[108:111], v[204:207], v[68:71]
    s_cbranch_vccnz RT_438
BK_439:
    v_fmac_f32 v42, v26, v94
    v_fmac_f32 v43, v27, v94
    s_waitcnt lgkmcnt(7)
    v_mfma_f32_16x16x32_bf16 v[72:75], v[112:115], v[200:203], v[72:75]
    ds_read_b128 v[104:107], v88 offset:10240
    v_fmac_f32 v44, v24, v95
    v_mfma_f32_16x16x32_bf16 v[76:79], v[112:115], v[204:207], v[76:79]
    v_fmac_f32 v45, v25, v95
    v_fmac_f32 v46, v26, v95
    s_waitcnt lgkmcnt(6)
    v_mfma_f32_16x16x32_bf16 v[80:83], v[116:119], v[200:203], v[80:83]
    ds_read_b128 v[108:111], v88 offset:26624
    v_fmac_f32 v47, v27, v95
    v_mfma_f32_16x16x32_bf16 v[84:87], v[116:119], v[204:207], v[84:87]
    s_waitcnt lgkmcnt(6)
    v_fmac_f32 v48, v12, v92
    v_fmac_f32 v49, v13, v92
    s_waitcnt lgkmcnt(5)
    v_mfma_f32_16x16x32_bf16 v[32:35], v[120:123], v[208:211], v[32:35]
    ds_read_b128 v[112:115], v88 offset:43008
    v_fmac_f32 v50, v14, v92
    v_mfma_f32_16x16x32_bf16 v[36:39], v[120:123], v[212:215], v[36:39]
    buffer_load_dwordx4 v[240:243], v89, s[4:7], s47 offen offset:0 sc1
    v_fmac_f32 v51, v15, v92
    v_fmac_f32 v52, v12, v93
    v_fmac_f32 v53, v13, v93
    v_fmac_f32 v54, v14, v93
    v_fmac_f32 v55, v15, v93
    ds_read_b128 v[20:23], v91 offset:256
    s_waitcnt lgkmcnt(6)
    v_mfma_f32_16x16x32_bf16 v[40:43], v[124:127], v[208:211], v[40:43]
    ds_read_b128 v[116:119], v1 offset:11264
    v_mfma_f32_16x16x32_bf16 v[44:47], v[124:127], v[212:215], v[44:47]
    ds_read_b128 v[16:19], v91 offset:400
    s_waitcnt lgkmcnt(7)
    v_mfma_f32_16x16x32_bf16 v[48:51], v[96:99], v[208:211], v[48:51]
    ds_read_b128 v[120:123], v1 offset:27648
    v_mfma_f32_16x16x32_bf16 v[52:55], v[96:99], v[212:215], v[52:55]
    buffer_load_dwordx4 v[244:247], v89, s[4:7], s47 offen offset:256 sc1
    s_waitcnt lgkmcnt(7)
    v_mfma_f32_16x16x32_bf16 v[56:59], v[100:103], v[208:211], v[56:59]
    ds_read_b128 v[124:127], v1 offset:44032
    v_mfma_f32_16x16x32_bf16 v[60:63], v[100:103], v[212:215], v[60:63]
    s_waitcnt vmcnt(6)
    v_max_u32 v5, v216, v220
    v_cmp_eq_u32 vcc, -1, v5
    s_waitcnt lgkmcnt(7)
    v_mfma_f32_16x16x32_bf16 v[64:67], v[104:107], v[208:211], v[64:67]
    ds_read_b128 v[96:99], v1 offset:60416
    s_waitcnt lgkmcnt(5)
    v_fmac_f32 v48, v20, v94
    v_mfma_f32_16x16x32_bf16 v[68:71], v[104:107], v[212:215], v[68:71]
    s_cbranch_vccnz RT_442
BK_443:
    v_fmac_f32 v49, v21, v94
    v_fmac_f32 v50, v22, v94
    s_waitcnt lgkmcnt(7)
    v_mfma_f32_16x16x32_bf16 v[72:75], v[108:111], v[208:211], v[72:75]
    ds_read_b128 v[100:103], v88 offset:11264
    v_fmac_f32 v51, v23, v94
    v_mfma_f32_16x16x32_bf16 v[76:79], v[108:111], v[212:215], v[76:79]
    v_fmac_f32 v52, v20, v95
    v_fmac_f32 v53, v21, v95
    s_waitcnt lgkmcnt(7)
    v_mfma_f32_16x16x32_bf16 v[80:83], v[112:115], v[208:211], v[80:83]
    ds_read_b128 v[104:107], v88 offset:27648
    v_fmac_f32 v54, v22, v95
    v_mfma_f32_16x16x32_bf16 v[84:87], v[112:115], v[212:215], v[84:87]
    v_fmac_f32 v55, v23, v95
    s_waitcnt lgkmcnt(5)
    v_fmac_f32 v56, v16, v92
    s_waitcnt lgkmcnt(6)
    v_mfma_f32_16x16x32_bf16 v[32:35], v[116:119], v[216:219], v[32:35]
    ds_read_b128 v[108:111], v88 offset:44032
    v_fmac_f32 v57, v17, v92
    v_mfma_f32_16x16x32_bf16 v[36:39], v[116:119], v[220:223], v[36:39]
    buffer_load_dwordx4 v[248:251], v89, s[4:7], s47 offen offset:2048 sc1
    v_fmac_f32 v58, v18, v92
    s_waitcnt lgkmcnt(5)
    v_mfma_f32_16x16x32_bf16 v[40:43], v[120:123], v[216:219], v[40:43]
    ds_read_b128 v[112:115], v1 offset:12288
    v_fmac_f32 v59, v19, v92
    v_mfma_f32_16x16x32_bf16 v[44:47], v[120:123], v[220:223], v[44:47]
    v_fmac_f32 v60, v16, v93
    v_fmac_f32 v61, v17, v93
    v_fmac_f32 v62, v18, v93
    v_fmac_f32 v63, v19, v93
    ds_read_b128 v[24:27], v91 offset:384
    s_waitcnt lgkmcnt(6)
    v_mfma_f32_16x16x32_bf16 v[48:51], v[124:127], v[216:219], v[48:51]
    ds_read_b128 v[116:119], v1 offset:28672
    v_mfma_f32_16x16x32_bf16 v[52:55], v[124:127], v[220:223], v[52:55]
    buffer_load_dwordx4 v[252:255], v89, s[4:7], s47 offen offset:2304 sc1
    ds_read_b128 v[12:15], v91 offset:528
    s_waitcnt lgkmcnt(7)
    v_mfma_f32_16x16x32_bf16 v[56:59], v[96:99], v[216:219], v[56:59]
    ds_read_b128 v[120:123], v1 offset:45056
    v_mfma_f32_16x16x32_bf16 v[60:63], v[96:99], v[220:223], v[60:63]
    s_waitcnt vmcnt(6)
    v_max_u32 v5, v224, v228
    v_cmp_eq_u32 vcc, -1, v5
    s_waitcnt lgkmcnt(7)
    v_mfma_f32_16x16x32_bf16 v[64:67], v[100:103], v[216:219], v[64:67]
    ds_read_b128 v[124:127], v1 offset:61440
    v_mfma_f32_16x16x32_bf16 v[68:71], v[100:103], v[220:223], v[68:71]
    s_cbranch_vccnz RT_446
BK_447:
    s_waitcnt lgkmcnt(7)
    v_mfma_f32_16x16x32_bf16 v[72:75], v[104:107], v[216:219], v[72:75]
    ds_read_b128 v[96:99], v88 offset:12288
    s_waitcnt lgkmcnt(5)
    v_fmac_f32 v56, v24, v94
    v_mfma_f32_16x16x32_bf16 v[76:79], v[104:107], v[220:223], v[76:79]
    v_fmac_f32 v57, v25, v94
    v_fmac_f32 v58, v26, v94
    s_waitcnt lgkmcnt(7)
    v_mfma_f32_16x16x32_bf16 v[80:83], v[108:111], v[216:219], v[80:83]
    ds_read_b128 v[100:103], v88 offset:28672
    v_fmac_f32 v59, v27, v94
    v_mfma_f32_16x16x32_bf16 v[84:87], v[108:111], v[220:223], v[84:87]
    v_fmac_f32 v60, v24, v95
    v_fmac_f32 v61, v25, v95
    s_waitcnt lgkmcnt(7)
    v_mfma_f32_16x16x32_bf16 v[32:35], v[112:115], v[224:227], v[32:35]
    s_lshr_b32 s70, s59, 3
    ds_read_b128 v[104:107], v88 offset:45056
    v_fmac_f32 v62, v26, v95
    v_mfma_f32_16x16x32_bf16 v[36:39], v[112:115], v[228:231], v[36:39]
    s_and_b32 s71, s59, 7
    v_fmac_f32 v63, v27, v95
    s_waitcnt lgkmcnt(5)
    v_fmac_f32 v64, v12, v92
    s_waitcnt lgkmcnt(6)
    v_mfma_f32_16x16x32_bf16 v[40:43], v[116:119], v[224:227], v[40:43]
    s_lshl2_add_u32 s71, s71, s60
    ds_read_b128 v[108:111], v1 offset:13312
    v_fmac_f32 v65, v13, v92
    v_mfma_f32_16x16x32_bf16 v[44:47], v[116:119], v[228:231], v[44:47]
    s_mul_i32 s32, s70, 229376
    v_fmac_f32 v66, v14, v92
    v_fmac_f32 v67, v15, v92
    s_waitcnt lgkmcnt(5)
    v_mfma_f32_16x16x32_bf16 v[48:51], v[120:123], v[224:227], v[48:51]
    s_mul_i32 s75, s60, 28672
    ds_read_b128 v[112:115], v1 offset:29696
    v_fmac_f32 v68, v12, v93
    v_mfma_f32_16x16x32_bf16 v[52:55], v[120:123], v[228:231], v[52:55]
    s_add_u32 s32, s32, s75
    v_fmac_f32 v69, v13, v93
    v_fmac_f32 v70, v14, v93
    v_fmac_f32 v71, v15, v93
    ds_read_b128 v[20:23], v91 offset:512
    s_waitcnt lgkmcnt(6)
    v_mfma_f32_16x16x32_bf16 v[56:59], v[124:127], v[224:227], v[56:59]
    s_add_u32 s32, s32, s63
    ds_read_b128 v[116:119], v1 offset:46080
    v_mfma_f32_16x16x32_bf16 v[60:63], v[124:127], v[228:231], v[60:63]
    s_add_u32 s32, s32, 524288
    s_waitcnt vmcnt(4)
    v_max_u32 v5, v232, v236
    v_cmp_eq_u32 vcc, -1, v5
    ds_read_b128 v[16:19], v91 offset:656
    s_waitcnt lgkmcnt(7)
    v_mfma_f32_16x16x32_bf16 v[64:67], v[96:99], v[224:227], v[64:67]
    s_add_u32 s33, s32, 7168
    ds_read_b128 v[120:123], v1 offset:62464
    v_mfma_f32_16x16x32_bf16 v[68:71], v[96:99], v[228:231], v[68:71]
    s_add_u32 s34, s32, 14336
    s_cbranch_vccnz RT_450
BK_451:
    s_waitcnt lgkmcnt(7)
    v_mfma_f32_16x16x32_bf16 v[72:75], v[100:103], v[224:227], v[72:75]
    s_add_u32 s35, s32, 21504
    ds_read_b128 v[124:127], v88 offset:13312
    v_mfma_f32_16x16x32_bf16 v[76:79], v[100:103], v[228:231], v[76:79]
    s_add_u32 s36, s32, 114688
    s_waitcnt lgkmcnt(7)
    v_mfma_f32_16x16x32_bf16 v[80:83], v[104:107], v[224:227], v[80:83]
    s_add_u32 s37, s32, 121856
    ds_read_b128 v[96:99], v88 offset:29696
    s_waitcnt lgkmcnt(5)
    v_fmac_f32 v64, v20, v94
    v_mfma_f32_16x16x32_bf16 v[84:87], v[104:107], v[228:231], v[84:87]
    s_add_u32 s38, s32, 129024
    v_fmac_f32 v65, v21, v94
    v_fmac_f32 v66, v22, v94
    s_waitcnt lgkmcnt(7)
    v_mfma_f32_16x16x32_bf16 v[32:35], v[108:111], v[232:235], v[32:35]
    s_add_u32 s39, s32, 136192
    ds_read_b128 v[100:103], v88 offset:46080
    v_fmac_f32 v67, v23, v94
    v_mfma_f32_16x16x32_bf16 v[36:39], v[108:111], v[236:239], v[36:39]
    s_lshl_b32 s75, s70, 16
    v_fmac_f32 v68, v20, v95
    v_fmac_f32 v69, v21, v95
    s_waitcnt lgkmcnt(7)
    v_mfma_f32_16x16x32_bf16 v[40:43], v[112:115], v[232:235], v[40:43]
    s_lshl_b32 s76, s71, 10
    ds_read_b128 v[104:107], v1 offset:14336
    v_fmac_f32 v70, v22, v95
    v_mfma_f32_16x16x32_bf16 v[44:47], v[112:115], v[236:239], v[44:47]
    s_add_u32 s75, s75, s76
    v_fmac_f32 v71, v23, v95
    s_waitcnt lgkmcnt(5)
    v_fmac_f32 v72, v16, v92
    s_waitcnt lgkmcnt(6)
    v_mfma_f32_16x16x32_bf16 v[48:51], v[116:119], v[232:235], v[48:51]
    s_add_u32 s75, s75, s63
    ds_read_b128 v[108:111], v1 offset:30720
    v_fmac_f32 v73, v17, v92
    v_mfma_f32_16x16x32_bf16 v[52:55], v[116:119], v[236:239], v[52:55]
    s_add_u32 s75, s75, 262144
    v_fmac_f32 v74, v18, v92
    v_fmac_f32 v75, v19, v92
    s_waitcnt lgkmcnt(5)
    v_mfma_f32_16x16x32_bf16 v[56:59], v[120:123], v[232:235], v[56:59]
    s_add_u32 s76, s75, 0x8000
    ds_read_b128 v[112:115], v1 offset:47104
    v_fmac_f32 v76, v16, v93
    v_mfma_f32_16x16x32_bf16 v[60:63], v[120:123], v[236:239], v[60:63]
    s_lshl2_add_u32 s78, s58, s70
    s_waitcnt vmcnt(2)
    v_max_u32 v5, v240, v244
    v_cmp_eq_u32 vcc, -1, v5
    v_fmac_f32 v77, v17, v93
    v_fmac_f32 v78, v18, v93
    v_fmac_f32 v79, v19, v93
    ds_read_b128 v[24:27], v91 offset:640
    s_waitcnt lgkmcnt(6)
    v_mfma_f32_16x16x32_bf16 v[64:67], v[124:127], v[232:235], v[64:67]
    s_lshl_b32 s78, s78, 16
    ds_read_b128 v[116:119], v1 offset:63488
    v_mfma_f32_16x16x32_bf16 v[68:71], v[124:127], v[236:239], v[68:71]
    s_lshl_b32 s71, s71, 5
    s_cbranch_vccnz RT_454
BK_455:
    ds_read_b128 v[12:15], v91 offset:784
    s_waitcnt lgkmcnt(7)
    v_mfma_f32_16x16x32_bf16 v[72:75], v[96:99], v[232:235], v[72:75]
    s_add_u32 s78, s78, s71
    ds_read_b128 v[120:123], v88 offset:14336
    v_mfma_f32_16x16x32_bf16 v[76:79], v[96:99], v[236:239], v[76:79]
    s_waitcnt lgkmcnt(7)
    v_mfma_f32_16x16x32_bf16 v[80:83], v[100:103], v[232:235], v[80:83]
    ds_read_b128 v[124:127], v88 offset:30720
    v_mfma_f32_16x16x32_bf16 v[84:87], v[100:103], v[236:239], v[84:87]
    s_waitcnt lgkmcnt(7)
    v_mfma_f32_16x16x32_bf16 v[32:35], v[104:107], v[240:243], v[32:35]
    ds_read_b128 v[96:99], v88 offset:47104
    s_waitcnt lgkmcnt(5)
    v_fmac_f32 v72, v24, v94
    v_mfma_f32_16x16x32_bf16 v[36:39], v[104:107], v[244:247], v[36:39]
    v_fmac_f32 v73, v25, v94
    v_fmac_f32 v74, v26, v94
    s_waitcnt lgkmcnt(7)
    v_mfma_f32_16x16x32_bf16 v[40:43], v[108:111], v[240:243], v[40:43]
    ds_read_b128 v[100:103], v1 offset:15360
    v_fmac_f32 v75, v27, v94
    v_mfma_f32_16x16x32_bf16 v[44:47], v[108:111], v[244:247], v[44:47]
    v_fmac_f32 v76, v24, v95
    v_fmac_f32 v77, v25, v95
    s_waitcnt lgkmcnt(7)
    v_mfma_f32_16x16x32_bf16 v[48:51], v[112:115], v[240:243], v[48:51]
    ds_read_b128 v[104:107], v1 offset:31744
    v_fmac_f32 v78, v26, v95
    v_mfma_f32_16x16x32_bf16 v[52:55], v[112:115], v[244:247], v[52:55]
    v_fmac_f32 v79, v27, v95
    s_waitcnt lgkmcnt(5)
    v_fmac_f32 v80, v12, v92
    s_waitcnt lgkmcnt(6)
    v_mfma_f32_16x16x32_bf16 v[56:59], v[116:119], v[240:243], v[56:59]
    ds_read_b128 v[108:111], v1 offset:48128
    v_fmac_f32 v81, v13, v92
    v_mfma_f32_16x16x32_bf16 v[60:63], v[116:119], v[244:247], v[60:63]
    s_waitcnt vmcnt(0)
    v_max_u32 v5, v248, v252
    v_cmp_eq_u32 vcc, -1, v5
    s_waitcnt lgkmcnt(5)
    v_mfma_f32_16x16x32_bf16 v[64:67], v[120:123], v[240:243], v[64:67]
    ds_read_b128 v[112:115], v1 offset:64512
    v_fmac_f32 v82, v14, v92
    v_mfma_f32_16x16x32_bf16 v[68:71], v[120:123], v[244:247], v[68:71]
    s_cbranch_vccnz RT_458
BK_459:
    v_fmac_f32 v83, v15, v92
    v_fmac_f32 v84, v12, v93
    v_fmac_f32 v85, v13, v93
    v_fmac_f32 v86, v14, v93
    v_fmac_f32 v87, v15, v93
    ds_read_b128 v[20:23], v91 offset:768
    s_waitcnt lgkmcnt(6)
    v_mfma_f32_16x16x32_bf16 v[72:75], v[124:127], v[240:243], v[72:75]
    ds_read_b128 v[116:119], v88 offset:15360
    v_mfma_f32_16x16x32_bf16 v[76:79], v[124:127], v[244:247], v[76:79]
    s_waitcnt lgkmcnt(6)
    v_mfma_f32_16x16x32_bf16 v[80:83], v[96:99], v[240:243], v[80:83]
    ds_read_b128 v[120:123], v88 offset:31744
    v_mfma_f32_16x16x32_bf16 v[84:87], v[96:99], v[244:247], v[84:87]
    s_waitcnt lgkmcnt(6)
    v_mfma_f32_16x16x32_bf16 v[32:35], v[100:103], v[248:251], v[32:35]
    s_add_u32 s40, s32, 4096
    ds_read_b128 v[124:127], v88 offset:48128
    v_mfma_f32_16x16x32_bf16 v[36:39], v[100:103], v[252:255], v[36:39]
    s_add_u32 s41, s33, 4096
    s_waitcnt lgkmcnt(6)
    v_mfma_f32_16x16x32_bf16 v[40:43], v[104:107], v[248:251], v[40:43]
    s_add_u32 s42, s34, 4096
    s_waitcnt lgkmcnt(3)
TCH13:
    s_cbranch_execz TCHRET
    v_fmac_f32 v80, v20, v94
    v_fmac_f32 v81, v21, v94
    v_mfma_f32_16x16x32_bf16 v[44:47], v[104:107], v[252:255], v[44:47]
    s_add_u32 s43, s35, 4096
    v_fmac_f32 v82, v22, v94
    v_fmac_f32 v83, v23, v94
    s_waitcnt lgkmcnt(5)
    v_mfma_f32_16x16x32_bf16 v[48:51], v[108:111], v[248:251], v[48:51]
    s_add_u32 s44, s36, 4096
    v_fmac_f32 v84, v20, v95
    v_fmac_f32 v85, v21, v95
    v_mfma_f32_16x16x32_bf16 v[52:55], v[108:111], v[252:255], v[52:55]
    s_add_u32 s45, s37, 4096
    v_fmac_f32 v86, v22, v95
    v_fmac_f32 v87, v23, v95
    s_waitcnt lgkmcnt(4)
    v_mfma_f32_16x16x32_bf16 v[56:59], v[112:115], v[248:251], v[56:59]
    s_add_u32 s46, s38, 4096
    v_mfma_f32_16x16x32_bf16 v[60:63], v[112:115], v[252:255], v[60:63]
    s_add_u32 s47, s39, 4096
    s_waitcnt lgkmcnt(2)
    v_mfma_f32_16x16x32_bf16 v[64:67], v[116:119], v[248:251], v[64:67]
    v_mfma_f32_16x16x32_bf16 v[68:71], v[116:119], v[252:255], v[68:71]
    s_waitcnt lgkmcnt(1)
    v_mfma_f32_16x16x32_bf16 v[72:75], v[120:123], v[248:251], v[72:75]
    v_mfma_f32_16x16x32_bf16 v[76:79], v[120:123], v[252:255], v[76:79]
    s_waitcnt lgkmcnt(0)
    v_mfma_f32_16x16x32_bf16 v[80:83], v[124:127], v[248:251], v[80:83]
    v_mfma_f32_16x16x32_bf16 v[84:87], v[124:127], v[252:255], v[84:87]
    v_pk_mul_f32 v[12:13], v[32:33], v[32:33]
    v_pk_mul_f32 v[14:15], v[34:35], v[34:35]
    v_pk_mul_f32 v[16:17], v[36:37], v[36:37]
    v_pk_mul_f32 v[18:19], v[38:39], v[38:39]
    v_pk_fma_f32 v[12:13], v[12:13], v[28:29], v[28:29] op_sel:[0,0,1] op_sel_hi:[1,0,1]
    v_pk_fma_f32 v[14:15], v[14:15], v[28:29], v[28:29] op_sel:[0,0,1] op_sel_hi:[1,0,1]
    v_pk_fma_f32 v[16:17], v[16:17], v[30:31], v[30:31] op_sel:[0,0,1] op_sel_hi:[1,0,1]
    v_pk_fma_f32 v[18:19], v[18:19], v[30:31], v[30:31] op_sel:[0,0,1] op_sel_hi:[1,0,1]
    v_pk_mul_f32 v[12:13], v[12:13], v[32:33]
    v_pk_mul_f32 v[14:15], v[14:15], v[34:35]
    v_pk_mul_f32 v[16:17], v[16:17], v[36:37]
    v_pk_mul_f32 v[18:19], v[18:19], v[38:39]
    v_exp_f32 v12, v12
    v_exp_f32 v13, v13
    v_exp_f32 v14, v14
    v_exp_f32 v15, v15
    v_exp_f32 v16, v16
    v_exp_f32 v17, v17
    v_exp_f32 v18, v18
    v_exp_f32 v19, v19
    v_pk_fma_f32 v[12:13], v[12:13], v[92:93], v[92:93] op_sel:[0,0,0] op_sel_hi:[1,0,0]
    v_pk_fma_f32 v[14:15], v[14:15], v[92:93], v[92:93] op_sel:[0,0,0] op_sel_hi:[1,0,0]
    v_pk_fma_f32 v[16:17], v[16:17], v[92:93], v[92:93] op_sel:[0,1,1] op_sel_hi:[1,1,1]
    v_pk_fma_f32 v[18:19], v[18:19], v[92:93], v[92:93] op_sel:[0,1,1] op_sel_hi:[1,1,1]
    v_rcp_f32 v12, v12
    v_rcp_f32 v13, v13
    v_rcp_f32 v14, v14
    v_rcp_f32 v15, v15
    v_rcp_f32 v16, v16
    v_rcp_f32 v17, v17
    v_rcp_f32 v18, v18
    v_rcp_f32 v19, v19
    v_pk_mul_f32 v[32:33], v[32:33], v[12:13]
    v_pk_mul_f32 v[34:35], v[34:35], v[14:15]
    v_pk_mul_f32 v[36:37], v[36:37], v[16:17]
    v_pk_mul_f32 v[38:39], v[38:39], v[18:19]
    v_cvt_pk_bf16_f32 v20, v32, v33
    v_cvt_pk_bf16_f32 v22, v36, v37
    v_cvt_pk_bf16_f32 v21, v34, v35
    v_cvt_pk_bf16_f32 v23, v38, v39
    s_nop 0
    v_permlane16_swap_b32 v20, v22
    v_permlane16_swap_b32 v21, v23
    buffer_store_dwordx4 v[20:23], v1, s[4:7], s77 offen offset:0
    v_pk_mul_f32 v[12:13], v[40:41], v[40:41]
    v_pk_mul_f32 v[14:15], v[42:43], v[42:43]
    v_pk_mul_f32 v[16:17], v[44:45], v[44:45]
    v_pk_mul_f32 v[18:19], v[46:47], v[46:47]
    v_pk_fma_f32 v[12:13], v[12:13], v[28:29], v[28:29] op_sel:[0,0,1] op_sel_hi:[1,0,1]
    v_pk_fma_f32 v[14:15], v[14:15], v[28:29], v[28:29] op_sel:[0,0,1] op_sel_hi:[1,0,1]
    v_pk_fma_f32 v[16:17], v[16:17], v[30:31], v[30:31] op_sel:[0,0,1] op_sel_hi:[1,0,1]
    v_pk_fma_f32 v[18:19], v[18:19], v[30:31], v[30:31] op_sel:[0,0,1] op_sel_hi:[1,0,1]
    v_pk_mul_f32 v[12:13], v[12:13], v[40:41]
    v_pk_mul_f32 v[14:15], v[14:15], v[42:43]
    v_pk_mul_f32 v[16:17], v[16:17], v[44:45]
    v_pk_mul_f32 v[18:19], v[18:19], v[46:47]
    v_exp_f32 v12, v12
    v_exp_f32 v13, v13
    v_exp_f32 v14, v14
    v_exp_f32 v15, v15
    v_exp_f32 v16, v16
    v_exp_f32 v17, v17
    v_exp_f32 v18, v18
    v_exp_f32 v19, v19
    v_pk_fma_f32 v[12:13], v[12:13], v[92:93], v[92:93] op_sel:[0,0,0] op_sel_hi:[1,0,0]
    v_pk_fma_f32 v[14:15], v[14:15], v[92:93], v[92:93] op_sel:[0,0,0] op_sel_hi:[1,0,0]
    v_pk_fma_f32 v[16:17], v[16:17], v[92:93], v[92:93] op_sel:[0,1,1] op_sel_hi:[1,1,1]
    v_pk_fma_f32 v[18:19], v[18:19], v[92:93], v[92:93] op_sel:[0,1,1] op_sel_hi:[1,1,1]
    v_rcp_f32 v12, v12
    v_rcp_f32 v13, v13
    v_rcp_f32 v14, v14
    v_rcp_f32 v15, v15
    v_rcp_f32 v16, v16
    v_rcp_f32 v17, v17
    v_rcp_f32 v18, v18
    v_rcp_f32 v19, v19
    v_pk_mul_f32 v[40:41], v[40:41], v[12:13]
    v_pk_mul_f32 v[42:43], v[42:43], v[14:15]
    v_pk_mul_f32 v[44:45], v[44:45], v[16:17]
    v_pk_mul_f32 v[46:47], v[46:47], v[18:19]
    v_cvt_pk_bf16_f32 v24, v40, v41
    v_cvt_pk_bf16_f32 v26, v44, v45
    v_cvt_pk_bf16_f32 v25, v42, v43
    v_cvt_pk_bf16_f32 v27, v46, v47
    s_nop 0
    v_permlane16_swap_b32 v24, v26
    v_permlane16_swap_b32 v25, v27
    buffer_store_dwordx4 v[24:27], v1, s[4:7], s77 offen offset:1024
    v_pk_mul_f32 v[12:13], v[48:49], v[48:49]
    v_pk_mul_f32 v[14:15], v[50:51], v[50:51]
    v_pk_mul_f32 v[16:17], v[52:53], v[52:53]
    v_pk_mul_f32 v[18:19], v[54:55], v[54:55]
    v_pk_fma_f32 v[12:13], v[12:13], v[28:29], v[28:29] op_sel:[0,0,1] op_sel_hi:[1,0,1]
    v_pk_fma_f32 v[14:15], v[14:15], v[28:29], v[28:29] op_sel:[0,0,1] op_sel_hi:[1,0,1]
    v_pk_fma_f32 v[16:17], v[16:17], v[30:31], v[30:31] op_sel:[0,0,1] op_sel_hi:[1,0,1]
    v_pk_fma_f32 v[18:19], v[18:19], v[30:31], v[30:31] op_sel:[0,0,1] op_sel_hi:[1,0,1]
    v_pk_mul_f32 v[12:13], v[12:13], v[48:49]
    v_pk_mul_f32 v[14:15], v[14:15], v[50:51]
    v_pk_mul_f32 v[16:17], v[16:17], v[52:53]
    v_pk_mul_f32 v[18:19], v[18:19], v[54:55]
    v_exp_f32 v12, v12
    v_exp_f32 v13, v13
    v_exp_f32 v14, v14
    v_exp_f32 v15, v15
    v_exp_f32 v16, v16
    v_exp_f32 v17, v17
    v_exp_f32 v18, v18
    v_exp_f32 v19, v19
    v_pk_fma_f32 v[12:13], v[12:13], v[92:93], v[92:93] op_sel:[0,0,0] op_sel_hi:[1,0,0]
    v_pk_fma_f32 v[14:15], v[14:15], v[92:93], v[92:93] op_sel:[0,0,0] op_sel_hi:[1,0,0]
    v_pk_fma_f32 v[16:17], v[16:17], v[92:93], v[92:93] op_sel:[0,1,1] op_sel_hi:[1,1,1]
    v_pk_fma_f32 v[18:19], v[18:19], v[92:93], v[92:93] op_sel:[0,1,1] op_sel_hi:[1,1,1]
    v_rcp_f32 v12, v12
    v_rcp_f32 v13, v13
    v_rcp_f32 v14, v14
    v_rcp_f32 v15, v15
    v_rcp_f32 v16, v16
    v_rcp_f32 v17, v17
    v_rcp_f32 v18, v18
    v_rcp_f32 v19, v19
    v_pk_mul_f32 v[48:49], v[48:49], v[12:13]
    v_pk_mul_f32 v[50:51], v[50:51], v[14:15]
    v_pk_mul_f32 v[52:53], v[52:53], v[16:17]
    v_pk_mul_f32 v[54:55], v[54:55], v[18:19]
    v_cvt_pk_bf16_f32 v20, v48, v49
    v_cvt_pk_bf16_f32 v22, v52, v53
    v_cvt_pk_bf16_f32 v21, v50, v51
    v_cvt_pk_bf16_f32 v23, v54, v55
    s_nop 0
    v_permlane16_swap_b32 v20, v22
    v_permlane16_swap_b32 v21, v23
    buffer_store_dwordx4 v[20:23], v1, s[4:7], s77 offen offset:2048
    v_pk_mul_f32 v[12:13], v[56:57], v[56:57]
    v_pk_mul_f32 v[14:15], v[58:59], v[58:59]
    v_pk_mul_f32 v[16:17], v[60:61], v[60:61]
    v_pk_mul_f32 v[18:19], v[62:63], v[62:63]
    v_pk_fma_f32 v[12:13], v[12:13], v[28:29], v[28:29] op_sel:[0,0,1] op_sel_hi:[1,0,1]
    v_pk_fma_f32 v[14:15], v[14:15], v[28:29], v[28:29] op_sel:[0,0,1] op_sel_hi:[1,0,1]
    v_pk_fma_f32 v[16:17], v[16:17], v[30:31], v[30:31] op_sel:[0,0,1] op_sel_hi:[1,0,1]
    v_pk_fma_f32 v[18:19], v[18:19], v[30:31], v[30:31] op_sel:[0,0,1] op_sel_hi:[1,0,1]
    v_pk_mul_f32 v[12:13], v[12:13], v[56:57]
    v_pk_mul_f32 v[14:15], v[14:15], v[58:59]
    v_pk_mul_f32 v[16:17], v[16:17], v[60:61]
    v_pk_mul_f32 v[18:19], v[18:19], v[62:63]
    buffer_load_dwordx4 v[96:99], v1, s[4:7], s32 offen offset:0 sc1
    v_exp_f32 v12, v12
    v_exp_f32 v13, v13
    v_exp_f32 v14, v14
    v_exp_f32 v15, v15
    v_exp_f32 v16, v16
    v_exp_f32 v17, v17
    v_exp_f32 v18, v18
    v_exp_f32 v19, v19
    buffer_load_dwordx4 v[100:103], v1, s[4:7], s36 offen offset:0 sc1
    v_pk_fma_f32 v[12:13], v[12:13], v[92:93], v[92:93] op_sel:[0,0,0] op_sel_hi:[1,0,0]
    v_pk_fma_f32 v[14:15], v[14:15], v[92:93], v[92:93] op_sel:[0,0,0] op_sel_hi:[1,0,0]
    v_pk_fma_f32 v[16:17], v[16:17], v[92:93], v[92:93] op_sel:[0,1,1] op_sel_hi:[1,1,1]
    v_pk_fma_f32 v[18:19], v[18:19], v[92:93], v[92:93] op_sel:[0,1,1] op_sel_hi:[1,1,1]
    v_rcp_f32 v12, v12
    v_rcp_f32 v13, v13
    v_rcp_f32 v14, v14
    v_rcp_f32 v15, v15
    buffer_load_dwordx4 v[104:107], v1, s[4:7], s33 offen offset:0 sc1
    v_rcp_f32 v16, v16
    v_rcp_f32 v17, v17
    v_rcp_f32 v18, v18
    v_rcp_f32 v19, v19
    v_pk_mul_f32 v[56:57], v[56:57], v[12:13]
    v_pk_mul_f32 v[58:59], v[58:59], v[14:15]
    v_pk_mul_f32 v[60:61], v[60:61], v[16:17]
    v_pk_mul_f32 v[62:63], v[62:63], v[18:19]
    v_cvt_pk_bf16_f32 v24, v56, v57
    v_cvt_pk_bf16_f32 v26, v60, v61
    v_cvt_pk_bf16_f32 v25, v58, v59
    v_cvt_pk_bf16_f32 v27, v62, v63
    buffer_load_dwordx4 v[108:111], v1, s[4:7], s37 offen offset:0 sc1
    v_permlane16_swap_b32 v24, v26
    v_permlane16_swap_b32 v25, v27
    buffer_store_dwordx4 v[24:27], v1, s[4:7], s77 offen offset:3072
    v_pk_mul_f32 v[12:13], v[64:65], v[64:65]
    v_pk_mul_f32 v[14:15], v[66:67], v[66:67]
    v_pk_mul_f32 v[16:17], v[68:69], v[68:69]
    v_pk_mul_f32 v[18:19], v[70:71], v[70:71]
    v_pk_fma_f32 v[12:13], v[12:13], v[28:29], v[28:29] op_sel:[0,0,1] op_sel_hi:[1,0,1]
    v_pk_fma_f32 v[14:15], v[14:15], v[28:29], v[28:29] op_sel:[0,0,1] op_sel_hi:[1,0,1]
    v_pk_fma_f32 v[16:17], v[16:17], v[30:31], v[30:31] op_sel:[0,0,1] op_sel_hi:[1,0,1]
    v_pk_fma_f32 v[18:19], v[18:19], v[30:31], v[30:31] op_sel:[0,0,1] op_sel_hi:[1,0,1]
    v_pk_mul_f32 v[12:13], v[12:13], v[64:65]
    v_pk_mul_f32 v[14:15], v[14:15], v[66:67]
    v_pk_mul_f32 v[16:17], v[16:17], v[68:69]
    v_pk_mul_f32 v[18:19], v[18:19], v[70:71]
    buffer_load_dwordx4 v[112:115], v1, s[4:7], s34 offen offset:0 sc1
    v_exp_f32 v12, v12
    v_exp_f32 v13, v13
    v_exp_f32 v14, v14
    v_exp_f32 v15, v15
    v_exp_f32 v16, v16
    v_exp_f32 v17, v17
    v_exp_f32 v18, v18
    v_exp_f32 v19, v19
    buffer_load_dwordx4 v[116:119], v1, s[4:7], s38 offen offset:0 sc1
    v_pk_fma_f32 v[12:13], v[12:13], v[92:93], v[92:93] op_sel:[0,0,0] op_sel_hi:[1,0,0]
    v_pk_fma_f32 v[14:15], v[14:15], v[92:93], v[92:93] op_sel:[0,0,0] op_sel_hi:[1,0,0]
    v_pk_fma_f32 v[16:17], v[16:17], v[92:93], v[92:93] op_sel:[0,1,1] op_sel_hi:[1,1,1]
    v_pk_fma_f32 v[18:19], v[18:19], v[92:93], v[92:93] op_sel:[0,1,1] op_sel_hi:[1,1,1]
    v_rcp_f32 v12, v12
    v_rcp_f32 v13, v13
    v_rcp_f32 v14, v14
    v_rcp_f32 v15, v15
    buffer_load_dwordx4 v[120:123], v1, s[4:7], s35 offen offset:0 sc1
    v_rcp_f32 v16, v16
    v_rcp_f32 v17, v17
    v_rcp_f32 v18, v18
    v_rcp_f32 v19, v19
    v_pk_mul_f32 v[64:65], v[64:65], v[12:13]
    v_pk_mul_f32 v[66:67], v[66:67], v[14:15]
    v_pk_mul_f32 v[68:69], v[68:69], v[16:17]
    v_pk_mul_f32 v[70:71], v[70:71], v[18:19]
    v_cvt_pk_bf16_f32 v20, v64, v65
    v_cvt_pk_bf16_f32 v22, v68, v69
    v_cvt_pk_bf16_f32 v21, v66, v67
    v_cvt_pk_bf16_f32 v23, v70, v71
    buffer_load_dwordx4 v[124:127], v1, s[4:7], s39 offen offset:0 sc1
    v_permlane16_swap_b32 v20, v22
    v_permlane16_swap_b32 v21, v23
    s_add_u32 s77, s77, 4096
    buffer_store_dwordx4 v[20:23], v1, s[4:7], s77 offen offset:0
    v_pk_mul_f32 v[12:13], v[72:73], v[72:73]
    v_pk_mul_f32 v[14:15], v[74:75], v[74:75]
    v_pk_mul_f32 v[16:17], v[76:77], v[76:77]
    v_pk_mul_f32 v[18:19], v[78:79], v[78:79]
    v_pk_fma_f32 v[12:13], v[12:13], v[28:29], v[28:29] op_sel:[0,0,1] op_sel_hi:[1,0,1]
    v_pk_fma_f32 v[14:15], v[14:15], v[28:29], v[28:29] op_sel:[0,0,1] op_sel_hi:[1,0,1]
    v_pk_fma_f32 v[16:17], v[16:17], v[30:31], v[30:31] op_sel:[0,0,1] op_sel_hi:[1,0,1]
    v_pk_fma_f32 v[18:19], v[18:19], v[30:31], v[30:31] op_sel:[0,0,1] op_sel_hi:[1,0,1]
    v_pk_mul_f32 v[12:13], v[12:13], v[72:73]
    v_pk_mul_f32 v[14:15], v[14:15], v[74:75]
    v_pk_mul_f32 v[16:17], v[16:17], v[76:77]
    v_pk_mul_f32 v[18:19], v[18:19], v[78:79]
    buffer_load_dwordx4 v[128:131], v1, s[4:7], s32 offen offset:1024 sc1
    v_exp_f32 v12, v12
    v_exp_f32 v13, v13
    v_exp_f32 v14, v14
    v_exp_f32 v15, v15
    v_exp_f32 v16, v16
    v_exp_f32 v17, v17
    v_exp_f32 v18, v18
    v_exp_f32 v19, v19
    buffer_load_dwordx4 v[132:135], v1, s[4:7], s36 offen offset:1024 sc1
    v_pk_fma_f32 v[12:13], v[12:13], v[92:93], v[92:93] op_sel:[0,0,0] op_sel_hi:[1,0,0]
    v_pk_fma_f32 v[14:15], v[14:15], v[92:93], v[92:93] op_sel:[0,0,0] op_sel_hi:[1,0,0]
    v_pk_fma_f32 v[16:17], v[16:17], v[92:93], v[92:93] op_sel:[0,1,1] op_sel_hi:[1,1,1]
    v_pk_fma_f32 v[18:19], v[18:19], v[92:93], v[92:93] op_sel:[0,1,1] op_sel_hi:[1,1,1]
    v_rcp_f32 v12, v12
    v_rcp_f32 v13, v13
    v_rcp_f32 v14, v14
    v_rcp_f32 v15, v15
    buffer_load_dwordx4 v[136:139], v1, s[4:7], s33 offen offset:1024 sc1
    v_rcp_f32 v16, v16
    v_rcp_f32 v17, v17
    v_rcp_f32 v18, v18
    v_rcp_f32 v19, v19
    v_pk_mul_f32 v[72:73], v[72:73], v[12:13]
    v_pk_mul_f32 v[74:75], v[74:75], v[14:15]
    v_pk_mul_f32 v[76:77], v[76:77], v[16:17]
    v_pk_mul_f32 v[78:79], v[78:79], v[18:19]
    v_cvt_pk_bf16_f32 v24, v72, v73
    v_cvt_pk_bf16_f32 v26, v76, v77
    v_cvt_pk_bf16_f32 v25, v74, v75
    v_cvt_pk_bf16_f32 v27, v78, v79
    buffer_load_dwordx4 v[140:143], v1, s[4:7], s37 offen offset:1024 sc1
    v_permlane16_swap_b32 v24, v26
    v_permlane16_swap_b32 v25, v27
    buffer_store_dwordx4 v[24:27], v1, s[4:7], s77 offen offset:1024
    v_pk_mul_f32 v[12:13], v[80:81], v[80:81]
    v_pk_mul_f32 v[14:15], v[82:83], v[82:83]
    v_pk_mul_f32 v[16:17], v[84:85], v[84:85]
    v_pk_mul_f32 v[18:19], v[86:87], v[86:87]
    v_pk_fma_f32 v[12:13], v[12:13], v[28:29], v[28:29] op_sel:[0,0,1] op_sel_hi:[1,0,1]
    v_pk_fma_f32 v[14:15], v[14:15], v[28:29], v[28:29] op_sel:[0,0,1] op_sel_hi:[1,0,1]
    v_pk_fma_f32 v[16:17], v[16:17], v[30:31], v[30:31] op_sel:[0,0,1] op_sel_hi:[1,0,1]
    v_pk_fma_f32 v[18:19], v[18:19], v[30:31], v[30:31] op_sel:[0,0,1] op_sel_hi:[1,0,1]
    v_pk_mul_f32 v[12:13], v[12:13], v[80:81]
    v_pk_mul_f32 v[14:15], v[14:15], v[82:83]
    v_pk_mul_f32 v[16:17], v[16:17], v[84:85]
    v_pk_mul_f32 v[18:19], v[18:19], v[86:87]
    buffer_load_dwordx4 v[144:147], v1, s[4:7], s34 offen offset:1024 sc1
    v_exp_f32 v12, v12
    v_exp_f32 v13, v13
    v_exp_f32 v14, v14
    v_exp_f32 v15, v15
    v_exp_f32 v16, v16
    v_exp_f32 v17, v17
    v_exp_f32 v18, v18
    v_exp_f32 v19, v19
    buffer_load_dwordx4 v[148:151], v1, s[4:7], s38 offen offset:1024 sc1
    v_pk_fma_f32 v[12:13], v[12:13], v[92:93], v[92:93] op_sel:[0,0,0] op_sel_hi:[1,0,0]
    v_pk_fma_f32 v[14:15], v[14:15], v[92:93], v[92:93] op_sel:[0,0,0] op_sel_hi:[1,0,0]
    v_pk_fma_f32 v[16:17], v[16:17], v[92:93], v[92:93] op_sel:[0,1,1] op_sel_hi:[1,1,1]
    v_pk_fma_f32 v[18:19], v[18:19], v[92:93], v[92:93] op_sel:[0,1,1] op_sel_hi:[1,1,1]
    v_rcp_f32 v12, v12
    v_rcp_f32 v13, v13
    v_rcp_f32 v14, v14
    v_rcp_f32 v15, v15
    v_rcp_f32 v16, v16
    v_rcp_f32 v17, v17
    v_rcp_f32 v18, v18
    v_rcp_f32 v19, v19
    v_pk_mul_f32 v[80:81], v[80:81], v[12:13]
    v_pk_mul_f32 v[82:83], v[82:83], v[14:15]
    v_pk_mul_f32 v[84:85], v[84:85], v[16:17]
    v_pk_mul_f32 v[86:87], v[86:87], v[18:19]
    v_cvt_pk_bf16_f32 v20, v80, v81
    v_cvt_pk_bf16_f32 v22, v84, v85
    v_cvt_pk_bf16_f32 v21, v82, v83
    v_cvt_pk_bf16_f32 v23, v86, v87
    s_nop 0
    v_permlane16_swap_b32 v20, v22
    v_permlane16_swap_b32 v21, v23
    buffer_store_dwordx4 v[20:23], v1, s[4:7], s77 offen offset:2048
    s_cmp_lg_u32 s31, 0
    s_cbranch_scc1 SF_466
SFD_467:
    s_waitcnt vmcnt(17)
    v_cmp_eq_u32 vcc, -1, v96
    v_bfe_u32 v7, v1, 4, 5
    v_lshrrev_b32 v4, 9, v1
    v_lshlrev_b32 v4, 4, v4
    v_lshl_add_u32 v7, v7, 10, v4
    s_lshl_b32 s79, s60, 11
    v_add_u32 v31, s79, v1
    s_cbranch_vccnz RT_468
BK_469:
    v_mfma_f32_32x32x16_bf16 v[32:47], a[0:3], v[96:99], 0
    s_waitcnt vmcnt(16)
    v_cmp_eq_u32 vcc, -1, v100
    buffer_load_dwordx4 v[152:155], v1, s[4:7], s35 offen offset:1024 sc1
    v_xor_b32 v28, 2048, v31
    v_xor_b32 v29, 4096, v31
    v_xor_b32 v30, 6144, v31
    v_mfma_f32_32x32x16_bf16 v[48:63], a[4:7], v[96:99], 0
    buffer_load_dwordx4 v[156:159], v1, s[4:7], s39 offen offset:1024 sc1
    v_add_u32 v28, 117760, v28
    v_add_u32 v29, 117760, v29
    v_add_u32 v30, 117760, v30
    v_add_u32 v31, 117760, v31
    s_cbranch_vccnz RT_472
BK_473:
    v_mfma_f32_32x32x16_bf16 v[64:79], a[0:3], v[100:103], 0
    s_waitcnt vmcnt(17)
    v_cmp_eq_u32 vcc, -1, v104
    buffer_load_dwordx4 v[160:163], v1, s[4:7], s32 offen offset:2048 sc1
    v_mfma_f32_32x32x16_bf16 v[80:95], a[4:7], v[100:103], 0
    buffer_load_dwordx4 v[164:167], v1, s[4:7], s36 offen offset:2048 sc1
    s_cbranch_vccnz RT_476
BK_477:
    v_mfma_f32_32x32x16_bf16 v[32:47], a[56:59], v[104:107], v[32:47]
    s_waitcnt vmcnt(18)
    v_cmp_eq_u32 vcc, -1, v108
    buffer_load_dwordx4 v[168:171], v1, s[4:7], s33 offen offset:2048 sc1
    v_mfma_f32_32x32x16_bf16 v[48:63], a[60:63], v[104:107], v[48:63]
    buffer_load_dwordx4 v[172:175], v1, s[4:7], s37 offen offset:2048 sc1
    s_cbranch_vccnz RT_480
BK_481:
    v_mfma_f32_32x32x16_bf16 v[64:79], a[56:59], v[108:111], v[64:79]
    s_waitcnt vmcnt(18)
    v_cmp_eq_u32 vcc, -1, v112
    buffer_load_dwordx4 v[176:179], v1, s[4:7], s34 offen offset:2048 sc1
    v_mfma_f32_32x32x16_bf16 v[80:95], a[60:63], v[108:111], v[80:95]
    buffer_load_dwordx4 v[180:183], v1, s[4:7], s38 offen offset:2048 sc1
    s_cbranch_vccnz RT_484
BK_485:
    v_mfma_f32_32x32x16_bf16 v[32:47], a[112:115], v[112:115], v[32:47]
    s_waitcnt vmcnt(19)
    v_cmp_eq_u32 vcc, -1, v116
    buffer_load_dwordx4 v[184:187], v1, s[4:7], s35 offen offset:2048 sc1
    v_mfma_f32_32x32x16_bf16 v[48:63], a[116:119], v[112:115], v[48:63]
    buffer_load_dwordx4 v[188:191], v1, s[4:7], s39 offen offset:2048 sc1
    s_cbranch_vccnz RT_488
BK_489:
    v_mfma_f32_32x32x16_bf16 v[64:79], a[112:115], v[116:119], v[64:79]
    s_waitcnt vmcnt(20)
    v_cmp_eq_u32 vcc, -1, v120
    buffer_load_dwordx4 v[96:99], v1, s[4:7], s76 offen sc1
    v_mfma_f32_32x32x16_bf16 v[80:95], a[116:119], v[116:119], v[80:95]
    buffer_load_dwordx4 v[100:103], v1, s[4:7], s32 offen offset:3072 sc1
    s_cbranch_vccnz RT_492
BK_493:
    v_mfma_f32_32x32x16_bf16 v[32:47], a[168:171], v[120:123], v[32:47]
    s_waitcnt vmcnt(21)
    v_cmp_eq_u32 vcc, -1, v124
    buffer_load_dwordx4 v[104:107], v1, s[4:7], s33 offen offset:3072 sc1
    v_mfma_f32_32x32x16_bf16 v[48:63], a[172:175], v[120:123], v[48:63]
    buffer_load_dwordx4 v[108:111], v1, s[4:7], s34 offen offset:3072 sc1
    s_cbranch_vccnz RT_496
BK_497:
    v_mfma_f32_32x32x16_bf16 v[64:79], a[168:171], v[124:127], v[64:79]
    s_waitcnt vmcnt(21)
    v_cmp_eq_u32 vcc, -1, v128
    buffer_load_dwordx4 v[112:115], v1, s[4:7], s35 offen offset:3072 sc1
    v_mfma_f32_32x32x16_bf16 v[80:95], a[172:175], v[124:127], v[80:95]
    buffer_load_dwordx4 v[116:119], v1, s[4:7], s40 offen offset:0 sc1
    s_cbranch_vccnz RT_500
BK_501:
    v_mfma_f32_32x32x16_bf16 v[32:47], a[8:11], v[128:131], v[32:47]
    s_waitcnt vmcnt(22)
    v_cmp_eq_u32 vcc, -1, v132
    buffer_load_dwordx4 v[120:123], v1, s[4:7], s41 offen offset:0 sc1
    v_mfma_f32_32x32x16_bf16 v[48:63], a[12:15], v[128:131], v[48:63]
    buffer_load_dwordx4 v[124:127], v1, s[4:7], s42 offen offset:0 sc1
    s_cbranch_vccnz RT_504
BK_505:
    v_mfma_f32_32x32x16_bf16 v[64:79], a[8:11], v[132:135], v[64:79]
    s_waitcnt vmcnt(23)
    v_cmp_eq_u32 vcc, -1, v136
    buffer_load_dwordx4 v[128:131], v1, s[4:7], s43 offen offset:0 sc1
    v_mfma_f32_32x32x16_bf16 v[80:95], a[12:15], v[132:135], v[80:95]
    buffer_load_dwordx4 v[132:135], v1, s[4:7], s40 offen offset:1024 sc1
    s_cbranch_vccnz RT_508
BK_509:
    v_mfma_f32_32x32x16_bf16 v[32:47], a[64:67], v[136:139], v[32:47]
    s_waitcnt vmcnt(24)
    v_cmp_eq_u32 vcc, -1, v140
    v_mfma_f32_32x32x16_bf16 v[48:63], a[68:71], v[136:139], v[48:63]
    buffer_load_dwordx4 v[136:139], v1, s[4:7], s41 offen offset:1024 sc1
    s_cbranch_vccnz RT_512
BK_513:
    v_mfma_f32_32x32x16_bf16 v[64:79], a[64:67], v[140:143], v[64:79]
    s_waitcnt vmcnt(23)
    v_cmp_eq_u32 vcc, -1, v144
    v_mfma_f32_32x32x16_bf16 v[80:95], a[68:71], v[140:143], v[80:95]
    buffer_load_dwordx4 v[140:143], v1, s[4:7], s42 offen offset:1024 sc1
    s_cbranch_vccnz RT_516
BK_517:
    v_mfma_f32_32x32x16_bf16 v[32:47], a[120:123], v[144:147], v[32:47]
    s_waitcnt vmcnt(23)
    v_cmp_eq_u32 vcc, -1, v148
    v_mfma_f32_32x32x16_bf16 v[48:63], a[124:127], v[144:147], v[48:63]
    buffer_load_dwordx4 v[144:147], v1, s[4:7], s43 offen offset:1024 sc1
    s_cbranch_vccnz RT_520
BK_521:
    v_mfma_f32_32x32x16_bf16 v[64:79], a[120:123], v[148:151], v[64:79]
    s_waitcnt vmcnt(22)
    v_cmp_eq_u32 vcc, -1, v152
    v_mfma_f32_32x32x16_bf16 v[80:95], a[124:127], v[148:151], v[80:95]
    buffer_load_dwordx4 v[148:151], v1, s[4:7], s40 offen offset:2048 sc1
    s_cbranch_vccnz RT_524
BK_525:
    v_mfma_f32_32x32x16_bf16 v[32:47], a[176:179], v[152:155], v[32:47]
    s_waitcnt vmcnt(22)
    v_cmp_eq_u32 vcc, -1, v156
    v_mfma_f32_32x32x16_bf16 v[48:63], a[180:183], v[152:155], v[48:63]
    buffer_load_dwordx4 v[152:155], v1, s[4:7], s41 offen offset:2048 sc1
    s_cbranch_vccnz RT_528
BK_529:
    v_mfma_f32_32x32x16_bf16 v[64:79], a[176:179], v[156:159], v[64:79]
    s_waitcnt vmcnt(22)
    v_cmp_eq_u32 vcc, -1, v160
    v_mfma_f32_32x32x16_bf16 v[80:95], a[180:183], v[156:159], v[80:95]
    buffer_load_dwordx4 v[156:159], v1, s[4:7], s42 offen offset:2048 sc1
    s_cbranch_vccnz RT_532
BK_533:
    v_mfma_f32_32x32x16_bf16 v[32:47], a[16:19], v[160:163], v[32:47]
    s_waitcnt vmcnt(22)
    v_cmp_eq_u32 vcc, -1, v164
    v_mfma_f32_32x32x16_bf16 v[48:63], a[20:23], v[160:163], v[48:63]
    buffer_load_dwordx4 v[160:163], v1, s[4:7], s43 offen offset:2048 sc1
    s_cbranch_vccnz RT_536
BK_537:
    v_mfma_f32_32x32x16_bf16 v[64:79], a[16:19], v[164:167], v[64:79]
    s_waitcnt vmcnt(22)
    v_cmp_eq_u32 vcc, -1, v168
    v_mfma_f32_32x32x16_bf16 v[80:95], a[20:23], v[164:167], v[80:95]
    buffer_load_dwordx4 v[164:167], v1, s[4:7], s75 offen sc1
    s_cbranch_vccnz RT_540
BK_541:
    v_mfma_f32_32x32x16_bf16 v[32:47], a[72:75], v[168:171], v[32:47]
    s_waitcnt vmcnt(22)
    v_cmp_eq_u32 vcc, -1, v172
    v_mfma_f32_32x32x16_bf16 v[48:63], a[76:79], v[168:171], v[48:63]
    buffer_load_dwordx4 v[168:171], v1, s[4:7], s36 offen offset:3072 sc1
    s_cbranch_vccnz RT_544
BK_545:
    v_mfma_f32_32x32x16_bf16 v[64:79], a[72:75], v[172:175], v[64:79]
    s_waitcnt vmcnt(22)
    v_cmp_eq_u32 vcc, -1, v176
    v_mfma_f32_32x32x16_bf16 v[80:95], a[76:79], v[172:175], v[80:95]
    buffer_load_dwordx4 v[172:175], v1, s[4:7], s37 offen offset:3072 sc1
    s_cbranch_vccnz RT_548
BK_549:
    v_mfma_f32_32x32x16_bf16 v[32:47], a[128:131], v[176:179], v[32:47]
    s_waitcnt vmcnt(22)
    v_cmp_eq_u32 vcc, -1, v180
    v_mfma_f32_32x32x16_bf16 v[48:63], a[132:135], v[176:179], v[48:63]
    buffer_load_dwordx4 v[176:179], v1, s[4:7], s38 offen offset:3072 sc1
    s_cbranch_vccnz RT_552
BK_553:
    v_mfma_f32_32x32x16_bf16 v[64:79], a[128:131], v[180:183], v[64:79]
    s_waitcnt vmcnt(22)
    v_cmp_eq_u32 vcc, -1, v184
    v_mfma_f32_32x32x16_bf16 v[80:95], a[132:135], v[180:183], v[80:95]
    buffer_load_dwordx4 v[180:183], v1, s[4:7], s39 offen offset:3072 sc1
    s_cbranch_vccnz RT_556
BK_557:
    v_mfma_f32_32x32x16_bf16 v[32:47], a[184:187], v[184:187], v[32:47]
    s_waitcnt vmcnt(22)
    v_cmp_eq_u32 vcc, -1, v188
    v_mfma_f32_32x32x16_bf16 v[48:63], a[188:191], v[184:187], v[48:63]
    buffer_load_dwordx4 v[184:187], v1, s[4:7], s44 offen offset:0 sc1
    s_cbranch_vccnz RT_560
BK_561:
    v_mfma_f32_32x32x16_bf16 v[64:79], a[184:187], v[188:191], v[64:79]
    s_waitcnt vmcnt(21)
    v_cmp_eq_u32 vcc, -1, v100
    v_mfma_f32_32x32x16_bf16 v[80:95], a[188:191], v[188:191], v[80:95]
    buffer_load_dwordx4 v[188:191], v1, s[4:7], s45 offen offset:0 sc1
    s_cbranch_vccnz RT_564
BK_565:
    v_mfma_f32_32x32x16_bf16 v[32:47], a[24:27], v[100:103], v[32:47]
    s_waitcnt vmcnt(21)
    v_cmp_eq_u32 vcc, -1, v104
    v_mfma_f32_32x32x16_bf16 v[48:63], a[28:31], v[100:103], v[48:63]
    s_cbranch_vccnz RT_568
BK_569:
    v_mfma_f32_32x32x16_bf16 v[32:47], a[80:83], v[104:107], v[32:47]
    s_waitcnt vmcnt(20)
    v_cmp_eq_u32 vcc, -1, v108
    s_waitcnt vmcnt(23)
    v_lshlrev_b32 v4, 16, v96
    v_and_b32 v5, s91, v96
    v_add_f32 v64, v64, v4
    v_mfma_f32_32x32x16_bf16 v[48:63], a[84:87], v[104:107], v[48:63]
    v_add_f32 v65, v65, v5
    v_lshlrev_b32 v4, 16, v97
    v_and_b32 v5, s91, v97
    v_add_f32 v66, v66, v4
    v_add_f32 v67, v67, v5
    s_cbranch_vccnz RT_572
BK_573:
    v_mfma_f32_32x32x16_bf16 v[32:47], a[136:139], v[108:111], v[32:47]
    s_waitcnt vmcnt(19)
    v_cmp_eq_u32 vcc, -1, v112
    v_lshlrev_b32 v4, 16, v98
    v_and_b32 v5, s91, v98
    v_add_f32 v68, v68, v4
    v_add_f32 v69, v69, v5
    v_mfma_f32_32x32x16_bf16 v[48:63], a[140:143], v[108:111], v[48:63]
    v_lshlrev_b32 v4, 16, v99
    v_and_b32 v5, s91, v99
    v_add_f32 v70, v70, v4
    v_add_f32 v71, v71, v5
    v_accvgpr_read_b32 v5, a240
    s_cbranch_vccnz RT_576
BK_577:
    v_mfma_f32_32x32x16_bf16 v[32:47], a[192:195], v[112:115], v[32:47]
    s_waitcnt vmcnt(18)
    v_cmp_eq_u32 vcc, -1, v116
    buffer_load_dwordx4 v[96:99], v1, s[4:7], s46 offen offset:0 sc1
    v_lshlrev_b32 v4, 16, v5
    v_and_b32 v5, s91, v5
    v_add_f32 v64, v64, v4
    v_mfma_f32_32x32x16_bf16 v[48:63], a[196:199], v[112:115], v[48:63]
    buffer_load_dwordx4 v[100:103], v1, s[4:7], s47 offen offset:0 sc1
    v_add_f32 v65, v65, v5
    v_accvgpr_read_b32 v5, a241
    v_lshlrev_b32 v4, 16, v5
    v_and_b32 v5, s91, v5
    s_cbranch_vccnz RT_580
BK_581:
    v_mfma_f32_32x32x16_bf16 v[32:47], a[32:35], v[116:119], v[32:47]
    s_waitcnt vmcnt(19)
    v_cmp_eq_u32 vcc, -1, v120
    buffer_load_dwordx4 v[104:107], v1, s[4:7], s44 offen offset:1024 sc1
    v_add_f32 v66, v66, v4
    v_add_f32 v67, v67, v5
    v_accvgpr_read_b32 v5, a242
    v_mfma_f32_32x32x16_bf16 v[48:63], a[36:39], v[116:119], v[48:63]
    buffer_load_dwordx4 v[108:111], v1, s[4:7], s45 offen offset:1024 sc1
    v_lshlrev_b32 v4, 16, v5
    v_and_b32 v5, s91, v5
    v_add_f32 v68, v68, v4
    v_add_f32 v69, v69, v5
    s_cbranch_vccnz RT_584
BK_585:
    v_mfma_f32_32x32x16_bf16 v[32:47], a[88:91], v[120:123], v[32:47]
    s_waitcnt vmcnt(20)
    v_cmp_eq_u32 vcc, -1, v124
    buffer_load_dwordx4 v[112:115], v1, s[4:7], s46 offen offset:1024 sc1
    v_accvgpr_read_b32 v5, a243
    v_lshlrev_b32 v4, 16, v5
    v_and_b32 v5, s91, v5
    v_mfma_f32_32x32x16_bf16 v[48:63], a[92:95], v[120:123], v[48:63]
    buffer_load_dwordx4 v[116:119], v1, s[4:7], s47 offen offset:1024 sc1
    v_add_f32 v70, v70, v4
    v_add_f32 v71, v71, v5
    s_cbranch_vccnz RT_588
BK_589:
    v_mfma_f32_32x32x16_bf16 v[32:47], a[144:147], v[124:127], v[32:47]
    s_waitcnt vmcnt(21)
    v_cmp_eq_u32 vcc, -1, v128
    buffer_load_dwordx4 v[120:123], v1, s[4:7], s44 offen offset:2048 sc1
    v_mfma_f32_32x32x16_bf16 v[48:63], a[148:151], v[124:127], v[48:63]
    buffer_load_dwordx4 v[124:127], v1, s[4:7], s45 offen offset:2048 sc1
    s_cbranch_vccnz RT_592
BK_593:
    v_mfma_f32_32x32x16_bf16 v[32:47], a[200:203], v[128:131], v[32:47]
    s_waitcnt vmcnt(22)
    v_cmp_eq_u32 vcc, -1, v132
    v_mfma_f32_32x32x16_bf16 v[48:63], a[204:207], v[128:131], v[48:63]
    buffer_load_dwordx4 v[128:131], v1, s[4:7], s46 offen offset:2048 sc1
    s_cbranch_vccnz RT_596
BK_597:
    v_mfma_f32_32x32x16_bf16 v[32:47], a[40:43], v[132:135], v[32:47]
    s_waitcnt vmcnt(22)
    v_cmp_eq_u32 vcc, -1, v136
    v_mfma_f32_32x32x16_bf16 v[48:63], a[44:47], v[132:135], v[48:63]
    buffer_load_dwordx4 v[132:135], v1, s[4:7], s47 offen offset:2048 sc1
    s_cbranch_vccnz RT_600
BK_601:
    v_mfma_f32_32x32x16_bf16 v[32:47], a[96:99], v[136:139], v[32:47]
    s_waitcnt vmcnt(22)
    v_cmp_eq_u32 vcc, -1, v140
    v_mfma_f32_32x32x16_bf16 v[48:63], a[100:103], v[136:139], v[48:63]
    s_cbranch_vccnz RT_604
BK_605:
    v_mfma_f32_32x32x16_bf16 v[32:47], a[152:155], v[140:143], v[32:47]
    s_waitcnt vmcnt(21)
    v_cmp_eq_u32 vcc, -1, v144
    v_mfma_f32_32x32x16_bf16 v[48:63], a[156:159], v[140:143], v[48:63]
    s_cbranch_vccnz RT_608
BK_609:
    v_mfma_f32_32x32x16_bf16 v[32:47], a[208:211], v[144:147], v[32:47]
    s_waitcnt vmcnt(20)
    v_cmp_eq_u32 vcc, -1, v148
    v_mfma_f32_32x32x16_bf16 v[48:63], a[212:215], v[144:147], v[48:63]
    s_cbranch_vccnz RT_612
BK_613:
    v_mfma_f32_32x32x16_bf16 v[32:47], a[48:51], v[148:151], v[32:47]
    s_waitcnt vmcnt(19)
    v_cmp_eq_u32 vcc, -1, v152
    v_mfma_f32_32x32x16_bf16 v[48:63], a[52:55], v[148:151], v[48:63]
    s_cbranch_vccnz RT_616
BK_617:
    v_mfma_f32_32x32x16_bf16 v[32:47], a[104:107], v[152:155], v[32:47]
    s_waitcnt vmcnt(18)
    v_cmp_eq_u32 vcc, -1, v156
    v_mfma_f32_32x32x16_bf16 v[48:63], a[108:111], v[152:155], v[48:63]
    s_cbranch_vccnz RT_620
BK_621:
    v_mfma_f32_32x32x16_bf16 v[32:47], a[160:163], v[156:159], v[32:47]
    s_waitcnt vmcnt(17)
    v_cmp_eq_u32 vcc, -1, v160
    v_mfma_f32_32x32x16_bf16 v[48:63], a[164:167], v[156:159], v[48:63]
    s_cbranch_vccnz RT_624
BK_625:
    v_mfma_f32_32x32x16_bf16 v[32:47], a[216:219], v[160:163], v[32:47]
    s_waitcnt vmcnt(15)
    v_cmp_eq_u32 vcc, -1, v168
    v_mfma_f32_32x32x16_bf16 v[48:63], a[220:223], v[160:163], v[48:63]
    s_cbranch_vccnz RT_628
BK_629:
    v_mfma_f32_32x32x16_bf16 v[64:79], a[24:27], v[168:171], v[64:79]
    s_waitcnt vmcnt(14)
    v_cmp_eq_u32 vcc, -1, v172
    v_mfma_f32_32x32x16_bf16 v[80:95], a[28:31], v[168:171], v[80:95]
    s_cbranch_vccnz RT_632
BK_633:
    v_mfma_f32_32x32x16_bf16 v[64:79], a[80:83], v[172:175], v[64:79]
    s_waitcnt vmcnt(13)
    v_cmp_eq_u32 vcc, -1, v176
    s_waitcnt vmcnt(16)
    ds_write_b128 v28, v[40:43] offset:0
    v_lshlrev_b32 v4, 16, v164
    v_and_b32 v5, s91, v164
    v_mfma_f32_32x32x16_bf16 v[80:95], a[84:87], v[172:175], v[80:95]
    v_add_f32 v32, v32, v4
    v_add_f32 v33, v33, v5
    v_lshlrev_b32 v4, 16, v165
    v_and_b32 v5, s91, v165
    s_cbranch_vccnz RT_636
BK_637:
    v_mfma_f32_32x32x16_bf16 v[64:79], a[136:139], v[176:179], v[64:79]
    s_waitcnt vmcnt(12)
    v_cmp_eq_u32 vcc, -1, v180
    ds_write_b128 v28, v[44:47] offset:1024
    v_add_f32 v34, v34, v4
    v_add_f32 v35, v35, v5
    v_mfma_f32_32x32x16_bf16 v[80:95], a[140:143], v[176:179], v[80:95]
TCH14:
    s_cbranch_execz TCHRET
    v_lshlrev_b32 v4, 16, v166
    v_and_b32 v5, s91, v166
    v_add_f32 v36, v36, v4
    v_add_f32 v37, v37, v5
    s_cbranch_vccnz RT_640
BK_641:
    v_mfma_f32_32x32x16_bf16 v[64:79], a[192:195], v[180:183], v[64:79]
    s_waitcnt vmcnt(11)
    v_cmp_eq_u32 vcc, -1, v184
    ds_write_b128 v29, v[48:51] offset:8192
    v_lshlrev_b32 v4, 16, v167
    v_and_b32 v5, s91, v167
    v_mfma_f32_32x32x16_bf16 v[80:95], a[196:199], v[180:183], v[80:95]
    v_add_f32 v38, v38, v4
    v_add_f32 v39, v39, v5
    v_accvgpr_read_b32 v5, a240
    v_lshlrev_b32 v4, 16, v5
    s_cbranch_vccnz RT_644
BK_645:
    v_mfma_f32_32x32x16_bf16 v[64:79], a[32:35], v[184:187], v[64:79]
    s_waitcnt vmcnt(10)
    v_cmp_eq_u32 vcc, -1, v188
    ds_write_b128 v29, v[52:55] offset:9216
    v_and_b32 v5, s91, v5
    v_add_f32 v32, v32, v4
    v_mfma_f32_32x32x16_bf16 v[80:95], a[36:39], v[184:187], v[80:95]
    v_add_f32 v33, v33, v5
    v_accvgpr_read_b32 v5, a241
    v_lshlrev_b32 v4, 16, v5
    v_and_b32 v5, s91, v5
    s_cbranch_vccnz RT_648
BK_649:
    v_mfma_f32_32x32x16_bf16 v[64:79], a[88:91], v[188:191], v[64:79]
    s_waitcnt vmcnt(9)
    v_cmp_eq_u32 vcc, -1, v96
    ds_write_b128 v30, v[56:59] offset:16384
    v_add_f32 v34, v34, v4
    v_add_f32 v35, v35, v5
    v_mfma_f32_32x32x16_bf16 v[80:95], a[92:95], v[188:191], v[80:95]
    v_accvgpr_read_b32 v5, a242
    v_lshlrev_b32 v4, 16, v5
    v_and_b32 v5, s91, v5
    v_add_f32 v36, v36, v4
    s_cbranch_vccnz RT_652
BK_653:
    v_mfma_f32_32x32x16_bf16 v[64:79], a[144:147], v[96:99], v[64:79]
    s_waitcnt vmcnt(8)
    v_cmp_eq_u32 vcc, -1, v100
    ds_write_b128 v30, v[60:63] offset:17408
    v_add_f32 v37, v37, v5
    v_accvgpr_read_b32 v5, a243
    v_mfma_f32_32x32x16_bf16 v[80:95], a[148:151], v[96:99], v[80:95]
    v_lshlrev_b32 v4, 16, v5
    v_and_b32 v5, s91, v5
    v_add_f32 v38, v38, v4
    v_add_f32 v39, v39, v5
    s_cbranch_vccnz RT_656
BK_657:
    v_mfma_f32_32x32x16_bf16 v[64:79], a[200:203], v[100:103], v[64:79]
    s_waitcnt vmcnt(7)
    v_cmp_eq_u32 vcc, -1, v104
    v_mfma_f32_32x32x16_bf16 v[80:95], a[204:207], v[100:103], v[80:95]
    s_waitcnt lgkmcnt(0)
    s_barrier
    ds_read_b128 v[40:43], v31 offset:0
    ds_read_b128 v[44:47], v31 offset:1024
    ds_read_b128 v[48:51], v31 offset:8192
    s_cbranch_vccnz RT_660
BK_661:
    v_mfma_f32_32x32x16_bf16 v[64:79], a[40:43], v[104:107], v[64:79]
    s_waitcnt vmcnt(6)
    v_cmp_eq_u32 vcc, -1, v108
    ds_read_b128 v[52:55], v31 offset:9216
    ds_read_b128 v[56:59], v31 offset:16384
    ds_read_b128 v[60:63], v31 offset:17408
    v_mfma_f32_32x32x16_bf16 v[80:95], a[44:47], v[104:107], v[80:95]
    s_cbranch_vccnz RT_664
BK_665:
    v_mfma_f32_32x32x16_bf16 v[64:79], a[96:99], v[108:111], v[64:79]
    s_waitcnt vmcnt(5)
    v_cmp_eq_u32 vcc, -1, v112
    s_waitcnt lgkmcnt(4)
    v_add_f32 v32, v32, v40
    v_add_f32 v33, v33, v41
    v_add_f32 v34, v34, v42
    v_mfma_f32_32x32x16_bf16 v[80:95], a[100:103], v[108:111], v[80:95]
    v_add_f32 v35, v35, v43
    v_add_f32 v36, v36, v44
    v_add_f32 v37, v37, v45
    s_cbranch_vccnz RT_668
BK_669:
    s_waitcnt vmcnt(4)
    v_cmp_eq_u32 vcc, -1, v116
    v_mfma_f32_32x32x16_bf16 v[80:95], a[156:159], v[112:115], v[80:95]
    v_add_f32 v38, v38, v46
    v_add_f32 v39, v39, v47
    s_waitcnt lgkmcnt(2)
    s_cbranch_vccnz RT_672
BK_673:
    s_waitcnt vmcnt(3)
    v_cmp_eq_u32 vcc, -1, v120
    v_mfma_f32_32x32x16_bf16 v[80:95], a[212:215], v[116:119], v[80:95]
    v_add_f32 v32, v32, v48
    v_add_f32 v33, v33, v49
    v_add_f32 v34, v34, v50
    s_cbranch_vccnz RT_676
BK_677:
    s_waitcnt vmcnt(2)
    v_cmp_eq_u32 vcc, -1, v124
    v_mfma_f32_32x32x16_bf16 v[80:95], a[52:55], v[120:123], v[80:95]
    v_add_f32 v35, v35, v51
    v_add_f32 v36, v36, v52
    v_add_f32 v37, v37, v53
    s_cbranch_vccnz RT_680
BK_681:
    s_waitcnt vmcnt(1)
    v_cmp_eq_u32 vcc, -1, v128
    v_mfma_f32_32x32x16_bf16 v[80:95], a[108:111], v[124:127], v[80:95]
    v_add_f32 v38, v38, v54
    v_add_f32 v39, v39, v55
    s_waitcnt lgkmcnt(0)
    s_cbranch_vccnz RT_684
BK_685:
    s_waitcnt vmcnt(0)
    v_cmp_eq_u32 vcc, -1, v132
    v_mfma_f32_32x32x16_bf16 v[80:95], a[164:167], v[128:131], v[80:95]
    s_barrier
    v_add_f32 v32, v32, v56
    v_add_f32 v33, v33, v57
    v_add_f32 v34, v34, v58
    v_add_f32 v35, v35, v59
    s_cbranch_vccnz RT_688
BK_689:
    v_mfma_f32_32x32x16_bf16 v[80:95], a[220:223], v[132:135], v[80:95]
    v_add_f32 v36, v36, v60
    v_add_f32 v37, v37, v61
    v_add_f32 v38, v38, v62
    v_add_f32 v39, v39, v63
    v_cvt_pk_bf16_f32 v32, v32, v33
    v_cvt_pk_bf16_f32 v33, v34, v35
    v_mfma_f32_32x32x16_bf16 v[64:79], a[152:155], v[112:115], v[64:79]
    v_cvt_pk_bf16_f32 v34, v36, v37
    v_cvt_pk_bf16_f32 v35, v38, v39
    buffer_store_dwordx4 v[32:35], v7, s[12:15], s78 offen
    s_add_u32 s78, s78, 0x8000
    s_nop 0
    ds_write_b128 v29, v[80:83] offset:8192
    v_mfma_f32_32x32x16_bf16 v[64:79], a[208:211], v[116:119], v[64:79]
    ds_write_b128 v29, v[84:87] offset:9216
    v_mfma_f32_32x32x16_bf16 v[64:79], a[48:51], v[120:123], v[64:79]
    ds_write_b128 v30, v[88:91] offset:16384
    v_mfma_f32_32x32x16_bf16 v[64:79], a[104:107], v[124:127], v[64:79]
    ds_write_b128 v30, v[92:95] offset:17408
    v_mfma_f32_32x32x16_bf16 v[64:79], a[160:163], v[128:131], v[64:79]
    v_mfma_f32_32x32x16_bf16 v[64:79], a[216:219], v[132:135], v[64:79]
    s_nop 11
    ds_write_b128 v28, v[72:75] offset:0
    ds_write_b128 v28, v[76:79] offset:1024
    s_waitcnt lgkmcnt(0)
    s_barrier
    ds_read_b128 v[80:83], v31 offset:8192
    ds_read_b128 v[84:87], v31 offset:9216
    ds_read_b128 v[88:91], v31 offset:16384
    ds_read_b128 v[92:95], v31 offset:17408
    ds_read_b128 v[72:75], v31 offset:0
    ds_read_b128 v[76:79], v31 offset:1024
    s_waitcnt lgkmcnt(4)
    v_pk_add_f32 v[64:65], v[64:65], v[80:81]
    v_pk_add_f32 v[66:67], v[66:67], v[82:83]
    v_pk_add_f32 v[68:69], v[68:69], v[84:85]
    v_pk_add_f32 v[70:71], v[70:71], v[86:87]
    s_waitcnt lgkmcnt(2)
    v_pk_add_f32 v[64:65], v[64:65], v[88:89]
    v_pk_add_f32 v[66:67], v[66:67], v[90:91]
    v_pk_add_f32 v[68:69], v[68:69], v[92:93]
    v_pk_add_f32 v[70:71], v[70:71], v[94:95]
    s_waitcnt lgkmcnt(0)
    v_pk_add_f32 v[64:65], v[64:65], v[72:73]
    v_pk_add_f32 v[66:67], v[66:67], v[74:75]
    v_pk_add_f32 v[68:69], v[68:69], v[76:77]
    v_pk_add_f32 v[70:71], v[70:71], v[78:79]
    v_cvt_pk_bf16_f32 v64, v64, v65
    v_cvt_pk_bf16_f32 v65, v66, v67
    v_cvt_pk_bf16_f32 v66, v68, v69
    v_cvt_pk_bf16_f32 v67, v70, v71
    buffer_store_dwordx4 v[64:67], v7, s[12:15], s78 offen
    s_or_b32 s70, s2, s60
    s_cmp_lg_u32 s70, 0
    s_cbranch_scc1 KEXIT
    s_mov_b64 exec, 1
    buffer_store_dword v6, off, s[4:7], 0 sc1
KEXIT:
    s_endpgm
KVV_1:
    s_waitcnt lgkmcnt(3)
    v_mfma_f32_16x16x32_bf16 v[80:83], v[64:67], a[224:227], 0
    v_mfma_f32_16x16x32_bf16 v[8:11], a[248:251], a[224:227], 0
    s_waitcnt lgkmcnt(2)
    v_mfma_f32_16x16x32_bf16 v[80:83], v[68:71], a[228:231], v[80:83]
    v_mfma_f32_16x16x32_bf16 v[8:11], a[248:251], a[228:231], v[8:11]
    s_waitcnt lgkmcnt(1)
    v_mfma_f32_16x16x32_bf16 v[80:83], v[72:75], a[232:235], v[80:83]
    v_mfma_f32_16x16x32_bf16 v[8:11], a[248:251], a[232:235], v[8:11]
    s_waitcnt lgkmcnt(0)
    v_mfma_f32_16x16x32_bf16 v[80:83], v[76:79], a[236:239], v[80:83]
    v_mfma_f32_16x16x32_bf16 v[8:11], a[248:251], a[236:239], v[8:11]
    s_branch KVD_2
SF_6:
    s_waitcnt vmcnt(0)
    buffer_wbl2 sc1
    s_waitcnt vmcnt(0)
    s_branch SFD_7
SF_10:
    buffer_inv sc1
    s_branch SFD_11
SF_14:
    buffer_inv sc1
    s_branch SFD_15
SF_18:
    buffer_inv sc1
    s_branch SFD_19
RT_16:
    s_cmp_eq_u32 s29, 0
    s_cbranch_scc1 BK_17
    s_sub_u32 s29, s29, 1
    s_cmp_lg_u32 s31, 0
    s_cbranch_scc1 SF_18
SFD_19:
    s_mov_b64 exec, vcc
    buffer_load_dword v160, v123, s[4:7], s78 offen sc1
    s_waitcnt vmcnt(0)
    v_sad_u32 v160, v160, s28, 0
    v_cmp_lt_u32 vcc, 0, v160
    s_mov_b64 exec, -1
    s_cbranch_vccnz RT_16
    s_branch BK_17
PFS_20:
    buffer_store_dword v6, off, s[4:7], s74 sc1
    s_branch PFD_21
SF_24:
    buffer_inv sc1
    s_branch SFD_25
RT_22:
    s_cmp_eq_u32 s29, 0
    s_cbranch_scc1 BK_23
    s_sub_u32 s29, s29, 1
    s_cmp_lg_u32 s31, 0
    s_cbranch_scc1 SF_24
SFD_25:
    buffer_load_dword v121, v122, s[4:7], s64 offen sc1
    s_waitcnt vmcnt(0)
    v_cmp_ne_u32 vcc, v121, v6
    s_cbranch_vccnz RT_22
    s_branch BK_23
SF_26:
    buffer_inv sc1
    s_branch SFD_27
SLOW0:
    v_mov_b32 v121, 0xff800000
    v_mov_b32 v122, 0xff800000
    s_mov_b32 s74, s65
    s_mov_b32 s75, 64
SLOW0A:
    buffer_load_dwordx4 v[96:99], v1, s[4:7], s74 offen sc1
    s_waitcnt vmcnt(0)
    v_mfma_f32_32x32x16_bf16 v[32:47], v[96:99], v[20:23], 0
    v_mfma_f32_32x32x16_bf16 v[48:63], v[96:99], v[24:27], 0
    s_nop 4
    v_max3_f32 v121, v32, v33, v121
    v_max3_f32 v121, v34, v35, v121
    v_max3_f32 v121, v36, v37, v121
    v_max3_f32 v121, v38, v39, v121
    v_max3_f32 v121, v40, v41, v121
    v_max3_f32 v121, v42, v43, v121
    v_max3_f32 v121, v44, v45, v121
    v_max3_f32 v121, v46, v47, v121
    v_max3_f32 v122, v48, v49, v122
    v_max3_f32 v122, v50, v51, v122
    v_max3_f32 v122, v52, v53, v122
    v_max3_f32 v122, v54, v55, v122
    v_max3_f32 v122, v56, v57, v122
    v_max3_f32 v122, v58, v59, v122
    v_max3_f32 v122, v60, v61, v122
    v_max3_f32 v122, v62, v63, v122
    s_add_u32 s74, s74, 2048
    s_sub_u32 s75, s75, 1
    s_cmp_lg_u32 s75, 0
    s_cbranch_scc1 SLOW0A
    v_mov_b32 v124, v121
    s_nop 1
    v_permlane32_swap_b32 v121, v124
    v_max_f32 v121, v121, v124
    v_mov_b32 v124, v122
    s_nop 1
    v_permlane32_swap_b32 v122, v124
    v_max_f32 v122, v122, v124
    v_mov_b32 v64, 0
    v_mov_b32 v65, 0
    v_mov_b32 v66, 0
    v_mov_b32 v67, 0
    v_mov_b32 v68, 0
    v_mov_b32 v69, 0
    v_mov_b32 v70, 0
    v_mov_b32 v71, 0
    v_mov_b32 v72, 0
    v_mov_b32 v73, 0
    v_mov_b32 v74, 0
    v_mov_b32 v75, 0
    v_mov_b32 v76, 0
    v_mov_b32 v77, 0
    v_mov_b32 v78, 0
    v_mov_b32 v79, 0
    v_mov_b32 v80, 0
    v_mov_b32 v81, 0
    v_mov_b32 v82, 0
    v_mov_b32 v83, 0
    v_mov_b32 v84, 0
    v_mov_b32 v85, 0
    v_mov_b32 v86, 0
    v_mov_b32 v87, 0
    v_mov_b32 v88, 0
    v_mov_b32 v89, 0
    v_mov_b32 v90, 0
    v_mov_b32 v91, 0
    v_mov_b32 v92, 0
    v_mov_b32 v93, 0
    v_mov_b32 v94, 0
    v_mov_b32 v95, 0
    v_lshrrev_b32 v120, 9, v1
    v_and_b32 v124, 0xf0, v1
    v_lshl_add_u32 v124, v120, 8, v124
    v_and_b32 v120, 0x100, v1
    v_cmp_ne_u32 vcc, 0, v120
    v_mov_b32 v120, s68
    s_mov_b32 s74, s65
    s_mov_b32 s75, 64
SLOW0B:
    buffer_load_dwordx4 v[96:99], v1, s[4:7], s74 offen sc1
    buffer_load_dwordx4 v[104:107], v124, s[4:7], s74 offen offset:1024 sc1
    buffer_load_dwordx4 v[112:115], v124, s[4:7], s74 offen offset:1536 sc1
    s_waitcnt vmcnt(0)
    v_mfma_f32_32x32x16_bf16 v[32:47], v[96:99], v[20:23], 0
    v_mfma_f32_32x32x16_bf16 v[48:63], v[96:99], v[24:27], 0
    v_cndmask_b32 v104, v104, v120, vcc
    v_cndmask_b32 v105, v105, v120, vcc
    v_cndmask_b32 v106, v106, v120, vcc
    v_cndmask_b32 v107, v107, v120, vcc
    v_cndmask_b32 v112, v112, v120, vcc
    v_cndmask_b32 v113, v113, v120, vcc
    v_cndmask_b32 v114, v114, v120, vcc
    v_cndmask_b32 v115, v115, v120, vcc
    v_sub_f32 v32, v32, v121
    v_sub_f32 v33, v33, v121
    v_sub_f32 v34, v34, v121
    v_sub_f32 v35, v35, v121
    v_sub_f32 v36, v36, v121
    v_sub_f32 v37, v37, v121
    v_sub_f32 v38, v38, v121
    v_sub_f32 v39, v39, v121
    v_sub_f32 v40, v40, v121
    v_sub_f32 v41, v41, v121
    v_sub_f32 v42, v42, v121
    v_sub_f32 v43, v43, v121
    v_sub_f32 v44, v44, v121
    v_sub_f32 v45, v45, v121
    v_sub_f32 v46, v46, v121
    v_sub_f32 v47, v47, v121
    v_exp_f32 v32, v32
    v_exp_f32 v33, v33
    v_exp_f32 v34, v34
    v_exp_f32 v35, v35
    v_exp_f32 v36, v36
    v_exp_f32 v37, v37
    v_exp_f32 v38, v38
    v_exp_f32 v39, v39
    v_exp_f32 v40, v40
    v_exp_f32 v41, v41
    v_exp_f32 v42, v42
    v_exp_f32 v43, v43
    v_exp_f32 v44, v44
    v_exp_f32 v45, v45
    v_exp_f32 v46, v46
    v_exp_f32 v47, v47
    v_sub_f32 v48, v48, v122
    v_sub_f32 v49, v49, v122
    v_sub_f32 v50, v50, v122
    v_sub_f32 v51, v51, v122
    v_sub_f32 v52, v52, v122
    v_sub_f32 v53, v53, v122
    v_sub_f32 v54, v54, v122
    v_sub_f32 v55, v55, v122
    v_sub_f32 v56, v56, v122
    v_sub_f32 v57, v57, v122
    v_sub_f32 v58, v58, v122
    v_sub_f32 v59, v59, v122
    v_sub_f32 v60, v60, v122
    v_sub_f32 v61, v61, v122
    v_sub_f32 v62, v62, v122
    v_sub_f32 v63, v63, v122
    v_exp_f32 v48, v48
    v_exp_f32 v49, v49
    v_exp_f32 v50, v50
    v_exp_f32 v51, v51
    v_exp_f32 v52, v52
    v_exp_f32 v53, v53
    v_exp_f32 v54, v54
    v_exp_f32 v55, v55
    v_exp_f32 v56, v56
    v_exp_f32 v57, v57
    v_exp_f32 v58, v58
    v_exp_f32 v59, v59
    v_exp_f32 v60, v60
    v_exp_f32 v61, v61
    v_exp_f32 v62, v62
    v_exp_f32 v63, v63
    v_smfmac_f32_32x32x32_bf16 v[64:79], v[104:107], v[32:39], v2
    v_smfmac_f32_32x32x32_bf16 v[64:79], v[112:115], v[40:47], v2
    v_smfmac_f32_32x32x32_bf16 v[80:95], v[104:107], v[48:55], v2
    v_smfmac_f32_32x32x32_bf16 v[80:95], v[112:115], v[56:63], v2
    s_nop 7
    s_nop 7
    s_add_u32 s74, s74, 2048
    s_sub_u32 s75, s75, 1
    s_cmp_lg_u32 s75, 0
    s_cbranch_scc1 SLOW0B
    v_rcp_f32 v74, v72
    v_rcp_f32 v90, v88
    v_mul_f32 v64, v64, v74
    v_mul_f32 v65, v65, v74
    v_mul_f32 v66, v66, v74
    v_mul_f32 v67, v67, v74
    v_mul_f32 v68, v68, v74
    v_mul_f32 v69, v69, v74
    v_mul_f32 v70, v70, v74
    v_mul_f32 v71, v71, v74
    v_pk_mul_f32 v[80:81], v[80:81], v[90:91] op_sel_hi:[1,0]
    v_pk_mul_f32 v[82:83], v[82:83], v[90:91] op_sel_hi:[1,0]
    v_pk_mul_f32 v[84:85], v[84:85], v[90:91] op_sel_hi:[1,0]
    v_pk_mul_f32 v[86:87], v[86:87], v[90:91] op_sel_hi:[1,0]
    v_cvt_pk_bf16_f32 v64, v64, v65
    v_cvt_pk_bf16_f32 v65, v66, v67
    v_cvt_pk_bf16_f32 v66, v68, v69
    v_cvt_pk_bf16_f32 v67, v70, v71
    s_branch SLOW0D
SF_28:
    s_waitcnt vmcnt(0)
    buffer_wbl2 sc1
    s_waitcnt vmcnt(0)
    s_branch SFD_29
SF_34:
    buffer_inv sc1
    s_branch SFD_35
SF_39:
    buffer_inv sc1
    s_branch SFD_40
SF_44:
    buffer_inv sc1
    s_branch SFD_45
SF_46:
    s_waitcnt vmcnt(0)
    buffer_wbl2 sc1
    s_waitcnt vmcnt(0)
    s_branch SFD_47
SF_49:
    buffer_inv sc1
    s_branch SFD_50
SF_53:
    buffer_inv sc1
    s_branch SFD_54
RT_51:
    s_cmp_eq_u32 s29, 0
    s_cbranch_scc1 BK_52
    s_sub_u32 s29, s29, 1
    s_cmp_lg_u32 s31, 0
    s_cbranch_scc1 SF_53
SFD_54:
    buffer_load_dwordx4 v[144:147], v89, s[4:7], s41 offen offset:0 sc1
    buffer_load_dwordx4 v[148:151], v89, s[4:7], s41 offen offset:256 sc1
    s_waitcnt vmcnt(0)
    v_max_u32 v5, v144, v148
    v_cmp_eq_u32 vcc, -1, v5
    s_cbranch_vccnz RT_51
    s_branch BK_52
SF_57:
    buffer_inv sc1
    s_branch SFD_58
RT_55:
    s_cmp_eq_u32 s29, 0
    s_cbranch_scc1 BK_56
    s_sub_u32 s29, s29, 1
    s_cmp_lg_u32 s31, 0
    s_cbranch_scc1 SF_57
SFD_58:
    buffer_load_dwordx4 v[152:155], v89, s[4:7], s41 offen offset:2048 sc1
    buffer_load_dwordx4 v[156:159], v89, s[4:7], s41 offen offset:2304 sc1
    s_waitcnt vmcnt(0)
    v_max_u32 v5, v152, v156
    v_cmp_eq_u32 vcc, -1, v5
    s_cbranch_vccnz RT_55
    s_branch BK_56
SF_61:
    buffer_inv sc1
    s_branch SFD_62
RT_59:
    s_cmp_eq_u32 s29, 0
    s_cbranch_scc1 BK_60
    s_sub_u32 s29, s29, 1
    s_cmp_lg_u32 s31, 0
    s_cbranch_scc1 SF_61
SFD_62:
    buffer_load_dwordx4 v[160:163], v89, s[4:7], s42 offen offset:0 sc1
    buffer_load_dwordx4 v[164:167], v89, s[4:7], s42 offen offset:256 sc1
    s_waitcnt vmcnt(0)
    v_max_u32 v5, v160, v164
    v_cmp_eq_u32 vcc, -1, v5
    s_cbranch_vccnz RT_59
    s_branch BK_60
SF_65:
    buffer_inv sc1
    s_branch SFD_66
RT_63:
    s_cmp_eq_u32 s29, 0
    s_cbranch_scc1 BK_64
    s_sub_u32 s29, s29, 1
    s_cmp_lg_u32 s31, 0
    s_cbranch_scc1 SF_65
SFD_66:
    buffer_load_dwordx4 v[168:171], v89, s[4:7], s42 offen offset:2048 sc1
    buffer_load_dwordx4 v[172:175], v89, s[4:7], s42 offen offset:2304 sc1
    s_waitcnt vmcnt(0)
    v_max_u32 v5, v168, v172
    v_cmp_eq_u32 vcc, -1, v5
    s_cbranch_vccnz RT_63
    s_branch BK_64
SF_69:
    buffer_inv sc1
    s_branch SFD_70
RT_67:
    s_cmp_eq_u32 s29, 0
    s_cbranch_scc1 BK_68
    s_sub_u32 s29, s29, 1
    s_cmp_lg_u32 s31, 0
    s_cbranch_scc1 SF_69
SFD_70:
    buffer_load_dwordx4 v[176:179], v89, s[4:7], s43 offen offset:0 sc1
    buffer_load_dwordx4 v[180:183], v89, s[4:7], s43 offen offset:256 sc1
    s_waitcnt vmcnt(0)
    v_max_u32 v5, v176, v180
    v_cmp_eq_u32 vcc, -1, v5
    s_cbranch_vccnz RT_67
    s_branch BK_68
SF_73:
    buffer_inv sc1
    s_branch SFD_74
RT_71:
    s_cmp_eq_u32 s29, 0
    s_cbranch_scc1 BK_72
    s_sub_u32 s29, s29, 1
    s_cmp_lg_u32 s31, 0
    s_cbranch_scc1 SF_73
SFD_74:
    buffer_load_dwordx4 v[184:187], v89, s[4:7], s43 offen offset:2048 sc1
    buffer_load_dwordx4 v[188:191], v89, s[4:7], s43 offen offset:2304 sc1
    s_waitcnt vmcnt(0)
    v_max_u32 v5, v184, v188
    v_cmp_eq_u32 vcc, -1, v5
    s_cbranch_vccnz RT_71
    s_branch BK_72
SF_77:
    buffer_inv sc1
    s_branch SFD_78
RT_75:
    s_cmp_eq_u32 s29, 0
    s_cbranch_scc1 BK_76
    s_sub_u32 s29, s29, 1
    s_cmp_lg_u32 s31, 0
    s_cbranch_scc1 SF_77
SFD_78:
    buffer_load_dwordx4 v[192:195], v89, s[4:7], s44 offen offset:0 sc1
    buffer_load_dwordx4 v[196:199], v89, s[4:7], s44 offen offset:256 sc1
    s_waitcnt vmcnt(0)
    v_max_u32 v5, v192, v196
    v_cmp_eq_u32 vcc, -1, v5
    s_cbranch_vccnz RT_75
    s_branch BK_76
SF_81:
    buffer_inv sc1
    s_branch SFD_82
RT_79:
    s_cmp_eq_u32 s29, 0
    s_cbranch_scc1 BK_80
    s_sub_u32 s29, s29, 1
    s_cmp_lg_u32 s31, 0
    s_cbranch_scc1 SF_81
SFD_82:
    buffer_load_dwordx4 v[200:203], v89, s[4:7], s44 offen offset:2048 sc1
    buffer_load_dwordx4 v[204:207], v89, s[4:7], s44 offen offset:2304 sc1
    s_waitcnt vmcnt(0)
    v_max_u32 v5, v200, v204
    v_cmp_eq_u32 vcc, -1, v5
    s_cbranch_vccnz RT_79
    s_branch BK_80
SF_85:
    buffer_inv sc1
    s_branch SFD_86
RT_83:
    s_cmp_eq_u32 s29, 0
    s_cbranch_scc1 BK_84
    s_sub_u32 s29, s29, 1
    s_cmp_lg_u32 s31, 0
    s_cbranch_scc1 SF_85
SFD_86:
    buffer_load_dwordx4 v[208:211], v89, s[4:7], s45 offen offset:0 sc1
    buffer_load_dwordx4 v[212:215], v89, s[4:7], s45 offen offset:256 sc1
    s_waitcnt vmcnt(0)
    v_max_u32 v5, v208, v212
    v_cmp_eq_u32 vcc, -1, v5
    s_cbranch_vccnz RT_83
    s_branch BK_84
SF_89:
    buffer_inv sc1
    s_branch SFD_90
RT_87:
    s_cmp_eq_u32 s29, 0
    s_cbranch_scc1 BK_88
    s_sub_u32 s29, s29, 1
    s_cmp_lg_u32 s31, 0
    s_cbranch_scc1 SF_89
SFD_90:
    buffer_load_dwordx4 v[216:219], v89, s[4:7], s45 offen offset:2048 sc1
    buffer_load_dwordx4 v[220:223], v89, s[4:7], s45 offen offset:2304 sc1
    s_waitcnt vmcnt(0)
    v_max_u32 v5, v216, v220
    v_cmp_eq_u32 vcc, -1, v5
    s_cbranch_vccnz RT_87
    s_branch BK_88
SF_93:
    buffer_inv sc1
    s_branch SFD_94
RT_91:
    s_cmp_eq_u32 s29, 0
    s_cbranch_scc1 BK_92
    s_sub_u32 s29, s29, 1
    s_cmp_lg_u32 s31, 0
    s_cbranch_scc1 SF_93
SFD_94:
    buffer_load_dwordx4 v[224:227], v89, s[4:7], s46 offen offset:0 sc1
    buffer_load_dwordx4 v[228:231], v89, s[4:7], s46 offen offset:256 sc1
    s_waitcnt vmcnt(0)
    v_max_u32 v5, v224, v228
    v_cmp_eq_u32 vcc, -1, v5
    s_cbranch_vccnz RT_91
    s_branch BK_92
SF_97:
    buffer_inv sc1
    s_branch SFD_98
RT_95:
    s_cmp_eq_u32 s29, 0
    s_cbranch_scc1 BK_96
    s_sub_u32 s29, s29, 1
    s_cmp_lg_u32 s31, 0
    s_cbranch_scc1 SF_97
SFD_98:
    buffer_load_dwordx4 v[232:235], v89, s[4:7], s46 offen offset:2048 sc1
    buffer_load_dwordx4 v[236:239], v89, s[4:7], s46 offen offset:2304 sc1
    s_waitcnt vmcnt(0)
    v_max_u32 v5, v232, v236
    v_cmp_eq_u32 vcc, -1, v5
    s_cbranch_vccnz RT_95
    s_branch BK_96
SF_101:
    buffer_inv sc1
    s_branch SFD_102
RT_99:
    s_cmp_eq_u32 s29, 0
    s_cbranch_scc1 BK_100
    s_sub_u32 s29, s29, 1
    s_cmp_lg_u32 s31, 0
    s_cbranch_scc1 SF_101
SFD_102:
    buffer_load_dwordx4 v[240:243], v89, s[4:7], s47 offen offset:0 sc1
    buffer_load_dwordx4 v[244:247], v89, s[4:7], s47 offen offset:256 sc1
    s_waitcnt vmcnt(0)
    v_max_u32 v5, v240, v244
    v_cmp_eq_u32 vcc, -1, v5
    s_cbranch_vccnz RT_99
    s_branch BK_100
SF_105:
    buffer_inv sc1
    s_branch SFD_106
RT_103:
    s_cmp_eq_u32 s29, 0
    s_cbranch_scc1 BK_104
    s_sub_u32 s29, s29, 1
    s_cmp_lg_u32 s31, 0
    s_cbranch_scc1 SF_105
SFD_106:
    buffer_load_dwordx4 v[248:251], v89, s[4:7], s47 offen offset:2048 sc1
    buffer_load_dwordx4 v[252:255], v89, s[4:7], s47 offen offset:2304 sc1
    s_waitcnt vmcnt(0)
    v_max_u32 v5, v248, v252
    v_cmp_eq_u32 vcc, -1, v5
    s_cbranch_vccnz RT_103
    s_branch BK_104
SF_109:
    buffer_inv sc1
    s_branch SFD_110
RT_107:
    s_cmp_eq_u32 s29, 0
    s_cbranch_scc1 BK_108
    s_sub_u32 s29, s29, 1
    s_cmp_lg_u32 s31, 0
    s_cbranch_scc1 SF_109
SFD_110:
    buffer_load_dwordx4 v[12:15], v90, s[4:7], s74 offen offset:0 sc1
    buffer_load_dwordx4 v[16:19], v90, s[4:7], s74 offen offset:256 sc1
    buffer_load_dwordx4 v[20:23], v90, s[4:7], s74 offen offset:512 sc1
    buffer_load_dwordx4 v[24:27], v90, s[4:7], s74 offen offset:768 sc1
    s_waitcnt vmcnt(0)
    v_add_f32 v12, v12, v16
    v_add_f32 v13, v13, v17
    v_add_f32 v14, v14, v18
    v_add_f32 v15, v15, v19
    v_add_f32 v20, v20, v24
    v_add_f32 v21, v21, v25
    v_add_f32 v22, v22, v26
    v_add_f32 v23, v23, v27
    v_add_f32 v12, v12, v20
    v_add_f32 v13, v13, v21
    v_add_f32 v14, v14, v22
    v_add_f32 v15, v15, v23
    s_nop 0
    v_permlane32_swap_b32 v12, v14
    v_permlane32_swap_b32 v13, v15
    v_add_f32 v12, v12, v14
    v_add_f32 v13, v13, v15
    v_cmp_u_f32 vcc, v12, v13
    s_cbranch_vccnz RT_107
    s_branch BK_108
SF_111:
    s_waitcnt vmcnt(0)
    buffer_wbl2 sc1
    s_waitcnt vmcnt(0)
    s_branch SFD_112
SF_115:
    buffer_inv sc1
    s_branch SFD_116
RT_113:
    s_cmp_eq_u32 s29, 0
    s_cbranch_scc1 BK_114
    s_sub_u32 s29, s29, 1
    s_cmp_lg_u32 s31, 0
    s_cbranch_scc1 SF_115
SFD_116:
    buffer_load_dwordx4 v[96:99], v1, s[4:7], s32 offen offset:0 sc1
    s_waitcnt vmcnt(0)
    v_cmp_eq_u32 vcc, -1, v96
    s_cbranch_vccnz RT_113
    s_branch BK_114
SF_119:
    buffer_inv sc1
    s_branch SFD_120
RT_117:
    s_cmp_eq_u32 s29, 0
    s_cbranch_scc1 BK_118
    s_sub_u32 s29, s29, 1
    s_cmp_lg_u32 s31, 0
    s_cbranch_scc1 SF_119
SFD_120:
    buffer_load_dwordx4 v[100:103], v1, s[4:7], s36 offen offset:0 sc1
    s_waitcnt vmcnt(0)
    v_cmp_eq_u32 vcc, -1, v100
    s_cbranch_vccnz RT_117
    s_branch BK_118
SF_123:
    buffer_inv sc1
    s_branch SFD_124
RT_121:
    s_cmp_eq_u32 s29, 0
    s_cbranch_scc1 BK_122
    s_sub_u32 s29, s29, 1
    s_cmp_lg_u32 s31, 0
    s_cbranch_scc1 SF_123
SFD_124:
    buffer_load_dwordx4 v[104:107], v1, s[4:7], s33 offen offset:0 sc1
    s_waitcnt vmcnt(0)
    v_cmp_eq_u32 vcc, -1, v104
    s_cbranch_vccnz RT_121
    s_branch BK_122
SF_127:
    buffer_inv sc1
    s_branch SFD_128
RT_125:
    s_cmp_eq_u32 s29, 0
    s_cbranch_scc1 BK_126
    s_sub_u32 s29, s29, 1
    s_cmp_lg_u32 s31, 0
    s_cbranch_scc1 SF_127
SFD_128:
    buffer_load_dwordx4 v[108:111], v1, s[4:7], s37 offen offset:0 sc1
    s_waitcnt vmcnt(0)
    v_cmp_eq_u32 vcc, -1, v108
    s_cbranch_vccnz RT_125
    s_branch BK_126
SF_131:
    buffer_inv sc1
    s_branch SFD_132
RT_129:
    s_cmp_eq_u32 s29, 0
    s_cbranch_scc1 BK_130
    s_sub_u32 s29, s29, 1
    s_cmp_lg_u32 s31, 0
    s_cbranch_scc1 SF_131
SFD_132:
    buffer_load_dwordx4 v[112:115], v1, s[4:7], s34 offen offset:0 sc1
    s_waitcnt vmcnt(0)
    v_cmp_eq_u32 vcc, -1, v112
    s_cbranch_vccnz RT_129
    s_branch BK_130
SF_135:
    buffer_inv sc1
    s_branch SFD_136
RT_133:
    s_cmp_eq_u32 s29, 0
    s_cbranch_scc1 BK_134
    s_sub_u32 s29, s29, 1
    s_cmp_lg_u32 s31, 0
    s_cbranch_scc1 SF_135
SFD_136:
    buffer_load_dwordx4 v[116:119], v1, s[4:7], s38 offen offset:0 sc1
    s_waitcnt vmcnt(0)
    v_cmp_eq_u32 vcc, -1, v116
    s_cbranch_vccnz RT_133
    s_branch BK_134
SF_139:
    buffer_inv sc1
    s_branch SFD_140
RT_137:
    s_cmp_eq_u32 s29, 0
    s_cbranch_scc1 BK_138
    s_sub_u32 s29, s29, 1
    s_cmp_lg_u32 s31, 0
    s_cbranch_scc1 SF_139
SFD_140:
    buffer_load_dwordx4 v[120:123], v1, s[4:7], s35 offen offset:0 sc1
    s_waitcnt vmcnt(0)
    v_cmp_eq_u32 vcc, -1, v120
    s_cbranch_vccnz RT_137
    s_branch BK_138
SF_143:
    buffer_inv sc1
    s_branch SFD_144
RT_141:
    s_cmp_eq_u32 s29, 0
    s_cbranch_scc1 BK_142
    s_sub_u32 s29, s29, 1
    s_cmp_lg_u32 s31, 0
    s_cbranch_scc1 SF_143
SFD_144:
    buffer_load_dwordx4 v[124:127], v1, s[4:7], s39 offen offset:0 sc1
    s_waitcnt vmcnt(0)
    v_cmp_eq_u32 vcc, -1, v124
    s_cbranch_vccnz RT_141
    s_branch BK_142
SF_147:
    buffer_inv sc1
    s_branch SFD_148
RT_145:
    s_cmp_eq_u32 s29, 0
    s_cbranch_scc1 BK_146
    s_sub_u32 s29, s29, 1
    s_cmp_lg_u32 s31, 0
    s_cbranch_scc1 SF_147
SFD_148:
    buffer_load_dwordx4 v[12:15], v1, s[4:7], s32 offen offset:1024 sc1
    s_waitcnt vmcnt(0)
    v_cmp_eq_u32 vcc, -1, v12
    s_cbranch_vccnz RT_145
    s_branch BK_146
SF_151:
    buffer_inv sc1
    s_branch SFD_152
RT_149:
    s_cmp_eq_u32 s29, 0
    s_cbranch_scc1 BK_150
    s_sub_u32 s29, s29, 1
    s_cmp_lg_u32 s31, 0
    s_cbranch_scc1 SF_151
SFD_152:
    buffer_load_dwordx4 v[16:19], v1, s[4:7], s36 offen offset:1024 sc1
    s_waitcnt vmcnt(0)
    v_cmp_eq_u32 vcc, -1, v16
    s_cbranch_vccnz RT_149
    s_branch BK_150
SF_155:
    buffer_inv sc1
    s_branch SFD_156
RT_153:
    s_cmp_eq_u32 s29, 0
    s_cbranch_scc1 BK_154
    s_sub_u32 s29, s29, 1
    s_cmp_lg_u32 s31, 0
    s_cbranch_scc1 SF_155
SFD_156:
    buffer_load_dwordx4 v[20:23], v1, s[4:7], s33 offen offset:1024 sc1
    s_waitcnt vmcnt(0)
    v_cmp_eq_u32 vcc, -1, v20
    s_cbranch_vccnz RT_153
    s_branch BK_154
SF_159:
    buffer_inv sc1
    s_branch SFD_160
RT_157:
    s_cmp_eq_u32 s29, 0
    s_cbranch_scc1 BK_158
    s_sub_u32 s29, s29, 1
    s_cmp_lg_u32 s31, 0
    s_cbranch_scc1 SF_159
SFD_160:
    buffer_load_dwordx4 v[24:27], v1, s[4:7], s37 offen offset:1024 sc1
    s_waitcnt vmcnt(0)
    v_cmp_eq_u32 vcc, -1, v24
    s_cbranch_vccnz RT_157
    s_branch BK_158
SF_163:
    buffer_inv sc1
    s_branch SFD_164
RT_161:
    s_cmp_eq_u32 s29, 0
    s_cbranch_scc1 BK_162
    s_sub_u32 s29, s29, 1
    s_cmp_lg_u32 s31, 0
    s_cbranch_scc1 SF_163
SFD_164:
    buffer_load_dwordx4 v[96:99], v1, s[4:7], s34 offen offset:1024 sc1
    s_waitcnt vmcnt(0)
    v_cmp_eq_u32 vcc, -1, v96
    s_cbranch_vccnz RT_161
    s_branch BK_162
SF_167:
    buffer_inv sc1
    s_branch SFD_168
RT_165:
    s_cmp_eq_u32 s29, 0
    s_cbranch_scc1 BK_166
    s_sub_u32 s29, s29, 1
    s_cmp_lg_u32 s31, 0
    s_cbranch_scc1 SF_167
SFD_168:
    buffer_load_dwordx4 v[100:103], v1, s[4:7], s38 offen offset:1024 sc1
    s_waitcnt vmcnt(0)
    v_cmp_eq_u32 vcc, -1, v100
    s_cbranch_vccnz RT_165
    s_branch BK_166
SF_171:
    buffer_inv sc1
    s_branch SFD_172
RT_169:
    s_cmp_eq_u32 s29, 0
    s_cbranch_scc1 BK_170
    s_sub_u32 s29, s29, 1
    s_cmp_lg_u32 s31, 0
    s_cbranch_scc1 SF_171
SFD_172:
    buffer_load_dwordx4 v[104:107], v1, s[4:7], s35 offen offset:1024 sc1
    s_waitcnt vmcnt(0)
    v_cmp_eq_u32 vcc, -1, v104
    s_cbranch_vccnz RT_169
    s_branch BK_170
SF_175:
    buffer_inv sc1
    s_branch SFD_176
RT_173:
    s_cmp_eq_u32 s29, 0
    s_cbranch_scc1 BK_174
    s_sub_u32 s29, s29, 1
    s_cmp_lg_u32 s31, 0
    s_cbranch_scc1 SF_175
SFD_176:
    buffer_load_dwordx4 v[108:111], v1, s[4:7], s39 offen offset:1024 sc1
    s_waitcnt vmcnt(0)
    v_cmp_eq_u32 vcc, -1, v108
    s_cbranch_vccnz RT_173
    s_branch BK_174
SF_179:
    buffer_inv sc1
    s_branch SFD_180
RT_177:
    s_cmp_eq_u32 s29, 0
    s_cbranch_scc1 BK_178
    s_sub_u32 s29, s29, 1
    s_cmp_lg_u32 s31, 0
    s_cbranch_scc1 SF_179
SFD_180:
    buffer_load_dwordx4 v[112:115], v1, s[4:7], s32 offen offset:2048 sc1
    s_waitcnt vmcnt(0)
    v_cmp_eq_u32 vcc, -1, v112
    s_cbranch_vccnz RT_177
    s_branch BK_178
SF_183:
    buffer_inv sc1
    s_branch SFD_184
RT_181:
    s_cmp_eq_u32 s29, 0
    s_cbranch_scc1 BK_182
    s_sub_u32 s29, s29, 1
    s_cmp_lg_u32 s31, 0
    s_cbranch_scc1 SF_183
SFD_184:
    buffer_load_dwordx4 v[116:119], v1, s[4:7], s36 offen offset:2048 sc1
    s_waitcnt vmcnt(0)
    v_cmp_eq_u32 vcc, -1, v116
    s_cbranch_vccnz RT_181
    s_branch BK_182
SF_187:
    buffer_inv sc1
    s_branch SFD_188
RT_185:
    s_cmp_eq_u32 s29, 0
    s_cbranch_scc1 BK_186
    s_sub_u32 s29, s29, 1
    s_cmp_lg_u32 s31, 0
    s_cbranch_scc1 SF_187
SFD_188:
    buffer_load_dwordx4 v[120:123], v1, s[4:7], s33 offen offset:2048 sc1
    s_waitcnt vmcnt(0)
    v_cmp_eq_u32 vcc, -1, v120
    s_cbranch_vccnz RT_185
    s_branch BK_186
SF_191:
    buffer_inv sc1
    s_branch SFD_192
RT_189:
    s_cmp_eq_u32 s29, 0
    s_cbranch_scc1 BK_190
    s_sub_u32 s29, s29, 1
    s_cmp_lg_u32 s31, 0
    s_cbranch_scc1 SF_191
SFD_192:
    buffer_load_dwordx4 v[124:127], v1, s[4:7], s37 offen offset:2048 sc1
    s_waitcnt vmcnt(0)
    v_cmp_eq_u32 vcc, -1, v124
    s_cbranch_vccnz RT_189
    s_branch BK_190
SF_195:
    buffer_inv sc1
    s_branch SFD_196
RT_193:
    s_cmp_eq_u32 s29, 0
    s_cbranch_scc1 BK_194
    s_sub_u32 s29, s29, 1
    s_cmp_lg_u32 s31, 0
    s_cbranch_scc1 SF_195
SFD_196:
    buffer_load_dwordx4 v[12:15], v1, s[4:7], s34 offen offset:2048 sc1
    s_waitcnt vmcnt(0)
    v_cmp_eq_u32 vcc, -1, v12
    s_cbranch_vccnz RT_193
    s_branch BK_194
SF_199:
    buffer_inv sc1
    s_branch SFD_200
RT_197:
    s_cmp_eq_u32 s29, 0
    s_cbranch_scc1 BK_198
    s_sub_u32 s29, s29, 1
    s_cmp_lg_u32 s31, 0
    s_cbranch_scc1 SF_199
SFD_200:
    buffer_load_dwordx4 v[16:19], v1, s[4:7], s38 offen offset:2048 sc1
    s_waitcnt vmcnt(0)
    v_cmp_eq_u32 vcc, -1, v16
    s_cbranch_vccnz RT_197
    s_branch BK_198
SF_203:
    buffer_inv sc1
    s_branch SFD_204
RT_201:
    s_cmp_eq_u32 s29, 0
    s_cbranch_scc1 BK_202
    s_sub_u32 s29, s29, 1
    s_cmp_lg_u32 s31, 0
    s_cbranch_scc1 SF_203
SFD_204:
    buffer_load_dwordx4 v[20:23], v1, s[4:7], s35 offen offset:2048 sc1
    s_waitcnt vmcnt(0)
    v_cmp_eq_u32 vcc, -1, v20
    s_cbranch_vccnz RT_201
    s_branch BK_202
SF_207:
    buffer_inv sc1
    s_branch SFD_208
RT_205:
    s_cmp_eq_u32 s29, 0
    s_cbranch_scc1 BK_206
    s_sub_u32 s29, s29, 1
    s_cmp_lg_u32 s31, 0
    s_cbranch_scc1 SF_207
SFD_208:
    buffer_load_dwordx4 v[24:27], v1, s[4:7], s39 offen offset:2048 sc1
    s_waitcnt vmcnt(0)
    v_cmp_eq_u32 vcc, -1, v24
    s_cbranch_vccnz RT_205
    s_branch BK_206
SF_211:
    buffer_inv sc1
    s_branch SFD_212
RT_209:
    s_cmp_eq_u32 s29, 0
    s_cbranch_scc1 BK_210
    s_sub_u32 s29, s29, 1
    s_cmp_lg_u32 s31, 0
    s_cbranch_scc1 SF_211
SFD_212:
    buffer_load_dwordx4 v[100:103], v1, s[4:7], s32 offen offset:3072 sc1
    s_waitcnt vmcnt(0)
    v_cmp_eq_u32 vcc, -1, v100
    s_cbranch_vccnz RT_209
    s_branch BK_210
SF_215:
    buffer_inv sc1
    s_branch SFD_216
RT_213:
    s_cmp_eq_u32 s29, 0
    s_cbranch_scc1 BK_214
    s_sub_u32 s29, s29, 1
    s_cmp_lg_u32 s31, 0
    s_cbranch_scc1 SF_215
SFD_216:
    buffer_load_dwordx4 v[104:107], v1, s[4:7], s33 offen offset:3072 sc1
    s_waitcnt vmcnt(0)
    v_cmp_eq_u32 vcc, -1, v104
    s_cbranch_vccnz RT_213
    s_branch BK_214
SF_219:
    buffer_inv sc1
    s_branch SFD_220
RT_217:
    s_cmp_eq_u32 s29, 0
    s_cbranch_scc1 BK_218
    s_sub_u32 s29, s29, 1
    s_cmp_lg_u32 s31, 0
    s_cbranch_scc1 SF_219
SFD_220:
    buffer_load_dwordx4 v[108:111], v1, s[4:7], s34 offen offset:3072 sc1
    s_waitcnt vmcnt(0)
    v_cmp_eq_u32 vcc, -1, v108
    s_cbranch_vccnz RT_217
    s_branch BK_218
SF_223:
    buffer_inv sc1
    s_branch SFD_224
RT_221:
    s_cmp_eq_u32 s29, 0
    s_cbranch_scc1 BK_222
    s_sub_u32 s29, s29, 1
    s_cmp_lg_u32 s31, 0
    s_cbranch_scc1 SF_223
SFD_224:
    buffer_load_dwordx4 v[112:115], v1, s[4:7], s35 offen offset:3072 sc1
    s_waitcnt vmcnt(0)
    v_cmp_eq_u32 vcc, -1, v112
    s_cbranch_vccnz RT_221
    s_branch BK_222
SF_227:
    buffer_inv sc1
    s_branch SFD_228
RT_225:
    s_cmp_eq_u32 s29, 0
    s_cbranch_scc1 BK_226
    s_sub_u32 s29, s29, 1
    s_cmp_lg_u32 s31, 0
    s_cbranch_scc1 SF_227
SFD_228:
    buffer_load_dwordx4 v[116:119], v1, s[4:7], s40 offen offset:0 sc1
    s_waitcnt vmcnt(0)
    v_cmp_eq_u32 vcc, -1, v116
    s_cbranch_vccnz RT_225
    s_branch BK_226
SF_231:
    buffer_inv sc1
    s_branch SFD_232
RT_229:
    s_cmp_eq_u32 s29, 0
    s_cbranch_scc1 BK_230
    s_sub_u32 s29, s29, 1
    s_cmp_lg_u32 s31, 0
    s_cbranch_scc1 SF_231
SFD_232:
    buffer_load_dwordx4 v[120:123], v1, s[4:7], s41 offen offset:0 sc1
    s_waitcnt vmcnt(0)
    v_cmp_eq_u32 vcc, -1, v120
    s_cbranch_vccnz RT_229
    s_branch BK_230
SF_235:
    buffer_inv sc1
    s_branch SFD_236
RT_233:
    s_cmp_eq_u32 s29, 0
    s_cbranch_scc1 BK_234
    s_sub_u32 s29, s29, 1
    s_cmp_lg_u32 s31, 0
    s_cbranch_scc1 SF_235
SFD_236:
    buffer_load_dwordx4 v[124:127], v1, s[4:7], s42 offen offset:0 sc1
    s_waitcnt vmcnt(0)
    v_cmp_eq_u32 vcc, -1, v124
    s_cbranch_vccnz RT_233
    s_branch BK_234
SF_239:
    buffer_inv sc1
    s_branch SFD_240
RT_237:
    s_cmp_eq_u32 s29, 0
    s_cbranch_scc1 BK_238
    s_sub_u32 s29, s29, 1
    s_cmp_lg_u32 s31, 0
    s_cbranch_scc1 SF_239
SFD_240:
    buffer_load_dwordx4 v[12:15], v1, s[4:7], s43 offen offset:0 sc1
    s_waitcnt vmcnt(0)
    v_cmp_eq_u32 vcc, -1, v12
    s_cbranch_vccnz RT_237
    s_branch BK_238
SF_243:
    buffer_inv sc1
    s_branch SFD_244
RT_241:
    s_cmp_eq_u32 s29, 0
    s_cbranch_scc1 BK_242
    s_sub_u32 s29, s29, 1
    s_cmp_lg_u32 s31, 0
    s_cbranch_scc1 SF_243
SFD_244:
    buffer_load_dwordx4 v[16:19], v1, s[4:7], s40 offen offset:1024 sc1
    s_waitcnt vmcnt(0)
    v_cmp_eq_u32 vcc, -1, v16
    s_cbranch_vccnz RT_241
    s_branch BK_242
SF_247:
    buffer_inv sc1
    s_branch SFD_248
RT_245:
    s_cmp_eq_u32 s29, 0
    s_cbranch_scc1 BK_246
    s_sub_u32 s29, s29, 1
    s_cmp_lg_u32 s31, 0
    s_cbranch_scc1 SF_247
SFD_248:
    buffer_load_dwordx4 v[20:23], v1, s[4:7], s41 offen offset:1024 sc1
    s_waitcnt vmcnt(0)
    v_cmp_eq_u32 vcc, -1, v20
    s_cbranch_vccnz RT_245
    s_branch BK_246
SF_251:
    buffer_inv sc1
    s_branch SFD_252
RT_249:
    s_cmp_eq_u32 s29, 0
    s_cbranch_scc1 BK_250
    s_sub_u32 s29, s29, 1
    s_cmp_lg_u32 s31, 0
    s_cbranch_scc1 SF_251
SFD_252:
    buffer_load_dwordx4 v[24:27], v1, s[4:7], s42 offen offset:1024 sc1
    s_waitcnt vmcnt(0)
    v_cmp_eq_u32 vcc, -1, v24
    s_cbranch_vccnz RT_249
    s_branch BK_250
SF_255:
    buffer_inv sc1
    s_branch SFD_256
RT_253:
    s_cmp_eq_u32 s29, 0
    s_cbranch_scc1 BK_254
    s_sub_u32 s29, s29, 1
    s_cmp_lg_u32 s31, 0
    s_cbranch_scc1 SF_255
SFD_256:
    buffer_load_dwordx4 v[96:99], v1, s[4:7], s43 offen offset:1024 sc1
    s_waitcnt vmcnt(0)
    v_cmp_eq_u32 vcc, -1, v96
    s_cbranch_vccnz RT_253
    s_branch BK_254
SF_259:
    buffer_inv sc1
    s_branch SFD_260
RT_257:
    s_cmp_eq_u32 s29, 0
    s_cbranch_scc1 BK_258
    s_sub_u32 s29, s29, 1
    s_cmp_lg_u32 s31, 0
    s_cbranch_scc1 SF_259
SFD_260:
    buffer_load_dwordx4 v[100:103], v1, s[4:7], s40 offen offset:2048 sc1
    s_waitcnt vmcnt(0)
    v_cmp_eq_u32 vcc, -1, v100
    s_cbranch_vccnz RT_257
    s_branch BK_258
SF_263:
    buffer_inv sc1
    s_branch SFD_264
RT_261:
    s_cmp_eq_u32 s29, 0
    s_cbranch_scc1 BK_262
    s_sub_u32 s29, s29, 1
    s_cmp_lg_u32 s31, 0
    s_cbranch_scc1 SF_263
SFD_264:
    buffer_load_dwordx4 v[104:107], v1, s[4:7], s41 offen offset:2048 sc1
    s_waitcnt vmcnt(0)
    v_cmp_eq_u32 vcc, -1, v104
    s_cbranch_vccnz RT_261
    s_branch BK_262
SF_267:
    buffer_inv sc1
    s_branch SFD_268
RT_265:
    s_cmp_eq_u32 s29, 0
    s_cbranch_scc1 BK_266
    s_sub_u32 s29, s29, 1
    s_cmp_lg_u32 s31, 0
    s_cbranch_scc1 SF_267
SFD_268:
    buffer_load_dwordx4 v[108:111], v1, s[4:7], s42 offen offset:2048 sc1
    s_waitcnt vmcnt(0)
    v_cmp_eq_u32 vcc, -1, v108
    s_cbranch_vccnz RT_265
    s_branch BK_266
SF_271:
    buffer_inv sc1
    s_branch SFD_272
RT_269:
    s_cmp_eq_u32 s29, 0
    s_cbranch_scc1 BK_270
    s_sub_u32 s29, s29, 1
    s_cmp_lg_u32 s31, 0
    s_cbranch_scc1 SF_271
SFD_272:
    buffer_load_dwordx4 v[112:115], v1, s[4:7], s43 offen offset:2048 sc1
    s_waitcnt vmcnt(0)
    v_cmp_eq_u32 vcc, -1, v112
    s_cbranch_vccnz RT_269
    s_branch BK_270
SF_275:
    buffer_inv sc1
    s_branch SFD_276
RT_273:
    s_cmp_eq_u32 s29, 0
    s_cbranch_scc1 BK_274
    s_sub_u32 s29, s29, 1
    s_cmp_lg_u32 s31, 0
    s_cbranch_scc1 SF_275
SFD_276:
    buffer_load_dwordx4 v[120:123], v1, s[4:7], s36 offen offset:3072 sc1
    s_waitcnt vmcnt(0)
    v_cmp_eq_u32 vcc, -1, v120
    s_cbranch_vccnz RT_273
    s_branch BK_274
SF_279:
    buffer_inv sc1
    s_branch SFD_280
RT_277:
    s_cmp_eq_u32 s29, 0
    s_cbranch_scc1 BK_278
    s_sub_u32 s29, s29, 1
    s_cmp_lg_u32 s31, 0
    s_cbranch_scc1 SF_279
SFD_280:
    buffer_load_dwordx4 v[124:127], v1, s[4:7], s37 offen offset:3072 sc1
    s_waitcnt vmcnt(0)
    v_cmp_eq_u32 vcc, -1, v124
    s_cbranch_vccnz RT_277
    s_branch BK_278
SF_283:
    buffer_inv sc1
    s_branch SFD_284
RT_281:
    s_cmp_eq_u32 s29, 0
    s_cbranch_scc1 BK_282
    s_sub_u32 s29, s29, 1
    s_cmp_lg_u32 s31, 0
    s_cbranch_scc1 SF_283
SFD_284:
    buffer_load_dwordx4 v[12:15], v1, s[4:7], s38 offen offset:3072 sc1
    s_waitcnt vmcnt(0)
    v_cmp_eq_u32 vcc, -1, v12
    s_cbranch_vccnz RT_281
    s_branch BK_282
SF_287:
    buffer_inv sc1
    s_branch SFD_288
RT_285:
    s_cmp_eq_u32 s29, 0
    s_cbranch_scc1 BK_286
    s_sub_u32 s29, s29, 1
    s_cmp_lg_u32 s31, 0
    s_cbranch_scc1 SF_287
SFD_288:
    buffer_load_dwordx4 v[16:19], v1, s[4:7], s39 offen offset:3072 sc1
    s_waitcnt vmcnt(0)
    v_cmp_eq_u32 vcc, -1, v16
    s_cbranch_vccnz RT_285
    s_branch BK_286
SF_291:
    buffer_inv sc1
    s_branch SFD_292
RT_289:
    s_cmp_eq_u32 s29, 0
    s_cbranch_scc1 BK_290
    s_sub_u32 s29, s29, 1
    s_cmp_lg_u32 s31, 0
    s_cbranch_scc1 SF_291
SFD_292:
    buffer_load_dwordx4 v[20:23], v1, s[4:7], s44 offen offset:0 sc1
    s_waitcnt vmcnt(0)
    v_cmp_eq_u32 vcc, -1, v20
    s_cbranch_vccnz RT_289
    s_branch BK_290
SF_295:
    buffer_inv sc1
    s_branch SFD_296
RT_293:
    s_cmp_eq_u32 s29, 0
    s_cbranch_scc1 BK_294
    s_sub_u32 s29, s29, 1
    s_cmp_lg_u32 s31, 0
    s_cbranch_scc1 SF_295
SFD_296:
    buffer_load_dwordx4 v[24:27], v1, s[4:7], s45 offen offset:0 sc1
    s_waitcnt vmcnt(0)
    v_cmp_eq_u32 vcc, -1, v24
    s_cbranch_vccnz RT_293
    s_branch BK_294
SF_299:
    buffer_inv sc1
    s_branch SFD_300
RT_297:
    s_cmp_eq_u32 s29, 0
    s_cbranch_scc1 BK_298
    s_sub_u32 s29, s29, 1
    s_cmp_lg_u32 s31, 0
    s_cbranch_scc1 SF_299
SFD_300:
    buffer_load_dwordx4 v[96:99], v1, s[4:7], s46 offen offset:0 sc1
    s_waitcnt vmcnt(0)
    v_cmp_eq_u32 vcc, -1, v96
    s_cbranch_vccnz RT_297
    s_branch BK_298
SF_303:
    buffer_inv sc1
    s_branch SFD_304
RT_301:
    s_cmp_eq_u32 s29, 0
    s_cbranch_scc1 BK_302
    s_sub_u32 s29, s29, 1
    s_cmp_lg_u32 s31, 0
    s_cbranch_scc1 SF_303
SFD_304:
    buffer_load_dwordx4 v[100:103], v1, s[4:7], s47 offen offset:0 sc1
    s_waitcnt vmcnt(0)
    v_cmp_eq_u32 vcc, -1, v100
    s_cbranch_vccnz RT_301
    s_branch BK_302
SF_307:
    buffer_inv sc1
    s_branch SFD_308
RT_305:
    s_cmp_eq_u32 s29, 0
    s_cbranch_scc1 BK_306
    s_sub_u32 s29, s29, 1
    s_cmp_lg_u32 s31, 0
    s_cbranch_scc1 SF_307
SFD_308:
    buffer_load_dwordx4 v[104:107], v1, s[4:7], s44 offen offset:1024 sc1
    s_waitcnt vmcnt(0)
    v_cmp_eq_u32 vcc, -1, v104
    s_cbranch_vccnz RT_305
    s_branch BK_306
SF_311:
    buffer_inv sc1
    s_branch SFD_312
RT_309:
    s_cmp_eq_u32 s29, 0
    s_cbranch_scc1 BK_310
    s_sub_u32 s29, s29, 1
    s_cmp_lg_u32 s31, 0
    s_cbranch_scc1 SF_311
SFD_312:
    buffer_load_dwordx4 v[108:111], v1, s[4:7], s45 offen offset:1024 sc1
    s_waitcnt vmcnt(0)
    v_cmp_eq_u32 vcc, -1, v108
    s_cbranch_vccnz RT_309
    s_branch BK_310
SF_315:
    buffer_inv sc1
    s_branch SFD_316
RT_313:
    s_cmp_eq_u32 s29, 0
    s_cbranch_scc1 BK_314
    s_sub_u32 s29, s29, 1
    s_cmp_lg_u32 s31, 0
    s_cbranch_scc1 SF_315
SFD_316:
    buffer_load_dwordx4 v[112:115], v1, s[4:7], s46 offen offset:1024 sc1
    s_waitcnt vmcnt(0)
    v_cmp_eq_u32 vcc, -1, v112
    s_cbranch_vccnz RT_313
    s_branch BK_314
SF_319:
    buffer_inv sc1
    s_branch SFD_320
RT_317:
    s_cmp_eq_u32 s29, 0
    s_cbranch_scc1 BK_318
    s_sub_u32 s29, s29, 1
    s_cmp_lg_u32 s31, 0
    s_cbranch_scc1 SF_319
SFD_320:
    buffer_load_dwordx4 v[116:119], v1, s[4:7], s47 offen offset:1024 sc1
    s_waitcnt vmcnt(0)
    v_cmp_eq_u32 vcc, -1, v116
    s_cbranch_vccnz RT_317
    s_branch BK_318
SF_323:
    buffer_inv sc1
    s_branch SFD_324
RT_321:
    s_cmp_eq_u32 s29, 0
    s_cbranch_scc1 BK_322
    s_sub_u32 s29, s29, 1
    s_cmp_lg_u32 s31, 0
    s_cbranch_scc1 SF_323
SFD_324:
    buffer_load_dwordx4 v[120:123], v1, s[4:7], s44 offen offset:2048 sc1
    s_waitcnt vmcnt(0)
    v_cmp_eq_u32 vcc, -1, v120
    s_cbranch_vccnz RT_321
    s_branch BK_322
SF_327:
    buffer_inv sc1
    s_branch SFD_328
RT_325:
    s_cmp_eq_u32 s29, 0
    s_cbranch_scc1 BK_326
    s_sub_u32 s29, s29, 1
    s_cmp_lg_u32 s31, 0
    s_cbranch_scc1 SF_327
SFD_328:
    buffer_load_dwordx4 v[124:127], v1, s[4:7], s45 offen offset:2048 sc1
    s_waitcnt vmcnt(0)
    v_cmp_eq_u32 vcc, -1, v124
    s_cbranch_vccnz RT_325
    s_branch BK_326
SF_331:
    buffer_inv sc1
    s_branch SFD_332
RT_329:
    s_cmp_eq_u32 s29, 0
    s_cbranch_scc1 BK_330
    s_sub_u32 s29, s29, 1
    s_cmp_lg_u32 s31, 0
    s_cbranch_scc1 SF_331
SFD_332:
    buffer_load_dwordx4 v[12:15], v1, s[4:7], s46 offen offset:2048 sc1
    s_waitcnt vmcnt(0)
    v_cmp_eq_u32 vcc, -1, v12
    s_cbranch_vccnz RT_329
    s_branch BK_330
SF_335:
    buffer_inv sc1
    s_branch SFD_336
RT_333:
    s_cmp_eq_u32 s29, 0
    s_cbranch_scc1 BK_334
    s_sub_u32 s29, s29, 1
    s_cmp_lg_u32 s31, 0
    s_cbranch_scc1 SF_335
SFD_336:
    buffer_load_dwordx4 v[16:19], v1, s[4:7], s47 offen offset:2048 sc1
    s_waitcnt vmcnt(0)
    v_cmp_eq_u32 vcc, -1, v16
    s_cbranch_vccnz RT_333
    s_branch BK_334
SF_337:
    s_waitcnt vmcnt(0)
    buffer_wbl2 sc1
    s_waitcnt vmcnt(0)
    s_branch SFD_338
SF_343:
    buffer_inv sc1
    s_branch SFD_344
SF_348:
    buffer_inv sc1
    s_branch SFD_349
SF_353:
    buffer_inv sc1
    s_branch SFD_354
SF_358:
    buffer_inv sc1
    s_branch SFD_359
KVV_360:
    s_waitcnt lgkmcnt(3)
    v_mfma_f32_16x16x32_bf16 v[80:83], v[64:67], a[224:227], 0
    s_waitcnt lgkmcnt(2)
    v_mfma_f32_16x16x32_bf16 v[80:83], v[68:71], a[228:231], v[80:83]
    s_waitcnt lgkmcnt(1)
    v_mfma_f32_16x16x32_bf16 v[80:83], v[72:75], a[232:235], v[80:83]
    s_waitcnt lgkmcnt(0)
    v_mfma_f32_16x16x32_bf16 v[80:83], v[76:79], a[236:239], v[80:83]
    s_branch KVD_361
SF_365:
    s_waitcnt vmcnt(0)
    buffer_wbl2 sc1
    s_waitcnt vmcnt(0)
    s_branch SFD_366
SF_369:
    buffer_inv sc1
    s_branch SFD_370
SF_373:
    buffer_inv sc1
    s_branch SFD_374
PFS_375:
    buffer_store_dword v6, off, s[4:7], s74 sc1
    s_branch PFD_376
SF_379:
    buffer_inv sc1
    s_branch SFD_380
RT_377:
    s_cmp_eq_u32 s29, 0
    s_cbranch_scc1 BK_378
    s_sub_u32 s29, s29, 1
    s_cmp_lg_u32 s31, 0
    s_cbranch_scc1 SF_379
SFD_380:
    buffer_load_dword v121, v122, s[4:7], s64 offen sc1
    s_waitcnt vmcnt(0)
    v_cmp_ne_u32 vcc, v121, v6
    s_cbranch_vccnz RT_377
    s_branch BK_378
SF_381:
    buffer_inv sc1
    s_branch SFD_382
SLOW1:
    v_mov_b32 v121, 0xff800000
    v_mov_b32 v122, 0xff800000
    s_mov_b32 s74, s65
    s_mov_b32 s75, 64
SLOW1A:
    buffer_load_dwordx4 v[96:99], v1, s[4:7], s74 offen sc1
    s_waitcnt vmcnt(0)
    v_mfma_f32_32x32x16_bf16 v[32:47], v[96:99], v[20:23], 0
    v_mfma_f32_32x32x16_bf16 v[48:63], v[96:99], v[24:27], 0
    s_nop 4
    v_max3_f32 v121, v32, v33, v121
    v_max3_f32 v121, v34, v35, v121
    v_max3_f32 v121, v36, v37, v121
    v_max3_f32 v121, v38, v39, v121
    v_max3_f32 v121, v40, v41, v121
    v_max3_f32 v121, v42, v43, v121
    v_max3_f32 v121, v44, v45, v121
    v_max3_f32 v121, v46, v47, v121
    v_max3_f32 v122, v48, v49, v122
    v_max3_f32 v122, v50, v51, v122
    v_max3_f32 v122, v52, v53, v122
    v_max3_f32 v122, v54, v55, v122
    v_max3_f32 v122, v56, v57, v122
    v_max3_f32 v122, v58, v59, v122
    v_max3_f32 v122, v60, v61, v122
    v_max3_f32 v122, v62, v63, v122
    s_add_u32 s74, s74, 2048
    s_sub_u32 s75, s75, 1
    s_cmp_lg_u32 s75, 0
    s_cbranch_scc1 SLOW1A
    v_mov_b32 v124, v121
    s_nop 1
    v_permlane32_swap_b32 v121, v124
    v_max_f32 v121, v121, v124
    v_mov_b32 v124, v122
    s_nop 1
    v_permlane32_swap_b32 v122, v124
    v_max_f32 v122, v122, v124
    v_mov_b32 v64, 0
    v_mov_b32 v65, 0
    v_mov_b32 v66, 0
    v_mov_b32 v67, 0
    v_mov_b32 v68, 0
    v_mov_b32 v69, 0
    v_mov_b32 v70, 0
    v_mov_b32 v71, 0
    v_mov_b32 v72, 0
    v_mov_b32 v73, 0
    v_mov_b32 v74, 0
    v_mov_b32 v75, 0
    v_mov_b32 v76, 0
    v_mov_b32 v77, 0
    v_mov_b32 v78, 0
    v_mov_b32 v79, 0
    v_mov_b32 v80, 0
    v_mov_b32 v81, 0
    v_mov_b32 v82, 0
    v_mov_b32 v83, 0
    v_mov_b32 v84, 0
    v_mov_b32 v85, 0
    v_mov_b32 v86, 0
    v_mov_b32 v87, 0
    v_mov_b32 v88, 0
    v_mov_b32 v89, 0
    v_mov_b32 v90, 0
    v_mov_b32 v91, 0
    v_mov_b32 v92, 0
    v_mov_b32 v93, 0
    v_mov_b32 v94, 0
    v_mov_b32 v95, 0
    v_lshrrev_b32 v120, 9, v1
    v_and_b32 v124, 0xf0, v1
    v_lshl_add_u32 v124, v120, 8, v124
    v_and_b32 v120, 0x100, v1
    v_cmp_ne_u32 vcc, 0, v120
    v_mov_b32 v120, s68
    s_mov_b32 s74, s65
    s_mov_b32 s75, 64
SLOW1B:
    buffer_load_dwordx4 v[96:99], v1, s[4:7], s74 offen sc1
    buffer_load_dwordx4 v[104:107], v124, s[4:7], s74 offen offset:1024 sc1
    buffer_load_dwordx4 v[112:115], v124, s[4:7], s74 offen offset:1536 sc1
    s_waitcnt vmcnt(0)
    v_mfma_f32_32x32x16_bf16 v[32:47], v[96:99], v[20:23], 0
    v_mfma_f32_32x32x16_bf16 v[48:63], v[96:99], v[24:27], 0
    v_cndmask_b32 v104, v104, v120, vcc
    v_cndmask_b32 v105, v105, v120, vcc
    v_cndmask_b32 v106, v106, v120, vcc
    v_cndmask_b32 v107, v107, v120, vcc
    v_cndmask_b32 v112, v112, v120, vcc
    v_cndmask_b32 v113, v113, v120, vcc
    v_cndmask_b32 v114, v114, v120, vcc
    v_cndmask_b32 v115, v115, v120, vcc
    v_sub_f32 v32, v32, v121
    v_sub_f32 v33, v33, v121
    v_sub_f32 v34, v34, v121
    v_sub_f32 v35, v35, v121
    v_sub_f32 v36, v36, v121
    v_sub_f32 v37, v37, v121
    v_sub_f32 v38, v38, v121
    v_sub_f32 v39, v39, v121
    v_sub_f32 v40, v40, v121
    v_sub_f32 v41, v41, v121
    v_sub_f32 v42, v42, v121
    v_sub_f32 v43, v43, v121
    v_sub_f32 v44, v44, v121
    v_sub_f32 v45, v45, v121
    v_sub_f32 v46, v46, v121
    v_sub_f32 v47, v47, v121
    v_exp_f32 v32, v32
    v_exp_f32 v33, v33
    v_exp_f32 v34, v34
    v_exp_f32 v35, v35
    v_exp_f32 v36, v36
    v_exp_f32 v37, v37
    v_exp_f32 v38, v38
    v_exp_f32 v39, v39
    v_exp_f32 v40, v40
    v_exp_f32 v41, v41
    v_exp_f32 v42, v42
    v_exp_f32 v43, v43
    v_exp_f32 v44, v44
    v_exp_f32 v45, v45
    v_exp_f32 v46, v46
    v_exp_f32 v47, v47
    v_sub_f32 v48, v48, v122
    v_sub_f32 v49, v49, v122
    v_sub_f32 v50, v50, v122
    v_sub_f32 v51, v51, v122
    v_sub_f32 v52, v52, v122
    v_sub_f32 v53, v53, v122
    v_sub_f32 v54, v54, v122
    v_sub_f32 v55, v55, v122
    v_sub_f32 v56, v56, v122
    v_sub_f32 v57, v57, v122
    v_sub_f32 v58, v58, v122
    v_sub_f32 v59, v59, v122
    v_sub_f32 v60, v60, v122
    v_sub_f32 v61, v61, v122
    v_sub_f32 v62, v62, v122
    v_sub_f32 v63, v63, v122
    v_exp_f32 v48, v48
    v_exp_f32 v49, v49
    v_exp_f32 v50, v50
    v_exp_f32 v51, v51
    v_exp_f32 v52, v52
    v_exp_f32 v53, v53
    v_exp_f32 v54, v54
    v_exp_f32 v55, v55
    v_exp_f32 v56, v56
    v_exp_f32 v57, v57
    v_exp_f32 v58, v58
    v_exp_f32 v59, v59
    v_exp_f32 v60, v60
    v_exp_f32 v61, v61
    v_exp_f32 v62, v62
    v_exp_f32 v63, v63
    v_smfmac_f32_32x32x32_bf16 v[64:79], v[104:107], v[32:39], v2
    v_smfmac_f32_32x32x32_bf16 v[64:79], v[112:115], v[40:47], v2
    v_smfmac_f32_32x32x32_bf16 v[80:95], v[104:107], v[48:55], v2
    v_smfmac_f32_32x32x32_bf16 v[80:95], v[112:115], v[56:63], v2
    s_nop 7
    s_nop 7
    s_add_u32 s74, s74, 2048
    s_sub_u32 s75, s75, 1
    s_cmp_lg_u32 s75, 0
    s_cbranch_scc1 SLOW1B
    v_rcp_f32 v74, v72
    v_rcp_f32 v90, v88
    v_mul_f32 v64, v64, v74
    v_mul_f32 v65, v65, v74
    v_mul_f32 v66, v66, v74
    v_mul_f32 v67, v67, v74
    v_mul_f32 v68, v68, v74
    v_mul_f32 v69, v69, v74
    v_mul_f32 v70, v70, v74
    v_mul_f32 v71, v71, v74
    v_pk_mul_f32 v[80:81], v[80:81], v[90:91] op_sel_hi:[1,0]
    v_pk_mul_f32 v[82:83], v[82:83], v[90:91] op_sel_hi:[1,0]
    v_pk_mul_f32 v[84:85], v[84:85], v[90:91] op_sel_hi:[1,0]
    v_pk_mul_f32 v[86:87], v[86:87], v[90:91] op_sel_hi:[1,0]
    v_cvt_pk_bf16_f32 v64, v64, v65
    v_cvt_pk_bf16_f32 v65, v66, v67
    v_cvt_pk_bf16_f32 v66, v68, v69
    v_cvt_pk_bf16_f32 v67, v70, v71
    s_branch SLOW1D
SF_383:
    s_waitcnt vmcnt(0)
    buffer_wbl2 sc1
    s_waitcnt vmcnt(0)
    s_branch SFD_384
SF_389:
    buffer_inv sc1
    s_branch SFD_390
SF_394:
    buffer_inv sc1
    s_branch SFD_395
SF_399:
    buffer_inv sc1
    s_branch SFD_400
SF_401:
    s_waitcnt vmcnt(0)
    buffer_wbl2 sc1
    s_waitcnt vmcnt(0)
    s_branch SFD_402
SF_404:
    buffer_inv sc1
    s_branch SFD_405
SF_408:
    buffer_inv sc1
    s_branch SFD_409
RT_406:
    s_cmp_eq_u32 s29, 0
    s_cbranch_scc1 BK_407
    s_sub_u32 s29, s29, 1
    s_cmp_lg_u32 s31, 0
    s_cbranch_scc1 SF_408
SFD_409:
    buffer_load_dwordx4 v[144:147], v89, s[4:7], s41 offen offset:0 sc1
    buffer_load_dwordx4 v[148:151], v89, s[4:7], s41 offen offset:256 sc1
    s_waitcnt vmcnt(0)
    v_max_u32 v5, v144, v148
    v_cmp_eq_u32 vcc, -1, v5
    s_cbranch_vccnz RT_406
    s_branch BK_407
SF_412:
    buffer_inv sc1
    s_branch SFD_413
RT_410:
    s_cmp_eq_u32 s29, 0
    s_cbranch_scc1 BK_411
    s_sub_u32 s29, s29, 1
    s_cmp_lg_u32 s31, 0
    s_cbranch_scc1 SF_412
SFD_413:
    buffer_load_dwordx4 v[152:155], v89, s[4:7], s41 offen offset:2048 sc1
    buffer_load_dwordx4 v[156:159], v89, s[4:7], s41 offen offset:2304 sc1
    s_waitcnt vmcnt(0)
    v_max_u32 v5, v152, v156
    v_cmp_eq_u32 vcc, -1, v5
    s_cbranch_vccnz RT_410
    s_branch BK_411
SF_416:
    buffer_inv sc1
    s_branch SFD_417
RT_414:
    s_cmp_eq_u32 s29, 0
    s_cbranch_scc1 BK_415
    s_sub_u32 s29, s29, 1
    s_cmp_lg_u32 s31, 0
    s_cbranch_scc1 SF_416
SFD_417:
    buffer_load_dwordx4 v[160:163], v89, s[4:7], s42 offen offset:0 sc1
    buffer_load_dwordx4 v[164:167], v89, s[4:7], s42 offen offset:256 sc1
    s_waitcnt vmcnt(0)
    v_max_u32 v5, v160, v164
    v_cmp_eq_u32 vcc, -1, v5
    s_cbranch_vccnz RT_414
    s_branch BK_415
SF_420:
    buffer_inv sc1
    s_branch SFD_421
RT_418:
    s_cmp_eq_u32 s29, 0
    s_cbranch_scc1 BK_419
    s_sub_u32 s29, s29, 1
    s_cmp_lg_u32 s31, 0
    s_cbranch_scc1 SF_420
SFD_421:
    buffer_load_dwordx4 v[168:171], v89, s[4:7], s42 offen offset:2048 sc1
    buffer_load_dwordx4 v[172:175], v89, s[4:7], s42 offen offset:2304 sc1
    s_waitcnt vmcnt(0)
    v_max_u32 v5, v168, v172
    v_cmp_eq_u32 vcc, -1, v5
    s_cbranch_vccnz RT_418
    s_branch BK_419
SF_424:
    buffer_inv sc1
    s_branch SFD_425
RT_422:
    s_cmp_eq_u32 s29, 0
    s_cbranch_scc1 BK_423
    s_sub_u32 s29, s29, 1
    s_cmp_lg_u32 s31, 0
    s_cbranch_scc1 SF_424
SFD_425:
    buffer_load_dwordx4 v[176:179], v89, s[4:7], s43 offen offset:0 sc1
    buffer_load_dwordx4 v[180:183], v89, s[4:7], s43 offen offset:256 sc1
    s_waitcnt vmcnt(0)
    v_max_u32 v5, v176, v180
    v_cmp_eq_u32 vcc, -1, v5
    s_cbranch_vccnz RT_422
    s_branch BK_423
SF_428:
    buffer_inv sc1
    s_branch SFD_429
RT_426:
    s_cmp_eq_u32 s29, 0
    s_cbranch_scc1 BK_427
    s_sub_u32 s29, s29, 1
    s_cmp_lg_u32 s31, 0
    s_cbranch_scc1 SF_428
SFD_429:
    buffer_load_dwordx4 v[184:187], v89, s[4:7], s43 offen offset:2048 sc1
    buffer_load_dwordx4 v[188:191], v89, s[4:7], s43 offen offset:2304 sc1
    s_waitcnt vmcnt(0)
    v_max_u32 v5, v184, v188
    v_cmp_eq_u32 vcc, -1, v5
    s_cbranch_vccnz RT_426
    s_branch BK_427
SF_432:
    buffer_inv sc1
    s_branch SFD_433
RT_430:
    s_cmp_eq_u32 s29, 0
    s_cbranch_scc1 BK_431
    s_sub_u32 s29, s29, 1
    s_cmp_lg_u32 s31, 0
    s_cbranch_scc1 SF_432
SFD_433:
    buffer_load_dwordx4 v[192:195], v89, s[4:7], s44 offen offset:0 sc1
    buffer_load_dwordx4 v[196:199], v89, s[4:7], s44 offen offset:256 sc1
    s_waitcnt vmcnt(0)
    v_max_u32 v5, v192, v196
    v_cmp_eq_u32 vcc, -1, v5
    s_cbranch_vccnz RT_430
    s_branch BK_431
SF_436:
    buffer_inv sc1
    s_branch SFD_437
RT_434:
    s_cmp_eq_u32 s29, 0
    s_cbranch_scc1 BK_435
    s_sub_u32 s29, s29, 1
    s_cmp_lg_u32 s31, 0
    s_cbranch_scc1 SF_436
SFD_437:
    buffer_load_dwordx4 v[200:203], v89, s[4:7], s44 offen offset:2048 sc1
    buffer_load_dwordx4 v[204:207], v89, s[4:7], s44 offen offset:2304 sc1
    s_waitcnt vmcnt(0)
    v_max_u32 v5, v200, v204
    v_cmp_eq_u32 vcc, -1, v5
    s_cbranch_vccnz RT_434
    s_branch BK_435
SF_440:
    buffer_inv sc1
    s_branch SFD_441
RT_438:
    s_cmp_eq_u32 s29, 0
    s_cbranch_scc1 BK_439
    s_sub_u32 s29, s29, 1
    s_cmp_lg_u32 s31, 0
    s_cbranch_scc1 SF_440
SFD_441:
    buffer_load_dwordx4 v[208:211], v89, s[4:7], s45 offen offset:0 sc1
    buffer_load_dwordx4 v[212:215], v89, s[4:7], s45 offen offset:256 sc1
    s_waitcnt vmcnt(0)
    v_max_u32 v5, v208, v212
    v_cmp_eq_u32 vcc, -1, v5
    s_cbranch_vccnz RT_438
    s_branch BK_439
SF_444:
    buffer_inv sc1
    s_branch SFD_445
RT_442:
    s_cmp_eq_u32 s29, 0
    s_cbranch_scc1 BK_443
    s_sub_u32 s29, s29, 1
    s_cmp_lg_u32 s31, 0
    s_cbranch_scc1 SF_444
SFD_445:
    buffer_load_dwordx4 v[216:219], v89, s[4:7], s45 offen offset:2048 sc1
    buffer_load_dwordx4 v[220:223], v89, s[4:7], s45 offen offset:2304 sc1
    s_waitcnt vmcnt(0)
    v_max_u32 v5, v216, v220
    v_cmp_eq_u32 vcc, -1, v5
    s_cbranch_vccnz RT_442
    s_branch BK_443
SF_448:
    buffer_inv sc1
    s_branch SFD_449
RT_446:
    s_cmp_eq_u32 s29, 0
    s_cbranch_scc1 BK_447
    s_sub_u32 s29, s29, 1
    s_cmp_lg_u32 s31, 0
    s_cbranch_scc1 SF_448
SFD_449:
    buffer_load_dwordx4 v[224:227], v89, s[4:7], s46 offen offset:0 sc1
    buffer_load_dwordx4 v[228:231], v89, s[4:7], s46 offen offset:256 sc1
    s_waitcnt vmcnt(0)
    v_max_u32 v5, v224, v228
    v_cmp_eq_u32 vcc, -1, v5
    s_cbranch_vccnz RT_446
    s_branch BK_447
SF_452:
    buffer_inv sc1
    s_branch SFD_453
RT_450:
    s_cmp_eq_u32 s29, 0
    s_cbranch_scc1 BK_451
    s_sub_u32 s29, s29, 1
    s_cmp_lg_u32 s31, 0
    s_cbranch_scc1 SF_452
SFD_453:
    buffer_load_dwordx4 v[232:235], v89, s[4:7], s46 offen offset:2048 sc1
    buffer_load_dwordx4 v[236:239], v89, s[4:7], s46 offen offset:2304 sc1
    s_waitcnt vmcnt(0)
    v_max_u32 v5, v232, v236
    v_cmp_eq_u32 vcc, -1, v5
    s_cbranch_vccnz RT_450
    s_branch BK_451
SF_456:
    buffer_inv sc1
    s_branch SFD_457
RT_454:
    s_cmp_eq_u32 s29, 0
    s_cbranch_scc1 BK_455
    s_sub_u32 s29, s29, 1
    s_cmp_lg_u32 s31, 0
    s_cbranch_scc1 SF_456
SFD_457:
    buffer_load_dwordx4 v[240:243], v89, s[4:7], s47 offen offset:0 sc1
    buffer_load_dwordx4 v[244:247], v89, s[4:7], s47 offen offset:256 sc1
    s_waitcnt vmcnt(0)
    v_max_u32 v5, v240, v244
    v_cmp_eq_u32 vcc, -1, v5
    s_cbranch_vccnz RT_454
    s_branch BK_455
SF_460:
    buffer_inv sc1
    s_branch SFD_461
RT_458:
    s_cmp_eq_u32 s29, 0
    s_cbranch_scc1 BK_459
    s_sub_u32 s29, s29, 1
    s_cmp_lg_u32 s31, 0
    s_cbranch_scc1 SF_460
SFD_461:
    buffer_load_dwordx4 v[248:251], v89, s[4:7], s47 offen offset:2048 sc1
    buffer_load_dwordx4 v[252:255], v89, s[4:7], s47 offen offset:2304 sc1
    s_waitcnt vmcnt(0)
    v_max_u32 v5, v248, v252
    v_cmp_eq_u32 vcc, -1, v5
    s_cbranch_vccnz RT_458
    s_branch BK_459
SF_464:
    buffer_inv sc1
    s_branch SFD_465
RT_462:
    s_cmp_eq_u32 s29, 0
    s_cbranch_scc1 BK_463
    s_sub_u32 s29, s29, 1
    s_cmp_lg_u32 s31, 0
    s_cbranch_scc1 SF_464
SFD_465:
    buffer_load_dwordx4 v[12:15], v90, s[4:7], s74 offen offset:0 sc1
    buffer_load_dwordx4 v[16:19], v90, s[4:7], s74 offen offset:256 sc1
    buffer_load_dwordx4 v[20:23], v90, s[4:7], s74 offen offset:512 sc1
    buffer_load_dwordx4 v[24:27], v90, s[4:7], s74 offen offset:768 sc1
    s_waitcnt vmcnt(0)
    v_add_f32 v12, v12, v16
    v_add_f32 v13, v13, v17
    v_add_f32 v14, v14, v18
    v_add_f32 v15, v15, v19
    v_add_f32 v20, v20, v24
    v_add_f32 v21, v21, v25
    v_add_f32 v22, v22, v26
    v_add_f32 v23, v23, v27
    v_add_f32 v12, v12, v20
    v_add_f32 v13, v13, v21
    v_add_f32 v14, v14, v22
    v_add_f32 v15, v15, v23
    s_nop 0
    v_permlane32_swap_b32 v12, v14
    v_permlane32_swap_b32 v13, v15
    v_add_f32 v12, v12, v14
    v_add_f32 v13, v13, v15
    v_cmp_u_f32 vcc, v12, v13
    s_cbranch_vccnz RT_462
    s_branch BK_463
SF_466:
    s_waitcnt vmcnt(0)
    buffer_wbl2 sc1
    s_waitcnt vmcnt(0)
    s_branch SFD_467
SF_470:
    buffer_inv sc1
    s_branch SFD_471
RT_468:
    s_cmp_eq_u32 s29, 0
    s_cbranch_scc1 BK_469
    s_sub_u32 s29, s29, 1
    s_cmp_lg_u32 s31, 0
    s_cbranch_scc1 SF_470
SFD_471:
    buffer_load_dwordx4 v[96:99], v1, s[4:7], s32 offen offset:0 sc1
    s_waitcnt vmcnt(0)
    v_cmp_eq_u32 vcc, -1, v96
    s_cbranch_vccnz RT_468
    s_branch BK_469
SF_474:
    buffer_inv sc1
    s_branch SFD_475
RT_472:
    s_cmp_eq_u32 s29, 0
    s_cbranch_scc1 BK_473
    s_sub_u32 s29, s29, 1
    s_cmp_lg_u32 s31, 0
    s_cbranch_scc1 SF_474
SFD_475:
    buffer_load_dwordx4 v[100:103], v1, s[4:7], s36 offen offset:0 sc1
    s_waitcnt vmcnt(0)
    v_cmp_eq_u32 vcc, -1, v100
    s_cbranch_vccnz RT_472
    s_branch BK_473
SF_478:
    buffer_inv sc1
    s_branch SFD_479
RT_476:
    s_cmp_eq_u32 s29, 0
    s_cbranch_scc1 BK_477
    s_sub_u32 s29, s29, 1
    s_cmp_lg_u32 s31, 0
    s_cbranch_scc1 SF_478
SFD_479:
    buffer_load_dwordx4 v[104:107], v1, s[4:7], s33 offen offset:0 sc1
    s_waitcnt vmcnt(0)
    v_cmp_eq_u32 vcc, -1, v104
    s_cbranch_vccnz RT_476
    s_branch BK_477
SF_482:
    buffer_inv sc1
    s_branch SFD_483
RT_480:
    s_cmp_eq_u32 s29, 0
    s_cbranch_scc1 BK_481
    s_sub_u32 s29, s29, 1
    s_cmp_lg_u32 s31, 0
    s_cbranch_scc1 SF_482
SFD_483:
    buffer_load_dwordx4 v[108:111], v1, s[4:7], s37 offen offset:0 sc1
    s_waitcnt vmcnt(0)
    v_cmp_eq_u32 vcc, -1, v108
    s_cbranch_vccnz RT_480
    s_branch BK_481
SF_486:
    buffer_inv sc1
    s_branch SFD_487
RT_484:
    s_cmp_eq_u32 s29, 0
    s_cbranch_scc1 BK_485
    s_sub_u32 s29, s29, 1
    s_cmp_lg_u32 s31, 0
    s_cbranch_scc1 SF_486
SFD_487:
    buffer_load_dwordx4 v[112:115], v1, s[4:7], s34 offen offset:0 sc1
    s_waitcnt vmcnt(0)
    v_cmp_eq_u32 vcc, -1, v112
    s_cbranch_vccnz RT_484
    s_branch BK_485
SF_490:
    buffer_inv sc1
    s_branch SFD_491
RT_488:
    s_cmp_eq_u32 s29, 0
    s_cbranch_scc1 BK_489
    s_sub_u32 s29, s29, 1
    s_cmp_lg_u32 s31, 0
    s_cbranch_scc1 SF_490
SFD_491:
    buffer_load_dwordx4 v[116:119], v1, s[4:7], s38 offen offset:0 sc1
    s_waitcnt vmcnt(0)
    v_cmp_eq_u32 vcc, -1, v116
    s_cbranch_vccnz RT_488
    s_branch BK_489
SF_494:
    buffer_inv sc1
    s_branch SFD_495
RT_492:
    s_cmp_eq_u32 s29, 0
    s_cbranch_scc1 BK_493
    s_sub_u32 s29, s29, 1
    s_cmp_lg_u32 s31, 0
    s_cbranch_scc1 SF_494
SFD_495:
    buffer_load_dwordx4 v[120:123], v1, s[4:7], s35 offen offset:0 sc1
    s_waitcnt vmcnt(0)
    v_cmp_eq_u32 vcc, -1, v120
    s_cbranch_vccnz RT_492
    s_branch BK_493
SF_498:
    buffer_inv sc1
    s_branch SFD_499
RT_496:
    s_cmp_eq_u32 s29, 0
    s_cbranch_scc1 BK_497
    s_sub_u32 s29, s29, 1
    s_cmp_lg_u32 s31, 0
    s_cbranch_scc1 SF_498
SFD_499:
    buffer_load_dwordx4 v[124:127], v1, s[4:7], s39 offen offset:0 sc1
    s_waitcnt vmcnt(0)
    v_cmp_eq_u32 vcc, -1, v124
    s_cbranch_vccnz RT_496
    s_branch BK_497
SF_502:
    buffer_inv sc1
    s_branch SFD_503
RT_500:
    s_cmp_eq_u32 s29, 0
    s_cbranch_scc1 BK_501
    s_sub_u32 s29, s29, 1
    s_cmp_lg_u32 s31, 0
    s_cbranch_scc1 SF_502
SFD_503:
    buffer_load_dwordx4 v[128:131], v1, s[4:7], s32 offen offset:1024 sc1
    s_waitcnt vmcnt(0)
    v_cmp_eq_u32 vcc, -1, v128
    s_cbranch_vccnz RT_500
    s_branch BK_501
SF_506:
    buffer_inv sc1
    s_branch SFD_507
RT_504:
    s_cmp_eq_u32 s29, 0
    s_cbranch_scc1 BK_505
    s_sub_u32 s29, s29, 1
    s_cmp_lg_u32 s31, 0
    s_cbranch_scc1 SF_506
SFD_507:
    buffer_load_dwordx4 v[132:135], v1, s[4:7], s36 offen offset:1024 sc1
    s_waitcnt vmcnt(0)
    v_cmp_eq_u32 vcc, -1, v132
    s_cbranch_vccnz RT_504
    s_branch BK_505
SF_510:
    buffer_inv sc1
    s_branch SFD_511
RT_508:
    s_cmp_eq_u32 s29, 0
    s_cbranch_scc1 BK_509
    s_sub_u32 s29, s29, 1
    s_cmp_lg_u32 s31, 0
    s_cbranch_scc1 SF_510
SFD_511:
    buffer_load_dwordx4 v[136:139], v1, s[4:7], s33 offen offset:1024 sc1
    s_waitcnt vmcnt(0)
    v_cmp_eq_u32 vcc, -1, v136
    s_cbranch_vccnz RT_508
    s_branch BK_509
SF_514:
    buffer_inv sc1
    s_branch SFD_515
RT_512:
    s_cmp_eq_u32 s29, 0
    s_cbranch_scc1 BK_513
    s_sub_u32 s29, s29, 1
    s_cmp_lg_u32 s31, 0
    s_cbranch_scc1 SF_514
SFD_515:
    buffer_load_dwordx4 v[140:143], v1, s[4:7], s37 offen offset:1024 sc1
    s_waitcnt vmcnt(0)
    v_cmp_eq_u32 vcc, -1, v140
    s_cbranch_vccnz RT_512
    s_branch BK_513
SF_518:
    buffer_inv sc1
    s_branch SFD_519
RT_516:
    s_cmp_eq_u32 s29, 0
    s_cbranch_scc1 BK_517
    s_sub_u32 s29, s29, 1
    s_cmp_lg_u32 s31, 0
    s_cbranch_scc1 SF_518
SFD_519:
    buffer_load_dwordx4 v[144:147], v1, s[4:7], s34 offen offset:1024 sc1
    s_waitcnt vmcnt(0)
    v_cmp_eq_u32 vcc, -1, v144
    s_cbranch_vccnz RT_516
    s_branch BK_517
SF_522:
    buffer_inv sc1
    s_branch SFD_523
RT_520:
    s_cmp_eq_u32 s29, 0
    s_cbranch_scc1 BK_521
    s_sub_u32 s29, s29, 1
    s_cmp_lg_u32 s31, 0
    s_cbranch_scc1 SF_522
SFD_523:
    buffer_load_dwordx4 v[148:151], v1, s[4:7], s38 offen offset:1024 sc1
    s_waitcnt vmcnt(0)
    v_cmp_eq_u32 vcc, -1, v148
    s_cbranch_vccnz RT_520
    s_branch BK_521
SF_526:
    buffer_inv sc1
    s_branch SFD_527
RT_524:
    s_cmp_eq_u32 s29, 0
    s_cbranch_scc1 BK_525
    s_sub_u32 s29, s29, 1
    s_cmp_lg_u32 s31, 0
    s_cbranch_scc1 SF_526
SFD_527:
    buffer_load_dwordx4 v[152:155], v1, s[4:7], s35 offen offset:1024 sc1
    s_waitcnt vmcnt(0)
    v_cmp_eq_u32 vcc, -1, v152
    s_cbranch_vccnz RT_524
    s_branch BK_525
SF_530:
    buffer_inv sc1
    s_branch SFD_531
RT_528:
    s_cmp_eq_u32 s29, 0
    s_cbranch_scc1 BK_529
    s_sub_u32 s29, s29, 1
    s_cmp_lg_u32 s31, 0
    s_cbranch_scc1 SF_530
SFD_531:
    buffer_load_dwordx4 v[156:159], v1, s[4:7], s39 offen offset:1024 sc1
    s_waitcnt vmcnt(0)
    v_cmp_eq_u32 vcc, -1, v156
    s_cbranch_vccnz RT_528
    s_branch BK_529
SF_534:
    buffer_inv sc1
    s_branch SFD_535
RT_532:
    s_cmp_eq_u32 s29, 0
    s_cbranch_scc1 BK_533
    s_sub_u32 s29, s29, 1
    s_cmp_lg_u32 s31, 0
    s_cbranch_scc1 SF_534
SFD_535:
    buffer_load_dwordx4 v[160:163], v1, s[4:7], s32 offen offset:2048 sc1
    s_waitcnt vmcnt(0)
    v_cmp_eq_u32 vcc, -1, v160
    s_cbranch_vccnz RT_532
    s_branch BK_533
SF_538:
    buffer_inv sc1
    s_branch SFD_539
RT_536:
    s_cmp_eq_u32 s29, 0
    s_cbranch_scc1 BK_537
    s_sub_u32 s29, s29, 1
    s_cmp_lg_u32 s31, 0
    s_cbranch_scc1 SF_538
SFD_539:
    buffer_load_dwordx4 v[164:167], v1, s[4:7], s36 offen offset:2048 sc1
    s_waitcnt vmcnt(0)
    v_cmp_eq_u32 vcc, -1, v164
    s_cbranch_vccnz RT_536
    s_branch BK_537
SF_542:
    buffer_inv sc1
    s_branch SFD_543
RT_540:
    s_cmp_eq_u32 s29, 0
    s_cbranch_scc1 BK_541
    s_sub_u32 s29, s29, 1
    s_cmp_lg_u32 s31, 0
    s_cbranch_scc1 SF_542
SFD_543:
    buffer_load_dwordx4 v[168:171], v1, s[4:7], s33 offen offset:2048 sc1
    s_waitcnt vmcnt(0)
    v_cmp_eq_u32 vcc, -1, v168
    s_cbranch_vccnz RT_540
    s_branch BK_541
SF_546:
    buffer_inv sc1
    s_branch SFD_547
RT_544:
    s_cmp_eq_u32 s29, 0
    s_cbranch_scc1 BK_545
    s_sub_u32 s29, s29, 1
    s_cmp_lg_u32 s31, 0
    s_cbranch_scc1 SF_546
SFD_547:
    buffer_load_dwordx4 v[172:175], v1, s[4:7], s37 offen offset:2048 sc1
    s_waitcnt vmcnt(0)
    v_cmp_eq_u32 vcc, -1, v172
    s_cbranch_vccnz RT_544
    s_branch BK_545
SF_550:
    buffer_inv sc1
    s_branch SFD_551
RT_548:
    s_cmp_eq_u32 s29, 0
    s_cbranch_scc1 BK_549
    s_sub_u32 s29, s29, 1
    s_cmp_lg_u32 s31, 0
    s_cbranch_scc1 SF_550
SFD_551:
    buffer_load_dwordx4 v[176:179], v1, s[4:7], s34 offen offset:2048 sc1
    s_waitcnt vmcnt(0)
    v_cmp_eq_u32 vcc, -1, v176
    s_cbranch_vccnz RT_548
    s_branch BK_549
SF_554:
    buffer_inv sc1
    s_branch SFD_555
RT_552:
    s_cmp_eq_u32 s29, 0
    s_cbranch_scc1 BK_553
    s_sub_u32 s29, s29, 1
    s_cmp_lg_u32 s31, 0
    s_cbranch_scc1 SF_554
SFD_555:
    buffer_load_dwordx4 v[180:183], v1, s[4:7], s38 offen offset:2048 sc1
    s_waitcnt vmcnt(0)
    v_cmp_eq_u32 vcc, -1, v180
    s_cbranch_vccnz RT_552
    s_branch BK_553
SF_558:
    buffer_inv sc1
    s_branch SFD_559
RT_556:
    s_cmp_eq_u32 s29, 0
    s_cbranch_scc1 BK_557
    s_sub_u32 s29, s29, 1
    s_cmp_lg_u32 s31, 0
    s_cbranch_scc1 SF_558
SFD_559:
    buffer_load_dwordx4 v[184:187], v1, s[4:7], s35 offen offset:2048 sc1
    s_waitcnt vmcnt(0)
    v_cmp_eq_u32 vcc, -1, v184
    s_cbranch_vccnz RT_556
    s_branch BK_557
SF_562:
    buffer_inv sc1
    s_branch SFD_563
RT_560:
    s_cmp_eq_u32 s29, 0
    s_cbranch_scc1 BK_561
    s_sub_u32 s29, s29, 1
    s_cmp_lg_u32 s31, 0
    s_cbranch_scc1 SF_562
SFD_563:
    buffer_load_dwordx4 v[188:191], v1, s[4:7], s39 offen offset:2048 sc1
    s_waitcnt vmcnt(0)
    v_cmp_eq_u32 vcc, -1, v188
    s_cbranch_vccnz RT_560
    s_branch BK_561
SF_566:
    buffer_inv sc1
    s_branch SFD_567
RT_564:
    s_cmp_eq_u32 s29, 0
    s_cbranch_scc1 BK_565
    s_sub_u32 s29, s29, 1
    s_cmp_lg_u32 s31, 0
    s_cbranch_scc1 SF_566
SFD_567:
    buffer_load_dwordx4 v[100:103], v1, s[4:7], s32 offen offset:3072 sc1
    s_waitcnt vmcnt(0)
    v_cmp_eq_u32 vcc, -1, v100
    s_cbranch_vccnz RT_564
    s_branch BK_565
SF_570:
    buffer_inv sc1
    s_branch SFD_571
RT_568:
    s_cmp_eq_u32 s29, 0
    s_cbranch_scc1 BK_569
    s_sub_u32 s29, s29, 1
    s_cmp_lg_u32 s31, 0
    s_cbranch_scc1 SF_570
SFD_571:
    buffer_load_dwordx4 v[104:107], v1, s[4:7], s33 offen offset:3072 sc1
    s_waitcnt vmcnt(0)
    v_cmp_eq_u32 vcc, -1, v104
    s_cbranch_vccnz RT_568
    s_branch BK_569
SF_574:
    buffer_inv sc1
    s_branch SFD_575
RT_572:
    s_cmp_eq_u32 s29, 0
    s_cbranch_scc1 BK_573
    s_sub_u32 s29, s29, 1
    s_cmp_lg_u32 s31, 0
    s_cbranch_scc1 SF_574
SFD_575:
    buffer_load_dwordx4 v[108:111], v1, s[4:7], s34 offen offset:3072 sc1
    s_waitcnt vmcnt(0)
    v_cmp_eq_u32 vcc, -1, v108
    s_cbranch_vccnz RT_572
    s_branch BK_573
SF_578:
    buffer_inv sc1
    s_branch SFD_579
RT_576:
    s_cmp_eq_u32 s29, 0
    s_cbranch_scc1 BK_577
    s_sub_u32 s29, s29, 1
    s_cmp_lg_u32 s31, 0
    s_cbranch_scc1 SF_578
SFD_579:
    buffer_load_dwordx4 v[112:115], v1, s[4:7], s35 offen offset:3072 sc1
    s_waitcnt vmcnt(0)
    v_cmp_eq_u32 vcc, -1, v112
    s_cbranch_vccnz RT_576
    s_branch BK_577
SF_582:
    buffer_inv sc1
    s_branch SFD_583
RT_580:
    s_cmp_eq_u32 s29, 0
    s_cbranch_scc1 BK_581
    s_sub_u32 s29, s29, 1
    s_cmp_lg_u32 s31, 0
    s_cbranch_scc1 SF_582
SFD_583:
    buffer_load_dwordx4 v[116:119], v1, s[4:7], s40 offen offset:0 sc1
    s_waitcnt vmcnt(0)
    v_cmp_eq_u32 vcc, -1, v116
    s_cbranch_vccnz RT_580
    s_branch BK_581
SF_586:
    buffer_inv sc1
    s_branch SFD_587
RT_584:
    s_cmp_eq_u32 s29, 0
    s_cbranch_scc1 BK_585
    s_sub_u32 s29, s29, 1
    s_cmp_lg_u32 s31, 0
    s_cbranch_scc1 SF_586
SFD_587:
    buffer_load_dwordx4 v[120:123], v1, s[4:7], s41 offen offset:0 sc1
    s_waitcnt vmcnt(0)
    v_cmp_eq_u32 vcc, -1, v120
    s_cbranch_vccnz RT_584
    s_branch BK_585
SF_590:
    buffer_inv sc1
    s_branch SFD_591
RT_588:
    s_cmp_eq_u32 s29, 0
    s_cbranch_scc1 BK_589
    s_sub_u32 s29, s29, 1
    s_cmp_lg_u32 s31, 0
    s_cbranch_scc1 SF_590
SFD_591:
    buffer_load_dwordx4 v[124:127], v1, s[4:7], s42 offen offset:0 sc1
    s_waitcnt vmcnt(0)
    v_cmp_eq_u32 vcc, -1, v124
    s_cbranch_vccnz RT_588
    s_branch BK_589
SF_594:
    buffer_inv sc1
    s_branch SFD_595
RT_592:
    s_cmp_eq_u32 s29, 0
    s_cbranch_scc1 BK_593
    s_sub_u32 s29, s29, 1
    s_cmp_lg_u32 s31, 0
    s_cbranch_scc1 SF_594
SFD_595:
    buffer_load_dwordx4 v[128:131], v1, s[4:7], s43 offen offset:0 sc1
    s_waitcnt vmcnt(0)
    v_cmp_eq_u32 vcc, -1, v128
    s_cbranch_vccnz RT_592
    s_branch BK_593
SF_598:
    buffer_inv sc1
    s_branch SFD_599
RT_596:
    s_cmp_eq_u32 s29, 0
    s_cbranch_scc1 BK_597
    s_sub_u32 s29, s29, 1
    s_cmp_lg_u32 s31, 0
    s_cbranch_scc1 SF_598
SFD_599:
    buffer_load_dwordx4 v[132:135], v1, s[4:7], s40 offen offset:1024 sc1
    s_waitcnt vmcnt(0)
    v_cmp_eq_u32 vcc, -1, v132
    s_cbranch_vccnz RT_596
    s_branch BK_597
SF_602:
    buffer_inv sc1
    s_branch SFD_603
RT_600:
    s_cmp_eq_u32 s29, 0
    s_cbranch_scc1 BK_601
    s_sub_u32 s29, s29, 1
    s_cmp_lg_u32 s31, 0
    s_cbranch_scc1 SF_602
SFD_603:
    buffer_load_dwordx4 v[136:139], v1, s[4:7], s41 offen offset:1024 sc1
    s_waitcnt vmcnt(0)
    v_cmp_eq_u32 vcc, -1, v136
    s_cbranch_vccnz RT_600
    s_branch BK_601
SF_606:
    buffer_inv sc1
    s_branch SFD_607
RT_604:
    s_cmp_eq_u32 s29, 0
    s_cbranch_scc1 BK_605
    s_sub_u32 s29, s29, 1
    s_cmp_lg_u32 s31, 0
    s_cbranch_scc1 SF_606
SFD_607:
    buffer_load_dwordx4 v[140:143], v1, s[4:7], s42 offen offset:1024 sc1
    s_waitcnt vmcnt(0)
    v_cmp_eq_u32 vcc, -1, v140
    s_cbranch_vccnz RT_604
    s_branch BK_605
SF_610:
    buffer_inv sc1
    s_branch SFD_611
RT_608:
    s_cmp_eq_u32 s29, 0
    s_cbranch_scc1 BK_609
    s_sub_u32 s29, s29, 1
    s_cmp_lg_u32 s31, 0
    s_cbranch_scc1 SF_610
SFD_611:
    buffer_load_dwordx4 v[144:147], v1, s[4:7], s43 offen offset:1024 sc1
    s_waitcnt vmcnt(0)
    v_cmp_eq_u32 vcc, -1, v144
    s_cbranch_vccnz RT_608
    s_branch BK_609
SF_614:
    buffer_inv sc1
    s_branch SFD_615
RT_612:
    s_cmp_eq_u32 s29, 0
    s_cbranch_scc1 BK_613
    s_sub_u32 s29, s29, 1
    s_cmp_lg_u32 s31, 0
    s_cbranch_scc1 SF_614
SFD_615:
    buffer_load_dwordx4 v[148:151], v1, s[4:7], s40 offen offset:2048 sc1
    s_waitcnt vmcnt(0)
    v_cmp_eq_u32 vcc, -1, v148
    s_cbranch_vccnz RT_612
    s_branch BK_613
SF_618:
    buffer_inv sc1
    s_branch SFD_619
RT_616:
    s_cmp_eq_u32 s29, 0
    s_cbranch_scc1 BK_617
    s_sub_u32 s29, s29, 1
    s_cmp_lg_u32 s31, 0
    s_cbranch_scc1 SF_618
SFD_619:
    buffer_load_dwordx4 v[152:155], v1, s[4:7], s41 offen offset:2048 sc1
    s_waitcnt vmcnt(0)
    v_cmp_eq_u32 vcc, -1, v152
    s_cbranch_vccnz RT_616
    s_branch BK_617
SF_622:
    buffer_inv sc1
    s_branch SFD_623
RT_620:
    s_cmp_eq_u32 s29, 0
    s_cbranch_scc1 BK_621
    s_sub_u32 s29, s29, 1
    s_cmp_lg_u32 s31, 0
    s_cbranch_scc1 SF_622
SFD_623:
    buffer_load_dwordx4 v[156:159], v1, s[4:7], s42 offen offset:2048 sc1
    s_waitcnt vmcnt(0)
    v_cmp_eq_u32 vcc, -1, v156
    s_cbranch_vccnz RT_620
    s_branch BK_621
SF_626:
    buffer_inv sc1
    s_branch SFD_627
RT_624:
    s_cmp_eq_u32 s29, 0
    s_cbranch_scc1 BK_625
    s_sub_u32 s29, s29, 1
    s_cmp_lg_u32 s31, 0
    s_cbranch_scc1 SF_626
SFD_627:
    buffer_load_dwordx4 v[160:163], v1, s[4:7], s43 offen offset:2048 sc1
    s_waitcnt vmcnt(0)
    v_cmp_eq_u32 vcc, -1, v160
    s_cbranch_vccnz RT_624
    s_branch BK_625
SF_630:
    buffer_inv sc1
    s_branch SFD_631
RT_628:
    s_cmp_eq_u32 s29, 0
    s_cbranch_scc1 BK_629
    s_sub_u32 s29, s29, 1
    s_cmp_lg_u32 s31, 0
    s_cbranch_scc1 SF_630
SFD_631:
    buffer_load_dwordx4 v[168:171], v1, s[4:7], s36 offen offset:3072 sc1
    s_waitcnt vmcnt(0)
    v_cmp_eq_u32 vcc, -1, v168
    s_cbranch_vccnz RT_628
    s_branch BK_629
SF_634:
    buffer_inv sc1
    s_branch SFD_635
RT_632:
    s_cmp_eq_u32 s29, 0
    s_cbranch_scc1 BK_633
    s_sub_u32 s29, s29, 1
    s_cmp_lg_u32 s31, 0
    s_cbranch_scc1 SF_634
SFD_635:
    buffer_load_dwordx4 v[172:175], v1, s[4:7], s37 offen offset:3072 sc1
    s_waitcnt vmcnt(0)
    v_cmp_eq_u32 vcc, -1, v172
    s_cbranch_vccnz RT_632
    s_branch BK_633
SF_638:
    buffer_inv sc1
    s_branch SFD_639
RT_636:
    s_cmp_eq_u32 s29, 0
    s_cbranch_scc1 BK_637
    s_sub_u32 s29, s29, 1
    s_cmp_lg_u32 s31, 0
    s_cbranch_scc1 SF_638
SFD_639:
    buffer_load_dwordx4 v[176:179], v1, s[4:7], s38 offen offset:3072 sc1
    s_waitcnt vmcnt(0)
    v_cmp_eq_u32 vcc, -1, v176
    s_cbranch_vccnz RT_636
    s_branch BK_637
SF_642:
    buffer_inv sc1
    s_branch SFD_643
RT_640:
    s_cmp_eq_u32 s29, 0
    s_cbranch_scc1 BK_641
    s_sub_u32 s29, s29, 1
    s_cmp_lg_u32 s31, 0
    s_cbranch_scc1 SF_642
SFD_643:
    buffer_load_dwordx4 v[180:183], v1, s[4:7], s39 offen offset:3072 sc1
    s_waitcnt vmcnt(0)
    v_cmp_eq_u32 vcc, -1, v180
    s_cbranch_vccnz RT_640
    s_branch BK_641
SF_646:
    buffer_inv sc1
    s_branch SFD_647
RT_644:
    s_cmp_eq_u32 s29, 0
    s_cbranch_scc1 BK_645
    s_sub_u32 s29, s29, 1
    s_cmp_lg_u32 s31, 0
    s_cbranch_scc1 SF_646
SFD_647:
    buffer_load_dwordx4 v[184:187], v1, s[4:7], s44 offen offset:0 sc1
    s_waitcnt vmcnt(0)
    v_cmp_eq_u32 vcc, -1, v184
    s_cbranch_vccnz RT_644
    s_branch BK_645
SF_650:
    buffer_inv sc1
    s_branch SFD_651
RT_648:
    s_cmp_eq_u32 s29, 0
    s_cbranch_scc1 BK_649
    s_sub_u32 s29, s29, 1
    s_cmp_lg_u32 s31, 0
    s_cbranch_scc1 SF_650
SFD_651:
    buffer_load_dwordx4 v[188:191], v1, s[4:7], s45 offen offset:0 sc1
    s_waitcnt vmcnt(0)
    v_cmp_eq_u32 vcc, -1, v188
    s_cbranch_vccnz RT_648
    s_branch BK_649
SF_654:
    buffer_inv sc1
    s_branch SFD_655
RT_652:
    s_cmp_eq_u32 s29, 0
    s_cbranch_scc1 BK_653
    s_sub_u32 s29, s29, 1
    s_cmp_lg_u32 s31, 0
    s_cbranch_scc1 SF_654
SFD_655:
    buffer_load_dwordx4 v[96:99], v1, s[4:7], s46 offen offset:0 sc1
    s_waitcnt vmcnt(0)
    v_cmp_eq_u32 vcc, -1, v96
    s_cbranch_vccnz RT_652
    s_branch BK_653
SF_658:
    buffer_inv sc1
    s_branch SFD_659
RT_656:
    s_cmp_eq_u32 s29, 0
    s_cbranch_scc1 BK_657
    s_sub_u32 s29, s29, 1
    s_cmp_lg_u32 s31, 0
    s_cbranch_scc1 SF_658
SFD_659:
    buffer_load_dwordx4 v[100:103], v1, s[4:7], s47 offen offset:0 sc1
    s_waitcnt vmcnt(0)
    v_cmp_eq_u32 vcc, -1, v100
    s_cbranch_vccnz RT_656
    s_branch BK_657
SF_662:
    buffer_inv sc1
    s_branch SFD_663
RT_660:
    s_cmp_eq_u32 s29, 0
    s_cbranch_scc1 BK_661
    s_sub_u32 s29, s29, 1
    s_cmp_lg_u32 s31, 0
    s_cbranch_scc1 SF_662
SFD_663:
    buffer_load_dwordx4 v[104:107], v1, s[4:7], s44 offen offset:1024 sc1
    s_waitcnt vmcnt(0)
    v_cmp_eq_u32 vcc, -1, v104
    s_cbranch_vccnz RT_660
    s_branch BK_661
SF_666:
    buffer_inv sc1
    s_branch SFD_667
RT_664:
    s_cmp_eq_u32 s29, 0
    s_cbranch_scc1 BK_665
    s_sub_u32 s29, s29, 1
    s_cmp_lg_u32 s31, 0
    s_cbranch_scc1 SF_666
SFD_667:
    buffer_load_dwordx4 v[108:111], v1, s[4:7], s45 offen offset:1024 sc1
    s_waitcnt vmcnt(0)
    v_cmp_eq_u32 vcc, -1, v108
    s_cbranch_vccnz RT_664
    s_branch BK_665
SF_670:
    buffer_inv sc1
    s_branch SFD_671
RT_668:
    s_cmp_eq_u32 s29, 0
    s_cbranch_scc1 BK_669
    s_sub_u32 s29, s29, 1
    s_cmp_lg_u32 s31, 0
    s_cbranch_scc1 SF_670
SFD_671:
    buffer_load_dwordx4 v[112:115], v1, s[4:7], s46 offen offset:1024 sc1
    s_waitcnt vmcnt(0)
    v_cmp_eq_u32 vcc, -1, v112
    s_cbranch_vccnz RT_668
    s_branch BK_669
SF_674:
    buffer_inv sc1
    s_branch SFD_675
RT_672:
    s_cmp_eq_u32 s29, 0
    s_cbranch_scc1 BK_673
    s_sub_u32 s29, s29, 1
    s_cmp_lg_u32 s31, 0
    s_cbranch_scc1 SF_674
SFD_675:
    buffer_load_dwordx4 v[116:119], v1, s[4:7], s47 offen offset:1024 sc1
    s_waitcnt vmcnt(0)
    v_cmp_eq_u32 vcc, -1, v116
    s_cbranch_vccnz RT_672
    s_branch BK_673
SF_678:
    buffer_inv sc1
    s_branch SFD_679
RT_676:
    s_cmp_eq_u32 s29, 0
    s_cbranch_scc1 BK_677
    s_sub_u32 s29, s29, 1
    s_cmp_lg_u32 s31, 0
    s_cbranch_scc1 SF_678
SFD_679:
    buffer_load_dwordx4 v[120:123], v1, s[4:7], s44 offen offset:2048 sc1
    s_waitcnt vmcnt(0)
    v_cmp_eq_u32 vcc, -1, v120
    s_cbranch_vccnz RT_676
    s_branch BK_677
SF_682:
    buffer_inv sc1
    s_branch SFD_683
RT_680:
    s_cmp_eq_u32 s29, 0
    s_cbranch_scc1 BK_681
    s_sub_u32 s29, s29, 1
    s_cmp_lg_u32 s31, 0
    s_cbranch_scc1 SF_682
SFD_683:
    buffer_load_dwordx4 v[124:127], v1, s[4:7], s45 offen offset:2048 sc1
    s_waitcnt vmcnt(0)
    v_cmp_eq_u32 vcc, -1, v124
    s_cbranch_vccnz RT_680
    s_branch BK_681
SF_686:
    buffer_inv sc1
    s_branch SFD_687
RT_684:
    s_cmp_eq_u32 s29, 0
    s_cbranch_scc1 BK_685
    s_sub_u32 s29, s29, 1
    s_cmp_lg_u32 s31, 0
    s_cbranch_scc1 SF_686
SFD_687:
    buffer_load_dwordx4 v[128:131], v1, s[4:7], s46 offen offset:2048 sc1
    s_waitcnt vmcnt(0)
    v_cmp_eq_u32 vcc, -1, v128
    s_cbranch_vccnz RT_684
    s_branch BK_685
SF_690:
    buffer_inv sc1
    s_branch SFD_691
RT_688:
    s_cmp_eq_u32 s29, 0
    s_cbranch_scc1 BK_689
    s_sub_u32 s29, s29, 1
    s_cmp_lg_u32 s31, 0
    s_cbranch_scc1 SF_690
SFD_691:
    buffer_load_dwordx4 v[132:135], v1, s[4:7], s47 offen offset:2048 sc1
    s_waitcnt vmcnt(0)
    v_cmp_eq_u32 vcc, -1, v132
    s_cbranch_vccnz RT_688
    s_branch BK_689
KEND:
.section .rodata,"a"
.p2align 6
.amdhsa_kernel interleave_layers__grouped_kv_mqa__dense_activation_gelu__prompt_kernel
  .amdhsa_next_free_vgpr 512
  .amdhsa_next_free_sgpr 102
  .amdhsa_accum_offset 256
  .amdhsa_group_segment_fixed_size 0
  .amdhsa_kernarg_size 104
  .amdhsa_user_sgpr_count 2
  .amdhsa_user_sgpr_kernarg_segment_ptr 1
  .amdhsa_system_sgpr_workgroup_id_x 1
.end_amdhsa_kernel
```
